```python
import torch

def _softmax(x, axis=-1):
    return torch.softmax(x, dim=axis)

def _gelu(x):
    return torch.nn.functional.gelu(x, approximate='tanh')

def _silu(x):
    return torch.nn.functional.silu(x)

def _sigmoid(x):
    return torch.sigmoid(x)

def _layernorm(x, axis=-1, eps=1e-05):
    m = x.mean(dim=axis, keepdim=True)
    v = x.var(dim=axis, keepdim=True, unbiased=False)
    return (x - m) / torch.sqrt(v + eps)

def _scatter_add(tgt, idx, src, axis=0):
    return tgt.clone().index_add_(axis, idx, src)

def _segment_sum(src, seg, n):
    out = torch.zeros((n,) + src.shape[1:], dtype=src.dtype)
    return out.index_add_(0, seg, src)

def _pad(x, pw):
    flat = tuple((v for pair in reversed(pw) for v in pair))
    return torch.nn.functional.pad(x, flat)
kernel_name = 'adaLN_cond__mha_block_cached__glu_gated_reglu__prompt'

def setup_inputs():

    _w = lambda a: (lambda t: t.to(torch.bfloat16) if t.is_floating_point() else t)(torch.as_tensor(a))

    def _A_setup():
        B, Sq, D = (1, 2048, 576)
        H, Sk, Dh = (32, 2048, 128)
        return {'x': _w((lambda *s: torch.randn(*s, dtype=torch.bfloat16) * 0.05)(B, Sq, D)), 'k_cache': _w((lambda *s: torch.randn(*s, dtype=torch.bfloat16) * 1.6)(B, H, Sk, Dh)), 'v_cache': _w((lambda *s: torch.randn(*s, dtype=torch.bfloat16) * 0.8)(B, H, Sk, Dh)), 'wq': _w((lambda *s: torch.randn(*s, dtype=torch.bfloat16) * 1.6)(D, H * Dh) * D ** (-0.5)), 'wo': _w((lambda *s: torch.randn(*s, dtype=torch.bfloat16) * 0.8)(H * Dh, D) * (H * Dh) ** (-0.5))}
    _A_in = _A_setup()

    def _B_setup():
        B, S, D, F = (1, 2048, 576, 4608)
        return {'x': _w((lambda *s: torch.randn(*s, dtype=torch.bfloat16) * 0.05)(B, S, D)), 'W_gate': _w((lambda *s: torch.randn(*s, dtype=torch.bfloat16) * 0.4)(D, F) * (2.0 / D) ** 0.5), 'W_up': _w((lambda *s: torch.randn(*s, dtype=torch.bfloat16) * 0.4)(D, F) * (2.0 / D) ** 0.5), 'W_down': _w((lambda *s: torch.randn(*s, dtype=torch.bfloat16) * 0.4)(F, D) * (1.0 / F) ** 0.5)}
    _B_in = _B_setup()
    return {'A_x': _A_in['x'], 'A_k_cache': _A_in['k_cache'], 'A_v_cache': _A_in['v_cache'], 'A_wq': _A_in['wq'], 'A_wo': _A_in['wo'], 'B_x': _B_in['x'], 'B_W_gate': _B_in['W_gate'], 'B_W_up': _B_in['W_up'], 'B_W_down': _B_in['W_down'], 'c': _w((lambda *s: torch.randn(*s, dtype=torch.bfloat16) * 0.1)(1, 576) * 8.0), 'w_mod': _w((lambda *s: torch.randn(*s, dtype=torch.bfloat16) * 0.1)(576, 6 * 576) * 576 ** (-0.5) * 8.0)}

def reference(A_x, A_k_cache, A_v_cache, A_wq, A_wo, B_x, B_W_gate, B_W_up, B_W_down, c, w_mod):

    def _A_ref(x, k_cache, v_cache, wq, wo):
        B, Sq, D = x.shape
        H, Dh = (32, 128)
        q = (lambda x, *d: x.permute(*d))((x @ wq).reshape(B, Sq, H, Dh), 0, 2, 1, 3)
        scores = torch.einsum('bhqd,bhkd->bhqk', q, k_cache) * Dh ** (-0.5)
        p = _softmax(scores, axis=-1)
        o = torch.einsum('bhqk,bhkd->bhqd', p, v_cache)
        return (lambda x, *d: x.permute(*d))(o, 0, 2, 1, 3).reshape(B, Sq, H * Dh) @ wo

    def _B_ref(x, W_gate, W_up, W_down):
        gate = torch.einsum('bsd,df->bsf', x, W_gate)
        up = torch.einsum('bsd,df->bsf', x, W_up)
        gate = gate * (lambda x, dt: x.to(dt))(gate > 0, gate.dtype)
        h = gate * up
        return torch.einsum('bsf,fd->bsd', h, W_down)
    x = A_x
    mod = (_silu(c) @ w_mod).reshape(c.shape[0], 6, 1, -1)
    sa, ca, ga, sb, cb, gb = (mod[:, 0].clone(), mod[:, 1].clone(), mod[:, 2].clone(), mod[:, 3].clone(), mod[:, 4].clone(), mod[:, 5].clone())
    h = _layernorm(x, axis=-1) * (1 + ca) + sa
    x = x + ga * _A_ref(h, A_k_cache, A_v_cache, A_wq, A_wo)
    h = _layernorm(x, axis=-1) * (1 + cb) + sb
    x = x + gb * _B_ref(h, B_W_gate, B_W_up, B_W_down)
    return x
```

```asm
; @launch kernel=mod_kernel grid=(182,1,1) block=(1024,1,1) lds=8192
; @launch kernel=attn_kernel grid=(256,1,1) block=(256,1,1) lds=163840
; @launch kernel=wo_kernel grid=(512,1,1) block=(512,1,1) lds=139264
; @launch kernel=ffn1_kernel grid=(256,1,1) block=(512,1,1) lds=139264
; @launch kernel=down_kernel grid=(512,1,1) block=(512,1,1) lds=139264
.amdgcn_target "amdgcn-amd-amdhsa--gfx950"
.text
.globl mod_kernel
.p2align 8
.type mod_kernel,@function
mod_kernel:
    s_cmp_ge_u32 s2, 54
    s_cbranch_scc1 .mod_ln1
    s_load_dwordx2 s[34:35], s[0:1], 96
    s_load_dwordx2 s[4:5], s[0:1], 72
    s_load_dwordx2 s[6:7], s[0:1], 80
    s_load_dwordx2 s[20:21], s[0:1], 104
    v_lshrrev_b32 v1, 6, v0
    v_and_b32 v2, 63, v0
    s_nop 0
    v_readfirstlane_b32 s3, v1
    v_lshrrev_b32 v13, 5, v2
    v_and_b32 v14, 31, v2
    s_waitcnt lgkmcnt(0)
    s_mov_b32 s8, s4
    s_mov_b32 s9, s5
    s_mov_b32 s10, 1152
    s_mov_b32 s11, 0x00020000
    s_mov_b32 s12, s6
    s_mov_b32 s13, s7
    s_mov_b32 s14, 3981312
    s_mov_b32 s15, 0x00020000
    s_add_u32 s16, s20, 0
    s_addc_u32 s17, s21, 0
    s_mov_b32 s18, 13824
    s_mov_b32 s19, 0x00020000
    s_add_u32 s44, s20, 32768
    s_addc_u32 s45, s21, 0
    s_mov_b32 s46, 32768
    s_mov_b32 s47, 0x00020000
    s_cmp_lg_u32 s2, 53
    s_cbranch_scc1 .mod_nz
    v_lshlrev_b32 v6, 8, v0
    v_mov_b32 v7, 0
    buffer_store_dword v7, v6, s[44:47], 0 offen
.mod_nz:
    s_mul_i32 s22, s3, 72
    v_lshlrev_b32 v3, 1, v2
    buffer_load_ushort v4, v3, s[8:11], s22 offen
    s_mul_i32 s23, s3, 36*6912
    s_lshl_b32 s24, s2, 7
    s_add_u32 s23, s23, s24
    v_mul_u32_u24 v5, 6912, v13
    v_lshl_add_u32 v5, v14, 2, v5
    s_add_u32 s25, s23, 0
    buffer_load_dword v16, v5, s[12:15], s25 offen
    s_add_u32 s25, s23, 13824
    buffer_load_dword v17, v5, s[12:15], s25 offen
    s_add_u32 s25, s23, 27648
    buffer_load_dword v18, v5, s[12:15], s25 offen
    s_add_u32 s25, s23, 41472
    buffer_load_dword v19, v5, s[12:15], s25 offen
    s_add_u32 s25, s23, 55296
    buffer_load_dword v20, v5, s[12:15], s25 offen
    s_add_u32 s25, s23, 69120
    buffer_load_dword v21, v5, s[12:15], s25 offen
    s_add_u32 s25, s23, 82944
    buffer_load_dword v22, v5, s[12:15], s25 offen
    s_add_u32 s25, s23, 96768
    buffer_load_dword v23, v5, s[12:15], s25 offen
    s_add_u32 s25, s23, 110592
    buffer_load_dword v24, v5, s[12:15], s25 offen
    s_add_u32 s25, s23, 124416
    buffer_load_dword v25, v5, s[12:15], s25 offen
    s_add_u32 s25, s23, 138240
    buffer_load_dword v26, v5, s[12:15], s25 offen
    s_add_u32 s25, s23, 152064
    buffer_load_dword v27, v5, s[12:15], s25 offen
    s_add_u32 s25, s23, 165888
    buffer_load_dword v28, v5, s[12:15], s25 offen
    s_add_u32 s25, s23, 179712
    buffer_load_dword v29, v5, s[12:15], s25 offen
    s_add_u32 s25, s23, 193536
    buffer_load_dword v30, v5, s[12:15], s25 offen
    s_add_u32 s25, s23, 207360
    buffer_load_dword v31, v5, s[12:15], s25 offen
    s_add_u32 s25, s23, 221184
    buffer_load_dword v32, v5, s[12:15], s25 offen
    s_add_u32 s25, s23, 235008
    buffer_load_dword v33, v5, s[12:15], s25 offen
    s_waitcnt vmcnt(18)
    v_lshlrev_b32 v4, 16, v4
    s_mov_b32 s26, 1069066811
    v_mul_f32 v6, s26, v4
    v_sub_f32 v6, 0, v6
    v_exp_f32 v6, v6
    s_nop 0
    v_add_f32 v6, 1.0, v6
    v_rcp_f32 v6, v6
    s_nop 0
    v_mul_f32 v6, v4, v6
    v_cvt_pk_bf16_f32 v6, v6, v6
    v_lshlrev_b32 v6, 16, v6
    v_lshlrev_b32 v7, 2, v13
    ds_bpermute_b32 v40, v7, v6 offset:0
    ds_bpermute_b32 v41, v7, v6 offset:8
    ds_bpermute_b32 v42, v7, v6 offset:16
    ds_bpermute_b32 v43, v7, v6 offset:24
    ds_bpermute_b32 v44, v7, v6 offset:32
    ds_bpermute_b32 v45, v7, v6 offset:40
    ds_bpermute_b32 v46, v7, v6 offset:48
    ds_bpermute_b32 v47, v7, v6 offset:56
    ds_bpermute_b32 v48, v7, v6 offset:64
    ds_bpermute_b32 v49, v7, v6 offset:72
    ds_bpermute_b32 v50, v7, v6 offset:80
    ds_bpermute_b32 v51, v7, v6 offset:88
    ds_bpermute_b32 v52, v7, v6 offset:96
    ds_bpermute_b32 v53, v7, v6 offset:104
    ds_bpermute_b32 v54, v7, v6 offset:112
    ds_bpermute_b32 v55, v7, v6 offset:120
    ds_bpermute_b32 v56, v7, v6 offset:128
    ds_bpermute_b32 v57, v7, v6 offset:136
    v_mov_b32 v8, 0
    v_mov_b32 v9, 0
    s_waitcnt vmcnt(0) lgkmcnt(0)
    v_lshlrev_b32 v10, 16, v16
    v_and_b32 v11, 0xffff0000, v16
    v_fmac_f32 v8, v40, v10
    v_fmac_f32 v9, v40, v11
    v_lshlrev_b32 v10, 16, v17
    v_and_b32 v11, 0xffff0000, v17
    v_fmac_f32 v8, v41, v10
    v_fmac_f32 v9, v41, v11
    v_lshlrev_b32 v10, 16, v18
    v_and_b32 v11, 0xffff0000, v18
    v_fmac_f32 v8, v42, v10
    v_fmac_f32 v9, v42, v11
    v_lshlrev_b32 v10, 16, v19
    v_and_b32 v11, 0xffff0000, v19
    v_fmac_f32 v8, v43, v10
    v_fmac_f32 v9, v43, v11
    v_lshlrev_b32 v10, 16, v20
    v_and_b32 v11, 0xffff0000, v20
    v_fmac_f32 v8, v44, v10
    v_fmac_f32 v9, v44, v11
    v_lshlrev_b32 v10, 16, v21
    v_and_b32 v11, 0xffff0000, v21
    v_fmac_f32 v8, v45, v10
    v_fmac_f32 v9, v45, v11
    v_lshlrev_b32 v10, 16, v22
    v_and_b32 v11, 0xffff0000, v22
    v_fmac_f32 v8, v46, v10
    v_fmac_f32 v9, v46, v11
    v_lshlrev_b32 v10, 16, v23
    v_and_b32 v11, 0xffff0000, v23
    v_fmac_f32 v8, v47, v10
    v_fmac_f32 v9, v47, v11
    v_lshlrev_b32 v10, 16, v24
    v_and_b32 v11, 0xffff0000, v24
    v_fmac_f32 v8, v48, v10
    v_fmac_f32 v9, v48, v11
    v_lshlrev_b32 v10, 16, v25
    v_and_b32 v11, 0xffff0000, v25
    v_fmac_f32 v8, v49, v10
    v_fmac_f32 v9, v49, v11
    v_lshlrev_b32 v10, 16, v26
    v_and_b32 v11, 0xffff0000, v26
    v_fmac_f32 v8, v50, v10
    v_fmac_f32 v9, v50, v11
    v_lshlrev_b32 v10, 16, v27
    v_and_b32 v11, 0xffff0000, v27
    v_fmac_f32 v8, v51, v10
    v_fmac_f32 v9, v51, v11
    v_lshlrev_b32 v10, 16, v28
    v_and_b32 v11, 0xffff0000, v28
    v_fmac_f32 v8, v52, v10
    v_fmac_f32 v9, v52, v11
    v_lshlrev_b32 v10, 16, v29
    v_and_b32 v11, 0xffff0000, v29
    v_fmac_f32 v8, v53, v10
    v_fmac_f32 v9, v53, v11
    v_lshlrev_b32 v10, 16, v30
    v_and_b32 v11, 0xffff0000, v30
    v_fmac_f32 v8, v54, v10
    v_fmac_f32 v9, v54, v11
    v_lshlrev_b32 v10, 16, v31
    v_and_b32 v11, 0xffff0000, v31
    v_fmac_f32 v8, v55, v10
    v_fmac_f32 v9, v55, v11
    v_lshlrev_b32 v10, 16, v32
    v_and_b32 v11, 0xffff0000, v32
    v_fmac_f32 v8, v56, v10
    v_fmac_f32 v9, v56, v11
    v_lshlrev_b32 v10, 16, v33
    v_and_b32 v11, 0xffff0000, v33
    v_fmac_f32 v8, v57, v10
    v_fmac_f32 v9, v57, v11
    v_lshlrev_b32 v12, 3, v0
    ds_write_b64 v12, v[8:9]
    s_waitcnt lgkmcnt(0)
    s_barrier
    s_cmp_lg_u32 s3, 0
    s_cbranch_scc1 .mod_end
    ds_read_b64 v[16:17], v12 offset:0
    ds_read_b64 v[18:19], v12 offset:512
    ds_read_b64 v[20:21], v12 offset:1024
    ds_read_b64 v[22:23], v12 offset:1536
    ds_read_b64 v[24:25], v12 offset:2048
    ds_read_b64 v[26:27], v12 offset:2560
    ds_read_b64 v[28:29], v12 offset:3072
    ds_read_b64 v[30:31], v12 offset:3584
    ds_read_b64 v[32:33], v12 offset:4096
    ds_read_b64 v[34:35], v12 offset:4608
    ds_read_b64 v[36:37], v12 offset:5120
    ds_read_b64 v[38:39], v12 offset:5632
    ds_read_b64 v[40:41], v12 offset:6144
    ds_read_b64 v[42:43], v12 offset:6656
    ds_read_b64 v[44:45], v12 offset:7168
    ds_read_b64 v[46:47], v12 offset:7680
    s_waitcnt lgkmcnt(0)
    v_add_f32 v16, v16, v18
    v_add_f32 v17, v17, v19
    v_add_f32 v16, v16, v20
    v_add_f32 v17, v17, v21
    v_add_f32 v16, v16, v22
    v_add_f32 v17, v17, v23
    v_add_f32 v16, v16, v24
    v_add_f32 v17, v17, v25
    v_add_f32 v16, v16, v26
    v_add_f32 v17, v17, v27
    v_add_f32 v16, v16, v28
    v_add_f32 v17, v17, v29
    v_add_f32 v16, v16, v30
    v_add_f32 v17, v17, v31
    v_add_f32 v16, v16, v32
    v_add_f32 v17, v17, v33
    v_add_f32 v16, v16, v34
    v_add_f32 v17, v17, v35
    v_add_f32 v16, v16, v36
    v_add_f32 v17, v17, v37
    v_add_f32 v16, v16, v38
    v_add_f32 v17, v17, v39
    v_add_f32 v16, v16, v40
    v_add_f32 v17, v17, v41
    v_add_f32 v16, v16, v42
    v_add_f32 v17, v17, v43
    v_add_f32 v16, v16, v44
    v_add_f32 v17, v17, v45
    v_add_f32 v16, v16, v46
    v_add_f32 v17, v17, v47
    v_mov_b32 v18, v16
    v_mov_b32 v19, v17
    s_nop 1
    v_permlane32_swap_b32 v18, v16
    v_permlane32_swap_b32 v19, v17
    s_nop 0
    v_add_f32 v16, v16, v18
    v_add_f32 v17, v17, v19
    v_cvt_pk_bf16_f32 v18, v16, v17
    v_lshlrev_b32 v16, 16, v18
    v_and_b32 v17, 0xffff0000, v18
    s_lshl_b32 s24, s2, 8
    v_lshlrev_b32 v12, 3, v14
    buffer_store_dwordx2 v[16:17], v12, s[16:19], s24 offen sc1
    s_mov_b32 s40, s34
    s_mov_b32 s41, s35
    s_mov_b32 s42, 256
    s_mov_b32 s43, 0x00020000
    v_mov_b32 v1, 1
    v_mov_b32 v2, 0
    s_cmp_ge_u32 s2, 18
    s_cbranch_scc1 .mod_end
    s_waitcnt vmcnt(0)
    s_mov_b64 exec, 1
    buffer_atomic_add v1, v2, s[40:43], 0 offen sc1
    s_mov_b64 exec, -1
    s_endpgm
.mod_ln1:
    s_cmp_ge_u32 s2, 54+128
    s_cbranch_scc1 .mod_end
    s_sub_u32 s36, s2, 54
    v_lshrrev_b32 v7, 6, v0
    s_nop 0
    v_readfirstlane_b32 s33, v7
    s_nop 3
    s_cmp_lt_u32 s33, 8
    s_cbranch_scc1 .mod_rows
    s_load_dwordx2 s[44:45], s[0:1], 24
    v_and_b32 v120, 511, v0
    v_lshlrev_b32 v120, 7, v120
    s_lshl_b32 s37, s36, 16
    s_waitcnt lgkmcnt(0)
    s_mov_b32 s44, s44
    s_mov_b32 s45, s45
    s_mov_b32 s46, 4718592
    s_mov_b32 s47, 0x00020000
    buffer_load_dword v121, v120, s[44:47], s37 offen
    s_endpgm
.mod_rows:
    s_load_dwordx2 s[4:5], s[0:1], 0
    s_load_dwordx2 s[6:7], s[0:1], 104
    s_load_dwordx2 s[28:29], s[0:1], 88
    s_load_dwordx2 s[34:35], s[0:1], 96
    v_lshrrev_b32 v1, 5, v0
    s_lshl_b32 s3, s36, 4
    v_add_u32 v1, s3, v1
    v_and_b32 v2, 31, v0
    s_movk_i32 s30, 1152
    v_mul_lo_u32 v3, v1, s30
    v_lshl_add_u32 v3, v2, 2, v3
    v_lshlrev_b32 v4, 3, v2
    s_waitcnt lgkmcnt(0)
    s_add_u32 s12, s6, 0
    s_addc_u32 s13, s7, 0
    s_mov_b32 s14, 13824
    s_mov_b32 s15, 0x00020000
    s_mov_b32 s40, s34
    s_mov_b32 s41, s35
    s_mov_b32 s42, 256
    s_mov_b32 s43, 0x00020000
    s_mov_b32 s8, s4
    s_mov_b32 s9, s5
    s_mov_b32 s10, 2359296
    s_mov_b32 s11, 0x00020000
    s_add_u32 s16, s6, 65536
    s_addc_u32 s17, s7, 0
    s_mov_b32 s18, 2359296
    s_mov_b32 s19, 0x00020000
    buffer_load_dword v8, v3, s[8:11], 0 offen offset:0
    buffer_load_dword v9, v3, s[8:11], 0 offen offset:128
    buffer_load_dword v10, v3, s[8:11], 0 offen offset:256
    buffer_load_dword v11, v3, s[8:11], 0 offen offset:384
    buffer_load_dword v12, v3, s[8:11], 0 offen offset:512
    buffer_load_dword v13, v3, s[8:11], 0 offen offset:640
    buffer_load_dword v14, v3, s[8:11], 0 offen offset:768
    buffer_load_dword v15, v3, s[8:11], 0 offen offset:896
    buffer_load_dword v16, v3, s[8:11], 0 offen offset:1024
    s_waitcnt vmcnt(0)
    v_lshlrev_b32 v20, 16, v8
    v_and_b32 v21, 0xffff0000, v8
    v_lshlrev_b32 v22, 16, v9
    v_and_b32 v23, 0xffff0000, v9
    v_lshlrev_b32 v24, 16, v10
    v_and_b32 v25, 0xffff0000, v10
    v_lshlrev_b32 v26, 16, v11
    v_and_b32 v27, 0xffff0000, v11
    v_lshlrev_b32 v28, 16, v12
    v_and_b32 v29, 0xffff0000, v12
    v_lshlrev_b32 v30, 16, v13
    v_and_b32 v31, 0xffff0000, v13
    v_lshlrev_b32 v32, 16, v14
    v_and_b32 v33, 0xffff0000, v14
    v_lshlrev_b32 v34, 16, v15
    v_and_b32 v35, 0xffff0000, v15
    v_lshlrev_b32 v36, 16, v16
    v_and_b32 v37, 0xffff0000, v16
    v_add_f32 v6, v20, v21
    v_add_f32 v6, v6, v22
    v_add_f32 v6, v6, v23
    v_add_f32 v6, v6, v24
    v_add_f32 v6, v6, v25
    v_add_f32 v6, v6, v26
    v_add_f32 v6, v6, v27
    v_add_f32 v6, v6, v28
    v_add_f32 v6, v6, v29
    v_add_f32 v6, v6, v30
    v_add_f32 v6, v6, v31
    v_add_f32 v6, v6, v32
    v_add_f32 v6, v6, v33
    v_add_f32 v6, v6, v34
    v_add_f32 v6, v6, v35
    v_add_f32 v6, v6, v36
    v_add_f32 v6, v6, v37
    s_nop 1
    v_add_f32_dpp v6, v6, v6 quad_perm:[1,0,3,2] row_mask:0xf bank_mask:0xf
    s_nop 1
    v_add_f32_dpp v6, v6, v6 quad_perm:[2,3,0,1] row_mask:0xf bank_mask:0xf
    s_nop 1
    v_add_f32_dpp v6, v6, v6 row_half_mirror row_mask:0xf bank_mask:0xf
    s_nop 1
    v_add_f32_dpp v6, v6, v6 row_mirror row_mask:0xf bank_mask:0xf
    v_mov_b32 v7, v6
    s_nop 1
    v_permlane16_swap_b32 v7, v6
    s_nop 0
    v_add_f32 v6, v6, v7
    s_mov_b32 s30, 0x3ae38e39
    v_mul_f32 v6, s30, v6
    v_sub_f32 v7, v20, v6
    v_mul_f32 v18, v7, v7
    v_sub_f32 v7, v21, v6
    v_fmac_f32 v18, v7, v7
    v_sub_f32 v7, v22, v6
    v_fmac_f32 v18, v7, v7
    v_sub_f32 v7, v23, v6
    v_fmac_f32 v18, v7, v7
    v_sub_f32 v7, v24, v6
    v_fmac_f32 v18, v7, v7
    v_sub_f32 v7, v25, v6
    v_fmac_f32 v18, v7, v7
    v_sub_f32 v7, v26, v6
    v_fmac_f32 v18, v7, v7
    v_sub_f32 v7, v27, v6
    v_fmac_f32 v18, v7, v7
    v_sub_f32 v7, v28, v6
    v_fmac_f32 v18, v7, v7
    v_sub_f32 v7, v29, v6
    v_fmac_f32 v18, v7, v7
    v_sub_f32 v7, v30, v6
    v_fmac_f32 v18, v7, v7
    v_sub_f32 v7, v31, v6
    v_fmac_f32 v18, v7, v7
    v_sub_f32 v7, v32, v6
    v_fmac_f32 v18, v7, v7
    v_sub_f32 v7, v33, v6
    v_fmac_f32 v18, v7, v7
    v_sub_f32 v7, v34, v6
    v_fmac_f32 v18, v7, v7
    v_sub_f32 v7, v35, v6
    v_fmac_f32 v18, v7, v7
    v_sub_f32 v7, v36, v6
    v_fmac_f32 v18, v7, v7
    v_sub_f32 v7, v37, v6
    v_fmac_f32 v18, v7, v7
    s_nop 1
    v_add_f32_dpp v18, v18, v18 quad_perm:[1,0,3,2] row_mask:0xf bank_mask:0xf
    s_nop 1
    v_add_f32_dpp v18, v18, v18 quad_perm:[2,3,0,1] row_mask:0xf bank_mask:0xf
    s_nop 1
    v_add_f32_dpp v18, v18, v18 row_half_mirror row_mask:0xf bank_mask:0xf
    s_nop 1
    v_add_f32_dpp v18, v18, v18 row_mirror row_mask:0xf bank_mask:0xf
    v_mov_b32 v7, v18
    s_nop 1
    v_permlane16_swap_b32 v7, v18
    s_nop 0
    v_add_f32 v18, v18, v7
    v_mul_f32 v18, s30, v18
    v_cvt_pk_bf16_f32 v7, v6, v18
    v_lshlrev_b32 v6, 16, v7
    v_and_b32 v18, 0xffff0000, v7
    s_mov_b32 s30, 0x3727c5ac
    v_add_f32 v18, s30, v18
    v_cvt_pk_bf16_f32 v7, v18, v18
    v_lshlrev_b32 v18, 16, v7
    v_sqrt_f32 v18, v18
    s_nop 0
    v_cvt_pk_bf16_f32 v7, v18, v18
    v_lshlrev_b32 v18, 16, v7
    v_rcp_f32 v18, v18
    s_nop 0
    v_mov_b32 v19, v6
    v_lshrrev_b32 v7, 6, v0
    s_nop 0
    v_readfirstlane_b32 s33, v7
    s_nop 3
    s_cmp_lg_u32 s33, 0
    s_cbranch_scc1 .poll_ln1_done
    v_mov_b32 v7, 0
.poll_ln1:
    buffer_load_dword v6, v7, s[40:43], 0 offen sc1
    s_waitcnt vmcnt(0)
    v_readfirstlane_b32 s33, v6
    s_nop 3
    s_cmp_ge_u32 s33, 18
    s_cbranch_scc1 .poll_ln1_done
    s_sleep 2
    s_branch .poll_ln1
.poll_ln1_done:
    v_lshrrev_b32 v7, 6, v0
    s_nop 0
    v_readfirstlane_b32 s33, v7
    s_nop 3
    s_cmp_lg_u32 s33, 0
    s_cbranch_scc1 .ln1_nl
    v_lshlrev_b32 v7, 4, v0
    buffer_load_dwordx4 v[40:43], v7, s[12:15], 0 offen offset:0 sc1
    buffer_load_dwordx4 v[44:47], v7, s[12:15], 0 offen offset:1024 sc1
    buffer_load_dwordx4 v[48:51], v7, s[12:15], 0 offen offset:2048 sc1
    buffer_load_dwordx4 v[52:55], v7, s[12:15], 0 offen offset:3072 sc1
    s_movk_i32 s31, 4096
    buffer_load_dwordx4 v[56:59], v7, s[12:15], s31 offen sc1
    s_waitcnt vmcnt(0)
    ds_write_b128 v7, v[40:43] offset:0
    ds_write_b128 v7, v[44:47] offset:1024
    ds_write_b128 v7, v[48:51] offset:2048
    ds_write_b128 v7, v[52:55] offset:3072
    ds_write_b128 v7, v[56:59] offset:4096
    s_waitcnt lgkmcnt(0)
.ln1_nl:
    s_barrier
    ds_read_b64 v[40:41], v4 offset:0
    ds_read_b64 v[60:61], v4 offset:2304
    ds_read_b64 v[42:43], v4 offset:256
    ds_read_b64 v[62:63], v4 offset:2560
    ds_read_b64 v[44:45], v4 offset:512
    ds_read_b64 v[64:65], v4 offset:2816
    ds_read_b64 v[46:47], v4 offset:768
    ds_read_b64 v[66:67], v4 offset:3072
    ds_read_b64 v[48:49], v4 offset:1024
    ds_read_b64 v[68:69], v4 offset:3328
    ds_read_b64 v[50:51], v4 offset:1280
    ds_read_b64 v[70:71], v4 offset:3584
    ds_read_b64 v[52:53], v4 offset:1536
    ds_read_b64 v[72:73], v4 offset:3840
    ds_read_b64 v[54:55], v4 offset:1792
    ds_read_b64 v[74:75], v4 offset:4096
    ds_read_b64 v[56:57], v4 offset:2048
    ds_read_b64 v[76:77], v4 offset:4352
    v_mov_b32 v6, v19
    s_waitcnt lgkmcnt(0)
    v_sub_f32 v20, v20, v6
    v_sub_f32 v21, v21, v6
    v_cvt_pk_bf16_f32 v7, v20, v21
    v_lshlrev_b32 v20, 16, v7
    v_and_b32 v21, 0xffff0000, v7
    v_mul_f32 v20, v20, v18
    v_mul_f32 v21, v21, v18
    v_cvt_pk_bf16_f32 v7, v20, v21
    v_lshlrev_b32 v20, 16, v7
    v_and_b32 v21, 0xffff0000, v7
    v_add_f32 v60, 1.0, v60
    v_add_f32 v61, 1.0, v61
    v_cvt_pk_bf16_f32 v7, v60, v61
    v_lshlrev_b32 v60, 16, v7
    v_and_b32 v61, 0xffff0000, v7
    v_mul_f32 v20, v20, v60
    v_mul_f32 v21, v21, v61
    v_cvt_pk_bf16_f32 v7, v20, v21
    v_lshlrev_b32 v20, 16, v7
    v_and_b32 v21, 0xffff0000, v7
    v_add_f32 v20, v20, v40
    v_add_f32 v21, v21, v41
    v_cvt_pk_bf16_f32 v100, v20, v21
    v_sub_f32 v22, v22, v6
    v_sub_f32 v23, v23, v6
    v_cvt_pk_bf16_f32 v7, v22, v23
    v_lshlrev_b32 v22, 16, v7
    v_and_b32 v23, 0xffff0000, v7
    v_mul_f32 v22, v22, v18
    v_mul_f32 v23, v23, v18
    v_cvt_pk_bf16_f32 v7, v22, v23
    v_lshlrev_b32 v22, 16, v7
    v_and_b32 v23, 0xffff0000, v7
    v_add_f32 v62, 1.0, v62
    v_add_f32 v63, 1.0, v63
    v_cvt_pk_bf16_f32 v7, v62, v63
    v_lshlrev_b32 v62, 16, v7
    v_and_b32 v63, 0xffff0000, v7
    v_mul_f32 v22, v22, v62
    v_mul_f32 v23, v23, v63
    v_cvt_pk_bf16_f32 v7, v22, v23
    v_lshlrev_b32 v22, 16, v7
    v_and_b32 v23, 0xffff0000, v7
    v_add_f32 v22, v22, v42
    v_add_f32 v23, v23, v43
    v_cvt_pk_bf16_f32 v101, v22, v23
    v_sub_f32 v24, v24, v6
    v_sub_f32 v25, v25, v6
    v_cvt_pk_bf16_f32 v7, v24, v25
    v_lshlrev_b32 v24, 16, v7
    v_and_b32 v25, 0xffff0000, v7
    v_mul_f32 v24, v24, v18
    v_mul_f32 v25, v25, v18
    v_cvt_pk_bf16_f32 v7, v24, v25
    v_lshlrev_b32 v24, 16, v7
    v_and_b32 v25, 0xffff0000, v7
    v_add_f32 v64, 1.0, v64
    v_add_f32 v65, 1.0, v65
    v_cvt_pk_bf16_f32 v7, v64, v65
    v_lshlrev_b32 v64, 16, v7
    v_and_b32 v65, 0xffff0000, v7
    v_mul_f32 v24, v24, v64
    v_mul_f32 v25, v25, v65
    v_cvt_pk_bf16_f32 v7, v24, v25
    v_lshlrev_b32 v24, 16, v7
    v_and_b32 v25, 0xffff0000, v7
    v_add_f32 v24, v24, v44
    v_add_f32 v25, v25, v45
    v_cvt_pk_bf16_f32 v102, v24, v25
    v_sub_f32 v26, v26, v6
    v_sub_f32 v27, v27, v6
    v_cvt_pk_bf16_f32 v7, v26, v27
    v_lshlrev_b32 v26, 16, v7
    v_and_b32 v27, 0xffff0000, v7
    v_mul_f32 v26, v26, v18
    v_mul_f32 v27, v27, v18
    v_cvt_pk_bf16_f32 v7, v26, v27
    v_lshlrev_b32 v26, 16, v7
    v_and_b32 v27, 0xffff0000, v7
    v_add_f32 v66, 1.0, v66
    v_add_f32 v67, 1.0, v67
    v_cvt_pk_bf16_f32 v7, v66, v67
    v_lshlrev_b32 v66, 16, v7
    v_and_b32 v67, 0xffff0000, v7
    v_mul_f32 v26, v26, v66
    v_mul_f32 v27, v27, v67
    v_cvt_pk_bf16_f32 v7, v26, v27
    v_lshlrev_b32 v26, 16, v7
    v_and_b32 v27, 0xffff0000, v7
    v_add_f32 v26, v26, v46
    v_add_f32 v27, v27, v47
    v_cvt_pk_bf16_f32 v103, v26, v27
    v_sub_f32 v28, v28, v6
    v_sub_f32 v29, v29, v6
    v_cvt_pk_bf16_f32 v7, v28, v29
    v_lshlrev_b32 v28, 16, v7
    v_and_b32 v29, 0xffff0000, v7
    v_mul_f32 v28, v28, v18
    v_mul_f32 v29, v29, v18
    v_cvt_pk_bf16_f32 v7, v28, v29
    v_lshlrev_b32 v28, 16, v7
    v_and_b32 v29, 0xffff0000, v7
    v_add_f32 v68, 1.0, v68
    v_add_f32 v69, 1.0, v69
    v_cvt_pk_bf16_f32 v7, v68, v69
    v_lshlrev_b32 v68, 16, v7
    v_and_b32 v69, 0xffff0000, v7
    v_mul_f32 v28, v28, v68
    v_mul_f32 v29, v29, v69
    v_cvt_pk_bf16_f32 v7, v28, v29
    v_lshlrev_b32 v28, 16, v7
    v_and_b32 v29, 0xffff0000, v7
    v_add_f32 v28, v28, v48
    v_add_f32 v29, v29, v49
    v_cvt_pk_bf16_f32 v104, v28, v29
    v_sub_f32 v30, v30, v6
    v_sub_f32 v31, v31, v6
    v_cvt_pk_bf16_f32 v7, v30, v31
    v_lshlrev_b32 v30, 16, v7
    v_and_b32 v31, 0xffff0000, v7
    v_mul_f32 v30, v30, v18
    v_mul_f32 v31, v31, v18
    v_cvt_pk_bf16_f32 v7, v30, v31
    v_lshlrev_b32 v30, 16, v7
    v_and_b32 v31, 0xffff0000, v7
    v_add_f32 v70, 1.0, v70
    v_add_f32 v71, 1.0, v71
    v_cvt_pk_bf16_f32 v7, v70, v71
    v_lshlrev_b32 v70, 16, v7
    v_and_b32 v71, 0xffff0000, v7
    v_mul_f32 v30, v30, v70
    v_mul_f32 v31, v31, v71
    v_cvt_pk_bf16_f32 v7, v30, v31
    v_lshlrev_b32 v30, 16, v7
    v_and_b32 v31, 0xffff0000, v7
    v_add_f32 v30, v30, v50
    v_add_f32 v31, v31, v51
    v_cvt_pk_bf16_f32 v105, v30, v31
    v_sub_f32 v32, v32, v6
    v_sub_f32 v33, v33, v6
    v_cvt_pk_bf16_f32 v7, v32, v33
    v_lshlrev_b32 v32, 16, v7
    v_and_b32 v33, 0xffff0000, v7
    v_mul_f32 v32, v32, v18
    v_mul_f32 v33, v33, v18
    v_cvt_pk_bf16_f32 v7, v32, v33
    v_lshlrev_b32 v32, 16, v7
    v_and_b32 v33, 0xffff0000, v7
    v_add_f32 v72, 1.0, v72
    v_add_f32 v73, 1.0, v73
    v_cvt_pk_bf16_f32 v7, v72, v73
    v_lshlrev_b32 v72, 16, v7
    v_and_b32 v73, 0xffff0000, v7
    v_mul_f32 v32, v32, v72
    v_mul_f32 v33, v33, v73
    v_cvt_pk_bf16_f32 v7, v32, v33
    v_lshlrev_b32 v32, 16, v7
    v_and_b32 v33, 0xffff0000, v7
    v_add_f32 v32, v32, v52
    v_add_f32 v33, v33, v53
    v_cvt_pk_bf16_f32 v106, v32, v33
    v_sub_f32 v34, v34, v6
    v_sub_f32 v35, v35, v6
    v_cvt_pk_bf16_f32 v7, v34, v35
    v_lshlrev_b32 v34, 16, v7
    v_and_b32 v35, 0xffff0000, v7
    v_mul_f32 v34, v34, v18
    v_mul_f32 v35, v35, v18
    v_cvt_pk_bf16_f32 v7, v34, v35
    v_lshlrev_b32 v34, 16, v7
    v_and_b32 v35, 0xffff0000, v7
    v_add_f32 v74, 1.0, v74
    v_add_f32 v75, 1.0, v75
    v_cvt_pk_bf16_f32 v7, v74, v75
    v_lshlrev_b32 v74, 16, v7
    v_and_b32 v75, 0xffff0000, v7
    v_mul_f32 v34, v34, v74
    v_mul_f32 v35, v35, v75
    v_cvt_pk_bf16_f32 v7, v34, v35
    v_lshlrev_b32 v34, 16, v7
    v_and_b32 v35, 0xffff0000, v7
    v_add_f32 v34, v34, v54
    v_add_f32 v35, v35, v55
    v_cvt_pk_bf16_f32 v107, v34, v35
    v_sub_f32 v36, v36, v6
    v_sub_f32 v37, v37, v6
    v_cvt_pk_bf16_f32 v7, v36, v37
    v_lshlrev_b32 v36, 16, v7
    v_and_b32 v37, 0xffff0000, v7
    v_mul_f32 v36, v36, v18
    v_mul_f32 v37, v37, v18
    v_cvt_pk_bf16_f32 v7, v36, v37
    v_lshlrev_b32 v36, 16, v7
    v_and_b32 v37, 0xffff0000, v7
    v_add_f32 v76, 1.0, v76
    v_add_f32 v77, 1.0, v77
    v_cvt_pk_bf16_f32 v7, v76, v77
    v_lshlrev_b32 v76, 16, v7
    v_and_b32 v77, 0xffff0000, v7
    v_mul_f32 v36, v36, v76
    v_mul_f32 v37, v37, v77
    v_cvt_pk_bf16_f32 v7, v36, v37
    v_lshlrev_b32 v36, 16, v7
    v_and_b32 v37, 0xffff0000, v7
    v_add_f32 v36, v36, v56
    v_add_f32 v37, v37, v57
    v_cvt_pk_bf16_f32 v108, v36, v37
    buffer_store_dword v100, v3, s[16:19], 0 offen offset:0
    buffer_store_dword v101, v3, s[16:19], 0 offen offset:128
    buffer_store_dword v102, v3, s[16:19], 0 offen offset:256
    buffer_store_dword v103, v3, s[16:19], 0 offen offset:384
    buffer_store_dword v104, v3, s[16:19], 0 offen offset:512
    buffer_store_dword v105, v3, s[16:19], 0 offen offset:640
    buffer_store_dword v106, v3, s[16:19], 0 offen offset:768
    buffer_store_dword v107, v3, s[16:19], 0 offen offset:896
    buffer_store_dword v108, v3, s[16:19], 0 offen offset:1024
.mod_end:
    s_endpgm

.section .rodata,"a"
.p2align 6
.amdhsa_kernel mod_kernel
  .amdhsa_next_free_vgpr 128
  .amdhsa_next_free_sgpr 80
  .amdhsa_accum_offset 128
  .amdhsa_group_segment_fixed_size 0
  .amdhsa_kernarg_size 112
  .amdhsa_user_sgpr_count 2
  .amdhsa_user_sgpr_kernarg_segment_ptr 1
  .amdhsa_system_sgpr_workgroup_id_x 1
.end_amdhsa_kernel

.text
.globl attn_kernel
.p2align 8
.type attn_kernel,@function
attn_kernel:
    s_cmp_ge_u32 s2, 256
    s_cbranch_scc1 .attn_end
    s_load_dwordx4 s[4:7], s[0:1], 8
    s_load_dwordx2 s[32:33], s[0:1], 24
    s_load_dwordx2 s[34:35], s[0:1], 104
    v_lshrrev_b32 v1, 6, v0
    v_and_b32 v2, 63, v0
    s_nop 0
    v_readfirstlane_b32 s3, v1
    s_and_b32 s24, s2, 7
    s_lshl_b32 s24, s24, 2
    s_bfe_u32 s25, s2, 0x20003
    s_add_u32 s24, s24, s25
    s_lshr_b32 s25, s2, 5
    s_lshl_b32 s26, s3, 10
    s_waitcnt lgkmcnt(0)
    s_lshl_b32 s31, s24, 19
    s_add_u32 s8, s4, s31
    s_addc_u32 s9, s5, 0
    s_sub_u32 s10, 0x1000000, s31
    s_mov_b32 s11, 0x00020000
    s_add_u32 s12, s6, s31
    s_addc_u32 s13, s7, 0
    s_sub_u32 s14, 0x1000000, s31
    s_mov_b32 s15, 0x00020000
    s_mov_b32 s16, s32
    s_mov_b32 s17, s33
    s_mov_b32 s18, 4718592
    s_mov_b32 s19, 0x00020000
    s_add_u32 s20, s34, 65536
    s_addc_u32 s21, s35, 0
    s_mov_b32 s22, 2359296
    s_mov_b32 s23, 0x00020000
    v_and_b32 v3, 15, v2
    v_lshrrev_b32 v4, 4, v2
    v_lshrrev_b32 v5, 5, v2
    v_and_b32 v6, 31, v2
    v_lshrrev_b32 v7, 2, v3
    v_and_b32 v8, 3, v2
    v_xor_b32 v9, v4, v3
    v_lshlrev_b32 v9, 4, v9
    v_lshl_add_u32 v9, v3, 8, v9
    v_xor_b32 v16, 0, v9
    v_xor_b32 v17, 64, v9
    v_xor_b32 v18, 128, v9
    v_xor_b32 v19, 192, v9
    v_lshl_add_u32 v9, v4, 2, v7
    v_and_b32 v10, 7, v9
    v_lshlrev_b32 v10, 5, v10
    v_lshl_add_u32 v10, v9, 8, v10
    v_lshl_add_u32 v10, v8, 3, v10
    v_add_u32 v10, 65536, v10
    v_xor_b32 v20, 0, v10
    v_xor_b32 v21, 32, v10
    v_xor_b32 v22, 64, v10
    v_xor_b32 v23, 96, v10
    v_xor_b32 v24, 128, v10
    v_xor_b32 v25, 160, v10
    v_xor_b32 v26, 192, v10
    v_xor_b32 v27, 224, v10
    v_and_b32 v10, 1, v4
    v_lshlrev_b32 v10, 1, v10
    v_lshrrev_b32 v11, 1, v8
    v_add_u32 v10, v10, v11
    v_lshlrev_b32 v10, 4, v10
    v_and_b32 v11, 1, v2
    v_lshl_add_u32 v10, v11, 3, v10
    v_lshl_add_u32 v10, v7, 8, v10
    v_xor_b32 v11, 0, v7
    v_lshl_add_u32 v11, v11, 6, v10
    v_lshl_add_u32 v224, v5, 11, v11
    v_xor_b32 v11, 1, v7
    v_lshl_add_u32 v11, v11, 6, v10
    v_lshl_add_u32 v225, v5, 11, v11
    v_xor_b32 v11, 2, v7
    v_lshl_add_u32 v11, v11, 6, v10
    v_lshl_add_u32 v226, v5, 11, v11
    v_xor_b32 v11, 3, v7
    v_lshl_add_u32 v11, v11, 6, v10
    v_lshl_add_u32 v227, v5, 11, v11
    s_lshl_b32 s31, s3, 2
    v_add_u32 v9, s31, v4
    v_xor_b32 v10, v3, v9
    v_lshlrev_b32 v10, 4, v10
    v_lshlrev_b32 v11, 2, v4
    v_xor_b32 v11, v3, v11
    v_lshlrev_b32 v11, 4, v11
    v_and_b32 v13, 7, v9
    v_lshlrev_b32 v13, 1, v13
    v_xor_b32 v13, v3, v13
    v_lshlrev_b32 v13, 4, v13
    s_lshl_b32 s31, s24, 8
    v_add_u32 v12, 0, v9
    v_lshl_add_u32 v28, v12, 8, v10
    v_lshl_add_u32 v32, v12, 8, v13
    v_lshl_add_u32 v230, v12, 13, v11
    v_add_u32 v230, s31, v230
    v_add_u32 v12, 16, v9
    v_lshl_add_u32 v29, v12, 8, v10
    v_lshl_add_u32 v33, v12, 8, v13
    v_lshl_add_u32 v231, v12, 13, v11
    v_add_u32 v231, s31, v231
    v_add_u32 v12, 32, v9
    v_lshl_add_u32 v30, v12, 8, v10
    v_lshl_add_u32 v34, v12, 8, v13
    v_lshl_add_u32 v232, v12, 13, v11
    v_add_u32 v232, s31, v232
    v_add_u32 v12, 48, v9
    v_lshl_add_u32 v31, v12, 8, v10
    v_lshl_add_u32 v35, v12, 8, v13
    v_lshl_add_u32 v233, v12, 13, v11
    v_add_u32 v233, s31, v233
    s_lshl_b32 s31, s25, 8
    s_lshl_b32 s36, s3, 6
    s_add_u32 s31, s31, s36
    s_mov_b32 s37, s31
    v_lshrrev_b32 v9, 2, v2
    v_add_u32 v9, s31, v9
    s_movk_i32 s36, 1152
    v_mul_lo_u32 v9, v9, s36
    v_xor_b32 v10, v8, v4
    v_lshl_add_u32 v9, v10, 4, v9
    v_add_u32 v242, 0, v9
    v_add_u32 v243, 18432, v9
    v_add_u32 v244, 36864, v9
    v_add_u32 v245, 55296, v9
    v_lshrrev_b32 v9, 2, v6
    v_and_b32 v9, 3, v9
    v_xor_b32 v9, v5, v9
    v_lshlrev_b32 v9, 4, v9
    v_lshl_add_u32 v9, v6, 6, v9
    s_lshl_b32 s36, s3, 12
    v_add_u32 v228, s36, v9
    v_xor_b32 v229, 32, v228
    s_lshl_b32 s38, s3, 12
    s_mov_b32 s39, 0
    s_mov_b32 s36, 0
    s_mov_b32 s27, 16384
    v_add_u32 v246, 81920, v228
    v_add_u32 v247, 81920, v229
    s_nop 0
    s_add_u32 m0, s38, 40960
    s_nop 0
    buffer_load_dwordx4 v242, s[20:23], s39 offen lds
    s_nop 0
    s_add_u32 m0, s38, 41984
    s_nop 0
    buffer_load_dwordx4 v243, s[20:23], s39 offen lds
    s_nop 0
    s_add_u32 m0, s38, 43008
    s_nop 0
    buffer_load_dwordx4 v244, s[20:23], s39 offen lds
    s_nop 0
    s_add_u32 m0, s38, 44032
    s_nop 0
    buffer_load_dwordx4 v245, s[20:23], s39 offen lds
    s_nop 0
    s_add_u32 m0, s26, 57344
    s_nop 0
    buffer_load_dwordx4 v230, s[16:19], s36 offen lds
    s_nop 0
    s_add_u32 m0, s26, 61440
    s_nop 0
    buffer_load_dwordx4 v231, s[16:19], s36 offen lds
    s_nop 0
    s_add_u32 s39, s39, 64
    s_add_u32 s36, s36, 262144
    s_nop 0
    s_add_u32 m0, s38, 106496
    s_nop 0
    buffer_load_dwordx4 v242, s[20:23], s39 offen lds
    s_nop 0
    s_add_u32 m0, s38, 107520
    s_nop 0
    buffer_load_dwordx4 v243, s[20:23], s39 offen lds
    s_nop 0
    s_add_u32 m0, s38, 108544
    s_nop 0
    buffer_load_dwordx4 v244, s[20:23], s39 offen lds
    s_nop 0
    s_add_u32 m0, s38, 109568
    s_nop 0
    buffer_load_dwordx4 v245, s[20:23], s39 offen lds
    s_nop 0
    s_add_u32 m0, s26, 122880
    s_nop 0
    buffer_load_dwordx4 v230, s[16:19], s36 offen lds
    s_nop 0
    s_add_u32 m0, s26, 126976
    s_nop 0
    buffer_load_dwordx4 v231, s[16:19], s36 offen lds
    s_nop 0
    s_add_u32 s39, s39, 64
    s_add_u32 s36, s36, 262144
    s_nop 0
    s_add_u32 m0, s38, 131072
    s_nop 0
    buffer_load_dwordx4 v242, s[20:23], s39 offen lds
    s_nop 0
    s_add_u32 m0, s38, 132096
    s_nop 0
    buffer_load_dwordx4 v243, s[20:23], s39 offen lds
    s_nop 0
    s_add_u32 m0, s38, 133120
    s_nop 0
    buffer_load_dwordx4 v244, s[20:23], s39 offen lds
    s_nop 0
    s_add_u32 m0, s38, 134144
    s_nop 0
    buffer_load_dwordx4 v245, s[20:23], s39 offen lds
    s_nop 0
    s_add_u32 m0, s26, 147456
    s_nop 0
    buffer_load_dwordx4 v230, s[16:19], s36 offen lds
    s_nop 0
    s_add_u32 m0, s26, 151552
    s_nop 0
    buffer_load_dwordx4 v231, s[16:19], s36 offen lds
    s_nop 0
    s_add_u32 s39, s39, 64
    s_add_u32 s36, s36, 262144
    s_nop 0
    s_waitcnt vmcnt(12)
    s_barrier
    v_add_u32 v234, 57344, v224
    v_add_u32 v235, 57344, v225
    v_add_u32 v236, 57344, v226
    v_add_u32 v237, 57344, v227
    s_nop 0
    ds_read_b128 a[128:131], v228 offset:40960
    ds_read_b128 a[132:135], v228 offset:43008
    ds_read_b64_tr_b16 v[192:193], v234 offset:0
    s_add_u32 m0, s38, 16384
    s_nop 0
    ds_read_b64_tr_b16 v[194:195], v234 offset:1024
    buffer_load_dwordx4 v242, s[20:23], s39 offen lds
    s_nop 0
    ds_read_b64_tr_b16 v[196:197], v235 offset:0
    s_add_u32 m0, s38, 17408
    s_nop 0
    ds_read_b64_tr_b16 v[198:199], v235 offset:1024
    buffer_load_dwordx4 v243, s[20:23], s39 offen lds
    s_nop 0
    ds_read_b64_tr_b16 v[200:201], v236 offset:0
    s_add_u32 m0, s38, 18432
    s_nop 0
    ds_read_b64_tr_b16 v[202:203], v236 offset:1024
    buffer_load_dwordx4 v244, s[20:23], s39 offen lds
    s_waitcnt lgkmcnt(4)
    v_mfma_f32_32x32x16_bf16 v[64:79], v[192:195], a[128:131], 0
    ds_read_b64_tr_b16 v[204:205], v237 offset:0
    s_add_u32 m0, s38, 19456
    v_mfma_f32_32x32x16_bf16 v[80:95], v[192:195], a[132:135], 0
    ds_read_b64_tr_b16 v[206:207], v237 offset:1024
    buffer_load_dwordx4 v245, s[20:23], s39 offen lds
    s_waitcnt lgkmcnt(4)
    v_mfma_f32_32x32x16_bf16 v[96:111], v[196:199], a[128:131], 0
    ds_read_b128 a[136:139], v229 offset:40960
    ds_read_b128 a[140:143], v229 offset:43008
    ds_read_b64_tr_b16 v[208:209], v234 offset:4096
    s_add_u32 m0, s26, 32768
    v_mfma_f32_32x32x16_bf16 v[112:127], v[196:199], a[132:135], 0
    ds_read_b64_tr_b16 v[210:211], v234 offset:5120
    buffer_load_dwordx4 v230, s[16:19], s36 offen lds
    s_waitcnt lgkmcnt(6)
    v_mfma_f32_32x32x16_bf16 v[128:143], v[200:203], a[128:131], 0
    ds_read_b64_tr_b16 v[212:213], v235 offset:4096
    s_add_u32 m0, s26, 36864
    v_mfma_f32_32x32x16_bf16 v[144:159], v[200:203], a[132:135], 0
    ds_read_b64_tr_b16 v[214:215], v235 offset:5120
    buffer_load_dwordx4 v231, s[16:19], s36 offen lds
    s_waitcnt lgkmcnt(6)
    v_mfma_f32_32x32x16_bf16 v[160:175], v[204:207], a[128:131], 0
    ds_read_b64_tr_b16 v[216:217], v236 offset:4096
    s_add_u32 s39, s39, 64
    s_add_u32 s36, s36, 262144
    v_mfma_f32_32x32x16_bf16 v[176:191], v[204:207], a[132:135], 0
    ds_read_b64_tr_b16 v[218:219], v236 offset:5120
    s_waitcnt lgkmcnt(4)
    v_mfma_f32_32x32x16_bf16 v[64:79], v[208:211], a[136:139], v[64:79]
    ds_read_b64_tr_b16 v[220:221], v237 offset:4096
    v_mfma_f32_32x32x16_bf16 v[80:95], v[208:211], a[140:143], v[80:95]
    s_waitcnt vmcnt(12)
    s_barrier
    v_add_u32 v238, 122880, v224
    v_add_u32 v239, 122880, v225
    v_add_u32 v240, 122880, v226
    v_add_u32 v241, 122880, v227
    ds_read_b64_tr_b16 v[222:223], v237 offset:5120
    s_waitcnt lgkmcnt(4)
    v_mfma_f32_32x32x16_bf16 v[96:111], v[212:215], a[136:139], v[96:111]
    ds_read_b128 a[144:147], v246 offset:24576
    ds_read_b128 a[148:151], v246 offset:26624
    ds_read_b64_tr_b16 v[192:193], v238 offset:0
    s_add_u32 m0, s38, 81920
    v_mfma_f32_32x32x16_bf16 v[112:127], v[212:215], a[140:143], v[112:127]
    ds_read_b64_tr_b16 v[194:195], v238 offset:1024
    buffer_load_dwordx4 v242, s[20:23], s39 offen lds
    s_waitcnt lgkmcnt(6)
    v_mfma_f32_32x32x16_bf16 v[128:143], v[216:219], a[136:139], v[128:143]
    ds_read_b64_tr_b16 v[196:197], v239 offset:0
    s_add_u32 m0, s38, 82944
    v_mfma_f32_32x32x16_bf16 v[144:159], v[216:219], a[140:143], v[144:159]
    ds_read_b64_tr_b16 v[198:199], v239 offset:1024
    buffer_load_dwordx4 v243, s[20:23], s39 offen lds
    s_waitcnt lgkmcnt(6)
    v_mfma_f32_32x32x16_bf16 v[160:175], v[220:223], a[136:139], v[160:175]
    ds_read_b64_tr_b16 v[200:201], v240 offset:0
    s_add_u32 m0, s38, 83968
    v_mfma_f32_32x32x16_bf16 v[176:191], v[220:223], a[140:143], v[176:191]
    ds_read_b64_tr_b16 v[202:203], v240 offset:1024
    buffer_load_dwordx4 v244, s[20:23], s39 offen lds
    s_waitcnt lgkmcnt(4)
    v_mfma_f32_32x32x16_bf16 v[64:79], v[192:195], a[144:147], v[64:79]
    ds_read_b64_tr_b16 v[204:205], v241 offset:0
    s_add_u32 m0, s38, 84992
    v_mfma_f32_32x32x16_bf16 v[80:95], v[192:195], a[148:151], v[80:95]
    ds_read_b64_tr_b16 v[206:207], v241 offset:1024
    buffer_load_dwordx4 v245, s[20:23], s39 offen lds
    s_waitcnt lgkmcnt(4)
    v_mfma_f32_32x32x16_bf16 v[96:111], v[196:199], a[144:147], v[96:111]
    ds_read_b128 a[152:155], v247 offset:24576
    ds_read_b128 a[156:159], v247 offset:26624
    ds_read_b64_tr_b16 v[208:209], v238 offset:4096
    s_add_u32 m0, s26, 98304
    v_mfma_f32_32x32x16_bf16 v[112:127], v[196:199], a[148:151], v[112:127]
    ds_read_b64_tr_b16 v[210:211], v238 offset:5120
    buffer_load_dwordx4 v230, s[16:19], s36 offen lds
    s_waitcnt lgkmcnt(6)
    v_mfma_f32_32x32x16_bf16 v[128:143], v[200:203], a[144:147], v[128:143]
    ds_read_b64_tr_b16 v[212:213], v239 offset:4096
    s_add_u32 m0, s26, 102400
    v_mfma_f32_32x32x16_bf16 v[144:159], v[200:203], a[148:151], v[144:159]
    ds_read_b64_tr_b16 v[214:215], v239 offset:5120
    buffer_load_dwordx4 v231, s[16:19], s36 offen lds
    s_waitcnt lgkmcnt(6)
    v_mfma_f32_32x32x16_bf16 v[160:175], v[204:207], a[144:147], v[160:175]
    ds_read_b64_tr_b16 v[216:217], v240 offset:4096
    s_add_u32 s39, s39, 64
    s_add_u32 s36, s36, 262144
    v_mfma_f32_32x32x16_bf16 v[176:191], v[204:207], a[148:151], v[176:191]
    ds_read_b64_tr_b16 v[218:219], v240 offset:5120
    s_waitcnt lgkmcnt(4)
    v_mfma_f32_32x32x16_bf16 v[64:79], v[208:211], a[152:155], v[64:79]
    ds_read_b64_tr_b16 v[220:221], v241 offset:4096
    v_mfma_f32_32x32x16_bf16 v[80:95], v[208:211], a[156:159], v[80:95]
    s_waitcnt vmcnt(12)
    s_barrier
    v_add_u32 v234, 147456, v224
    v_add_u32 v235, 147456, v225
    v_add_u32 v236, 147456, v226
    v_add_u32 v237, 147456, v227
    ds_read_b64_tr_b16 v[222:223], v241 offset:5120
    s_waitcnt lgkmcnt(4)
    v_mfma_f32_32x32x16_bf16 v[96:111], v[212:215], a[152:155], v[96:111]
    ds_read_b128 a[128:131], v246 offset:49152
    ds_read_b128 a[132:135], v246 offset:51200
    ds_read_b64_tr_b16 v[192:193], v234 offset:0
    s_add_u32 m0, s38, 40960
    v_mfma_f32_32x32x16_bf16 v[112:127], v[212:215], a[156:159], v[112:127]
    ds_read_b64_tr_b16 v[194:195], v234 offset:1024
    buffer_load_dwordx4 v242, s[20:23], s39 offen lds
    s_waitcnt lgkmcnt(6)
    v_mfma_f32_32x32x16_bf16 v[128:143], v[216:219], a[152:155], v[128:143]
    ds_read_b64_tr_b16 v[196:197], v235 offset:0
    s_add_u32 m0, s38, 41984
    v_mfma_f32_32x32x16_bf16 v[144:159], v[216:219], a[156:159], v[144:159]
    ds_read_b64_tr_b16 v[198:199], v235 offset:1024
    buffer_load_dwordx4 v243, s[20:23], s39 offen lds
    s_waitcnt lgkmcnt(6)
    v_mfma_f32_32x32x16_bf16 v[160:175], v[220:223], a[152:155], v[160:175]
    ds_read_b64_tr_b16 v[200:201], v236 offset:0
    s_add_u32 m0, s38, 43008
    v_mfma_f32_32x32x16_bf16 v[176:191], v[220:223], a[156:159], v[176:191]
    ds_read_b64_tr_b16 v[202:203], v236 offset:1024
    buffer_load_dwordx4 v244, s[20:23], s39 offen lds
    s_waitcnt lgkmcnt(4)
    v_mfma_f32_32x32x16_bf16 v[64:79], v[192:195], a[128:131], v[64:79]
    ds_read_b64_tr_b16 v[204:205], v237 offset:0
    s_add_u32 m0, s38, 44032
    v_mfma_f32_32x32x16_bf16 v[80:95], v[192:195], a[132:135], v[80:95]
    ds_read_b64_tr_b16 v[206:207], v237 offset:1024
    buffer_load_dwordx4 v245, s[20:23], s39 offen lds
    s_waitcnt lgkmcnt(4)
    v_mfma_f32_32x32x16_bf16 v[96:111], v[196:199], a[128:131], v[96:111]
    ds_read_b128 a[136:139], v247 offset:49152
    ds_read_b128 a[140:143], v247 offset:51200
    ds_read_b64_tr_b16 v[208:209], v234 offset:4096
    s_add_u32 m0, s26, 57344
    v_mfma_f32_32x32x16_bf16 v[112:127], v[196:199], a[132:135], v[112:127]
    ds_read_b64_tr_b16 v[210:211], v234 offset:5120
    buffer_load_dwordx4 v230, s[16:19], s36 offen lds
    s_waitcnt lgkmcnt(6)
    v_mfma_f32_32x32x16_bf16 v[128:143], v[200:203], a[128:131], v[128:143]
    ds_read_b64_tr_b16 v[212:213], v235 offset:4096
    s_add_u32 m0, s26, 61440
    v_mfma_f32_32x32x16_bf16 v[144:159], v[200:203], a[132:135], v[144:159]
    ds_read_b64_tr_b16 v[214:215], v235 offset:5120
    buffer_load_dwordx4 v231, s[16:19], s36 offen lds
    s_waitcnt lgkmcnt(6)
    v_mfma_f32_32x32x16_bf16 v[160:175], v[204:207], a[128:131], v[160:175]
    ds_read_b64_tr_b16 v[216:217], v236 offset:4096
    s_add_u32 s39, s39, 64
    s_add_u32 s36, s36, 262144
    v_mfma_f32_32x32x16_bf16 v[176:191], v[204:207], a[132:135], v[176:191]
    ds_read_b64_tr_b16 v[218:219], v236 offset:5120
    s_waitcnt lgkmcnt(4)
    v_mfma_f32_32x32x16_bf16 v[64:79], v[208:211], a[136:139], v[64:79]
    ds_read_b64_tr_b16 v[220:221], v237 offset:4096
    v_accvgpr_write_b32 a0, 0
    v_mfma_f32_32x32x16_bf16 v[80:95], v[208:211], a[140:143], v[80:95]
    s_waitcnt vmcnt(12)
    s_barrier
    v_add_u32 v238, 32768, v224
    v_add_u32 v239, 32768, v225
    v_add_u32 v240, 32768, v226
    v_add_u32 v241, 32768, v227
    ds_read_b64_tr_b16 v[222:223], v237 offset:5120
    v_accvgpr_write_b32 a1, 0
    s_waitcnt lgkmcnt(4)
    v_mfma_f32_32x32x16_bf16 v[96:111], v[212:215], a[136:139], v[96:111]
    ds_read_b128 a[144:147], v228 offset:16384
    ds_read_b128 a[148:151], v228 offset:18432
    ds_read_b64_tr_b16 v[192:193], v238 offset:0
    s_add_u32 m0, s38, 106496
    v_accvgpr_write_b32 a2, 0
    v_mfma_f32_32x32x16_bf16 v[112:127], v[212:215], a[140:143], v[112:127]
    ds_read_b64_tr_b16 v[194:195], v238 offset:1024
    buffer_load_dwordx4 v242, s[20:23], s39 offen lds
    v_accvgpr_write_b32 a3, 0
    s_waitcnt lgkmcnt(6)
    v_mfma_f32_32x32x16_bf16 v[128:143], v[216:219], a[136:139], v[128:143]
    ds_read_b64_tr_b16 v[196:197], v239 offset:0
    s_add_u32 m0, s38, 107520
    v_accvgpr_write_b32 a4, 0
    v_mfma_f32_32x32x16_bf16 v[144:159], v[216:219], a[140:143], v[144:159]
    ds_read_b64_tr_b16 v[198:199], v239 offset:1024
    buffer_load_dwordx4 v243, s[20:23], s39 offen lds
    v_accvgpr_write_b32 a5, 0
    s_waitcnt lgkmcnt(6)
    v_mfma_f32_32x32x16_bf16 v[160:175], v[220:223], a[136:139], v[160:175]
    ds_read_b64_tr_b16 v[200:201], v240 offset:0
    s_add_u32 m0, s38, 108544
    v_accvgpr_write_b32 a6, 0
    v_mfma_f32_32x32x16_bf16 v[176:191], v[220:223], a[140:143], v[176:191]
    ds_read_b64_tr_b16 v[202:203], v240 offset:1024
    buffer_load_dwordx4 v244, s[20:23], s39 offen lds
    v_accvgpr_write_b32 a7, 0
    s_waitcnt lgkmcnt(4)
    v_mfma_f32_32x32x16_bf16 v[64:79], v[192:195], a[144:147], v[64:79]
    ds_read_b64_tr_b16 v[204:205], v241 offset:0
    s_add_u32 m0, s38, 109568
    v_accvgpr_write_b32 a8, 0
    v_mfma_f32_32x32x16_bf16 v[80:95], v[192:195], a[148:151], v[80:95]
    ds_read_b64_tr_b16 v[206:207], v241 offset:1024
    buffer_load_dwordx4 v245, s[20:23], s39 offen lds
    v_accvgpr_write_b32 a9, 0
    s_waitcnt lgkmcnt(4)
    v_mfma_f32_32x32x16_bf16 v[96:111], v[196:199], a[144:147], v[96:111]
    ds_read_b128 a[152:155], v229 offset:16384
    ds_read_b128 a[156:159], v229 offset:18432
    ds_read_b64_tr_b16 v[208:209], v238 offset:4096
    s_add_u32 m0, s26, 122880
    v_accvgpr_write_b32 a10, 0
    v_mfma_f32_32x32x16_bf16 v[112:127], v[196:199], a[148:151], v[112:127]
    ds_read_b64_tr_b16 v[210:211], v238 offset:5120
    buffer_load_dwordx4 v230, s[16:19], s36 offen lds
    v_accvgpr_write_b32 a11, 0
    s_waitcnt lgkmcnt(6)
    v_mfma_f32_32x32x16_bf16 v[128:143], v[200:203], a[144:147], v[128:143]
    ds_read_b64_tr_b16 v[212:213], v239 offset:4096
    s_add_u32 m0, s26, 126976
    v_accvgpr_write_b32 a12, 0
    v_mfma_f32_32x32x16_bf16 v[144:159], v[200:203], a[148:151], v[144:159]
    ds_read_b64_tr_b16 v[214:215], v239 offset:5120
    buffer_load_dwordx4 v231, s[16:19], s36 offen lds
    v_accvgpr_write_b32 a13, 0
    s_waitcnt lgkmcnt(6)
    v_mfma_f32_32x32x16_bf16 v[160:175], v[204:207], a[144:147], v[160:175]
    ds_read_b64_tr_b16 v[216:217], v240 offset:4096
    s_add_u32 s39, s39, 64
    s_add_u32 s36, s36, 262144
    v_accvgpr_write_b32 a14, 0
    v_mfma_f32_32x32x16_bf16 v[176:191], v[204:207], a[148:151], v[176:191]
    ds_read_b64_tr_b16 v[218:219], v240 offset:5120
    v_accvgpr_write_b32 a15, 0
    s_waitcnt lgkmcnt(4)
    v_mfma_f32_32x32x16_bf16 v[64:79], v[208:211], a[152:155], v[64:79]
    ds_read_b64_tr_b16 v[220:221], v241 offset:4096
    v_accvgpr_write_b32 a16, 0
    v_mfma_f32_32x32x16_bf16 v[80:95], v[208:211], a[156:159], v[80:95]
    s_waitcnt vmcnt(12)
    s_barrier
    v_add_u32 v234, 98304, v224
    v_add_u32 v235, 98304, v225
    v_add_u32 v236, 98304, v226
    v_add_u32 v237, 98304, v227
    ds_read_b64_tr_b16 v[222:223], v241 offset:5120
    v_accvgpr_write_b32 a17, 0
    s_waitcnt lgkmcnt(4)
    v_mfma_f32_32x32x16_bf16 v[96:111], v[212:215], a[152:155], v[96:111]
    ds_read_b128 a[128:131], v246 offset:0
    ds_read_b128 a[132:135], v246 offset:2048
    ds_read_b64_tr_b16 v[192:193], v234 offset:0
    s_add_u32 m0, s38, 131072
    v_accvgpr_write_b32 a18, 0
    v_mfma_f32_32x32x16_bf16 v[112:127], v[212:215], a[156:159], v[112:127]
    ds_read_b64_tr_b16 v[194:195], v234 offset:1024
    buffer_load_dwordx4 v242, s[20:23], s39 offen lds
    v_accvgpr_write_b32 a19, 0
    s_waitcnt lgkmcnt(6)
    v_mfma_f32_32x32x16_bf16 v[128:143], v[216:219], a[152:155], v[128:143]
    ds_read_b64_tr_b16 v[196:197], v235 offset:0
    s_add_u32 m0, s38, 132096
    v_accvgpr_write_b32 a20, 0
    v_mfma_f32_32x32x16_bf16 v[144:159], v[216:219], a[156:159], v[144:159]
    ds_read_b64_tr_b16 v[198:199], v235 offset:1024
    buffer_load_dwordx4 v243, s[20:23], s39 offen lds
    v_accvgpr_write_b32 a21, 0
    s_waitcnt lgkmcnt(6)
    v_mfma_f32_32x32x16_bf16 v[160:175], v[220:223], a[152:155], v[160:175]
    ds_read_b64_tr_b16 v[200:201], v236 offset:0
    s_add_u32 m0, s38, 133120
    v_accvgpr_write_b32 a22, 0
    v_mfma_f32_32x32x16_bf16 v[176:191], v[220:223], a[156:159], v[176:191]
    ds_read_b64_tr_b16 v[202:203], v236 offset:1024
    buffer_load_dwordx4 v244, s[20:23], s39 offen lds
    v_accvgpr_write_b32 a23, 0
    s_waitcnt lgkmcnt(4)
    v_mfma_f32_32x32x16_bf16 v[64:79], v[192:195], a[128:131], v[64:79]
    ds_read_b64_tr_b16 v[204:205], v237 offset:0
    s_add_u32 m0, s38, 134144
    v_accvgpr_write_b32 a24, 0
    v_mfma_f32_32x32x16_bf16 v[80:95], v[192:195], a[132:135], v[80:95]
    ds_read_b64_tr_b16 v[206:207], v237 offset:1024
    buffer_load_dwordx4 v245, s[20:23], s39 offen lds
    v_accvgpr_write_b32 a25, 0
    s_waitcnt lgkmcnt(4)
    v_mfma_f32_32x32x16_bf16 v[96:111], v[196:199], a[128:131], v[96:111]
    ds_read_b128 a[136:139], v247 offset:0
    ds_read_b128 a[140:143], v247 offset:2048
    ds_read_b64_tr_b16 v[208:209], v234 offset:4096
    s_add_u32 m0, s26, 147456
    v_accvgpr_write_b32 a26, 0
    v_mfma_f32_32x32x16_bf16 v[112:127], v[196:199], a[132:135], v[112:127]
    ds_read_b64_tr_b16 v[210:211], v234 offset:5120
    buffer_load_dwordx4 v230, s[16:19], s36 offen lds
    v_accvgpr_write_b32 a27, 0
    s_waitcnt lgkmcnt(6)
    v_mfma_f32_32x32x16_bf16 v[128:143], v[200:203], a[128:131], v[128:143]
    ds_read_b64_tr_b16 v[212:213], v235 offset:4096
    s_add_u32 m0, s26, 151552
    v_accvgpr_write_b32 a28, 0
    v_mfma_f32_32x32x16_bf16 v[144:159], v[200:203], a[132:135], v[144:159]
    ds_read_b64_tr_b16 v[214:215], v235 offset:5120
    buffer_load_dwordx4 v231, s[16:19], s36 offen lds
    v_accvgpr_write_b32 a29, 0
    s_waitcnt lgkmcnt(6)
    v_mfma_f32_32x32x16_bf16 v[160:175], v[204:207], a[128:131], v[160:175]
    ds_read_b64_tr_b16 v[216:217], v236 offset:4096
    s_add_u32 s39, s39, 64
    s_add_u32 s36, s36, 262144
    v_accvgpr_write_b32 a30, 0
    v_mfma_f32_32x32x16_bf16 v[176:191], v[204:207], a[132:135], v[176:191]
    ds_read_b64_tr_b16 v[218:219], v236 offset:5120
    v_accvgpr_write_b32 a31, 0
    s_waitcnt lgkmcnt(4)
    v_mfma_f32_32x32x16_bf16 v[64:79], v[208:211], a[136:139], v[64:79]
    ds_read_b64_tr_b16 v[220:221], v237 offset:4096
    v_accvgpr_write_b32 a32, 0
    v_mfma_f32_32x32x16_bf16 v[80:95], v[208:211], a[140:143], v[80:95]
    s_waitcnt vmcnt(12)
    s_barrier
    v_add_u32 v238, 57344, v224
    v_add_u32 v239, 57344, v225
    v_add_u32 v240, 57344, v226
    v_add_u32 v241, 57344, v227
    ds_read_b64_tr_b16 v[222:223], v237 offset:5120
    v_accvgpr_write_b32 a33, 0
    s_waitcnt lgkmcnt(4)
    v_mfma_f32_32x32x16_bf16 v[96:111], v[212:215], a[136:139], v[96:111]
    ds_read_b128 a[144:147], v228 offset:40960
    ds_read_b128 a[148:151], v228 offset:43008
    ds_read_b64_tr_b16 v[192:193], v238 offset:0
    s_add_u32 m0, s38, 16384
    v_accvgpr_write_b32 a34, 0
    v_mfma_f32_32x32x16_bf16 v[112:127], v[212:215], a[140:143], v[112:127]
    ds_read_b64_tr_b16 v[194:195], v238 offset:1024
    buffer_load_dwordx4 v242, s[20:23], s39 offen lds
    v_accvgpr_write_b32 a35, 0
    s_waitcnt lgkmcnt(6)
    v_mfma_f32_32x32x16_bf16 v[128:143], v[216:219], a[136:139], v[128:143]
    ds_read_b64_tr_b16 v[196:197], v239 offset:0
    s_add_u32 m0, s38, 17408
    v_accvgpr_write_b32 a36, 0
    v_mfma_f32_32x32x16_bf16 v[144:159], v[216:219], a[140:143], v[144:159]
    ds_read_b64_tr_b16 v[198:199], v239 offset:1024
    buffer_load_dwordx4 v243, s[20:23], s39 offen lds
    v_accvgpr_write_b32 a37, 0
    s_waitcnt lgkmcnt(6)
    v_mfma_f32_32x32x16_bf16 v[160:175], v[220:223], a[136:139], v[160:175]
    ds_read_b64_tr_b16 v[200:201], v240 offset:0
    s_add_u32 m0, s38, 18432
    v_accvgpr_write_b32 a38, 0
    v_mfma_f32_32x32x16_bf16 v[176:191], v[220:223], a[140:143], v[176:191]
    ds_read_b64_tr_b16 v[202:203], v240 offset:1024
    buffer_load_dwordx4 v244, s[20:23], s39 offen lds
    v_accvgpr_write_b32 a39, 0
    s_waitcnt lgkmcnt(4)
    v_mfma_f32_32x32x16_bf16 v[64:79], v[192:195], a[144:147], v[64:79]
    ds_read_b64_tr_b16 v[204:205], v241 offset:0
    s_add_u32 m0, s38, 19456
    v_accvgpr_write_b32 a40, 0
    v_mfma_f32_32x32x16_bf16 v[80:95], v[192:195], a[148:151], v[80:95]
    ds_read_b64_tr_b16 v[206:207], v241 offset:1024
    buffer_load_dwordx4 v245, s[20:23], s39 offen lds
    v_accvgpr_write_b32 a41, 0
    s_waitcnt lgkmcnt(4)
    v_mfma_f32_32x32x16_bf16 v[96:111], v[196:199], a[144:147], v[96:111]
    ds_read_b128 a[152:155], v229 offset:40960
    ds_read_b128 a[156:159], v229 offset:43008
    ds_read_b64_tr_b16 v[208:209], v238 offset:4096
    s_add_u32 m0, s26, 32768
    v_accvgpr_write_b32 a42, 0
    v_mfma_f32_32x32x16_bf16 v[112:127], v[196:199], a[148:151], v[112:127]
    ds_read_b64_tr_b16 v[210:211], v238 offset:5120
    buffer_load_dwordx4 v230, s[16:19], s36 offen lds
    v_accvgpr_write_b32 a43, 0
    s_waitcnt lgkmcnt(6)
    v_mfma_f32_32x32x16_bf16 v[128:143], v[200:203], a[144:147], v[128:143]
    ds_read_b64_tr_b16 v[212:213], v239 offset:4096
    s_add_u32 m0, s26, 36864
    v_accvgpr_write_b32 a44, 0
    v_mfma_f32_32x32x16_bf16 v[144:159], v[200:203], a[148:151], v[144:159]
    ds_read_b64_tr_b16 v[214:215], v239 offset:5120
    buffer_load_dwordx4 v231, s[16:19], s36 offen lds
    v_accvgpr_write_b32 a45, 0
    s_waitcnt lgkmcnt(6)
    v_mfma_f32_32x32x16_bf16 v[160:175], v[204:207], a[144:147], v[160:175]
    ds_read_b64_tr_b16 v[216:217], v240 offset:4096
    s_add_u32 s39, s39, 64
    s_add_u32 s36, s36, 262144
    v_accvgpr_write_b32 a46, 0
    v_mfma_f32_32x32x16_bf16 v[176:191], v[204:207], a[148:151], v[176:191]
    ds_read_b64_tr_b16 v[218:219], v240 offset:5120
    v_accvgpr_write_b32 a47, 0
    s_waitcnt lgkmcnt(4)
    v_mfma_f32_32x32x16_bf16 v[64:79], v[208:211], a[152:155], v[64:79]
    ds_read_b64_tr_b16 v[220:221], v241 offset:4096
    v_accvgpr_write_b32 a48, 0
    v_mfma_f32_32x32x16_bf16 v[80:95], v[208:211], a[156:159], v[80:95]
    s_waitcnt vmcnt(12)
    s_barrier
    v_add_u32 v234, 122880, v224
    v_add_u32 v235, 122880, v225
    v_add_u32 v236, 122880, v226
    v_add_u32 v237, 122880, v227
    ds_read_b64_tr_b16 v[222:223], v241 offset:5120
    v_accvgpr_write_b32 a49, 0
    s_waitcnt lgkmcnt(4)
    v_mfma_f32_32x32x16_bf16 v[96:111], v[212:215], a[152:155], v[96:111]
    ds_read_b128 a[128:131], v246 offset:24576
    ds_read_b128 a[132:135], v246 offset:26624
    ds_read_b64_tr_b16 v[192:193], v234 offset:0
    s_add_u32 m0, s38, 81920
    v_accvgpr_write_b32 a50, 0
    v_mfma_f32_32x32x16_bf16 v[112:127], v[212:215], a[156:159], v[112:127]
    ds_read_b64_tr_b16 v[194:195], v234 offset:1024
    buffer_load_dwordx4 v242, s[20:23], s39 offen lds
    v_accvgpr_write_b32 a51, 0
    s_waitcnt lgkmcnt(6)
    v_mfma_f32_32x32x16_bf16 v[128:143], v[216:219], a[152:155], v[128:143]
    ds_read_b64_tr_b16 v[196:197], v235 offset:0
    s_add_u32 m0, s38, 82944
    v_accvgpr_write_b32 a52, 0
    v_mfma_f32_32x32x16_bf16 v[144:159], v[216:219], a[156:159], v[144:159]
    ds_read_b64_tr_b16 v[198:199], v235 offset:1024
    buffer_load_dwordx4 v243, s[20:23], s39 offen lds
    v_accvgpr_write_b32 a53, 0
    s_waitcnt lgkmcnt(6)
    v_mfma_f32_32x32x16_bf16 v[160:175], v[220:223], a[152:155], v[160:175]
    ds_read_b64_tr_b16 v[200:201], v236 offset:0
    s_add_u32 m0, s38, 83968
    v_accvgpr_write_b32 a54, 0
    v_mfma_f32_32x32x16_bf16 v[176:191], v[220:223], a[156:159], v[176:191]
    ds_read_b64_tr_b16 v[202:203], v236 offset:1024
    buffer_load_dwordx4 v244, s[20:23], s39 offen lds
    v_accvgpr_write_b32 a55, 0
    s_waitcnt lgkmcnt(4)
    v_mfma_f32_32x32x16_bf16 v[64:79], v[192:195], a[128:131], v[64:79]
    ds_read_b64_tr_b16 v[204:205], v237 offset:0
    s_add_u32 m0, s38, 84992
    v_accvgpr_write_b32 a56, 0
    v_mfma_f32_32x32x16_bf16 v[80:95], v[192:195], a[132:135], v[80:95]
    ds_read_b64_tr_b16 v[206:207], v237 offset:1024
    buffer_load_dwordx4 v245, s[20:23], s39 offen lds
    v_accvgpr_write_b32 a57, 0
    s_waitcnt lgkmcnt(4)
    v_mfma_f32_32x32x16_bf16 v[96:111], v[196:199], a[128:131], v[96:111]
    ds_read_b128 a[136:139], v247 offset:24576
    ds_read_b128 a[140:143], v247 offset:26624
    ds_read_b64_tr_b16 v[208:209], v234 offset:4096
    s_add_u32 m0, s26, 98304
    v_accvgpr_write_b32 a58, 0
    v_mfma_f32_32x32x16_bf16 v[112:127], v[196:199], a[132:135], v[112:127]
    ds_read_b64_tr_b16 v[210:211], v234 offset:5120
    buffer_load_dwordx4 v230, s[16:19], s36 offen lds
    v_accvgpr_write_b32 a59, 0
    s_waitcnt lgkmcnt(6)
    v_mfma_f32_32x32x16_bf16 v[128:143], v[200:203], a[128:131], v[128:143]
    ds_read_b64_tr_b16 v[212:213], v235 offset:4096
    s_add_u32 m0, s26, 102400
    v_accvgpr_write_b32 a60, 0
    v_mfma_f32_32x32x16_bf16 v[144:159], v[200:203], a[132:135], v[144:159]
    ds_read_b64_tr_b16 v[214:215], v235 offset:5120
    buffer_load_dwordx4 v231, s[16:19], s36 offen lds
    v_accvgpr_write_b32 a61, 0
    s_waitcnt lgkmcnt(6)
    v_mfma_f32_32x32x16_bf16 v[160:175], v[204:207], a[128:131], v[160:175]
    ds_read_b64_tr_b16 v[216:217], v236 offset:4096
    s_add_u32 s39, s39, 64
    s_add_u32 s36, s36, 262144
    v_accvgpr_write_b32 a62, 0
    v_mfma_f32_32x32x16_bf16 v[176:191], v[204:207], a[132:135], v[176:191]
    ds_read_b64_tr_b16 v[218:219], v236 offset:5120
    v_accvgpr_write_b32 a63, 0
    s_waitcnt lgkmcnt(4)
    v_mfma_f32_32x32x16_bf16 v[64:79], v[208:211], a[136:139], v[64:79]
    ds_read_b64_tr_b16 v[220:221], v237 offset:4096
    v_accvgpr_write_b32 a64, 0
    v_mfma_f32_32x32x16_bf16 v[80:95], v[208:211], a[140:143], v[80:95]
    s_waitcnt vmcnt(12)
    s_barrier
    v_add_u32 v238, 147456, v224
    v_add_u32 v239, 147456, v225
    v_add_u32 v240, 147456, v226
    v_add_u32 v241, 147456, v227
    ds_read_b64_tr_b16 v[222:223], v237 offset:5120
    v_accvgpr_write_b32 a65, 0
    s_waitcnt lgkmcnt(4)
    v_mfma_f32_32x32x16_bf16 v[96:111], v[212:215], a[136:139], v[96:111]
    ds_read_b128 a[144:147], v246 offset:49152
    ds_read_b128 a[148:151], v246 offset:51200
    ds_read_b64_tr_b16 v[192:193], v238 offset:0
    s_add_u32 m0, s38, 40960
    v_accvgpr_write_b32 a66, 0
    v_mfma_f32_32x32x16_bf16 v[112:127], v[212:215], a[140:143], v[112:127]
    ds_read_b64_tr_b16 v[194:195], v238 offset:1024
    buffer_load_dwordx4 v242, s[20:23], s39 offen lds
    v_accvgpr_write_b32 a67, 0
    s_waitcnt lgkmcnt(6)
    v_mfma_f32_32x32x16_bf16 v[128:143], v[216:219], a[136:139], v[128:143]
    ds_read_b64_tr_b16 v[196:197], v239 offset:0
    s_add_u32 m0, s38, 41984
    v_accvgpr_write_b32 a68, 0
    v_mfma_f32_32x32x16_bf16 v[144:159], v[216:219], a[140:143], v[144:159]
    ds_read_b64_tr_b16 v[198:199], v239 offset:1024
    buffer_load_dwordx4 v243, s[20:23], s39 offen lds
    v_accvgpr_write_b32 a69, 0
    s_waitcnt lgkmcnt(6)
    v_mfma_f32_32x32x16_bf16 v[160:175], v[220:223], a[136:139], v[160:175]
    ds_read_b64_tr_b16 v[200:201], v240 offset:0
    s_add_u32 m0, s38, 43008
    v_accvgpr_write_b32 a70, 0
    v_mfma_f32_32x32x16_bf16 v[176:191], v[220:223], a[140:143], v[176:191]
    ds_read_b64_tr_b16 v[202:203], v240 offset:1024
    buffer_load_dwordx4 v244, s[20:23], s39 offen lds
    v_accvgpr_write_b32 a71, 0
    s_waitcnt lgkmcnt(4)
    v_mfma_f32_32x32x16_bf16 v[64:79], v[192:195], a[144:147], v[64:79]
    ds_read_b64_tr_b16 v[204:205], v241 offset:0
    s_add_u32 m0, s38, 44032
    v_accvgpr_write_b32 a72, 0
    v_mfma_f32_32x32x16_bf16 v[80:95], v[192:195], a[148:151], v[80:95]
    ds_read_b64_tr_b16 v[206:207], v241 offset:1024
    buffer_load_dwordx4 v245, s[20:23], s39 offen lds
    v_accvgpr_write_b32 a73, 0
    s_waitcnt lgkmcnt(4)
    v_mfma_f32_32x32x16_bf16 v[96:111], v[196:199], a[144:147], v[96:111]
    ds_read_b128 a[152:155], v247 offset:49152
    ds_read_b128 a[156:159], v247 offset:51200
    ds_read_b64_tr_b16 v[208:209], v238 offset:4096
    s_add_u32 m0, s26, 57344
    v_accvgpr_write_b32 a74, 0
    v_mfma_f32_32x32x16_bf16 v[112:127], v[196:199], a[148:151], v[112:127]
    ds_read_b64_tr_b16 v[210:211], v238 offset:5120
    buffer_load_dwordx4 v230, s[16:19], s36 offen lds
    v_accvgpr_write_b32 a75, 0
    s_waitcnt lgkmcnt(6)
    v_mfma_f32_32x32x16_bf16 v[128:143], v[200:203], a[144:147], v[128:143]
    ds_read_b64_tr_b16 v[212:213], v239 offset:4096
    s_add_u32 m0, s26, 61440
    v_accvgpr_write_b32 a76, 0
    v_mfma_f32_32x32x16_bf16 v[144:159], v[200:203], a[148:151], v[144:159]
    ds_read_b64_tr_b16 v[214:215], v239 offset:5120
    buffer_load_dwordx4 v231, s[16:19], s36 offen lds
    v_accvgpr_write_b32 a77, 0
    s_waitcnt lgkmcnt(6)
    v_mfma_f32_32x32x16_bf16 v[160:175], v[204:207], a[144:147], v[160:175]
    ds_read_b64_tr_b16 v[216:217], v240 offset:4096
    s_add_u32 s39, s39, 64
    s_add_u32 s36, s36, 262144
    v_accvgpr_write_b32 a78, 0
    v_mfma_f32_32x32x16_bf16 v[176:191], v[204:207], a[148:151], v[176:191]
    ds_read_b64_tr_b16 v[218:219], v240 offset:5120
    v_accvgpr_write_b32 a79, 0
    s_waitcnt lgkmcnt(4)
    v_mfma_f32_32x32x16_bf16 v[64:79], v[208:211], a[152:155], v[64:79]
    ds_read_b64_tr_b16 v[220:221], v241 offset:4096
    v_accvgpr_write_b32 a80, 0
    v_mfma_f32_32x32x16_bf16 v[80:95], v[208:211], a[156:159], v[80:95]
    s_waitcnt vmcnt(12)
    s_barrier
    v_add_u32 v234, 32768, v224
    v_add_u32 v235, 32768, v225
    v_add_u32 v236, 32768, v226
    v_add_u32 v237, 32768, v227
    ds_read_b64_tr_b16 v[222:223], v241 offset:5120
    v_accvgpr_write_b32 a81, 0
    s_waitcnt lgkmcnt(4)
    v_mfma_f32_32x32x16_bf16 v[96:111], v[212:215], a[152:155], v[96:111]
    ds_read_b128 a[128:131], v228 offset:16384
    ds_read_b128 a[132:135], v228 offset:18432
    ds_read_b64_tr_b16 v[192:193], v234 offset:0
    s_add_u32 m0, s38, 106496
    v_accvgpr_write_b32 a82, 0
    v_mfma_f32_32x32x16_bf16 v[112:127], v[212:215], a[156:159], v[112:127]
    ds_read_b64_tr_b16 v[194:195], v234 offset:1024
    buffer_load_dwordx4 v242, s[20:23], s39 offen lds
    v_accvgpr_write_b32 a83, 0
    s_waitcnt lgkmcnt(6)
    v_mfma_f32_32x32x16_bf16 v[128:143], v[216:219], a[152:155], v[128:143]
    ds_read_b64_tr_b16 v[196:197], v235 offset:0
    s_add_u32 m0, s38, 107520
    v_accvgpr_write_b32 a84, 0
    v_mfma_f32_32x32x16_bf16 v[144:159], v[216:219], a[156:159], v[144:159]
    ds_read_b64_tr_b16 v[198:199], v235 offset:1024
    buffer_load_dwordx4 v243, s[20:23], s39 offen lds
    v_accvgpr_write_b32 a85, 0
    s_waitcnt lgkmcnt(6)
    v_mfma_f32_32x32x16_bf16 v[160:175], v[220:223], a[152:155], v[160:175]
    ds_read_b64_tr_b16 v[200:201], v236 offset:0
    s_add_u32 m0, s38, 108544
    v_accvgpr_write_b32 a86, 0
    v_mfma_f32_32x32x16_bf16 v[176:191], v[220:223], a[156:159], v[176:191]
    ds_read_b64_tr_b16 v[202:203], v236 offset:1024
    buffer_load_dwordx4 v244, s[20:23], s39 offen lds
    v_accvgpr_write_b32 a87, 0
    s_waitcnt lgkmcnt(4)
    v_mfma_f32_32x32x16_bf16 v[64:79], v[192:195], a[128:131], v[64:79]
    ds_read_b64_tr_b16 v[204:205], v237 offset:0
    s_add_u32 m0, s38, 109568
    v_accvgpr_write_b32 a88, 0
    v_mfma_f32_32x32x16_bf16 v[80:95], v[192:195], a[132:135], v[80:95]
    ds_read_b64_tr_b16 v[206:207], v237 offset:1024
    buffer_load_dwordx4 v245, s[20:23], s39 offen lds
    v_accvgpr_write_b32 a89, 0
    s_waitcnt lgkmcnt(4)
    v_mfma_f32_32x32x16_bf16 v[96:111], v[196:199], a[128:131], v[96:111]
    ds_read_b128 a[136:139], v229 offset:16384
    ds_read_b128 a[140:143], v229 offset:18432
    ds_read_b64_tr_b16 v[208:209], v234 offset:4096
    s_add_u32 m0, s26, 122880
    v_accvgpr_write_b32 a90, 0
    v_mfma_f32_32x32x16_bf16 v[112:127], v[196:199], a[132:135], v[112:127]
    ds_read_b64_tr_b16 v[210:211], v234 offset:5120
    buffer_load_dwordx4 v230, s[16:19], s36 offen lds
    v_accvgpr_write_b32 a91, 0
    s_waitcnt lgkmcnt(6)
    v_mfma_f32_32x32x16_bf16 v[128:143], v[200:203], a[128:131], v[128:143]
    ds_read_b64_tr_b16 v[212:213], v235 offset:4096
    s_add_u32 m0, s26, 126976
    v_accvgpr_write_b32 a92, 0
    v_mfma_f32_32x32x16_bf16 v[144:159], v[200:203], a[132:135], v[144:159]
    ds_read_b64_tr_b16 v[214:215], v235 offset:5120
    buffer_load_dwordx4 v231, s[16:19], s36 offen lds
    v_accvgpr_write_b32 a93, 0
    s_waitcnt lgkmcnt(6)
    v_mfma_f32_32x32x16_bf16 v[160:175], v[204:207], a[128:131], v[160:175]
    ds_read_b64_tr_b16 v[216:217], v236 offset:4096
    s_add_u32 s39, s39, 64
    s_add_u32 s36, s36, 262144
    v_accvgpr_write_b32 a94, 0
    v_mfma_f32_32x32x16_bf16 v[176:191], v[204:207], a[132:135], v[176:191]
    ds_read_b64_tr_b16 v[218:219], v236 offset:5120
    v_accvgpr_write_b32 a95, 0
    s_waitcnt lgkmcnt(4)
    v_mfma_f32_32x32x16_bf16 v[64:79], v[208:211], a[136:139], v[64:79]
    ds_read_b64_tr_b16 v[220:221], v237 offset:4096
    v_accvgpr_write_b32 a96, 0
    v_mfma_f32_32x32x16_bf16 v[80:95], v[208:211], a[140:143], v[80:95]
    s_waitcnt vmcnt(12)
    s_barrier
    v_add_u32 v238, 98304, v224
    v_add_u32 v239, 98304, v225
    v_add_u32 v240, 98304, v226
    v_add_u32 v241, 98304, v227
    ds_read_b64_tr_b16 v[222:223], v237 offset:5120
    v_accvgpr_write_b32 a97, 0
    s_waitcnt lgkmcnt(4)
    v_mfma_f32_32x32x16_bf16 v[96:111], v[212:215], a[136:139], v[96:111]
    ds_read_b128 a[144:147], v246 offset:0
    ds_read_b128 a[148:151], v246 offset:2048
    ds_read_b64_tr_b16 v[192:193], v238 offset:0
    s_add_u32 m0, s38, 131072
    v_accvgpr_write_b32 a98, 0
    v_mfma_f32_32x32x16_bf16 v[112:127], v[212:215], a[140:143], v[112:127]
    ds_read_b64_tr_b16 v[194:195], v238 offset:1024
    buffer_load_dwordx4 v242, s[20:23], s39 offen lds
    v_accvgpr_write_b32 a99, 0
    s_waitcnt lgkmcnt(6)
    v_mfma_f32_32x32x16_bf16 v[128:143], v[216:219], a[136:139], v[128:143]
    ds_read_b64_tr_b16 v[196:197], v239 offset:0
    s_add_u32 m0, s38, 132096
    v_accvgpr_write_b32 a100, 0
    v_mfma_f32_32x32x16_bf16 v[144:159], v[216:219], a[140:143], v[144:159]
    ds_read_b64_tr_b16 v[198:199], v239 offset:1024
    buffer_load_dwordx4 v243, s[20:23], s39 offen lds
    v_accvgpr_write_b32 a101, 0
    s_waitcnt lgkmcnt(6)
    v_mfma_f32_32x32x16_bf16 v[160:175], v[220:223], a[136:139], v[160:175]
    ds_read_b64_tr_b16 v[200:201], v240 offset:0
    s_add_u32 m0, s38, 133120
    v_accvgpr_write_b32 a102, 0
    v_mfma_f32_32x32x16_bf16 v[176:191], v[220:223], a[140:143], v[176:191]
    ds_read_b64_tr_b16 v[202:203], v240 offset:1024
    buffer_load_dwordx4 v244, s[20:23], s39 offen lds
    v_accvgpr_write_b32 a103, 0
    s_waitcnt lgkmcnt(4)
    v_mfma_f32_32x32x16_bf16 v[64:79], v[192:195], a[144:147], v[64:79]
    ds_read_b64_tr_b16 v[204:205], v241 offset:0
    s_add_u32 m0, s38, 134144
    v_accvgpr_write_b32 a104, 0
    v_mfma_f32_32x32x16_bf16 v[80:95], v[192:195], a[148:151], v[80:95]
    ds_read_b64_tr_b16 v[206:207], v241 offset:1024
    buffer_load_dwordx4 v245, s[20:23], s39 offen lds
    v_accvgpr_write_b32 a105, 0
    s_waitcnt lgkmcnt(4)
    v_mfma_f32_32x32x16_bf16 v[96:111], v[196:199], a[144:147], v[96:111]
    ds_read_b128 a[152:155], v247 offset:0
    ds_read_b128 a[156:159], v247 offset:2048
    ds_read_b64_tr_b16 v[208:209], v238 offset:4096
    s_add_u32 m0, s26, 147456
    v_accvgpr_write_b32 a106, 0
    v_mfma_f32_32x32x16_bf16 v[112:127], v[196:199], a[148:151], v[112:127]
    ds_read_b64_tr_b16 v[210:211], v238 offset:5120
    buffer_load_dwordx4 v230, s[16:19], s36 offen lds
    v_accvgpr_write_b32 a107, 0
    s_waitcnt lgkmcnt(6)
    v_mfma_f32_32x32x16_bf16 v[128:143], v[200:203], a[144:147], v[128:143]
    ds_read_b64_tr_b16 v[212:213], v239 offset:4096
    s_add_u32 m0, s26, 151552
    v_accvgpr_write_b32 a108, 0
    v_mfma_f32_32x32x16_bf16 v[144:159], v[200:203], a[148:151], v[144:159]
    ds_read_b64_tr_b16 v[214:215], v239 offset:5120
    buffer_load_dwordx4 v231, s[16:19], s36 offen lds
    v_accvgpr_write_b32 a109, 0
    s_waitcnt lgkmcnt(6)
    v_mfma_f32_32x32x16_bf16 v[160:175], v[204:207], a[144:147], v[160:175]
    ds_read_b64_tr_b16 v[216:217], v240 offset:4096
    s_add_u32 s39, s39, 64
    s_add_u32 s36, s36, 262144
    v_accvgpr_write_b32 a110, 0
    v_mfma_f32_32x32x16_bf16 v[176:191], v[204:207], a[148:151], v[176:191]
    ds_read_b64_tr_b16 v[218:219], v240 offset:5120
    v_accvgpr_write_b32 a111, 0
    s_waitcnt lgkmcnt(4)
    v_mfma_f32_32x32x16_bf16 v[64:79], v[208:211], a[152:155], v[64:79]
    ds_read_b64_tr_b16 v[220:221], v241 offset:4096
    v_accvgpr_write_b32 a112, 0
    v_mfma_f32_32x32x16_bf16 v[80:95], v[208:211], a[156:159], v[80:95]
    s_waitcnt vmcnt(12)
    s_barrier
    v_add_u32 v234, 57344, v224
    v_add_u32 v235, 57344, v225
    v_add_u32 v236, 57344, v226
    v_add_u32 v237, 57344, v227
    ds_read_b64_tr_b16 v[222:223], v241 offset:5120
    v_accvgpr_write_b32 a113, 0
    s_waitcnt lgkmcnt(4)
    v_mfma_f32_32x32x16_bf16 v[96:111], v[212:215], a[152:155], v[96:111]
    ds_read_b128 a[128:131], v228 offset:40960
    ds_read_b128 a[132:135], v228 offset:43008
    ds_read_b64_tr_b16 v[192:193], v234 offset:0
    s_add_u32 m0, s38, 16384
    v_accvgpr_write_b32 a114, 0
    v_mfma_f32_32x32x16_bf16 v[112:127], v[212:215], a[156:159], v[112:127]
    ds_read_b64_tr_b16 v[194:195], v234 offset:1024
    buffer_load_dwordx4 v242, s[20:23], s39 offen lds
    v_accvgpr_write_b32 a115, 0
    s_waitcnt lgkmcnt(6)
    v_mfma_f32_32x32x16_bf16 v[128:143], v[216:219], a[152:155], v[128:143]
    ds_read_b64_tr_b16 v[196:197], v235 offset:0
    s_add_u32 m0, s38, 17408
    v_accvgpr_write_b32 a116, 0
    v_mfma_f32_32x32x16_bf16 v[144:159], v[216:219], a[156:159], v[144:159]
    ds_read_b64_tr_b16 v[198:199], v235 offset:1024
    buffer_load_dwordx4 v243, s[20:23], s39 offen lds
    v_accvgpr_write_b32 a117, 0
    s_waitcnt lgkmcnt(6)
    v_mfma_f32_32x32x16_bf16 v[160:175], v[220:223], a[152:155], v[160:175]
    ds_read_b64_tr_b16 v[200:201], v236 offset:0
    s_add_u32 m0, s38, 18432
    v_accvgpr_write_b32 a118, 0
    v_mfma_f32_32x32x16_bf16 v[176:191], v[220:223], a[156:159], v[176:191]
    ds_read_b64_tr_b16 v[202:203], v236 offset:1024
    buffer_load_dwordx4 v244, s[20:23], s39 offen lds
    v_accvgpr_write_b32 a119, 0
    s_waitcnt lgkmcnt(4)
    v_mfma_f32_32x32x16_bf16 v[64:79], v[192:195], a[128:131], v[64:79]
    ds_read_b64_tr_b16 v[204:205], v237 offset:0
    s_add_u32 m0, s38, 19456
    v_accvgpr_write_b32 a120, 0
    v_mfma_f32_32x32x16_bf16 v[80:95], v[192:195], a[132:135], v[80:95]
    ds_read_b64_tr_b16 v[206:207], v237 offset:1024
    buffer_load_dwordx4 v245, s[20:23], s39 offen lds
    v_accvgpr_write_b32 a121, 0
    s_waitcnt lgkmcnt(4)
    v_mfma_f32_32x32x16_bf16 v[96:111], v[196:199], a[128:131], v[96:111]
    ds_read_b128 a[136:139], v229 offset:40960
    ds_read_b128 a[140:143], v229 offset:43008
    ds_read_b64_tr_b16 v[208:209], v234 offset:4096
    s_add_u32 m0, s26, 32768
    v_accvgpr_write_b32 a122, 0
    v_mfma_f32_32x32x16_bf16 v[112:127], v[196:199], a[132:135], v[112:127]
    ds_read_b64_tr_b16 v[210:211], v234 offset:5120
    buffer_load_dwordx4 v230, s[16:19], s36 offen lds
    v_accvgpr_write_b32 a123, 0
    s_waitcnt lgkmcnt(6)
    v_mfma_f32_32x32x16_bf16 v[128:143], v[200:203], a[128:131], v[128:143]
    ds_read_b64_tr_b16 v[212:213], v235 offset:4096
    s_add_u32 m0, s26, 36864
    v_accvgpr_write_b32 a124, 0
    v_mfma_f32_32x32x16_bf16 v[144:159], v[200:203], a[132:135], v[144:159]
    ds_read_b64_tr_b16 v[214:215], v235 offset:5120
    buffer_load_dwordx4 v231, s[16:19], s36 offen lds
    v_accvgpr_write_b32 a125, 0
    s_waitcnt lgkmcnt(6)
    v_mfma_f32_32x32x16_bf16 v[160:175], v[204:207], a[128:131], v[160:175]
    ds_read_b64_tr_b16 v[216:217], v236 offset:4096
    s_add_u32 s39, s39, 64
    s_add_u32 s36, s36, 262144
    v_accvgpr_write_b32 a126, 0
    v_mfma_f32_32x32x16_bf16 v[176:191], v[204:207], a[132:135], v[176:191]
    ds_read_b64_tr_b16 v[218:219], v236 offset:5120
    v_accvgpr_write_b32 a127, 0
    s_waitcnt lgkmcnt(4)
    v_mfma_f32_32x32x16_bf16 v[64:79], v[208:211], a[136:139], v[64:79]
    ds_read_b64_tr_b16 v[220:221], v237 offset:4096
    v_mfma_f32_32x32x16_bf16 v[80:95], v[208:211], a[140:143], v[80:95]
    s_waitcnt vmcnt(12)
    s_barrier
    v_add_u32 v238, 122880, v224
    v_add_u32 v239, 122880, v225
    v_add_u32 v240, 122880, v226
    v_add_u32 v241, 122880, v227
    ds_read_b64_tr_b16 v[222:223], v237 offset:5120
    s_waitcnt lgkmcnt(4)
    v_mfma_f32_32x32x16_bf16 v[96:111], v[212:215], a[136:139], v[96:111]
    ds_read_b128 a[144:147], v246 offset:24576
    ds_read_b128 a[148:151], v246 offset:26624
    ds_read_b64_tr_b16 v[192:193], v238 offset:0
    s_add_u32 m0, s38, 81920
    v_mfma_f32_32x32x16_bf16 v[112:127], v[212:215], a[140:143], v[112:127]
    ds_read_b64_tr_b16 v[194:195], v238 offset:1024
    buffer_load_dwordx4 v242, s[20:23], s39 offen lds
    s_waitcnt lgkmcnt(6)
    v_mfma_f32_32x32x16_bf16 v[128:143], v[216:219], a[136:139], v[128:143]
    ds_read_b64_tr_b16 v[196:197], v239 offset:0
    s_add_u32 m0, s38, 82944
    v_mfma_f32_32x32x16_bf16 v[144:159], v[216:219], a[140:143], v[144:159]
    ds_read_b64_tr_b16 v[198:199], v239 offset:1024
    buffer_load_dwordx4 v243, s[20:23], s39 offen lds
    s_waitcnt lgkmcnt(6)
    v_mfma_f32_32x32x16_bf16 v[160:175], v[220:223], a[136:139], v[160:175]
    ds_read_b64_tr_b16 v[200:201], v240 offset:0
    s_add_u32 m0, s38, 83968
    v_mfma_f32_32x32x16_bf16 v[176:191], v[220:223], a[140:143], v[176:191]
    ds_read_b64_tr_b16 v[202:203], v240 offset:1024
    buffer_load_dwordx4 v244, s[20:23], s39 offen lds
    s_waitcnt lgkmcnt(4)
    v_mfma_f32_32x32x16_bf16 v[64:79], v[192:195], a[144:147], v[64:79]
    ds_read_b64_tr_b16 v[204:205], v241 offset:0
    s_add_u32 m0, s38, 84992
    v_mfma_f32_32x32x16_bf16 v[80:95], v[192:195], a[148:151], v[80:95]
    ds_read_b64_tr_b16 v[206:207], v241 offset:1024
    buffer_load_dwordx4 v245, s[20:23], s39 offen lds
    s_waitcnt lgkmcnt(4)
    v_mfma_f32_32x32x16_bf16 v[96:111], v[196:199], a[144:147], v[96:111]
    ds_read_b128 a[152:155], v247 offset:24576
    ds_read_b128 a[156:159], v247 offset:26624
    ds_read_b64_tr_b16 v[208:209], v238 offset:4096
    s_add_u32 m0, s26, 98304
    v_mfma_f32_32x32x16_bf16 v[112:127], v[196:199], a[148:151], v[112:127]
    ds_read_b64_tr_b16 v[210:211], v238 offset:5120
    buffer_load_dwordx4 v230, s[16:19], s36 offen lds
    s_waitcnt lgkmcnt(6)
    v_mfma_f32_32x32x16_bf16 v[128:143], v[200:203], a[144:147], v[128:143]
    ds_read_b64_tr_b16 v[212:213], v239 offset:4096
    s_add_u32 m0, s26, 102400
    v_mfma_f32_32x32x16_bf16 v[144:159], v[200:203], a[148:151], v[144:159]
    ds_read_b64_tr_b16 v[214:215], v239 offset:5120
    buffer_load_dwordx4 v231, s[16:19], s36 offen lds
    s_waitcnt lgkmcnt(6)
    v_mfma_f32_32x32x16_bf16 v[160:175], v[204:207], a[144:147], v[160:175]
    ds_read_b64_tr_b16 v[216:217], v240 offset:4096
    s_add_u32 s39, s39, 64
    s_add_u32 s36, s36, 262144
    v_mfma_f32_32x32x16_bf16 v[176:191], v[204:207], a[148:151], v[176:191]
    ds_read_b64_tr_b16 v[218:219], v240 offset:5120
    s_waitcnt lgkmcnt(4)
    v_mfma_f32_32x32x16_bf16 v[64:79], v[208:211], a[152:155], v[64:79]
    ds_read_b64_tr_b16 v[220:221], v241 offset:4096
    v_mfma_f32_32x32x16_bf16 v[80:95], v[208:211], a[156:159], v[80:95]
    s_waitcnt vmcnt(12)
    s_barrier
    v_add_u32 v234, 147456, v224
    v_add_u32 v235, 147456, v225
    v_add_u32 v236, 147456, v226
    v_add_u32 v237, 147456, v227
    ds_read_b64_tr_b16 v[222:223], v241 offset:5120
    s_waitcnt lgkmcnt(4)
    v_mfma_f32_32x32x16_bf16 v[96:111], v[212:215], a[152:155], v[96:111]
    ds_read_b128 a[128:131], v246 offset:49152
    ds_read_b128 a[132:135], v246 offset:51200
    ds_read_b64_tr_b16 v[192:193], v234 offset:0
    s_add_u32 m0, s38, 40960
    v_mfma_f32_32x32x16_bf16 v[112:127], v[212:215], a[156:159], v[112:127]
    ds_read_b64_tr_b16 v[194:195], v234 offset:1024
    buffer_load_dwordx4 v242, s[20:23], s39 offen lds
    s_waitcnt lgkmcnt(6)
    v_mfma_f32_32x32x16_bf16 v[128:143], v[216:219], a[152:155], v[128:143]
    ds_read_b64_tr_b16 v[196:197], v235 offset:0
    s_add_u32 m0, s38, 41984
    v_mfma_f32_32x32x16_bf16 v[144:159], v[216:219], a[156:159], v[144:159]
    ds_read_b64_tr_b16 v[198:199], v235 offset:1024
    buffer_load_dwordx4 v243, s[20:23], s39 offen lds
    s_waitcnt lgkmcnt(6)
    v_mfma_f32_32x32x16_bf16 v[160:175], v[220:223], a[152:155], v[160:175]
    ds_read_b64_tr_b16 v[200:201], v236 offset:0
    s_add_u32 m0, s38, 43008
    v_mfma_f32_32x32x16_bf16 v[176:191], v[220:223], a[156:159], v[176:191]
    ds_read_b64_tr_b16 v[202:203], v236 offset:1024
    buffer_load_dwordx4 v244, s[20:23], s39 offen lds
    s_waitcnt lgkmcnt(4)
    v_mfma_f32_32x32x16_bf16 v[64:79], v[192:195], a[128:131], v[64:79]
    ds_read_b64_tr_b16 v[204:205], v237 offset:0
    s_add_u32 m0, s38, 44032
    v_mfma_f32_32x32x16_bf16 v[80:95], v[192:195], a[132:135], v[80:95]
    ds_read_b64_tr_b16 v[206:207], v237 offset:1024
    buffer_load_dwordx4 v245, s[20:23], s39 offen lds
    s_waitcnt lgkmcnt(4)
    v_mfma_f32_32x32x16_bf16 v[96:111], v[196:199], a[128:131], v[96:111]
    ds_read_b128 a[136:139], v247 offset:49152
    ds_read_b128 a[140:143], v247 offset:51200
    ds_read_b64_tr_b16 v[208:209], v234 offset:4096
    s_add_u32 m0, s26, 57344
    v_mfma_f32_32x32x16_bf16 v[112:127], v[196:199], a[132:135], v[112:127]
    ds_read_b64_tr_b16 v[210:211], v234 offset:5120
    buffer_load_dwordx4 v230, s[16:19], s36 offen lds
    s_waitcnt lgkmcnt(6)
    v_mfma_f32_32x32x16_bf16 v[128:143], v[200:203], a[128:131], v[128:143]
    ds_read_b64_tr_b16 v[212:213], v235 offset:4096
    s_add_u32 m0, s26, 61440
    v_mfma_f32_32x32x16_bf16 v[144:159], v[200:203], a[132:135], v[144:159]
    ds_read_b64_tr_b16 v[214:215], v235 offset:5120
    buffer_load_dwordx4 v231, s[16:19], s36 offen lds
    s_waitcnt lgkmcnt(6)
    v_mfma_f32_32x32x16_bf16 v[160:175], v[204:207], a[128:131], v[160:175]
    ds_read_b64_tr_b16 v[216:217], v236 offset:4096
    s_add_u32 s39, s39, 64
    s_add_u32 s36, s36, 262144
    v_mfma_f32_32x32x16_bf16 v[176:191], v[204:207], a[132:135], v[176:191]
    ds_read_b64_tr_b16 v[218:219], v236 offset:5120
    s_waitcnt lgkmcnt(4)
    v_mfma_f32_32x32x16_bf16 v[64:79], v[208:211], a[136:139], v[64:79]
    ds_read_b64_tr_b16 v[220:221], v237 offset:4096
    v_mfma_f32_32x32x16_bf16 v[80:95], v[208:211], a[140:143], v[80:95]
    s_waitcnt vmcnt(12)
    s_barrier
    v_add_u32 v238, 32768, v224
    v_add_u32 v239, 32768, v225
    v_add_u32 v240, 32768, v226
    v_add_u32 v241, 32768, v227
    ds_read_b64_tr_b16 v[222:223], v237 offset:5120
    s_waitcnt lgkmcnt(4)
    v_mfma_f32_32x32x16_bf16 v[96:111], v[212:215], a[136:139], v[96:111]
    ds_read_b128 a[144:147], v228 offset:16384
    ds_read_b128 a[148:151], v228 offset:18432
    ds_read_b64_tr_b16 v[192:193], v238 offset:0
    s_add_u32 m0, s38, 106496
    v_mfma_f32_32x32x16_bf16 v[112:127], v[212:215], a[140:143], v[112:127]
    ds_read_b64_tr_b16 v[194:195], v238 offset:1024
    buffer_load_dwordx4 v242, s[20:23], s39 offen lds
    s_waitcnt lgkmcnt(6)
    v_mfma_f32_32x32x16_bf16 v[128:143], v[216:219], a[136:139], v[128:143]
    ds_read_b64_tr_b16 v[196:197], v239 offset:0
    s_add_u32 m0, s38, 107520
    v_mfma_f32_32x32x16_bf16 v[144:159], v[216:219], a[140:143], v[144:159]
    ds_read_b64_tr_b16 v[198:199], v239 offset:1024
    buffer_load_dwordx4 v243, s[20:23], s39 offen lds
    s_waitcnt lgkmcnt(6)
    v_mfma_f32_32x32x16_bf16 v[160:175], v[220:223], a[136:139], v[160:175]
    ds_read_b64_tr_b16 v[200:201], v240 offset:0
    s_add_u32 m0, s38, 108544
    v_mfma_f32_32x32x16_bf16 v[176:191], v[220:223], a[140:143], v[176:191]
    ds_read_b64_tr_b16 v[202:203], v240 offset:1024
    buffer_load_dwordx4 v244, s[20:23], s39 offen lds
    s_waitcnt lgkmcnt(4)
    v_mfma_f32_32x32x16_bf16 v[64:79], v[192:195], a[144:147], v[64:79]
    ds_read_b64_tr_b16 v[204:205], v241 offset:0
    s_add_u32 m0, s38, 109568
    v_mfma_f32_32x32x16_bf16 v[80:95], v[192:195], a[148:151], v[80:95]
    ds_read_b64_tr_b16 v[206:207], v241 offset:1024
    buffer_load_dwordx4 v245, s[20:23], s39 offen lds
    s_waitcnt lgkmcnt(4)
    v_mfma_f32_32x32x16_bf16 v[96:111], v[196:199], a[144:147], v[96:111]
    ds_read_b128 a[152:155], v229 offset:16384
    ds_read_b128 a[156:159], v229 offset:18432
    ds_read_b64_tr_b16 v[208:209], v238 offset:4096
    s_add_u32 m0, s26, 122880
    v_mfma_f32_32x32x16_bf16 v[112:127], v[196:199], a[148:151], v[112:127]
    ds_read_b64_tr_b16 v[210:211], v238 offset:5120
    buffer_load_dwordx4 v230, s[16:19], s36 offen lds
    s_waitcnt lgkmcnt(6)
    v_mfma_f32_32x32x16_bf16 v[128:143], v[200:203], a[144:147], v[128:143]
    ds_read_b64_tr_b16 v[212:213], v239 offset:4096
    s_add_u32 m0, s26, 126976
    v_mfma_f32_32x32x16_bf16 v[144:159], v[200:203], a[148:151], v[144:159]
    ds_read_b64_tr_b16 v[214:215], v239 offset:5120
    buffer_load_dwordx4 v231, s[16:19], s36 offen lds
    s_waitcnt lgkmcnt(6)
    v_mfma_f32_32x32x16_bf16 v[160:175], v[204:207], a[144:147], v[160:175]
    ds_read_b64_tr_b16 v[216:217], v240 offset:4096
    s_add_u32 s39, s39, 64
    s_add_u32 s36, s36, 262144
    v_mfma_f32_32x32x16_bf16 v[176:191], v[204:207], a[148:151], v[176:191]
    ds_read_b64_tr_b16 v[218:219], v240 offset:5120
    s_waitcnt lgkmcnt(4)
    v_mfma_f32_32x32x16_bf16 v[64:79], v[208:211], a[152:155], v[64:79]
    ds_read_b64_tr_b16 v[220:221], v241 offset:4096
    v_mfma_f32_32x32x16_bf16 v[80:95], v[208:211], a[156:159], v[80:95]
    s_waitcnt vmcnt(12)
    s_barrier
    v_add_u32 v234, 98304, v224
    v_add_u32 v235, 98304, v225
    v_add_u32 v236, 98304, v226
    v_add_u32 v237, 98304, v227
    ds_read_b64_tr_b16 v[222:223], v241 offset:5120
    s_waitcnt lgkmcnt(4)
    v_mfma_f32_32x32x16_bf16 v[96:111], v[212:215], a[152:155], v[96:111]
    ds_read_b128 a[128:131], v246 offset:0
    ds_read_b128 a[132:135], v246 offset:2048
    ds_read_b64_tr_b16 v[192:193], v234 offset:0
    s_add_u32 m0, s38, 131072
    v_mfma_f32_32x32x16_bf16 v[112:127], v[212:215], a[156:159], v[112:127]
    ds_read_b64_tr_b16 v[194:195], v234 offset:1024
    buffer_load_dwordx4 v242, s[20:23], s39 offen lds
    s_waitcnt lgkmcnt(6)
    v_mfma_f32_32x32x16_bf16 v[128:143], v[216:219], a[152:155], v[128:143]
    ds_read_b64_tr_b16 v[196:197], v235 offset:0
    s_add_u32 m0, s38, 132096
    v_mfma_f32_32x32x16_bf16 v[144:159], v[216:219], a[156:159], v[144:159]
    ds_read_b64_tr_b16 v[198:199], v235 offset:1024
    buffer_load_dwordx4 v243, s[20:23], s39 offen lds
    s_waitcnt lgkmcnt(6)
    v_mfma_f32_32x32x16_bf16 v[160:175], v[220:223], a[152:155], v[160:175]
    ds_read_b64_tr_b16 v[200:201], v236 offset:0
    s_add_u32 m0, s38, 133120
    v_mfma_f32_32x32x16_bf16 v[176:191], v[220:223], a[156:159], v[176:191]
    ds_read_b64_tr_b16 v[202:203], v236 offset:1024
    buffer_load_dwordx4 v244, s[20:23], s39 offen lds
    s_waitcnt lgkmcnt(4)
    v_mfma_f32_32x32x16_bf16 v[64:79], v[192:195], a[128:131], v[64:79]
    ds_read_b64_tr_b16 v[204:205], v237 offset:0
    s_add_u32 m0, s38, 134144
    v_mfma_f32_32x32x16_bf16 v[80:95], v[192:195], a[132:135], v[80:95]
    ds_read_b64_tr_b16 v[206:207], v237 offset:1024
    buffer_load_dwordx4 v245, s[20:23], s39 offen lds
    s_waitcnt lgkmcnt(4)
    v_mfma_f32_32x32x16_bf16 v[96:111], v[196:199], a[128:131], v[96:111]
    ds_read_b128 a[136:139], v247 offset:0
    ds_read_b128 a[140:143], v247 offset:2048
    ds_read_b64_tr_b16 v[208:209], v234 offset:4096
    s_add_u32 m0, s26, 147456
    v_mfma_f32_32x32x16_bf16 v[112:127], v[196:199], a[132:135], v[112:127]
    ds_read_b64_tr_b16 v[210:211], v234 offset:5120
    buffer_load_dwordx4 v230, s[16:19], s36 offen lds
    s_waitcnt lgkmcnt(6)
    v_mfma_f32_32x32x16_bf16 v[128:143], v[200:203], a[128:131], v[128:143]
    ds_read_b64_tr_b16 v[212:213], v235 offset:4096
    s_add_u32 m0, s26, 151552
    v_mfma_f32_32x32x16_bf16 v[144:159], v[200:203], a[132:135], v[144:159]
    ds_read_b64_tr_b16 v[214:215], v235 offset:5120
    buffer_load_dwordx4 v231, s[16:19], s36 offen lds
    s_waitcnt lgkmcnt(6)
    v_mfma_f32_32x32x16_bf16 v[160:175], v[204:207], a[128:131], v[160:175]
    ds_read_b64_tr_b16 v[216:217], v236 offset:4096
    s_add_u32 s39, s39, 64
    s_add_u32 s36, s36, 262144
    v_mfma_f32_32x32x16_bf16 v[176:191], v[204:207], a[132:135], v[176:191]
    ds_read_b64_tr_b16 v[218:219], v236 offset:5120
    s_waitcnt lgkmcnt(4)
    v_mfma_f32_32x32x16_bf16 v[64:79], v[208:211], a[136:139], v[64:79]
    ds_read_b64_tr_b16 v[220:221], v237 offset:4096
    v_mfma_f32_32x32x16_bf16 v[80:95], v[208:211], a[140:143], v[80:95]
    s_waitcnt vmcnt(12)
    s_barrier
    v_add_u32 v238, 57344, v224
    v_add_u32 v239, 57344, v225
    v_add_u32 v240, 57344, v226
    v_add_u32 v241, 57344, v227
    ds_read_b64_tr_b16 v[222:223], v237 offset:5120
    s_waitcnt lgkmcnt(4)
    v_mfma_f32_32x32x16_bf16 v[96:111], v[212:215], a[136:139], v[96:111]
    ds_read_b128 a[144:147], v228 offset:40960
    ds_read_b128 a[148:151], v228 offset:43008
    ds_read_b64_tr_b16 v[192:193], v238 offset:0
    s_add_u32 m0, s26, 0
    v_mfma_f32_32x32x16_bf16 v[112:127], v[212:215], a[140:143], v[112:127]
    ds_read_b64_tr_b16 v[194:195], v238 offset:1024
    buffer_load_dwordx4 v28, s[8:11], 0 offen lds
    s_waitcnt lgkmcnt(6)
    v_mfma_f32_32x32x16_bf16 v[128:143], v[216:219], a[136:139], v[128:143]
    ds_read_b64_tr_b16 v[196:197], v239 offset:0
    s_add_u32 m0, s26, 4096
    v_mfma_f32_32x32x16_bf16 v[144:159], v[216:219], a[140:143], v[144:159]
    ds_read_b64_tr_b16 v[198:199], v239 offset:1024
    buffer_load_dwordx4 v29, s[8:11], 0 offen lds
    s_waitcnt lgkmcnt(6)
    v_mfma_f32_32x32x16_bf16 v[160:175], v[220:223], a[136:139], v[160:175]
    ds_read_b64_tr_b16 v[200:201], v240 offset:0
    s_add_u32 m0, s26, 8192
    v_mfma_f32_32x32x16_bf16 v[176:191], v[220:223], a[140:143], v[176:191]
    ds_read_b64_tr_b16 v[202:203], v240 offset:1024
    buffer_load_dwordx4 v30, s[8:11], 0 offen lds
    s_waitcnt lgkmcnt(4)
    v_mfma_f32_32x32x16_bf16 v[64:79], v[192:195], a[144:147], v[64:79]
    ds_read_b64_tr_b16 v[204:205], v241 offset:0
    s_add_u32 m0, s26, 12288
    v_mfma_f32_32x32x16_bf16 v[80:95], v[192:195], a[148:151], v[80:95]
    ds_read_b64_tr_b16 v[206:207], v241 offset:1024
    buffer_load_dwordx4 v31, s[8:11], 0 offen lds
    s_waitcnt lgkmcnt(4)
    v_mfma_f32_32x32x16_bf16 v[96:111], v[196:199], a[144:147], v[96:111]
    ds_read_b128 a[152:155], v229 offset:40960
    ds_read_b128 a[156:159], v229 offset:43008
    ds_read_b64_tr_b16 v[208:209], v238 offset:4096
    s_add_u32 m0, s26, 65536
    v_mfma_f32_32x32x16_bf16 v[112:127], v[196:199], a[148:151], v[112:127]
    ds_read_b64_tr_b16 v[210:211], v238 offset:5120
    buffer_load_dwordx4 v32, s[12:15], 0 offen lds
    s_waitcnt lgkmcnt(6)
    v_mfma_f32_32x32x16_bf16 v[128:143], v[200:203], a[144:147], v[128:143]
    ds_read_b64_tr_b16 v[212:213], v239 offset:4096
    s_add_u32 m0, s26, 69632
    v_mfma_f32_32x32x16_bf16 v[144:159], v[200:203], a[148:151], v[144:159]
    ds_read_b64_tr_b16 v[214:215], v239 offset:5120
    buffer_load_dwordx4 v33, s[12:15], 0 offen lds
    s_waitcnt lgkmcnt(6)
    v_mfma_f32_32x32x16_bf16 v[160:175], v[204:207], a[144:147], v[160:175]
    ds_read_b64_tr_b16 v[216:217], v240 offset:4096
    s_add_u32 m0, s26, 73728
    v_mfma_f32_32x32x16_bf16 v[176:191], v[204:207], a[148:151], v[176:191]
    ds_read_b64_tr_b16 v[218:219], v240 offset:5120
    buffer_load_dwordx4 v34, s[12:15], 0 offen lds
    s_waitcnt lgkmcnt(4)
    v_mfma_f32_32x32x16_bf16 v[64:79], v[208:211], a[152:155], v[64:79]
    ds_read_b64_tr_b16 v[220:221], v241 offset:4096
    s_add_u32 m0, s26, 77824
    v_mfma_f32_32x32x16_bf16 v[80:95], v[208:211], a[156:159], v[80:95]
    s_waitcnt vmcnt(13)
    s_barrier
    v_add_u32 v234, 122880, v224
    v_add_u32 v235, 122880, v225
    v_add_u32 v236, 122880, v226
    v_add_u32 v237, 122880, v227
    ds_read_b64_tr_b16 v[222:223], v241 offset:5120
    buffer_load_dwordx4 v35, s[12:15], 0 offen lds
    s_waitcnt lgkmcnt(4)
    v_mfma_f32_32x32x16_bf16 v[96:111], v[212:215], a[152:155], v[96:111]
    ds_read_b128 a[128:131], v246 offset:24576
    ds_read_b128 a[132:135], v246 offset:26624
    ds_read_b64_tr_b16 v[192:193], v234 offset:0
    s_add_u32 m0, s26, 16384
    v_mfma_f32_32x32x16_bf16 v[112:127], v[212:215], a[156:159], v[112:127]
    ds_read_b64_tr_b16 v[194:195], v234 offset:1024
    buffer_load_dwordx4 v28, s[8:11], s27 offen lds
    s_waitcnt lgkmcnt(6)
    v_mfma_f32_32x32x16_bf16 v[128:143], v[216:219], a[152:155], v[128:143]
    ds_read_b64_tr_b16 v[196:197], v235 offset:0
    s_add_u32 m0, s26, 20480
    v_mfma_f32_32x32x16_bf16 v[144:159], v[216:219], a[156:159], v[144:159]
    ds_read_b64_tr_b16 v[198:199], v235 offset:1024
    buffer_load_dwordx4 v29, s[8:11], s27 offen lds
    s_waitcnt lgkmcnt(6)
    v_mfma_f32_32x32x16_bf16 v[160:175], v[220:223], a[152:155], v[160:175]
    ds_read_b64_tr_b16 v[200:201], v236 offset:0
    s_add_u32 m0, s26, 24576
    v_mfma_f32_32x32x16_bf16 v[176:191], v[220:223], a[156:159], v[176:191]
    ds_read_b64_tr_b16 v[202:203], v236 offset:1024
    buffer_load_dwordx4 v30, s[8:11], s27 offen lds
    s_waitcnt lgkmcnt(4)
    v_mfma_f32_32x32x16_bf16 v[64:79], v[192:195], a[128:131], v[64:79]
    ds_read_b64_tr_b16 v[204:205], v237 offset:0
    s_add_u32 m0, s26, 28672
    v_mfma_f32_32x32x16_bf16 v[80:95], v[192:195], a[132:135], v[80:95]
    ds_read_b64_tr_b16 v[206:207], v237 offset:1024
    buffer_load_dwordx4 v31, s[8:11], s27 offen lds
    s_waitcnt lgkmcnt(4)
    v_mfma_f32_32x32x16_bf16 v[96:111], v[196:199], a[128:131], v[96:111]
    ds_read_b128 a[136:139], v247 offset:24576
    ds_read_b128 a[140:143], v247 offset:26624
    ds_read_b64_tr_b16 v[208:209], v234 offset:4096
    s_add_u32 m0, s26, 81920
    v_mfma_f32_32x32x16_bf16 v[112:127], v[196:199], a[132:135], v[112:127]
    ds_read_b64_tr_b16 v[210:211], v234 offset:5120
    buffer_load_dwordx4 v32, s[12:15], s27 offen lds
    s_waitcnt lgkmcnt(6)
    v_mfma_f32_32x32x16_bf16 v[128:143], v[200:203], a[128:131], v[128:143]
    ds_read_b64_tr_b16 v[212:213], v235 offset:4096
    s_add_u32 m0, s26, 86016
    v_mfma_f32_32x32x16_bf16 v[144:159], v[200:203], a[132:135], v[144:159]
    ds_read_b64_tr_b16 v[214:215], v235 offset:5120
    buffer_load_dwordx4 v33, s[12:15], s27 offen lds
    s_waitcnt lgkmcnt(6)
    v_mfma_f32_32x32x16_bf16 v[160:175], v[204:207], a[128:131], v[160:175]
    ds_read_b64_tr_b16 v[216:217], v236 offset:4096
    s_add_u32 m0, s26, 90112
    v_mfma_f32_32x32x16_bf16 v[176:191], v[204:207], a[132:135], v[176:191]
    ds_read_b64_tr_b16 v[218:219], v236 offset:5120
    buffer_load_dwordx4 v34, s[12:15], s27 offen lds
    s_waitcnt lgkmcnt(4)
    v_mfma_f32_32x32x16_bf16 v[64:79], v[208:211], a[136:139], v[64:79]
    ds_read_b64_tr_b16 v[220:221], v237 offset:4096
    s_add_u32 m0, s26, 94208
    v_mfma_f32_32x32x16_bf16 v[80:95], v[208:211], a[140:143], v[80:95]
    s_waitcnt vmcnt(15)
    s_barrier
    v_add_u32 v238, 147456, v224
    v_add_u32 v239, 147456, v225
    v_add_u32 v240, 147456, v226
    v_add_u32 v241, 147456, v227
    ds_read_b64_tr_b16 v[222:223], v237 offset:5120
    buffer_load_dwordx4 v35, s[12:15], s27 offen lds
    s_waitcnt lgkmcnt(4)
    v_mfma_f32_32x32x16_bf16 v[96:111], v[212:215], a[136:139], v[96:111]
    ds_read_b128 a[144:147], v246 offset:49152
    ds_read_b128 a[148:151], v246 offset:51200
    ds_read_b64_tr_b16 v[192:193], v238 offset:0
    v_mfma_f32_32x32x16_bf16 v[112:127], v[212:215], a[140:143], v[112:127]
    ds_read_b64_tr_b16 v[194:195], v238 offset:1024
    s_waitcnt lgkmcnt(6)
    v_mfma_f32_32x32x16_bf16 v[128:143], v[216:219], a[136:139], v[128:143]
    ds_read_b64_tr_b16 v[196:197], v239 offset:0
    v_mfma_f32_32x32x16_bf16 v[144:159], v[216:219], a[140:143], v[144:159]
    ds_read_b64_tr_b16 v[198:199], v239 offset:1024
    s_waitcnt lgkmcnt(6)
    v_mfma_f32_32x32x16_bf16 v[160:175], v[220:223], a[136:139], v[160:175]
    ds_read_b64_tr_b16 v[200:201], v240 offset:0
    v_mfma_f32_32x32x16_bf16 v[176:191], v[220:223], a[140:143], v[176:191]
    ds_read_b64_tr_b16 v[202:203], v240 offset:1024
    s_waitcnt lgkmcnt(4)
    v_mfma_f32_32x32x16_bf16 v[64:79], v[192:195], a[144:147], v[64:79]
    ds_read_b64_tr_b16 v[204:205], v241 offset:0
    v_mfma_f32_32x32x16_bf16 v[80:95], v[192:195], a[148:151], v[80:95]
    ds_read_b64_tr_b16 v[206:207], v241 offset:1024
    s_waitcnt lgkmcnt(4)
    v_mfma_f32_32x32x16_bf16 v[96:111], v[196:199], a[144:147], v[96:111]
    ds_read_b128 a[152:155], v247 offset:49152
    ds_read_b128 a[156:159], v247 offset:51200
    ds_read_b64_tr_b16 v[208:209], v238 offset:4096
    v_mfma_f32_32x32x16_bf16 v[112:127], v[196:199], a[148:151], v[112:127]
    ds_read_b64_tr_b16 v[210:211], v238 offset:5120
    s_waitcnt lgkmcnt(6)
    v_mfma_f32_32x32x16_bf16 v[128:143], v[200:203], a[144:147], v[128:143]
    ds_read_b64_tr_b16 v[212:213], v239 offset:4096
    v_mfma_f32_32x32x16_bf16 v[144:159], v[200:203], a[148:151], v[144:159]
    ds_read_b64_tr_b16 v[214:215], v239 offset:5120
    s_waitcnt lgkmcnt(6)
    v_mfma_f32_32x32x16_bf16 v[160:175], v[204:207], a[144:147], v[160:175]
    ds_read_b64_tr_b16 v[216:217], v240 offset:4096
    v_mfma_f32_32x32x16_bf16 v[176:191], v[204:207], a[148:151], v[176:191]
    ds_read_b64_tr_b16 v[218:219], v240 offset:5120
    s_waitcnt lgkmcnt(4)
    v_mfma_f32_32x32x16_bf16 v[64:79], v[208:211], a[152:155], v[64:79]
    ds_read_b64_tr_b16 v[220:221], v241 offset:4096
    v_mfma_f32_32x32x16_bf16 v[80:95], v[208:211], a[156:159], v[80:95]
    ds_read_b64_tr_b16 v[222:223], v241 offset:5120
    s_waitcnt lgkmcnt(4)
    v_mfma_f32_32x32x16_bf16 v[96:111], v[212:215], a[152:155], v[96:111]
    v_mfma_f32_32x32x16_bf16 v[112:127], v[212:215], a[156:159], v[112:127]
    s_waitcnt lgkmcnt(2)
    v_mfma_f32_32x32x16_bf16 v[128:143], v[216:219], a[152:155], v[128:143]
    v_mfma_f32_32x32x16_bf16 v[144:159], v[216:219], a[156:159], v[144:159]
    s_waitcnt lgkmcnt(0)
    v_mfma_f32_32x32x16_bf16 v[160:175], v[220:223], a[152:155], v[160:175]
    v_mfma_f32_32x32x16_bf16 v[176:191], v[220:223], a[156:159], v[176:191]
    s_nop 15
    s_nop 7
    s_mov_b32 s36, 0x3e0293ee
    s_mul_i32 s31, s3, 17408
    s_add_u32 s31, s31, 98304-17408
    s_cmp_eq_u32 s3, 0
    s_cselect_b32 s31, 32768, s31
    v_mul_u32_u24 v9, 272, v6
    v_lshl_add_u32 v9, v5, 3, v9
    v_add_u32 v9, s31, v9
    v_mul_u32_u24 v10, 272, v3
    v_lshl_add_u32 v10, v4, 4, v10
    v_add_u32 v10, s31, v10
    s_barrier
    v_mul_f32 v64, s36, v64
    v_mul_f32 v65, s36, v65
    v_mul_f32 v66, s36, v66
    v_mul_f32 v67, s36, v67
    v_mul_f32 v68, s36, v68
    v_mul_f32 v69, s36, v69
    v_mul_f32 v70, s36, v70
    v_mul_f32 v71, s36, v71
    v_mul_f32 v72, s36, v72
    v_mul_f32 v73, s36, v73
    v_mul_f32 v74, s36, v74
    v_mul_f32 v75, s36, v75
    v_mul_f32 v76, s36, v76
    v_mul_f32 v77, s36, v77
    v_mul_f32 v78, s36, v78
    v_mul_f32 v79, s36, v79
    v_cvt_pk_bf16_f32 v64, v64, v65
    v_cvt_pk_bf16_f32 v65, v66, v67
    v_cvt_pk_bf16_f32 v66, v68, v69
    v_cvt_pk_bf16_f32 v67, v70, v71
    v_cvt_pk_bf16_f32 v68, v72, v73
    v_cvt_pk_bf16_f32 v69, v74, v75
    v_cvt_pk_bf16_f32 v70, v76, v77
    v_cvt_pk_bf16_f32 v71, v78, v79
    ds_write_b64 v9, v[64:65] offset:0
    ds_write_b64 v9, v[66:67] offset:16
    ds_write_b64 v9, v[68:69] offset:32
    ds_write_b64 v9, v[70:71] offset:48
    v_mul_f32 v80, s36, v80
    v_mul_f32 v81, s36, v81
    v_mul_f32 v82, s36, v82
    v_mul_f32 v83, s36, v83
    v_mul_f32 v84, s36, v84
    v_mul_f32 v85, s36, v85
    v_mul_f32 v86, s36, v86
    v_mul_f32 v87, s36, v87
    v_mul_f32 v88, s36, v88
    v_mul_f32 v89, s36, v89
    v_mul_f32 v90, s36, v90
    v_mul_f32 v91, s36, v91
    v_mul_f32 v92, s36, v92
    v_mul_f32 v93, s36, v93
    v_mul_f32 v94, s36, v94
    v_mul_f32 v95, s36, v95
    v_cvt_pk_bf16_f32 v80, v80, v81
    v_cvt_pk_bf16_f32 v81, v82, v83
    v_cvt_pk_bf16_f32 v82, v84, v85
    v_cvt_pk_bf16_f32 v83, v86, v87
    v_cvt_pk_bf16_f32 v84, v88, v89
    v_cvt_pk_bf16_f32 v85, v90, v91
    v_cvt_pk_bf16_f32 v86, v92, v93
    v_cvt_pk_bf16_f32 v87, v94, v95
    ds_write_b64 v9, v[80:81] offset:8704
    ds_write_b64 v9, v[82:83] offset:8720
    ds_write_b64 v9, v[84:85] offset:8736
    ds_write_b64 v9, v[86:87] offset:8752
    v_mul_f32 v96, s36, v96
    v_mul_f32 v97, s36, v97
    v_mul_f32 v98, s36, v98
    v_mul_f32 v99, s36, v99
    v_mul_f32 v100, s36, v100
    v_mul_f32 v101, s36, v101
    v_mul_f32 v102, s36, v102
    v_mul_f32 v103, s36, v103
    v_mul_f32 v104, s36, v104
    v_mul_f32 v105, s36, v105
    v_mul_f32 v106, s36, v106
    v_mul_f32 v107, s36, v107
    v_mul_f32 v108, s36, v108
    v_mul_f32 v109, s36, v109
    v_mul_f32 v110, s36, v110
    v_mul_f32 v111, s36, v111
    v_cvt_pk_bf16_f32 v96, v96, v97
    v_cvt_pk_bf16_f32 v97, v98, v99
    v_cvt_pk_bf16_f32 v98, v100, v101
    v_cvt_pk_bf16_f32 v99, v102, v103
    v_cvt_pk_bf16_f32 v100, v104, v105
    v_cvt_pk_bf16_f32 v101, v106, v107
    v_cvt_pk_bf16_f32 v102, v108, v109
    v_cvt_pk_bf16_f32 v103, v110, v111
    ds_write_b64 v9, v[96:97] offset:64
    ds_write_b64 v9, v[98:99] offset:80
    ds_write_b64 v9, v[100:101] offset:96
    ds_write_b64 v9, v[102:103] offset:112
    v_mul_f32 v112, s36, v112
    v_mul_f32 v113, s36, v113
    v_mul_f32 v114, s36, v114
    v_mul_f32 v115, s36, v115
    v_mul_f32 v116, s36, v116
    v_mul_f32 v117, s36, v117
    v_mul_f32 v118, s36, v118
    v_mul_f32 v119, s36, v119
    v_mul_f32 v120, s36, v120
    v_mul_f32 v121, s36, v121
    v_mul_f32 v122, s36, v122
    v_mul_f32 v123, s36, v123
    v_mul_f32 v124, s36, v124
    v_mul_f32 v125, s36, v125
    v_mul_f32 v126, s36, v126
    v_mul_f32 v127, s36, v127
    v_cvt_pk_bf16_f32 v112, v112, v113
    v_cvt_pk_bf16_f32 v113, v114, v115
    v_cvt_pk_bf16_f32 v114, v116, v117
    v_cvt_pk_bf16_f32 v115, v118, v119
    v_cvt_pk_bf16_f32 v116, v120, v121
    v_cvt_pk_bf16_f32 v117, v122, v123
    v_cvt_pk_bf16_f32 v118, v124, v125
    v_cvt_pk_bf16_f32 v119, v126, v127
    ds_write_b64 v9, v[112:113] offset:8768
    ds_write_b64 v9, v[114:115] offset:8784
    ds_write_b64 v9, v[116:117] offset:8800
    ds_write_b64 v9, v[118:119] offset:8816
    v_mul_f32 v128, s36, v128
    v_mul_f32 v129, s36, v129
    v_mul_f32 v130, s36, v130
    v_mul_f32 v131, s36, v131
    v_mul_f32 v132, s36, v132
    v_mul_f32 v133, s36, v133
    v_mul_f32 v134, s36, v134
    v_mul_f32 v135, s36, v135
    v_mul_f32 v136, s36, v136
    v_mul_f32 v137, s36, v137
    v_mul_f32 v138, s36, v138
    v_mul_f32 v139, s36, v139
    v_mul_f32 v140, s36, v140
    v_mul_f32 v141, s36, v141
    v_mul_f32 v142, s36, v142
    v_mul_f32 v143, s36, v143
    v_cvt_pk_bf16_f32 v128, v128, v129
    v_cvt_pk_bf16_f32 v129, v130, v131
    v_cvt_pk_bf16_f32 v130, v132, v133
    v_cvt_pk_bf16_f32 v131, v134, v135
    v_cvt_pk_bf16_f32 v132, v136, v137
    v_cvt_pk_bf16_f32 v133, v138, v139
    v_cvt_pk_bf16_f32 v134, v140, v141
    v_cvt_pk_bf16_f32 v135, v142, v143
    ds_write_b64 v9, v[128:129] offset:128
    ds_write_b64 v9, v[130:131] offset:144
    ds_write_b64 v9, v[132:133] offset:160
    ds_write_b64 v9, v[134:135] offset:176
    v_mul_f32 v144, s36, v144
    v_mul_f32 v145, s36, v145
    v_mul_f32 v146, s36, v146
    v_mul_f32 v147, s36, v147
    v_mul_f32 v148, s36, v148
    v_mul_f32 v149, s36, v149
    v_mul_f32 v150, s36, v150
    v_mul_f32 v151, s36, v151
    v_mul_f32 v152, s36, v152
    v_mul_f32 v153, s36, v153
    v_mul_f32 v154, s36, v154
    v_mul_f32 v155, s36, v155
    v_mul_f32 v156, s36, v156
    v_mul_f32 v157, s36, v157
    v_mul_f32 v158, s36, v158
    v_mul_f32 v159, s36, v159
    v_cvt_pk_bf16_f32 v144, v144, v145
    v_cvt_pk_bf16_f32 v145, v146, v147
    v_cvt_pk_bf16_f32 v146, v148, v149
    v_cvt_pk_bf16_f32 v147, v150, v151
    v_cvt_pk_bf16_f32 v148, v152, v153
    v_cvt_pk_bf16_f32 v149, v154, v155
    v_cvt_pk_bf16_f32 v150, v156, v157
    v_cvt_pk_bf16_f32 v151, v158, v159
    ds_write_b64 v9, v[144:145] offset:8832
    ds_write_b64 v9, v[146:147] offset:8848
    ds_write_b64 v9, v[148:149] offset:8864
    ds_write_b64 v9, v[150:151] offset:8880
    v_mul_f32 v160, s36, v160
    v_mul_f32 v161, s36, v161
    v_mul_f32 v162, s36, v162
    v_mul_f32 v163, s36, v163
    v_mul_f32 v164, s36, v164
    v_mul_f32 v165, s36, v165
    v_mul_f32 v166, s36, v166
    v_mul_f32 v167, s36, v167
    v_mul_f32 v168, s36, v168
    v_mul_f32 v169, s36, v169
    v_mul_f32 v170, s36, v170
    v_mul_f32 v171, s36, v171
    v_mul_f32 v172, s36, v172
    v_mul_f32 v173, s36, v173
    v_mul_f32 v174, s36, v174
    v_mul_f32 v175, s36, v175
    v_cvt_pk_bf16_f32 v160, v160, v161
    v_cvt_pk_bf16_f32 v161, v162, v163
    v_cvt_pk_bf16_f32 v162, v164, v165
    v_cvt_pk_bf16_f32 v163, v166, v167
    v_cvt_pk_bf16_f32 v164, v168, v169
    v_cvt_pk_bf16_f32 v165, v170, v171
    v_cvt_pk_bf16_f32 v166, v172, v173
    v_cvt_pk_bf16_f32 v167, v174, v175
    ds_write_b64 v9, v[160:161] offset:192
    ds_write_b64 v9, v[162:163] offset:208
    ds_write_b64 v9, v[164:165] offset:224
    ds_write_b64 v9, v[166:167] offset:240
    v_mul_f32 v176, s36, v176
    v_mul_f32 v177, s36, v177
    v_mul_f32 v178, s36, v178
    v_mul_f32 v179, s36, v179
    v_mul_f32 v180, s36, v180
    v_mul_f32 v181, s36, v181
    v_mul_f32 v182, s36, v182
    v_mul_f32 v183, s36, v183
    v_mul_f32 v184, s36, v184
    v_mul_f32 v185, s36, v185
    v_mul_f32 v186, s36, v186
    v_mul_f32 v187, s36, v187
    v_mul_f32 v188, s36, v188
    v_mul_f32 v189, s36, v189
    v_mul_f32 v190, s36, v190
    v_mul_f32 v191, s36, v191
    v_cvt_pk_bf16_f32 v176, v176, v177
    v_cvt_pk_bf16_f32 v177, v178, v179
    v_cvt_pk_bf16_f32 v178, v180, v181
    v_cvt_pk_bf16_f32 v179, v182, v183
    v_cvt_pk_bf16_f32 v180, v184, v185
    v_cvt_pk_bf16_f32 v181, v186, v187
    v_cvt_pk_bf16_f32 v182, v188, v189
    v_cvt_pk_bf16_f32 v183, v190, v191
    ds_write_b64 v9, v[176:177] offset:8896
    ds_write_b64 v9, v[178:179] offset:8912
    ds_write_b64 v9, v[180:181] offset:8928
    ds_write_b64 v9, v[182:183] offset:8944
    s_waitcnt lgkmcnt(0)
    ds_read_b128 a[128:131], v10 offset:0
    ds_read_b128 a[132:135], v10 offset:64
    ds_read_b128 a[136:139], v10 offset:128
    ds_read_b128 a[140:143], v10 offset:192
    ds_read_b128 a[144:147], v10 offset:4352
    ds_read_b128 a[148:151], v10 offset:4416
    ds_read_b128 a[152:155], v10 offset:4480
    ds_read_b128 a[156:159], v10 offset:4544
    ds_read_b128 a[160:163], v10 offset:8704
    ds_read_b128 a[164:167], v10 offset:8768
    ds_read_b128 a[168:171], v10 offset:8832
    ds_read_b128 a[172:175], v10 offset:8896
    ds_read_b128 a[176:179], v10 offset:13056
    ds_read_b128 a[180:183], v10 offset:13120
    ds_read_b128 a[184:187], v10 offset:13184
    ds_read_b128 a[188:191], v10 offset:13248
    v_mov_b32 v128, 0
    v_mov_b32 v129, 0
    v_mov_b32 v130, 0
    v_mov_b32 v131, 0
    v_mov_b32 v132, 0
    v_mov_b32 v133, 0
    v_mov_b32 v134, 0
    v_mov_b32 v135, 0
    v_mov_b32 v136, 0
    v_mov_b32 v137, 0
    v_mov_b32 v138, 0
    v_mov_b32 v139, 0
    v_mov_b32 v140, 0
    v_mov_b32 v141, 0
    v_mov_b32 v142, 0
    v_mov_b32 v143, 0
    v_mov_b32 v36, 0
    v_mov_b32 v37, 0
    v_mov_b32 v38, 0
    v_mov_b32 v39, 0
    s_mov_b32 s29, -1.0
    s_mov_b32 s30, 0xff800000
    s_mov_b32 s27, 32768
    s_mov_b32 s28, 8
    v_mov_b32 v15, 0x3f803f80
    s_cmp_ge_u32 s3, 2
    s_cselect_b32 s96, s12, s8
    s_cselect_b32 s97, s13, s9
    s_cselect_b32 s98, s14, s10
    s_mov_b32 s99, 0x00020000
    s_and_b32 s31, s3, 1
    s_lshl_b32 s31, s31, 13
    s_add_u32 s31, s31, 65536
    v_lshlrev_b32 v14, 7, v2
    v_add_u32 v14, s31, v14
    s_waitcnt vmcnt(0) lgkmcnt(0)
    s_load_dwordx2 s[80:81], s[0:1], 32
    s_load_dwordx4 s[84:87], s[0:1], 48
    s_load_dwordx2 s[88:89], s[0:1], 64
    s_lshl_b32 s31, s2, 2
    s_add_u32 s31, s31, s3
    s_lshl_b32 s31, s31, 13
    v_lshlrev_b32 v224, 7, v2
    s_waitcnt lgkmcnt(0)
    s_mov_b32 s92, s80
    s_mov_b32 s93, s81
    s_mov_b32 s94, 4718592
    s_mov_b32 s95, 0x00020000
    buffer_load_dword v225, v224, s[92:95], s31 offen
    s_mov_b32 s92, s84
    s_mov_b32 s93, s85
    s_mov_b32 s94, 5308416
    s_mov_b32 s95, 0x00020000
    buffer_load_dword v226, v224, s[92:95], s31 offen
    s_mov_b32 s92, s86
    s_mov_b32 s93, s87
    s_mov_b32 s94, 5308416
    s_mov_b32 s95, 0x00020000
    buffer_load_dword v227, v224, s[92:95], s31 offen
    s_mov_b32 s92, s88
    s_mov_b32 s93, s89
    s_mov_b32 s94, 5308416
    s_mov_b32 s95, 0x00020000
    buffer_load_dword v228, v224, s[92:95], s31 offen
    s_waitcnt vmcnt(8)
    s_barrier
    ds_read_b128 v[192:195], v16 offset:0
    s_add_u32 m0, s26, 32768
    buffer_load_dwordx4 v28, s[8:11], s27 offen lds
    ds_read_b128 v[196:199], v16 offset:4096
    s_add_u32 m0, s26, 36864
    buffer_load_dwordx4 v29, s[8:11], s27 offen lds
    ds_read_b128 v[200:203], v17 offset:0
    s_add_u32 m0, s26, 40960
    buffer_load_dwordx4 v30, s[8:11], s27 offen lds
    ds_read_b128 v[204:207], v17 offset:4096
    s_add_u32 m0, s26, 45056
    buffer_load_dwordx4 v31, s[8:11], s27 offen lds
    ds_read_b128 v[208:211], v18 offset:0
    s_add_u32 m0, s26, 98304
    buffer_load_dwordx4 v32, s[12:15], s27 offen lds
    s_waitcnt lgkmcnt(3)
    v_mfma_f32_16x16x32_bf16 v[64:67], v[192:195], a[128:131], v[128:131]
    v_mfma_f32_16x16x32_bf16 v[68:71], v[192:195], a[144:147], v[132:135]
    v_mfma_f32_16x16x32_bf16 v[72:75], v[192:195], a[160:163], v[136:139]
    ds_read_b128 v[212:215], v18 offset:4096
    s_add_u32 m0, s26, 102400
    v_mfma_f32_16x16x32_bf16 v[76:79], v[192:195], a[176:179], v[140:143]
    buffer_load_dwordx4 v33, s[12:15], s27 offen lds
    v_mfma_f32_16x16x32_bf16 v[80:83], v[196:199], a[128:131], v[128:131]
    v_mfma_f32_16x16x32_bf16 v[84:87], v[196:199], a[144:147], v[132:135]
    v_mfma_f32_16x16x32_bf16 v[88:91], v[196:199], a[160:163], v[136:139]
    ds_read_b128 v[216:219], v19 offset:0
    s_add_u32 m0, s26, 106496
    v_mfma_f32_16x16x32_bf16 v[92:95], v[196:199], a[176:179], v[140:143]
    buffer_load_dwordx4 v34, s[12:15], s27 offen lds
    s_waitcnt lgkmcnt(3)
    v_mfma_f32_16x16x32_bf16 v[64:67], v[200:203], a[132:135], v[64:67]
    v_mfma_f32_16x16x32_bf16 v[68:71], v[200:203], a[148:151], v[68:71]
    v_mfma_f32_16x16x32_bf16 v[72:75], v[200:203], a[164:167], v[72:75]
    ds_read_b128 v[220:223], v19 offset:4096
    s_add_u32 m0, s26, 110592
    v_mfma_f32_16x16x32_bf16 v[76:79], v[200:203], a[180:183], v[76:79]
    buffer_load_dwordx4 v35, s[12:15], s27 offen lds
    v_mfma_f32_16x16x32_bf16 v[80:83], v[204:207], a[132:135], v[80:83]
    v_mfma_f32_16x16x32_bf16 v[84:87], v[204:207], a[148:151], v[84:87]
    v_mfma_f32_16x16x32_bf16 v[88:91], v[204:207], a[164:167], v[88:91]
    v_mfma_f32_16x16x32_bf16 v[92:95], v[204:207], a[180:183], v[92:95]
    s_waitcnt lgkmcnt(2)
    v_mfma_f32_16x16x32_bf16 v[64:67], v[208:211], a[136:139], v[64:67]
    s_add_u32 s27, s27, 16384
    v_mfma_f32_16x16x32_bf16 v[68:71], v[208:211], a[152:155], v[68:71]
    v_mfma_f32_16x16x32_bf16 v[72:75], v[208:211], a[168:171], v[72:75]
    v_mfma_f32_16x16x32_bf16 v[76:79], v[208:211], a[184:187], v[76:79]
    v_mfma_f32_16x16x32_bf16 v[80:83], v[212:215], a[136:139], v[80:83]
    v_mfma_f32_16x16x32_bf16 v[84:87], v[212:215], a[152:155], v[84:87]
    v_mfma_f32_16x16x32_bf16 v[88:91], v[212:215], a[168:171], v[88:91]
    v_mfma_f32_16x16x32_bf16 v[92:95], v[212:215], a[184:187], v[92:95]
    s_waitcnt lgkmcnt(0)
    v_mfma_f32_16x16x32_bf16 v[64:67], v[216:219], a[140:143], v[64:67]
    v_mfma_f32_16x16x32_bf16 v[68:71], v[216:219], a[156:159], v[68:71]
    v_mfma_f32_16x16x32_bf16 v[72:75], v[216:219], a[172:175], v[72:75]
    v_mfma_f32_16x16x32_bf16 v[76:79], v[216:219], a[188:191], v[76:79]
    v_mfma_f32_16x16x32_bf16 v[80:83], v[220:223], a[140:143], v[80:83]
    v_mfma_f32_16x16x32_bf16 v[84:87], v[220:223], a[156:159], v[84:87]
    v_mfma_f32_16x16x32_bf16 v[88:91], v[220:223], a[172:175], v[88:91]
    v_mfma_f32_16x16x32_bf16 v[92:95], v[220:223], a[188:191], v[92:95]
    s_nop 15
    v_exp_f32 v44, v64
    v_exp_f32 v45, v65
    v_exp_f32 v46, v66
    v_exp_f32 v47, v67
    v_add_f32 v40, v44, v45
    v_cvt_pk_bf16_f32 v144, v44, v45
    v_exp_f32 v48, v80
    v_exp_f32 v49, v81
    v_add_f32 v40, v40, v46
    v_add_f32 v40, v40, v47
    v_cvt_pk_bf16_f32 v145, v46, v47
    v_exp_f32 v50, v82
    ds_read_b128 v[192:195], v16 offset:8192
    v_exp_f32 v51, v83
    v_add_f32 v40, v40, v48
    v_add_f32 v40, v40, v49
    v_cvt_pk_bf16_f32 v146, v48, v49
    v_exp_f32 v44, v68
    v_exp_f32 v45, v69
    ds_read_b128 v[196:199], v16 offset:12288
    v_add_f32 v40, v40, v50
    v_add_f32 v40, v40, v51
    v_cvt_pk_bf16_f32 v147, v50, v51
    v_exp_f32 v46, v70
    v_exp_f32 v47, v71
    ds_read_b128 v[200:203], v17 offset:8192
    v_add_f32 v41, v44, v45
    v_cvt_pk_bf16_f32 v148, v44, v45
    v_exp_f32 v48, v84
    v_exp_f32 v49, v85
    v_add_f32 v41, v41, v46
    ds_read_b128 v[204:207], v17 offset:12288
    v_add_f32 v41, v41, v47
    v_cvt_pk_bf16_f32 v149, v46, v47
    v_exp_f32 v50, v86
    v_exp_f32 v51, v87
    v_add_f32 v41, v41, v48
    ds_read_b128 v[208:211], v18 offset:8192
    v_add_f32 v41, v41, v49
    v_cvt_pk_bf16_f32 v150, v48, v49
    v_exp_f32 v44, v72
.attn_loop:
    s_waitcnt lgkmcnt(3)
    v_mfma_f32_16x16x32_bf16 v[96:99], v[192:195], a[128:131], v[128:131]
    v_exp_f32 v45, v73
    v_mfma_f32_16x16x32_bf16 v[100:103], v[192:195], a[144:147], v[132:135]
    v_add_f32 v41, v41, v50
    v_add_f32 v41, v41, v51
    v_mfma_f32_16x16x32_bf16 v[104:107], v[192:195], a[160:163], v[136:139]
    ds_read_b128 v[212:215], v18 offset:12288
    v_cvt_pk_bf16_f32 v151, v50, v51
    v_exp_f32 v46, v74
    v_mfma_f32_16x16x32_bf16 v[108:111], v[192:195], a[176:179], v[140:143]
    v_exp_f32 v47, v75
    v_mfma_f32_16x16x32_bf16 v[112:115], v[196:199], a[128:131], v[128:131]
    v_add_f32 v42, v44, v45
    v_mfma_f32_16x16x32_bf16 v[116:119], v[196:199], a[144:147], v[132:135]
    v_cvt_pk_bf16_f32 v152, v44, v45
    v_mfma_f32_16x16x32_bf16 v[120:123], v[196:199], a[160:163], v[136:139]
    ds_read_b128 v[216:219], v19 offset:8192
    v_exp_f32 v48, v88
    v_mfma_f32_16x16x32_bf16 v[124:127], v[196:199], a[176:179], v[140:143]
    v_exp_f32 v49, v89
    s_waitcnt lgkmcnt(3)
    v_mfma_f32_16x16x32_bf16 v[96:99], v[200:203], a[132:135], v[96:99]
    v_add_f32 v42, v42, v46
    v_add_f32 v42, v42, v47
    v_mfma_f32_16x16x32_bf16 v[100:103], v[200:203], a[148:151], v[100:103]
    v_cvt_pk_bf16_f32 v153, v46, v47
    v_exp_f32 v50, v90
    v_mfma_f32_16x16x32_bf16 v[104:107], v[200:203], a[164:167], v[104:107]
    ds_read_b128 v[220:223], v19 offset:12288
    v_exp_f32 v51, v91
    v_mfma_f32_16x16x32_bf16 v[108:111], v[200:203], a[180:183], v[108:111]
    v_add_f32 v42, v42, v48
    v_mfma_f32_16x16x32_bf16 v[112:115], v[204:207], a[132:135], v[112:115]
    v_add_f32 v42, v42, v49
    v_cvt_pk_bf16_f32 v154, v48, v49
    v_mfma_f32_16x16x32_bf16 v[116:119], v[204:207], a[148:151], v[116:119]
    v_exp_f32 v44, v76
    v_mfma_f32_16x16x32_bf16 v[120:123], v[204:207], a[164:167], v[120:123]
    ds_read_b64_tr_b16 v[192:193], v20 offset:0
    v_exp_f32 v45, v77
    v_mfma_f32_16x16x32_bf16 v[124:127], v[204:207], a[180:183], v[124:127]
    v_add_f32 v42, v42, v50
    s_waitcnt lgkmcnt(3)
    v_mfma_f32_16x16x32_bf16 v[96:99], v[208:211], a[136:139], v[96:99]
    ds_read_b64_tr_b16 v[194:195], v20 offset:4096
    v_add_f32 v42, v42, v51
    v_cvt_pk_bf16_f32 v155, v50, v51
    v_mfma_f32_16x16x32_bf16 v[100:103], v[208:211], a[152:155], v[100:103]
    v_exp_f32 v46, v78
    v_mfma_f32_16x16x32_bf16 v[104:107], v[208:211], a[168:171], v[104:107]
    ds_read_b64_tr_b16 v[196:197], v21 offset:0
    v_exp_f32 v47, v79
    v_mfma_f32_16x16x32_bf16 v[108:111], v[208:211], a[184:187], v[108:111]
    v_add_f32 v43, v44, v45
    v_cvt_pk_bf16_f32 v156, v44, v45
    v_mfma_f32_16x16x32_bf16 v[112:115], v[212:215], a[136:139], v[112:115]
    ds_read_b64_tr_b16 v[198:199], v21 offset:4096
    v_exp_f32 v48, v92
    v_mfma_f32_16x16x32_bf16 v[116:119], v[212:215], a[152:155], v[116:119]
    v_exp_f32 v49, v93
    v_mfma_f32_16x16x32_bf16 v[120:123], v[212:215], a[168:171], v[120:123]
    ds_read_b64_tr_b16 v[200:201], v22 offset:0
    v_add_f32 v43, v43, v46
    v_mfma_f32_16x16x32_bf16 v[124:127], v[212:215], a[184:187], v[124:127]
    v_add_f32 v43, v43, v47
    v_cvt_pk_bf16_f32 v157, v46, v47
    s_waitcnt lgkmcnt(5)
    v_mfma_f32_16x16x32_bf16 v[96:99], v[216:219], a[140:143], v[96:99]
    ds_read_b64_tr_b16 v[202:203], v22 offset:4096
    v_exp_f32 v50, v94
    v_mfma_f32_16x16x32_bf16 v[100:103], v[216:219], a[156:159], v[100:103]
    v_exp_f32 v51, v95
    v_mfma_f32_16x16x32_bf16 v[104:107], v[216:219], a[172:175], v[104:107]
    ds_read_b64_tr_b16 v[204:205], v23 offset:0
    v_add_f32 v43, v43, v48
    v_add_f32 v43, v43, v49
    v_mfma_f32_16x16x32_bf16 v[108:111], v[216:219], a[188:191], v[108:111]
    v_cvt_pk_bf16_f32 v158, v48, v49
    s_nop 0
    v_mfma_f32_16x16x32_bf16 v[112:115], v[220:223], a[140:143], v[112:115]
    ds_read_b64_tr_b16 v[206:207], v23 offset:4096
    v_add_f32 v43, v43, v50
    v_add_f32 v43, v43, v51
    v_mfma_f32_16x16x32_bf16 v[116:119], v[220:223], a[156:159], v[116:119]
    v_cvt_pk_bf16_f32 v159, v50, v51
    v_mfma_f32_16x16x32_bf16 v[120:123], v[220:223], a[172:175], v[120:123]
    ds_read_b64_tr_b16 v[208:209], v24 offset:0
    v_mfma_f32_16x16x32_bf16 v[124:127], v[220:223], a[188:191], v[124:127]
    v_max3_f32 v44, v40, v41, v42
    v_max_f32 v44, v44, v43
    v_cmp_lt_f32 vcc, s29, v44
    s_cbranch_vccnz .attn_fbs0
.attn_back0:
    v_add_f32 v36, v36, v40
    v_add_f32 v37, v37, v41
    v_add_f32 v38, v38, v42
    v_add_f32 v39, v39, v43
    s_waitcnt lgkmcnt(5)
    v_mfma_f32_16x16x32_bf16 a[0:3], v[192:195], v[144:147], a[0:3]
    ds_read_b64_tr_b16 v[210:211], v24 offset:4096
    v_mfma_f32_16x16x32_bf16 a[4:7], v[192:195], v[148:151], a[4:7]
    v_mfma_f32_16x16x32_bf16 a[8:11], v[192:195], v[152:155], a[8:11]
    ds_read_b64_tr_b16 v[212:213], v25 offset:0
    v_mfma_f32_16x16x32_bf16 a[12:15], v[192:195], v[156:159], a[12:15]
    v_mfma_f32_16x16x32_bf16 a[16:19], v[196:199], v[144:147], a[16:19]
    ds_read_b64_tr_b16 v[214:215], v25 offset:4096
    v_exp_f32 v44, v96
    v_mfma_f32_16x16x32_bf16 a[20:23], v[196:199], v[148:151], a[20:23]
    v_exp_f32 v45, v97
    v_mfma_f32_16x16x32_bf16 a[24:27], v[196:199], v[152:155], a[24:27]
    ds_read_b64_tr_b16 v[216:217], v26 offset:0
    v_exp_f32 v46, v98
    v_mfma_f32_16x16x32_bf16 a[28:31], v[196:199], v[156:159], a[28:31]
    v_exp_f32 v47, v99
    s_waitcnt lgkmcnt(5)
    v_mfma_f32_16x16x32_bf16 a[32:35], v[200:203], v[144:147], a[32:35]
    ds_read_b64_tr_b16 v[218:219], v26 offset:4096
    v_add_f32 v40, v44, v45
    v_cvt_pk_bf16_f32 v160, v44, v45
    v_mfma_f32_16x16x32_bf16 a[36:39], v[200:203], v[148:151], a[36:39]
    v_exp_f32 v48, v112
    v_mfma_f32_16x16x32_bf16 a[40:43], v[200:203], v[152:155], a[40:43]
    ds_read_b64_tr_b16 v[220:221], v27 offset:0
    v_exp_f32 v49, v113
    v_mfma_f32_16x16x32_bf16 a[44:47], v[200:203], v[156:159], a[44:47]
    v_add_f32 v40, v40, v46
    v_add_f32 v40, v40, v47
    v_mfma_f32_16x16x32_bf16 a[48:51], v[204:207], v[144:147], a[48:51]
    ds_read_b64_tr_b16 v[222:223], v27 offset:4096
    v_cvt_pk_bf16_f32 v161, v46, v47
    v_mfma_f32_16x16x32_bf16 a[52:55], v[204:207], v[148:151], a[52:55]
    s_waitcnt vmcnt(8)
    s_barrier
    v_exp_f32 v50, v114
    v_mfma_f32_16x16x32_bf16 a[56:59], v[204:207], v[152:155], a[56:59]
    ds_read_b128 v[192:195], v16 offset:16384
    s_add_u32 m0, s26, 49152
    v_exp_f32 v51, v115
    v_mfma_f32_16x16x32_bf16 a[60:63], v[204:207], v[156:159], a[60:63]
    buffer_load_dwordx4 v28, s[8:11], s27 offen lds
    v_add_f32 v40, v40, v48
    v_add_f32 v40, v40, v49
    s_waitcnt lgkmcnt(5)
    v_mfma_f32_16x16x32_bf16 a[64:67], v[208:211], v[144:147], a[64:67]
    v_cvt_pk_bf16_f32 v162, v48, v49
    v_exp_f32 v44, v100
    v_mfma_f32_16x16x32_bf16 a[68:71], v[208:211], v[148:151], a[68:71]
    v_exp_f32 v45, v101
    v_mfma_f32_16x16x32_bf16 a[72:75], v[208:211], v[152:155], a[72:75]
    ds_read_b128 v[196:199], v16 offset:20480
    s_add_u32 m0, s26, 53248
    v_add_f32 v40, v40, v50
    v_mfma_f32_16x16x32_bf16 a[76:79], v[208:211], v[156:159], a[76:79]
    buffer_load_dwordx4 v29, s[8:11], s27 offen lds
    v_add_f32 v40, v40, v51
    v_cvt_pk_bf16_f32 v163, v50, v51
    v_mfma_f32_16x16x32_bf16 a[80:83], v[212:215], v[144:147], a[80:83]
    v_exp_f32 v46, v102
    v_mfma_f32_16x16x32_bf16 a[84:87], v[212:215], v[148:151], a[84:87]
    v_exp_f32 v47, v103
    v_mfma_f32_16x16x32_bf16 a[88:91], v[212:215], v[152:155], a[88:91]
    ds_read_b128 v[200:203], v17 offset:16384
    s_add_u32 m0, s26, 57344
    v_add_f32 v41, v44, v45
    v_mfma_f32_16x16x32_bf16 a[92:95], v[212:215], v[156:159], a[92:95]
    buffer_load_dwordx4 v30, s[8:11], s27 offen lds
    v_cvt_pk_bf16_f32 v164, v44, v45
    v_exp_f32 v48, v116
    s_waitcnt lgkmcnt(3)
    v_mfma_f32_16x16x32_bf16 a[96:99], v[216:219], v[144:147], a[96:99]
    v_exp_f32 v49, v117
    v_mfma_f32_16x16x32_bf16 a[100:103], v[216:219], v[148:151], a[100:103]
    v_add_f32 v41, v41, v46
    v_mfma_f32_16x16x32_bf16 a[104:107], v[216:219], v[152:155], a[104:107]
    ds_read_b128 v[204:207], v17 offset:20480
    s_add_u32 m0, s26, 61440
    v_add_f32 v41, v41, v47
    v_cvt_pk_bf16_f32 v165, v46, v47
    v_mfma_f32_16x16x32_bf16 a[108:111], v[216:219], v[156:159], a[108:111]
    buffer_load_dwordx4 v31, s[8:11], s27 offen lds
    v_exp_f32 v50, v118
    v_mfma_f32_16x16x32_bf16 a[112:115], v[220:223], v[144:147], a[112:115]
    v_exp_f32 v51, v119
    v_mfma_f32_16x16x32_bf16 a[116:119], v[220:223], v[148:151], a[116:119]
    v_add_f32 v41, v41, v48
    v_mfma_f32_16x16x32_bf16 a[120:123], v[220:223], v[152:155], a[120:123]
    ds_read_b128 v[208:211], v18 offset:16384
    s_add_u32 m0, s26, 114688
    v_add_f32 v41, v41, v49
    v_cvt_pk_bf16_f32 v166, v48, v49
    v_mfma_f32_16x16x32_bf16 a[124:127], v[220:223], v[156:159], a[124:127]
    buffer_load_dwordx4 v32, s[12:15], s27 offen lds
    v_exp_f32 v44, v104
    s_waitcnt lgkmcnt(3)
    v_mfma_f32_16x16x32_bf16 v[64:67], v[192:195], a[128:131], v[128:131]
    v_exp_f32 v45, v105
    v_mfma_f32_16x16x32_bf16 v[68:71], v[192:195], a[144:147], v[132:135]
    v_add_f32 v41, v41, v50
    v_add_f32 v41, v41, v51
    v_mfma_f32_16x16x32_bf16 v[72:75], v[192:195], a[160:163], v[136:139]
    ds_read_b128 v[212:215], v18 offset:20480
    s_add_u32 m0, s26, 118784
    v_cvt_pk_bf16_f32 v167, v50, v51
    v_exp_f32 v46, v106
    v_mfma_f32_16x16x32_bf16 v[76:79], v[192:195], a[176:179], v[140:143]
    buffer_load_dwordx4 v33, s[12:15], s27 offen lds
    v_exp_f32 v47, v107
    v_mfma_f32_16x16x32_bf16 v[80:83], v[196:199], a[128:131], v[128:131]
    v_add_f32 v42, v44, v45
    v_mfma_f32_16x16x32_bf16 v[84:87], v[196:199], a[144:147], v[132:135]
    v_cvt_pk_bf16_f32 v168, v44, v45
    v_mfma_f32_16x16x32_bf16 v[88:91], v[196:199], a[160:163], v[136:139]
    ds_read_b128 v[216:219], v19 offset:16384
    s_add_u32 m0, s26, 122880
    v_exp_f32 v48, v120
    v_mfma_f32_16x16x32_bf16 v[92:95], v[196:199], a[176:179], v[140:143]
    buffer_load_dwordx4 v34, s[12:15], s27 offen lds
    v_exp_f32 v49, v121
    s_waitcnt lgkmcnt(3)
    v_mfma_f32_16x16x32_bf16 v[64:67], v[200:203], a[132:135], v[64:67]
    v_add_f32 v42, v42, v46
    v_add_f32 v42, v42, v47
    v_mfma_f32_16x16x32_bf16 v[68:71], v[200:203], a[148:151], v[68:71]
    v_cvt_pk_bf16_f32 v169, v46, v47
    v_exp_f32 v50, v122
    v_mfma_f32_16x16x32_bf16 v[72:75], v[200:203], a[164:167], v[72:75]
    ds_read_b128 v[220:223], v19 offset:20480
    s_add_u32 m0, s26, 126976
    v_exp_f32 v51, v123
    v_mfma_f32_16x16x32_bf16 v[76:79], v[200:203], a[180:183], v[76:79]
    buffer_load_dwordx4 v35, s[12:15], s27 offen lds
    v_add_f32 v42, v42, v48
    v_mfma_f32_16x16x32_bf16 v[80:83], v[204:207], a[132:135], v[80:83]
    v_add_f32 v42, v42, v49
    v_cvt_pk_bf16_f32 v170, v48, v49
    v_mfma_f32_16x16x32_bf16 v[84:87], v[204:207], a[148:151], v[84:87]
    v_exp_f32 v44, v108
    v_mfma_f32_16x16x32_bf16 v[88:91], v[204:207], a[164:167], v[88:91]
    ds_read_b64_tr_b16 v[192:193], v20 offset:8192
    v_exp_f32 v45, v109
    v_mfma_f32_16x16x32_bf16 v[92:95], v[204:207], a[180:183], v[92:95]
    v_add_f32 v42, v42, v50
    s_waitcnt lgkmcnt(3)
    v_mfma_f32_16x16x32_bf16 v[64:67], v[208:211], a[136:139], v[64:67]
    ds_read_b64_tr_b16 v[194:195], v20 offset:12288
    s_add_u32 s27, s27, 16384
    v_add_f32 v42, v42, v51
    v_cvt_pk_bf16_f32 v171, v50, v51
    v_mfma_f32_16x16x32_bf16 v[68:71], v[208:211], a[152:155], v[68:71]
    v_exp_f32 v46, v110
    v_mfma_f32_16x16x32_bf16 v[72:75], v[208:211], a[168:171], v[72:75]
    ds_read_b64_tr_b16 v[196:197], v21 offset:8192
    v_exp_f32 v47, v111
    v_mfma_f32_16x16x32_bf16 v[76:79], v[208:211], a[184:187], v[76:79]
    v_add_f32 v43, v44, v45
    v_cvt_pk_bf16_f32 v172, v44, v45
    v_mfma_f32_16x16x32_bf16 v[80:83], v[212:215], a[136:139], v[80:83]
    ds_read_b64_tr_b16 v[198:199], v21 offset:12288
    v_exp_f32 v48, v124
    v_mfma_f32_16x16x32_bf16 v[84:87], v[212:215], a[152:155], v[84:87]
    v_exp_f32 v49, v125
    v_mfma_f32_16x16x32_bf16 v[88:91], v[212:215], a[168:171], v[88:91]
    ds_read_b64_tr_b16 v[200:201], v22 offset:8192
    v_add_f32 v43, v43, v46
    v_mfma_f32_16x16x32_bf16 v[92:95], v[212:215], a[184:187], v[92:95]
    v_add_f32 v43, v43, v47
    v_cvt_pk_bf16_f32 v173, v46, v47
    s_waitcnt lgkmcnt(5)
    v_mfma_f32_16x16x32_bf16 v[64:67], v[216:219], a[140:143], v[64:67]
    ds_read_b64_tr_b16 v[202:203], v22 offset:12288
    v_exp_f32 v50, v126
    v_mfma_f32_16x16x32_bf16 v[68:71], v[216:219], a[156:159], v[68:71]
    v_exp_f32 v51, v127
    v_mfma_f32_16x16x32_bf16 v[72:75], v[216:219], a[172:175], v[72:75]
    ds_read_b64_tr_b16 v[204:205], v23 offset:8192
    v_add_f32 v43, v43, v48
    v_add_f32 v43, v43, v49
    v_mfma_f32_16x16x32_bf16 v[76:79], v[216:219], a[188:191], v[76:79]
    v_cvt_pk_bf16_f32 v174, v48, v49
    s_nop 0
    v_mfma_f32_16x16x32_bf16 v[80:83], v[220:223], a[140:143], v[80:83]
    ds_read_b64_tr_b16 v[206:207], v23 offset:12288
    v_add_f32 v43, v43, v50
    v_add_f32 v43, v43, v51
    v_mfma_f32_16x16x32_bf16 v[84:87], v[220:223], a[156:159], v[84:87]
    v_cvt_pk_bf16_f32 v175, v50, v51
    v_mfma_f32_16x16x32_bf16 v[88:91], v[220:223], a[172:175], v[88:91]
    ds_read_b64_tr_b16 v[208:209], v24 offset:8192
    v_mfma_f32_16x16x32_bf16 v[92:95], v[220:223], a[188:191], v[92:95]
    v_max3_f32 v44, v40, v41, v42
    v_max_f32 v44, v44, v43
    v_cmp_lt_f32 vcc, s29, v44
    s_cbranch_vccnz .attn_fbs1
.attn_back1:
    v_add_f32 v36, v36, v40
    v_add_f32 v37, v37, v41
    v_add_f32 v38, v38, v42
    v_add_f32 v39, v39, v43
    s_waitcnt lgkmcnt(5)
    v_mfma_f32_16x16x32_bf16 a[0:3], v[192:195], v[160:163], a[0:3]
    ds_read_b64_tr_b16 v[210:211], v24 offset:12288
    v_mfma_f32_16x16x32_bf16 a[4:7], v[192:195], v[164:167], a[4:7]
    v_mfma_f32_16x16x32_bf16 a[8:11], v[192:195], v[168:171], a[8:11]
    ds_read_b64_tr_b16 v[212:213], v25 offset:8192
    v_mfma_f32_16x16x32_bf16 a[12:15], v[192:195], v[172:175], a[12:15]
    v_mfma_f32_16x16x32_bf16 a[16:19], v[196:199], v[160:163], a[16:19]
    ds_read_b64_tr_b16 v[214:215], v25 offset:12288
    v_exp_f32 v44, v64
    v_mfma_f32_16x16x32_bf16 a[20:23], v[196:199], v[164:167], a[20:23]
    v_exp_f32 v45, v65
    v_mfma_f32_16x16x32_bf16 a[24:27], v[196:199], v[168:171], a[24:27]
    ds_read_b64_tr_b16 v[216:217], v26 offset:8192
    v_exp_f32 v46, v66
    v_mfma_f32_16x16x32_bf16 a[28:31], v[196:199], v[172:175], a[28:31]
    v_exp_f32 v47, v67
    s_waitcnt lgkmcnt(5)
    v_mfma_f32_16x16x32_bf16 a[32:35], v[200:203], v[160:163], a[32:35]
    ds_read_b64_tr_b16 v[218:219], v26 offset:12288
    v_add_f32 v40, v44, v45
    v_cvt_pk_bf16_f32 v144, v44, v45
    v_mfma_f32_16x16x32_bf16 a[36:39], v[200:203], v[164:167], a[36:39]
    v_exp_f32 v48, v80
    v_mfma_f32_16x16x32_bf16 a[40:43], v[200:203], v[168:171], a[40:43]
    ds_read_b64_tr_b16 v[220:221], v27 offset:8192
    v_exp_f32 v49, v81
    v_mfma_f32_16x16x32_bf16 a[44:47], v[200:203], v[172:175], a[44:47]
    v_add_f32 v40, v40, v46
    v_add_f32 v40, v40, v47
    v_mfma_f32_16x16x32_bf16 a[48:51], v[204:207], v[160:163], a[48:51]
    ds_read_b64_tr_b16 v[222:223], v27 offset:12288
    v_cvt_pk_bf16_f32 v145, v46, v47
    v_mfma_f32_16x16x32_bf16 a[52:55], v[204:207], v[164:167], a[52:55]
    v_exp_f32 v50, v82
    v_mfma_f32_16x16x32_bf16 a[56:59], v[204:207], v[168:171], a[56:59]
    ds_read_b128 v[192:195], v16 offset:24576
    v_exp_f32 v51, v83
    v_mfma_f32_16x16x32_bf16 a[60:63], v[204:207], v[172:175], a[60:63]
    v_add_f32 v40, v40, v48
    v_add_f32 v40, v40, v49
    s_waitcnt lgkmcnt(5)
    v_mfma_f32_16x16x32_bf16 a[64:67], v[208:211], v[160:163], a[64:67]
    v_cvt_pk_bf16_f32 v146, v48, v49
    v_exp_f32 v44, v68
    v_mfma_f32_16x16x32_bf16 a[68:71], v[208:211], v[164:167], a[68:71]
    v_exp_f32 v45, v69
    v_mfma_f32_16x16x32_bf16 a[72:75], v[208:211], v[168:171], a[72:75]
    ds_read_b128 v[196:199], v16 offset:28672
    v_add_f32 v40, v40, v50
    v_mfma_f32_16x16x32_bf16 a[76:79], v[208:211], v[172:175], a[76:79]
    v_add_f32 v40, v40, v51
    v_cvt_pk_bf16_f32 v147, v50, v51
    v_mfma_f32_16x16x32_bf16 a[80:83], v[212:215], v[160:163], a[80:83]
    v_exp_f32 v46, v70
    v_mfma_f32_16x16x32_bf16 a[84:87], v[212:215], v[164:167], a[84:87]
    v_exp_f32 v47, v71
    v_mfma_f32_16x16x32_bf16 a[88:91], v[212:215], v[168:171], a[88:91]
    ds_read_b128 v[200:203], v17 offset:24576
    v_add_f32 v41, v44, v45
    v_mfma_f32_16x16x32_bf16 a[92:95], v[212:215], v[172:175], a[92:95]
    v_cvt_pk_bf16_f32 v148, v44, v45
    v_exp_f32 v48, v84
    s_waitcnt lgkmcnt(3)
    v_mfma_f32_16x16x32_bf16 a[96:99], v[216:219], v[160:163], a[96:99]
    v_exp_f32 v49, v85
    v_mfma_f32_16x16x32_bf16 a[100:103], v[216:219], v[164:167], a[100:103]
    v_add_f32 v41, v41, v46
    v_mfma_f32_16x16x32_bf16 a[104:107], v[216:219], v[168:171], a[104:107]
    ds_read_b128 v[204:207], v17 offset:28672
    v_add_f32 v41, v41, v47
    v_cvt_pk_bf16_f32 v149, v46, v47
    v_mfma_f32_16x16x32_bf16 a[108:111], v[216:219], v[172:175], a[108:111]
    v_exp_f32 v50, v86
    v_mfma_f32_16x16x32_bf16 a[112:115], v[220:223], v[160:163], a[112:115]
    v_exp_f32 v51, v87
    v_mfma_f32_16x16x32_bf16 a[116:119], v[220:223], v[164:167], a[116:119]
    v_add_f32 v41, v41, v48
    v_mfma_f32_16x16x32_bf16 a[120:123], v[220:223], v[168:171], a[120:123]
    ds_read_b128 v[208:211], v18 offset:24576
    v_add_f32 v41, v41, v49
    v_cvt_pk_bf16_f32 v150, v48, v49
    v_mfma_f32_16x16x32_bf16 a[124:127], v[220:223], v[172:175], a[124:127]
    v_exp_f32 v44, v72
    s_waitcnt lgkmcnt(3)
    v_mfma_f32_16x16x32_bf16 v[96:99], v[192:195], a[128:131], v[128:131]
    v_exp_f32 v45, v73
    v_mfma_f32_16x16x32_bf16 v[100:103], v[192:195], a[144:147], v[132:135]
    v_add_f32 v41, v41, v50
    v_add_f32 v41, v41, v51
    v_mfma_f32_16x16x32_bf16 v[104:107], v[192:195], a[160:163], v[136:139]
    ds_read_b128 v[212:215], v18 offset:28672
    v_cvt_pk_bf16_f32 v151, v50, v51
    v_exp_f32 v46, v74
    v_mfma_f32_16x16x32_bf16 v[108:111], v[192:195], a[176:179], v[140:143]
    v_exp_f32 v47, v75
    v_mfma_f32_16x16x32_bf16 v[112:115], v[196:199], a[128:131], v[128:131]
    v_add_f32 v42, v44, v45
    v_mfma_f32_16x16x32_bf16 v[116:119], v[196:199], a[144:147], v[132:135]
    v_cvt_pk_bf16_f32 v152, v44, v45
    v_mfma_f32_16x16x32_bf16 v[120:123], v[196:199], a[160:163], v[136:139]
    ds_read_b128 v[216:219], v19 offset:24576
    v_exp_f32 v48, v88
    v_mfma_f32_16x16x32_bf16 v[124:127], v[196:199], a[176:179], v[140:143]
    v_exp_f32 v49, v89
    s_waitcnt lgkmcnt(3)
    v_mfma_f32_16x16x32_bf16 v[96:99], v[200:203], a[132:135], v[96:99]
    v_add_f32 v42, v42, v46
    v_add_f32 v42, v42, v47
    v_mfma_f32_16x16x32_bf16 v[100:103], v[200:203], a[148:151], v[100:103]
    v_cvt_pk_bf16_f32 v153, v46, v47
    v_exp_f32 v50, v90
    v_mfma_f32_16x16x32_bf16 v[104:107], v[200:203], a[164:167], v[104:107]
    ds_read_b128 v[220:223], v19 offset:28672
    v_exp_f32 v51, v91
    v_mfma_f32_16x16x32_bf16 v[108:111], v[200:203], a[180:183], v[108:111]
    v_add_f32 v42, v42, v48
    v_mfma_f32_16x16x32_bf16 v[112:115], v[204:207], a[132:135], v[112:115]
    v_add_f32 v42, v42, v49
    v_cvt_pk_bf16_f32 v154, v48, v49
    v_mfma_f32_16x16x32_bf16 v[116:119], v[204:207], a[148:151], v[116:119]
    v_exp_f32 v44, v76
    v_mfma_f32_16x16x32_bf16 v[120:123], v[204:207], a[164:167], v[120:123]
    ds_read_b64_tr_b16 v[192:193], v20 offset:16384
    v_exp_f32 v45, v77
    v_mfma_f32_16x16x32_bf16 v[124:127], v[204:207], a[180:183], v[124:127]
    v_add_f32 v42, v42, v50
    s_waitcnt lgkmcnt(3)
    v_mfma_f32_16x16x32_bf16 v[96:99], v[208:211], a[136:139], v[96:99]
    ds_read_b64_tr_b16 v[194:195], v20 offset:20480
    v_add_f32 v42, v42, v51
    v_cvt_pk_bf16_f32 v155, v50, v51
    v_mfma_f32_16x16x32_bf16 v[100:103], v[208:211], a[152:155], v[100:103]
    v_exp_f32 v46, v78
    v_mfma_f32_16x16x32_bf16 v[104:107], v[208:211], a[168:171], v[104:107]
    ds_read_b64_tr_b16 v[196:197], v21 offset:16384
    v_exp_f32 v47, v79
    v_mfma_f32_16x16x32_bf16 v[108:111], v[208:211], a[184:187], v[108:111]
    v_add_f32 v43, v44, v45
    v_cvt_pk_bf16_f32 v156, v44, v45
    v_mfma_f32_16x16x32_bf16 v[112:115], v[212:215], a[136:139], v[112:115]
    ds_read_b64_tr_b16 v[198:199], v21 offset:20480
    v_exp_f32 v48, v92
    v_mfma_f32_16x16x32_bf16 v[116:119], v[212:215], a[152:155], v[116:119]
    v_exp_f32 v49, v93
    v_mfma_f32_16x16x32_bf16 v[120:123], v[212:215], a[168:171], v[120:123]
    ds_read_b64_tr_b16 v[200:201], v22 offset:16384
    v_add_f32 v43, v43, v46
    v_mfma_f32_16x16x32_bf16 v[124:127], v[212:215], a[184:187], v[124:127]
    v_add_f32 v43, v43, v47
    v_cvt_pk_bf16_f32 v157, v46, v47
    s_waitcnt lgkmcnt(5)
    v_mfma_f32_16x16x32_bf16 v[96:99], v[216:219], a[140:143], v[96:99]
    ds_read_b64_tr_b16 v[202:203], v22 offset:20480
    v_exp_f32 v50, v94
    v_mfma_f32_16x16x32_bf16 v[100:103], v[216:219], a[156:159], v[100:103]
    v_exp_f32 v51, v95
    v_mfma_f32_16x16x32_bf16 v[104:107], v[216:219], a[172:175], v[104:107]
    ds_read_b64_tr_b16 v[204:205], v23 offset:16384
    v_add_f32 v43, v43, v48
    v_add_f32 v43, v43, v49
    v_mfma_f32_16x16x32_bf16 v[108:111], v[216:219], a[188:191], v[108:111]
    v_cvt_pk_bf16_f32 v158, v48, v49
    s_nop 0
    v_mfma_f32_16x16x32_bf16 v[112:115], v[220:223], a[140:143], v[112:115]
    ds_read_b64_tr_b16 v[206:207], v23 offset:20480
    v_add_f32 v43, v43, v50
    v_add_f32 v43, v43, v51
    v_mfma_f32_16x16x32_bf16 v[116:119], v[220:223], a[156:159], v[116:119]
    v_cvt_pk_bf16_f32 v159, v50, v51
    v_mfma_f32_16x16x32_bf16 v[120:123], v[220:223], a[172:175], v[120:123]
    ds_read_b64_tr_b16 v[208:209], v24 offset:16384
    v_mfma_f32_16x16x32_bf16 v[124:127], v[220:223], a[188:191], v[124:127]
    v_max3_f32 v44, v40, v41, v42
    v_max_f32 v44, v44, v43
    v_cmp_lt_f32 vcc, s29, v44
    s_cbranch_vccnz .attn_fbs2
.attn_back2:
    v_add_f32 v36, v36, v40
    v_add_f32 v37, v37, v41
    v_add_f32 v38, v38, v42
    v_add_f32 v39, v39, v43
    s_waitcnt lgkmcnt(5)
    v_mfma_f32_16x16x32_bf16 a[0:3], v[192:195], v[144:147], a[0:3]
    ds_read_b64_tr_b16 v[210:211], v24 offset:20480
    v_mfma_f32_16x16x32_bf16 a[4:7], v[192:195], v[148:151], a[4:7]
    v_mfma_f32_16x16x32_bf16 a[8:11], v[192:195], v[152:155], a[8:11]
    ds_read_b64_tr_b16 v[212:213], v25 offset:16384
    v_mfma_f32_16x16x32_bf16 a[12:15], v[192:195], v[156:159], a[12:15]
    v_mfma_f32_16x16x32_bf16 a[16:19], v[196:199], v[144:147], a[16:19]
    ds_read_b64_tr_b16 v[214:215], v25 offset:20480
    v_exp_f32 v44, v96
    v_mfma_f32_16x16x32_bf16 a[20:23], v[196:199], v[148:151], a[20:23]
    v_exp_f32 v45, v97
    v_mfma_f32_16x16x32_bf16 a[24:27], v[196:199], v[152:155], a[24:27]
    ds_read_b64_tr_b16 v[216:217], v26 offset:16384
    v_exp_f32 v46, v98
    v_mfma_f32_16x16x32_bf16 a[28:31], v[196:199], v[156:159], a[28:31]
    v_exp_f32 v47, v99
    s_waitcnt lgkmcnt(5)
    v_mfma_f32_16x16x32_bf16 a[32:35], v[200:203], v[144:147], a[32:35]
    ds_read_b64_tr_b16 v[218:219], v26 offset:20480
    v_add_f32 v40, v44, v45
    v_cvt_pk_bf16_f32 v160, v44, v45
    v_mfma_f32_16x16x32_bf16 a[36:39], v[200:203], v[148:151], a[36:39]
    v_exp_f32 v48, v112
    v_mfma_f32_16x16x32_bf16 a[40:43], v[200:203], v[152:155], a[40:43]
    ds_read_b64_tr_b16 v[220:221], v27 offset:16384
    v_exp_f32 v49, v113
    v_mfma_f32_16x16x32_bf16 a[44:47], v[200:203], v[156:159], a[44:47]
    v_add_f32 v40, v40, v46
    v_add_f32 v40, v40, v47
    v_mfma_f32_16x16x32_bf16 a[48:51], v[204:207], v[144:147], a[48:51]
    ds_read_b64_tr_b16 v[222:223], v27 offset:20480
    v_cvt_pk_bf16_f32 v161, v46, v47
    v_mfma_f32_16x16x32_bf16 a[52:55], v[204:207], v[148:151], a[52:55]
    s_waitcnt vmcnt(8)
    s_barrier
    v_exp_f32 v50, v114
    v_mfma_f32_16x16x32_bf16 a[56:59], v[204:207], v[152:155], a[56:59]
    ds_read_b128 v[192:195], v16 offset:32768
    s_add_u32 m0, s26, 0
    v_exp_f32 v51, v115
    v_mfma_f32_16x16x32_bf16 a[60:63], v[204:207], v[156:159], a[60:63]
    buffer_load_dwordx4 v28, s[8:11], s27 offen lds
    v_add_f32 v40, v40, v48
    v_add_f32 v40, v40, v49
    s_waitcnt lgkmcnt(5)
    v_mfma_f32_16x16x32_bf16 a[64:67], v[208:211], v[144:147], a[64:67]
    v_cvt_pk_bf16_f32 v162, v48, v49
    v_exp_f32 v44, v100
    v_mfma_f32_16x16x32_bf16 a[68:71], v[208:211], v[148:151], a[68:71]
    v_exp_f32 v45, v101
    v_mfma_f32_16x16x32_bf16 a[72:75], v[208:211], v[152:155], a[72:75]
    ds_read_b128 v[196:199], v16 offset:36864
    s_add_u32 m0, s26, 4096
    v_add_f32 v40, v40, v50
    v_mfma_f32_16x16x32_bf16 a[76:79], v[208:211], v[156:159], a[76:79]
    buffer_load_dwordx4 v29, s[8:11], s27 offen lds
    v_add_f32 v40, v40, v51
    v_cvt_pk_bf16_f32 v163, v50, v51
    v_mfma_f32_16x16x32_bf16 a[80:83], v[212:215], v[144:147], a[80:83]
    v_exp_f32 v46, v102
    v_mfma_f32_16x16x32_bf16 a[84:87], v[212:215], v[148:151], a[84:87]
    v_exp_f32 v47, v103
    v_mfma_f32_16x16x32_bf16 a[88:91], v[212:215], v[152:155], a[88:91]
    ds_read_b128 v[200:203], v17 offset:32768
    s_add_u32 m0, s26, 8192
    v_add_f32 v41, v44, v45
    v_mfma_f32_16x16x32_bf16 a[92:95], v[212:215], v[156:159], a[92:95]
    buffer_load_dwordx4 v30, s[8:11], s27 offen lds
    v_cvt_pk_bf16_f32 v164, v44, v45
    v_exp_f32 v48, v116
    s_waitcnt lgkmcnt(3)
    v_mfma_f32_16x16x32_bf16 a[96:99], v[216:219], v[144:147], a[96:99]
    v_exp_f32 v49, v117
    v_mfma_f32_16x16x32_bf16 a[100:103], v[216:219], v[148:151], a[100:103]
    v_add_f32 v41, v41, v46
    v_mfma_f32_16x16x32_bf16 a[104:107], v[216:219], v[152:155], a[104:107]
    ds_read_b128 v[204:207], v17 offset:36864
    s_add_u32 m0, s26, 12288
    v_add_f32 v41, v41, v47
    v_cvt_pk_bf16_f32 v165, v46, v47
    v_mfma_f32_16x16x32_bf16 a[108:111], v[216:219], v[156:159], a[108:111]
    buffer_load_dwordx4 v31, s[8:11], s27 offen lds
    v_exp_f32 v50, v118
    v_mfma_f32_16x16x32_bf16 a[112:115], v[220:223], v[144:147], a[112:115]
    v_exp_f32 v51, v119
    v_mfma_f32_16x16x32_bf16 a[116:119], v[220:223], v[148:151], a[116:119]
    v_add_f32 v41, v41, v48
    v_mfma_f32_16x16x32_bf16 a[120:123], v[220:223], v[152:155], a[120:123]
    ds_read_b128 v[208:211], v18 offset:32768
    s_add_u32 m0, s26, 65536
    v_add_f32 v41, v41, v49
    v_cvt_pk_bf16_f32 v166, v48, v49
    v_mfma_f32_16x16x32_bf16 a[124:127], v[220:223], v[156:159], a[124:127]
    buffer_load_dwordx4 v32, s[12:15], s27 offen lds
    v_exp_f32 v44, v104
    s_waitcnt lgkmcnt(3)
    v_mfma_f32_16x16x32_bf16 v[64:67], v[192:195], a[128:131], v[128:131]
    v_exp_f32 v45, v105
    v_mfma_f32_16x16x32_bf16 v[68:71], v[192:195], a[144:147], v[132:135]
    v_add_f32 v41, v41, v50
    v_add_f32 v41, v41, v51
    v_mfma_f32_16x16x32_bf16 v[72:75], v[192:195], a[160:163], v[136:139]
    ds_read_b128 v[212:215], v18 offset:36864
    s_add_u32 m0, s26, 69632
    v_cvt_pk_bf16_f32 v167, v50, v51
    v_exp_f32 v46, v106
    v_mfma_f32_16x16x32_bf16 v[76:79], v[192:195], a[176:179], v[140:143]
    buffer_load_dwordx4 v33, s[12:15], s27 offen lds
    v_exp_f32 v47, v107
    v_mfma_f32_16x16x32_bf16 v[80:83], v[196:199], a[128:131], v[128:131]
    v_add_f32 v42, v44, v45
    v_mfma_f32_16x16x32_bf16 v[84:87], v[196:199], a[144:147], v[132:135]
    v_cvt_pk_bf16_f32 v168, v44, v45
    v_mfma_f32_16x16x32_bf16 v[88:91], v[196:199], a[160:163], v[136:139]
    ds_read_b128 v[216:219], v19 offset:32768
    s_add_u32 m0, s26, 73728
    v_exp_f32 v48, v120
    v_mfma_f32_16x16x32_bf16 v[92:95], v[196:199], a[176:179], v[140:143]
    buffer_load_dwordx4 v34, s[12:15], s27 offen lds
    v_exp_f32 v49, v121
    s_waitcnt lgkmcnt(3)
    v_mfma_f32_16x16x32_bf16 v[64:67], v[200:203], a[132:135], v[64:67]
    v_add_f32 v42, v42, v46
    v_add_f32 v42, v42, v47
    v_mfma_f32_16x16x32_bf16 v[68:71], v[200:203], a[148:151], v[68:71]
    v_cvt_pk_bf16_f32 v169, v46, v47
    v_exp_f32 v50, v122
    v_mfma_f32_16x16x32_bf16 v[72:75], v[200:203], a[164:167], v[72:75]
    ds_read_b128 v[220:223], v19 offset:36864
    s_add_u32 m0, s26, 77824
    v_exp_f32 v51, v123
    v_mfma_f32_16x16x32_bf16 v[76:79], v[200:203], a[180:183], v[76:79]
    buffer_load_dwordx4 v35, s[12:15], s27 offen lds
    v_add_f32 v42, v42, v48
    v_mfma_f32_16x16x32_bf16 v[80:83], v[204:207], a[132:135], v[80:83]
    v_add_f32 v42, v42, v49
    v_cvt_pk_bf16_f32 v170, v48, v49
    v_mfma_f32_16x16x32_bf16 v[84:87], v[204:207], a[148:151], v[84:87]
    v_exp_f32 v44, v108
    v_mfma_f32_16x16x32_bf16 v[88:91], v[204:207], a[164:167], v[88:91]
    ds_read_b64_tr_b16 v[192:193], v20 offset:24576
    v_exp_f32 v45, v109
    v_mfma_f32_16x16x32_bf16 v[92:95], v[204:207], a[180:183], v[92:95]
    v_add_f32 v42, v42, v50
    s_waitcnt lgkmcnt(3)
    v_mfma_f32_16x16x32_bf16 v[64:67], v[208:211], a[136:139], v[64:67]
    ds_read_b64_tr_b16 v[194:195], v20 offset:28672
    s_add_u32 s27, s27, 16384
    v_add_f32 v42, v42, v51
    v_cvt_pk_bf16_f32 v171, v50, v51
    v_mfma_f32_16x16x32_bf16 v[68:71], v[208:211], a[152:155], v[68:71]
    v_exp_f32 v46, v110
    v_mfma_f32_16x16x32_bf16 v[72:75], v[208:211], a[168:171], v[72:75]
    ds_read_b64_tr_b16 v[196:197], v21 offset:24576
    v_exp_f32 v47, v111
    v_mfma_f32_16x16x32_bf16 v[76:79], v[208:211], a[184:187], v[76:79]
    v_add_f32 v43, v44, v45
    v_cvt_pk_bf16_f32 v172, v44, v45
    v_mfma_f32_16x16x32_bf16 v[80:83], v[212:215], a[136:139], v[80:83]
    ds_read_b64_tr_b16 v[198:199], v21 offset:28672
    v_exp_f32 v48, v124
    v_mfma_f32_16x16x32_bf16 v[84:87], v[212:215], a[152:155], v[84:87]
    v_exp_f32 v49, v125
    v_mfma_f32_16x16x32_bf16 v[88:91], v[212:215], a[168:171], v[88:91]
    ds_read_b64_tr_b16 v[200:201], v22 offset:24576
    v_add_f32 v43, v43, v46
    v_mfma_f32_16x16x32_bf16 v[92:95], v[212:215], a[184:187], v[92:95]
    v_add_f32 v43, v43, v47
    v_cvt_pk_bf16_f32 v173, v46, v47
    s_waitcnt lgkmcnt(5)
    v_mfma_f32_16x16x32_bf16 v[64:67], v[216:219], a[140:143], v[64:67]
    ds_read_b64_tr_b16 v[202:203], v22 offset:28672
    v_exp_f32 v50, v126
    v_mfma_f32_16x16x32_bf16 v[68:71], v[216:219], a[156:159], v[68:71]
    v_exp_f32 v51, v127
    v_mfma_f32_16x16x32_bf16 v[72:75], v[216:219], a[172:175], v[72:75]
    ds_read_b64_tr_b16 v[204:205], v23 offset:24576
    v_add_f32 v43, v43, v48
    v_add_f32 v43, v43, v49
    v_mfma_f32_16x16x32_bf16 v[76:79], v[216:219], a[188:191], v[76:79]
    v_cvt_pk_bf16_f32 v174, v48, v49
    s_nop 0
    v_mfma_f32_16x16x32_bf16 v[80:83], v[220:223], a[140:143], v[80:83]
    ds_read_b64_tr_b16 v[206:207], v23 offset:28672
    v_add_f32 v43, v43, v50
    v_add_f32 v43, v43, v51
    v_mfma_f32_16x16x32_bf16 v[84:87], v[220:223], a[156:159], v[84:87]
    v_cvt_pk_bf16_f32 v175, v50, v51
    v_mfma_f32_16x16x32_bf16 v[88:91], v[220:223], a[172:175], v[88:91]
    ds_read_b64_tr_b16 v[208:209], v24 offset:24576
    v_mfma_f32_16x16x32_bf16 v[92:95], v[220:223], a[188:191], v[92:95]
    v_max3_f32 v44, v40, v41, v42
    v_max_f32 v44, v44, v43
    v_cmp_lt_f32 vcc, s29, v44
    s_cbranch_vccnz .attn_fbs3
.attn_back3:
    v_add_f32 v36, v36, v40
    v_add_f32 v37, v37, v41
    v_add_f32 v38, v38, v42
    v_add_f32 v39, v39, v43
    s_waitcnt lgkmcnt(5)
    v_mfma_f32_16x16x32_bf16 a[0:3], v[192:195], v[160:163], a[0:3]
    ds_read_b64_tr_b16 v[210:211], v24 offset:28672
    v_mfma_f32_16x16x32_bf16 a[4:7], v[192:195], v[164:167], a[4:7]
    v_mfma_f32_16x16x32_bf16 a[8:11], v[192:195], v[168:171], a[8:11]
    ds_read_b64_tr_b16 v[212:213], v25 offset:24576
    v_mfma_f32_16x16x32_bf16 a[12:15], v[192:195], v[172:175], a[12:15]
    v_mfma_f32_16x16x32_bf16 a[16:19], v[196:199], v[160:163], a[16:19]
    ds_read_b64_tr_b16 v[214:215], v25 offset:28672
    v_exp_f32 v44, v64
    v_mfma_f32_16x16x32_bf16 a[20:23], v[196:199], v[164:167], a[20:23]
    v_exp_f32 v45, v65
    v_mfma_f32_16x16x32_bf16 a[24:27], v[196:199], v[168:171], a[24:27]
    ds_read_b64_tr_b16 v[216:217], v26 offset:24576
    v_exp_f32 v46, v66
    v_mfma_f32_16x16x32_bf16 a[28:31], v[196:199], v[172:175], a[28:31]
    v_exp_f32 v47, v67
    s_waitcnt lgkmcnt(5)
    v_mfma_f32_16x16x32_bf16 a[32:35], v[200:203], v[160:163], a[32:35]
    ds_read_b64_tr_b16 v[218:219], v26 offset:28672
    v_add_f32 v40, v44, v45
    v_cvt_pk_bf16_f32 v144, v44, v45
    v_mfma_f32_16x16x32_bf16 a[36:39], v[200:203], v[164:167], a[36:39]
    v_exp_f32 v48, v80
    v_mfma_f32_16x16x32_bf16 a[40:43], v[200:203], v[168:171], a[40:43]
    ds_read_b64_tr_b16 v[220:221], v27 offset:24576
    v_exp_f32 v49, v81
    v_mfma_f32_16x16x32_bf16 a[44:47], v[200:203], v[172:175], a[44:47]
    v_add_f32 v40, v40, v46
    v_add_f32 v40, v40, v47
    v_mfma_f32_16x16x32_bf16 a[48:51], v[204:207], v[160:163], a[48:51]
    ds_read_b64_tr_b16 v[222:223], v27 offset:28672
    v_cvt_pk_bf16_f32 v145, v46, v47
    v_mfma_f32_16x16x32_bf16 a[52:55], v[204:207], v[164:167], a[52:55]
    v_exp_f32 v50, v82
    v_mfma_f32_16x16x32_bf16 a[56:59], v[204:207], v[168:171], a[56:59]
    ds_read_b128 v[192:195], v16 offset:40960
    v_exp_f32 v51, v83
    v_mfma_f32_16x16x32_bf16 a[60:63], v[204:207], v[172:175], a[60:63]
    v_add_f32 v40, v40, v48
    v_add_f32 v40, v40, v49
    s_waitcnt lgkmcnt(5)
    v_mfma_f32_16x16x32_bf16 a[64:67], v[208:211], v[160:163], a[64:67]
    v_cvt_pk_bf16_f32 v146, v48, v49
    v_exp_f32 v44, v68
    v_mfma_f32_16x16x32_bf16 a[68:71], v[208:211], v[164:167], a[68:71]
    v_exp_f32 v45, v69
    v_mfma_f32_16x16x32_bf16 a[72:75], v[208:211], v[168:171], a[72:75]
    ds_read_b128 v[196:199], v16 offset:45056
    v_add_f32 v40, v40, v50
    v_mfma_f32_16x16x32_bf16 a[76:79], v[208:211], v[172:175], a[76:79]
    v_add_f32 v40, v40, v51
    v_cvt_pk_bf16_f32 v147, v50, v51
    v_mfma_f32_16x16x32_bf16 a[80:83], v[212:215], v[160:163], a[80:83]
    v_exp_f32 v46, v70
    v_mfma_f32_16x16x32_bf16 a[84:87], v[212:215], v[164:167], a[84:87]
    v_exp_f32 v47, v71
    v_mfma_f32_16x16x32_bf16 a[88:91], v[212:215], v[168:171], a[88:91]
    ds_read_b128 v[200:203], v17 offset:40960
    v_add_f32 v41, v44, v45
    v_mfma_f32_16x16x32_bf16 a[92:95], v[212:215], v[172:175], a[92:95]
    v_cvt_pk_bf16_f32 v148, v44, v45
    v_exp_f32 v48, v84
    s_waitcnt lgkmcnt(3)
    v_mfma_f32_16x16x32_bf16 a[96:99], v[216:219], v[160:163], a[96:99]
    v_exp_f32 v49, v85
    v_mfma_f32_16x16x32_bf16 a[100:103], v[216:219], v[164:167], a[100:103]
    v_add_f32 v41, v41, v46
    v_mfma_f32_16x16x32_bf16 a[104:107], v[216:219], v[168:171], a[104:107]
    ds_read_b128 v[204:207], v17 offset:45056
    v_add_f32 v41, v41, v47
    v_cvt_pk_bf16_f32 v149, v46, v47
    v_mfma_f32_16x16x32_bf16 a[108:111], v[216:219], v[172:175], a[108:111]
    v_exp_f32 v50, v86
    v_mfma_f32_16x16x32_bf16 a[112:115], v[220:223], v[160:163], a[112:115]
    v_exp_f32 v51, v87
    v_mfma_f32_16x16x32_bf16 a[116:119], v[220:223], v[164:167], a[116:119]
    v_add_f32 v41, v41, v48
    v_mfma_f32_16x16x32_bf16 a[120:123], v[220:223], v[168:171], a[120:123]
    ds_read_b128 v[208:211], v18 offset:40960
    v_add_f32 v41, v41, v49
    v_cvt_pk_bf16_f32 v150, v48, v49
    v_mfma_f32_16x16x32_bf16 a[124:127], v[220:223], v[172:175], a[124:127]
    v_exp_f32 v44, v72
    s_waitcnt lgkmcnt(3)
    v_mfma_f32_16x16x32_bf16 v[96:99], v[192:195], a[128:131], v[128:131]
    v_exp_f32 v45, v73
    v_mfma_f32_16x16x32_bf16 v[100:103], v[192:195], a[144:147], v[132:135]
    v_add_f32 v41, v41, v50
    v_add_f32 v41, v41, v51
    v_mfma_f32_16x16x32_bf16 v[104:107], v[192:195], a[160:163], v[136:139]
    ds_read_b128 v[212:215], v18 offset:45056
    v_cvt_pk_bf16_f32 v151, v50, v51
    v_exp_f32 v46, v74
    v_mfma_f32_16x16x32_bf16 v[108:111], v[192:195], a[176:179], v[140:143]
    v_exp_f32 v47, v75
    v_mfma_f32_16x16x32_bf16 v[112:115], v[196:199], a[128:131], v[128:131]
    v_add_f32 v42, v44, v45
    v_mfma_f32_16x16x32_bf16 v[116:119], v[196:199], a[144:147], v[132:135]
    v_cvt_pk_bf16_f32 v152, v44, v45
    v_mfma_f32_16x16x32_bf16 v[120:123], v[196:199], a[160:163], v[136:139]
    ds_read_b128 v[216:219], v19 offset:40960
    v_exp_f32 v48, v88
    v_mfma_f32_16x16x32_bf16 v[124:127], v[196:199], a[176:179], v[140:143]
    v_exp_f32 v49, v89
    s_waitcnt lgkmcnt(3)
    v_mfma_f32_16x16x32_bf16 v[96:99], v[200:203], a[132:135], v[96:99]
    v_add_f32 v42, v42, v46
    v_add_f32 v42, v42, v47
    v_mfma_f32_16x16x32_bf16 v[100:103], v[200:203], a[148:151], v[100:103]
    v_cvt_pk_bf16_f32 v153, v46, v47
    v_exp_f32 v50, v90
    v_mfma_f32_16x16x32_bf16 v[104:107], v[200:203], a[164:167], v[104:107]
    ds_read_b128 v[220:223], v19 offset:45056
    v_exp_f32 v51, v91
    v_mfma_f32_16x16x32_bf16 v[108:111], v[200:203], a[180:183], v[108:111]
    v_add_f32 v42, v42, v48
    v_mfma_f32_16x16x32_bf16 v[112:115], v[204:207], a[132:135], v[112:115]
    v_add_f32 v42, v42, v49
    v_cvt_pk_bf16_f32 v154, v48, v49
    v_mfma_f32_16x16x32_bf16 v[116:119], v[204:207], a[148:151], v[116:119]
    v_exp_f32 v44, v76
    v_mfma_f32_16x16x32_bf16 v[120:123], v[204:207], a[164:167], v[120:123]
    ds_read_b64_tr_b16 v[192:193], v20 offset:32768
    v_exp_f32 v45, v77
    v_mfma_f32_16x16x32_bf16 v[124:127], v[204:207], a[180:183], v[124:127]
    v_add_f32 v42, v42, v50
    s_waitcnt lgkmcnt(3)
    v_mfma_f32_16x16x32_bf16 v[96:99], v[208:211], a[136:139], v[96:99]
    ds_read_b64_tr_b16 v[194:195], v20 offset:36864
    v_add_f32 v42, v42, v51
    v_cvt_pk_bf16_f32 v155, v50, v51
    v_mfma_f32_16x16x32_bf16 v[100:103], v[208:211], a[152:155], v[100:103]
    v_exp_f32 v46, v78
    v_mfma_f32_16x16x32_bf16 v[104:107], v[208:211], a[168:171], v[104:107]
    ds_read_b64_tr_b16 v[196:197], v21 offset:32768
    v_exp_f32 v47, v79
    v_mfma_f32_16x16x32_bf16 v[108:111], v[208:211], a[184:187], v[108:111]
    v_add_f32 v43, v44, v45
    v_cvt_pk_bf16_f32 v156, v44, v45
    v_mfma_f32_16x16x32_bf16 v[112:115], v[212:215], a[136:139], v[112:115]
    ds_read_b64_tr_b16 v[198:199], v21 offset:36864
    v_exp_f32 v48, v92
    v_mfma_f32_16x16x32_bf16 v[116:119], v[212:215], a[152:155], v[116:119]
    v_exp_f32 v49, v93
    v_mfma_f32_16x16x32_bf16 v[120:123], v[212:215], a[168:171], v[120:123]
    ds_read_b64_tr_b16 v[200:201], v22 offset:32768
    v_add_f32 v43, v43, v46
    v_mfma_f32_16x16x32_bf16 v[124:127], v[212:215], a[184:187], v[124:127]
    v_add_f32 v43, v43, v47
    v_cvt_pk_bf16_f32 v157, v46, v47
    s_waitcnt lgkmcnt(5)
    v_mfma_f32_16x16x32_bf16 v[96:99], v[216:219], a[140:143], v[96:99]
    ds_read_b64_tr_b16 v[202:203], v22 offset:36864
    v_exp_f32 v50, v94
    v_mfma_f32_16x16x32_bf16 v[100:103], v[216:219], a[156:159], v[100:103]
    v_exp_f32 v51, v95
    v_mfma_f32_16x16x32_bf16 v[104:107], v[216:219], a[172:175], v[104:107]
    ds_read_b64_tr_b16 v[204:205], v23 offset:32768
    v_add_f32 v43, v43, v48
    v_add_f32 v43, v43, v49
    v_mfma_f32_16x16x32_bf16 v[108:111], v[216:219], a[188:191], v[108:111]
    v_cvt_pk_bf16_f32 v158, v48, v49
    s_nop 0
    v_mfma_f32_16x16x32_bf16 v[112:115], v[220:223], a[140:143], v[112:115]
    ds_read_b64_tr_b16 v[206:207], v23 offset:36864
    v_add_f32 v43, v43, v50
    v_add_f32 v43, v43, v51
    v_mfma_f32_16x16x32_bf16 v[116:119], v[220:223], a[156:159], v[116:119]
    v_cvt_pk_bf16_f32 v159, v50, v51
    v_mfma_f32_16x16x32_bf16 v[120:123], v[220:223], a[172:175], v[120:123]
    ds_read_b64_tr_b16 v[208:209], v24 offset:32768
    v_mfma_f32_16x16x32_bf16 v[124:127], v[220:223], a[188:191], v[124:127]
    v_max3_f32 v44, v40, v41, v42
    v_max_f32 v44, v44, v43
    v_cmp_lt_f32 vcc, s29, v44
    s_cbranch_vccnz .attn_fbs4
.attn_back4:
    v_add_f32 v36, v36, v40
    v_add_f32 v37, v37, v41
    v_add_f32 v38, v38, v42
    v_add_f32 v39, v39, v43
    s_waitcnt lgkmcnt(5)
    v_mfma_f32_16x16x32_bf16 a[0:3], v[192:195], v[144:147], a[0:3]
    ds_read_b64_tr_b16 v[210:211], v24 offset:36864
    v_mfma_f32_16x16x32_bf16 a[4:7], v[192:195], v[148:151], a[4:7]
    v_mfma_f32_16x16x32_bf16 a[8:11], v[192:195], v[152:155], a[8:11]
    ds_read_b64_tr_b16 v[212:213], v25 offset:32768
    v_mfma_f32_16x16x32_bf16 a[12:15], v[192:195], v[156:159], a[12:15]
    v_mfma_f32_16x16x32_bf16 a[16:19], v[196:199], v[144:147], a[16:19]
    ds_read_b64_tr_b16 v[214:215], v25 offset:36864
    v_exp_f32 v44, v96
    v_mfma_f32_16x16x32_bf16 a[20:23], v[196:199], v[148:151], a[20:23]
    v_exp_f32 v45, v97
    v_mfma_f32_16x16x32_bf16 a[24:27], v[196:199], v[152:155], a[24:27]
    ds_read_b64_tr_b16 v[216:217], v26 offset:32768
    v_exp_f32 v46, v98
    v_mfma_f32_16x16x32_bf16 a[28:31], v[196:199], v[156:159], a[28:31]
    v_exp_f32 v47, v99
    s_waitcnt lgkmcnt(5)
    v_mfma_f32_16x16x32_bf16 a[32:35], v[200:203], v[144:147], a[32:35]
    ds_read_b64_tr_b16 v[218:219], v26 offset:36864
    v_add_f32 v40, v44, v45
    v_cvt_pk_bf16_f32 v160, v44, v45
    v_mfma_f32_16x16x32_bf16 a[36:39], v[200:203], v[148:151], a[36:39]
    v_exp_f32 v48, v112
    v_mfma_f32_16x16x32_bf16 a[40:43], v[200:203], v[152:155], a[40:43]
    ds_read_b64_tr_b16 v[220:221], v27 offset:32768
    v_exp_f32 v49, v113
    v_mfma_f32_16x16x32_bf16 a[44:47], v[200:203], v[156:159], a[44:47]
    v_add_f32 v40, v40, v46
    v_add_f32 v40, v40, v47
    v_mfma_f32_16x16x32_bf16 a[48:51], v[204:207], v[144:147], a[48:51]
    ds_read_b64_tr_b16 v[222:223], v27 offset:36864
    v_cvt_pk_bf16_f32 v161, v46, v47
    v_mfma_f32_16x16x32_bf16 a[52:55], v[204:207], v[148:151], a[52:55]
    s_waitcnt vmcnt(8)
    s_barrier
    v_exp_f32 v50, v114
    v_mfma_f32_16x16x32_bf16 a[56:59], v[204:207], v[152:155], a[56:59]
    ds_read_b128 v[192:195], v16 offset:49152
    s_add_u32 m0, s26, 16384
    v_exp_f32 v51, v115
    v_mfma_f32_16x16x32_bf16 a[60:63], v[204:207], v[156:159], a[60:63]
    buffer_load_dwordx4 v28, s[8:11], s27 offen lds
    v_add_f32 v40, v40, v48
    v_add_f32 v40, v40, v49
    s_waitcnt lgkmcnt(5)
    v_mfma_f32_16x16x32_bf16 a[64:67], v[208:211], v[144:147], a[64:67]
    v_cvt_pk_bf16_f32 v162, v48, v49
    v_exp_f32 v44, v100
    v_mfma_f32_16x16x32_bf16 a[68:71], v[208:211], v[148:151], a[68:71]
    v_exp_f32 v45, v101
    v_mfma_f32_16x16x32_bf16 a[72:75], v[208:211], v[152:155], a[72:75]
    ds_read_b128 v[196:199], v16 offset:53248
    s_add_u32 m0, s26, 20480
    v_add_f32 v40, v40, v50
    v_mfma_f32_16x16x32_bf16 a[76:79], v[208:211], v[156:159], a[76:79]
    buffer_load_dwordx4 v29, s[8:11], s27 offen lds
    v_add_f32 v40, v40, v51
    v_cvt_pk_bf16_f32 v163, v50, v51
    v_mfma_f32_16x16x32_bf16 a[80:83], v[212:215], v[144:147], a[80:83]
    v_exp_f32 v46, v102
    v_mfma_f32_16x16x32_bf16 a[84:87], v[212:215], v[148:151], a[84:87]
    v_exp_f32 v47, v103
    v_mfma_f32_16x16x32_bf16 a[88:91], v[212:215], v[152:155], a[88:91]
    ds_read_b128 v[200:203], v17 offset:49152
    s_add_u32 m0, s26, 24576
    v_add_f32 v41, v44, v45
    v_mfma_f32_16x16x32_bf16 a[92:95], v[212:215], v[156:159], a[92:95]
    buffer_load_dwordx4 v30, s[8:11], s27 offen lds
    v_cvt_pk_bf16_f32 v164, v44, v45
    v_exp_f32 v48, v116
    s_waitcnt lgkmcnt(3)
    v_mfma_f32_16x16x32_bf16 a[96:99], v[216:219], v[144:147], a[96:99]
    v_exp_f32 v49, v117
    v_mfma_f32_16x16x32_bf16 a[100:103], v[216:219], v[148:151], a[100:103]
    v_add_f32 v41, v41, v46
    v_mfma_f32_16x16x32_bf16 a[104:107], v[216:219], v[152:155], a[104:107]
    ds_read_b128 v[204:207], v17 offset:53248
    s_add_u32 m0, s26, 28672
    v_add_f32 v41, v41, v47
    v_cvt_pk_bf16_f32 v165, v46, v47
    v_mfma_f32_16x16x32_bf16 a[108:111], v[216:219], v[156:159], a[108:111]
    buffer_load_dwordx4 v31, s[8:11], s27 offen lds
    v_exp_f32 v50, v118
    v_mfma_f32_16x16x32_bf16 a[112:115], v[220:223], v[144:147], a[112:115]
    v_exp_f32 v51, v119
    v_mfma_f32_16x16x32_bf16 a[116:119], v[220:223], v[148:151], a[116:119]
    v_add_f32 v41, v41, v48
    v_mfma_f32_16x16x32_bf16 a[120:123], v[220:223], v[152:155], a[120:123]
    ds_read_b128 v[208:211], v18 offset:49152
    s_add_u32 m0, s26, 81920
    v_add_f32 v41, v41, v49
    v_cvt_pk_bf16_f32 v166, v48, v49
    v_mfma_f32_16x16x32_bf16 a[124:127], v[220:223], v[156:159], a[124:127]
    buffer_load_dwordx4 v32, s[12:15], s27 offen lds
    v_exp_f32 v44, v104
    s_waitcnt lgkmcnt(3)
    v_mfma_f32_16x16x32_bf16 v[64:67], v[192:195], a[128:131], v[128:131]
    v_exp_f32 v45, v105
    v_mfma_f32_16x16x32_bf16 v[68:71], v[192:195], a[144:147], v[132:135]
    v_add_f32 v41, v41, v50
    v_add_f32 v41, v41, v51
    v_mfma_f32_16x16x32_bf16 v[72:75], v[192:195], a[160:163], v[136:139]
    ds_read_b128 v[212:215], v18 offset:53248
    s_add_u32 m0, s26, 86016
    v_cvt_pk_bf16_f32 v167, v50, v51
    v_exp_f32 v46, v106
    v_mfma_f32_16x16x32_bf16 v[76:79], v[192:195], a[176:179], v[140:143]
    buffer_load_dwordx4 v33, s[12:15], s27 offen lds
    v_exp_f32 v47, v107
    v_mfma_f32_16x16x32_bf16 v[80:83], v[196:199], a[128:131], v[128:131]
    v_add_f32 v42, v44, v45
    v_mfma_f32_16x16x32_bf16 v[84:87], v[196:199], a[144:147], v[132:135]
    v_cvt_pk_bf16_f32 v168, v44, v45
    v_mfma_f32_16x16x32_bf16 v[88:91], v[196:199], a[160:163], v[136:139]
    ds_read_b128 v[216:219], v19 offset:49152
    s_add_u32 m0, s26, 90112
    v_exp_f32 v48, v120
    v_mfma_f32_16x16x32_bf16 v[92:95], v[196:199], a[176:179], v[140:143]
    buffer_load_dwordx4 v34, s[12:15], s27 offen lds
    v_exp_f32 v49, v121
    s_waitcnt lgkmcnt(3)
    v_mfma_f32_16x16x32_bf16 v[64:67], v[200:203], a[132:135], v[64:67]
    v_add_f32 v42, v42, v46
    v_add_f32 v42, v42, v47
    v_mfma_f32_16x16x32_bf16 v[68:71], v[200:203], a[148:151], v[68:71]
    v_cvt_pk_bf16_f32 v169, v46, v47
    v_exp_f32 v50, v122
    v_mfma_f32_16x16x32_bf16 v[72:75], v[200:203], a[164:167], v[72:75]
    ds_read_b128 v[220:223], v19 offset:53248
    s_add_u32 m0, s26, 94208
    v_exp_f32 v51, v123
    v_mfma_f32_16x16x32_bf16 v[76:79], v[200:203], a[180:183], v[76:79]
    buffer_load_dwordx4 v35, s[12:15], s27 offen lds
    v_add_f32 v42, v42, v48
    v_mfma_f32_16x16x32_bf16 v[80:83], v[204:207], a[132:135], v[80:83]
    v_add_f32 v42, v42, v49
    v_cvt_pk_bf16_f32 v170, v48, v49
    v_mfma_f32_16x16x32_bf16 v[84:87], v[204:207], a[148:151], v[84:87]
    v_exp_f32 v44, v108
    v_mfma_f32_16x16x32_bf16 v[88:91], v[204:207], a[164:167], v[88:91]
    ds_read_b64_tr_b16 v[192:193], v20 offset:40960
    v_exp_f32 v45, v109
    v_mfma_f32_16x16x32_bf16 v[92:95], v[204:207], a[180:183], v[92:95]
    v_add_f32 v42, v42, v50
    s_waitcnt lgkmcnt(3)
    v_mfma_f32_16x16x32_bf16 v[64:67], v[208:211], a[136:139], v[64:67]
    ds_read_b64_tr_b16 v[194:195], v20 offset:45056
    s_add_u32 s27, s27, 16384
    v_add_f32 v42, v42, v51
    v_cvt_pk_bf16_f32 v171, v50, v51
    v_mfma_f32_16x16x32_bf16 v[68:71], v[208:211], a[152:155], v[68:71]
    v_exp_f32 v46, v110
    v_mfma_f32_16x16x32_bf16 v[72:75], v[208:211], a[168:171], v[72:75]
    ds_read_b64_tr_b16 v[196:197], v21 offset:40960
    v_exp_f32 v47, v111
    v_mfma_f32_16x16x32_bf16 v[76:79], v[208:211], a[184:187], v[76:79]
    v_add_f32 v43, v44, v45
    v_cvt_pk_bf16_f32 v172, v44, v45
    v_mfma_f32_16x16x32_bf16 v[80:83], v[212:215], a[136:139], v[80:83]
    ds_read_b64_tr_b16 v[198:199], v21 offset:45056
    v_exp_f32 v48, v124
    v_mfma_f32_16x16x32_bf16 v[84:87], v[212:215], a[152:155], v[84:87]
    v_exp_f32 v49, v125
    v_mfma_f32_16x16x32_bf16 v[88:91], v[212:215], a[168:171], v[88:91]
    ds_read_b64_tr_b16 v[200:201], v22 offset:40960
    v_add_f32 v43, v43, v46
    v_mfma_f32_16x16x32_bf16 v[92:95], v[212:215], a[184:187], v[92:95]
    v_add_f32 v43, v43, v47
    v_cvt_pk_bf16_f32 v173, v46, v47
    s_waitcnt lgkmcnt(5)
    v_mfma_f32_16x16x32_bf16 v[64:67], v[216:219], a[140:143], v[64:67]
    ds_read_b64_tr_b16 v[202:203], v22 offset:45056
    v_exp_f32 v50, v126
    v_mfma_f32_16x16x32_bf16 v[68:71], v[216:219], a[156:159], v[68:71]
    v_exp_f32 v51, v127
    v_mfma_f32_16x16x32_bf16 v[72:75], v[216:219], a[172:175], v[72:75]
    ds_read_b64_tr_b16 v[204:205], v23 offset:40960
    v_add_f32 v43, v43, v48
    v_add_f32 v43, v43, v49
    v_mfma_f32_16x16x32_bf16 v[76:79], v[216:219], a[188:191], v[76:79]
    v_cvt_pk_bf16_f32 v174, v48, v49
    s_nop 0
    v_mfma_f32_16x16x32_bf16 v[80:83], v[220:223], a[140:143], v[80:83]
    ds_read_b64_tr_b16 v[206:207], v23 offset:45056
    v_add_f32 v43, v43, v50
    v_add_f32 v43, v43, v51
    v_mfma_f32_16x16x32_bf16 v[84:87], v[220:223], a[156:159], v[84:87]
    v_cvt_pk_bf16_f32 v175, v50, v51
    v_mfma_f32_16x16x32_bf16 v[88:91], v[220:223], a[172:175], v[88:91]
    ds_read_b64_tr_b16 v[208:209], v24 offset:40960
    v_mfma_f32_16x16x32_bf16 v[92:95], v[220:223], a[188:191], v[92:95]
    v_max3_f32 v44, v40, v41, v42
    v_max_f32 v44, v44, v43
    v_cmp_lt_f32 vcc, s29, v44
    s_cbranch_vccnz .attn_fbs5
.attn_back5:
    v_add_f32 v36, v36, v40
    v_add_f32 v37, v37, v41
    v_add_f32 v38, v38, v42
    v_add_f32 v39, v39, v43
    s_waitcnt lgkmcnt(5)
    v_mfma_f32_16x16x32_bf16 a[0:3], v[192:195], v[160:163], a[0:3]
    ds_read_b64_tr_b16 v[210:211], v24 offset:45056
    v_mfma_f32_16x16x32_bf16 a[4:7], v[192:195], v[164:167], a[4:7]
    v_mfma_f32_16x16x32_bf16 a[8:11], v[192:195], v[168:171], a[8:11]
    ds_read_b64_tr_b16 v[212:213], v25 offset:40960
    v_mfma_f32_16x16x32_bf16 a[12:15], v[192:195], v[172:175], a[12:15]
    v_mfma_f32_16x16x32_bf16 a[16:19], v[196:199], v[160:163], a[16:19]
    ds_read_b64_tr_b16 v[214:215], v25 offset:45056
    v_exp_f32 v44, v64
    v_mfma_f32_16x16x32_bf16 a[20:23], v[196:199], v[164:167], a[20:23]
    v_exp_f32 v45, v65
    v_mfma_f32_16x16x32_bf16 a[24:27], v[196:199], v[168:171], a[24:27]
    ds_read_b64_tr_b16 v[216:217], v26 offset:40960
    v_exp_f32 v46, v66
    v_mfma_f32_16x16x32_bf16 a[28:31], v[196:199], v[172:175], a[28:31]
    v_exp_f32 v47, v67
    s_waitcnt lgkmcnt(5)
    v_mfma_f32_16x16x32_bf16 a[32:35], v[200:203], v[160:163], a[32:35]
    ds_read_b64_tr_b16 v[218:219], v26 offset:45056
    v_add_f32 v40, v44, v45
    v_cvt_pk_bf16_f32 v144, v44, v45
    v_mfma_f32_16x16x32_bf16 a[36:39], v[200:203], v[164:167], a[36:39]
    v_exp_f32 v48, v80
    v_mfma_f32_16x16x32_bf16 a[40:43], v[200:203], v[168:171], a[40:43]
    ds_read_b64_tr_b16 v[220:221], v27 offset:40960
    v_exp_f32 v49, v81
    v_mfma_f32_16x16x32_bf16 a[44:47], v[200:203], v[172:175], a[44:47]
    v_add_f32 v40, v40, v46
    v_add_f32 v40, v40, v47
    v_mfma_f32_16x16x32_bf16 a[48:51], v[204:207], v[160:163], a[48:51]
    ds_read_b64_tr_b16 v[222:223], v27 offset:45056
    v_cvt_pk_bf16_f32 v145, v46, v47
    v_mfma_f32_16x16x32_bf16 a[52:55], v[204:207], v[164:167], a[52:55]
    v_exp_f32 v50, v82
    v_mfma_f32_16x16x32_bf16 a[56:59], v[204:207], v[168:171], a[56:59]
    ds_read_b128 v[192:195], v16 offset:57344
    v_exp_f32 v51, v83
    v_mfma_f32_16x16x32_bf16 a[60:63], v[204:207], v[172:175], a[60:63]
    v_add_f32 v40, v40, v48
    v_add_f32 v40, v40, v49
    s_waitcnt lgkmcnt(5)
    v_mfma_f32_16x16x32_bf16 a[64:67], v[208:211], v[160:163], a[64:67]
    v_cvt_pk_bf16_f32 v146, v48, v49
    v_exp_f32 v44, v68
    v_mfma_f32_16x16x32_bf16 a[68:71], v[208:211], v[164:167], a[68:71]
    v_exp_f32 v45, v69
    v_mfma_f32_16x16x32_bf16 a[72:75], v[208:211], v[168:171], a[72:75]
    ds_read_b128 v[196:199], v16 offset:61440
    v_add_f32 v40, v40, v50
    v_mfma_f32_16x16x32_bf16 a[76:79], v[208:211], v[172:175], a[76:79]
    v_add_f32 v40, v40, v51
    v_cvt_pk_bf16_f32 v147, v50, v51
    v_mfma_f32_16x16x32_bf16 a[80:83], v[212:215], v[160:163], a[80:83]
    v_exp_f32 v46, v70
    v_mfma_f32_16x16x32_bf16 a[84:87], v[212:215], v[164:167], a[84:87]
    v_exp_f32 v47, v71
    v_mfma_f32_16x16x32_bf16 a[88:91], v[212:215], v[168:171], a[88:91]
    ds_read_b128 v[200:203], v17 offset:57344
    v_add_f32 v41, v44, v45
    v_mfma_f32_16x16x32_bf16 a[92:95], v[212:215], v[172:175], a[92:95]
    v_cvt_pk_bf16_f32 v148, v44, v45
    v_exp_f32 v48, v84
    s_waitcnt lgkmcnt(3)
    v_mfma_f32_16x16x32_bf16 a[96:99], v[216:219], v[160:163], a[96:99]
    v_exp_f32 v49, v85
    v_mfma_f32_16x16x32_bf16 a[100:103], v[216:219], v[164:167], a[100:103]
    v_add_f32 v41, v41, v46
    v_mfma_f32_16x16x32_bf16 a[104:107], v[216:219], v[168:171], a[104:107]
    ds_read_b128 v[204:207], v17 offset:61440
    v_add_f32 v41, v41, v47
    v_cvt_pk_bf16_f32 v149, v46, v47
    v_mfma_f32_16x16x32_bf16 a[108:111], v[216:219], v[172:175], a[108:111]
    v_exp_f32 v50, v86
    v_mfma_f32_16x16x32_bf16 a[112:115], v[220:223], v[160:163], a[112:115]
    v_exp_f32 v51, v87
    v_mfma_f32_16x16x32_bf16 a[116:119], v[220:223], v[164:167], a[116:119]
    v_add_f32 v41, v41, v48
    v_mfma_f32_16x16x32_bf16 a[120:123], v[220:223], v[168:171], a[120:123]
    ds_read_b128 v[208:211], v18 offset:57344
    v_add_f32 v41, v41, v49
    v_cvt_pk_bf16_f32 v150, v48, v49
    v_mfma_f32_16x16x32_bf16 a[124:127], v[220:223], v[172:175], a[124:127]
    v_exp_f32 v44, v72
    s_waitcnt lgkmcnt(3)
    v_mfma_f32_16x16x32_bf16 v[96:99], v[192:195], a[128:131], v[128:131]
    v_exp_f32 v45, v73
    v_mfma_f32_16x16x32_bf16 v[100:103], v[192:195], a[144:147], v[132:135]
    v_add_f32 v41, v41, v50
    v_add_f32 v41, v41, v51
    v_mfma_f32_16x16x32_bf16 v[104:107], v[192:195], a[160:163], v[136:139]
    ds_read_b128 v[212:215], v18 offset:61440
    v_cvt_pk_bf16_f32 v151, v50, v51
    v_exp_f32 v46, v74
    v_mfma_f32_16x16x32_bf16 v[108:111], v[192:195], a[176:179], v[140:143]
    v_exp_f32 v47, v75
    v_mfma_f32_16x16x32_bf16 v[112:115], v[196:199], a[128:131], v[128:131]
    v_add_f32 v42, v44, v45
    v_mfma_f32_16x16x32_bf16 v[116:119], v[196:199], a[144:147], v[132:135]
    v_cvt_pk_bf16_f32 v152, v44, v45
    v_mfma_f32_16x16x32_bf16 v[120:123], v[196:199], a[160:163], v[136:139]
    ds_read_b128 v[216:219], v19 offset:57344
    v_exp_f32 v48, v88
    v_mfma_f32_16x16x32_bf16 v[124:127], v[196:199], a[176:179], v[140:143]
    v_exp_f32 v49, v89
    s_waitcnt lgkmcnt(3)
    v_mfma_f32_16x16x32_bf16 v[96:99], v[200:203], a[132:135], v[96:99]
    v_add_f32 v42, v42, v46
    v_add_f32 v42, v42, v47
    v_mfma_f32_16x16x32_bf16 v[100:103], v[200:203], a[148:151], v[100:103]
    v_cvt_pk_bf16_f32 v153, v46, v47
    v_exp_f32 v50, v90
    v_mfma_f32_16x16x32_bf16 v[104:107], v[200:203], a[164:167], v[104:107]
    ds_read_b128 v[220:223], v19 offset:61440
    v_exp_f32 v51, v91
    v_mfma_f32_16x16x32_bf16 v[108:111], v[200:203], a[180:183], v[108:111]
    v_add_f32 v42, v42, v48
    v_mfma_f32_16x16x32_bf16 v[112:115], v[204:207], a[132:135], v[112:115]
    v_add_f32 v42, v42, v49
    v_cvt_pk_bf16_f32 v154, v48, v49
    v_mfma_f32_16x16x32_bf16 v[116:119], v[204:207], a[148:151], v[116:119]
    v_exp_f32 v44, v76
    v_mfma_f32_16x16x32_bf16 v[120:123], v[204:207], a[164:167], v[120:123]
    ds_read_b64_tr_b16 v[192:193], v20 offset:49152
    v_exp_f32 v45, v77
    v_mfma_f32_16x16x32_bf16 v[124:127], v[204:207], a[180:183], v[124:127]
    v_add_f32 v42, v42, v50
    s_waitcnt lgkmcnt(3)
    v_mfma_f32_16x16x32_bf16 v[96:99], v[208:211], a[136:139], v[96:99]
    ds_read_b64_tr_b16 v[194:195], v20 offset:53248
    v_add_f32 v42, v42, v51
    v_cvt_pk_bf16_f32 v155, v50, v51
    v_mfma_f32_16x16x32_bf16 v[100:103], v[208:211], a[152:155], v[100:103]
    v_exp_f32 v46, v78
    v_mfma_f32_16x16x32_bf16 v[104:107], v[208:211], a[168:171], v[104:107]
    ds_read_b64_tr_b16 v[196:197], v21 offset:49152
    v_exp_f32 v47, v79
    v_mfma_f32_16x16x32_bf16 v[108:111], v[208:211], a[184:187], v[108:111]
    v_add_f32 v43, v44, v45
    v_cvt_pk_bf16_f32 v156, v44, v45
    v_mfma_f32_16x16x32_bf16 v[112:115], v[212:215], a[136:139], v[112:115]
    ds_read_b64_tr_b16 v[198:199], v21 offset:53248
    v_exp_f32 v48, v92
    v_mfma_f32_16x16x32_bf16 v[116:119], v[212:215], a[152:155], v[116:119]
    v_exp_f32 v49, v93
    v_mfma_f32_16x16x32_bf16 v[120:123], v[212:215], a[168:171], v[120:123]
    ds_read_b64_tr_b16 v[200:201], v22 offset:49152
    v_add_f32 v43, v43, v46
    v_mfma_f32_16x16x32_bf16 v[124:127], v[212:215], a[184:187], v[124:127]
    v_add_f32 v43, v43, v47
    v_cvt_pk_bf16_f32 v157, v46, v47
    s_waitcnt lgkmcnt(5)
    v_mfma_f32_16x16x32_bf16 v[96:99], v[216:219], a[140:143], v[96:99]
    ds_read_b64_tr_b16 v[202:203], v22 offset:53248
    v_exp_f32 v50, v94
    v_mfma_f32_16x16x32_bf16 v[100:103], v[216:219], a[156:159], v[100:103]
    v_exp_f32 v51, v95
    v_mfma_f32_16x16x32_bf16 v[104:107], v[216:219], a[172:175], v[104:107]
    ds_read_b64_tr_b16 v[204:205], v23 offset:49152
    v_add_f32 v43, v43, v48
    v_add_f32 v43, v43, v49
    v_mfma_f32_16x16x32_bf16 v[108:111], v[216:219], a[188:191], v[108:111]
    v_cvt_pk_bf16_f32 v158, v48, v49
    s_nop 0
    v_mfma_f32_16x16x32_bf16 v[112:115], v[220:223], a[140:143], v[112:115]
    ds_read_b64_tr_b16 v[206:207], v23 offset:53248
    v_add_f32 v43, v43, v50
    v_add_f32 v43, v43, v51
    v_mfma_f32_16x16x32_bf16 v[116:119], v[220:223], a[156:159], v[116:119]
    v_cvt_pk_bf16_f32 v159, v50, v51
    v_mfma_f32_16x16x32_bf16 v[120:123], v[220:223], a[172:175], v[120:123]
    ds_read_b64_tr_b16 v[208:209], v24 offset:49152
    v_mfma_f32_16x16x32_bf16 v[124:127], v[220:223], a[188:191], v[124:127]
    v_max3_f32 v44, v40, v41, v42
    v_max_f32 v44, v44, v43
    v_cmp_lt_f32 vcc, s29, v44
    s_cbranch_vccnz .attn_fbs6
.attn_back6:
    v_add_f32 v36, v36, v40
    v_add_f32 v37, v37, v41
    v_add_f32 v38, v38, v42
    v_add_f32 v39, v39, v43
    s_waitcnt lgkmcnt(5)
    v_mfma_f32_16x16x32_bf16 a[0:3], v[192:195], v[144:147], a[0:3]
    ds_read_b64_tr_b16 v[210:211], v24 offset:53248
    v_mfma_f32_16x16x32_bf16 a[4:7], v[192:195], v[148:151], a[4:7]
    v_mfma_f32_16x16x32_bf16 a[8:11], v[192:195], v[152:155], a[8:11]
    ds_read_b64_tr_b16 v[212:213], v25 offset:49152
    v_mfma_f32_16x16x32_bf16 a[12:15], v[192:195], v[156:159], a[12:15]
    v_mfma_f32_16x16x32_bf16 a[16:19], v[196:199], v[144:147], a[16:19]
    ds_read_b64_tr_b16 v[214:215], v25 offset:53248
    v_exp_f32 v44, v96
    v_mfma_f32_16x16x32_bf16 a[20:23], v[196:199], v[148:151], a[20:23]
    v_exp_f32 v45, v97
    v_mfma_f32_16x16x32_bf16 a[24:27], v[196:199], v[152:155], a[24:27]
    ds_read_b64_tr_b16 v[216:217], v26 offset:49152
    v_exp_f32 v46, v98
    v_mfma_f32_16x16x32_bf16 a[28:31], v[196:199], v[156:159], a[28:31]
    v_exp_f32 v47, v99
    s_waitcnt lgkmcnt(5)
    v_mfma_f32_16x16x32_bf16 a[32:35], v[200:203], v[144:147], a[32:35]
    ds_read_b64_tr_b16 v[218:219], v26 offset:53248
    v_add_f32 v40, v44, v45
    v_cvt_pk_bf16_f32 v160, v44, v45
    v_mfma_f32_16x16x32_bf16 a[36:39], v[200:203], v[148:151], a[36:39]
    v_exp_f32 v48, v112
    v_mfma_f32_16x16x32_bf16 a[40:43], v[200:203], v[152:155], a[40:43]
    ds_read_b64_tr_b16 v[220:221], v27 offset:49152
    v_exp_f32 v49, v113
    v_mfma_f32_16x16x32_bf16 a[44:47], v[200:203], v[156:159], a[44:47]
    v_add_f32 v40, v40, v46
    v_add_f32 v40, v40, v47
    v_mfma_f32_16x16x32_bf16 a[48:51], v[204:207], v[144:147], a[48:51]
    ds_read_b64_tr_b16 v[222:223], v27 offset:53248
    v_cvt_pk_bf16_f32 v161, v46, v47
    v_mfma_f32_16x16x32_bf16 a[52:55], v[204:207], v[148:151], a[52:55]
    s_waitcnt vmcnt(8)
    s_barrier
    v_exp_f32 v50, v114
    v_mfma_f32_16x16x32_bf16 a[56:59], v[204:207], v[152:155], a[56:59]
    ds_read_b128 v[192:195], v16 offset:0
    s_add_u32 m0, s26, 32768
    v_exp_f32 v51, v115
    v_mfma_f32_16x16x32_bf16 a[60:63], v[204:207], v[156:159], a[60:63]
    buffer_load_dwordx4 v28, s[8:11], s27 offen lds
    v_add_f32 v40, v40, v48
    v_add_f32 v40, v40, v49
    s_waitcnt lgkmcnt(5)
    v_mfma_f32_16x16x32_bf16 a[64:67], v[208:211], v[144:147], a[64:67]
    v_cvt_pk_bf16_f32 v162, v48, v49
    v_exp_f32 v44, v100
    v_mfma_f32_16x16x32_bf16 a[68:71], v[208:211], v[148:151], a[68:71]
    v_exp_f32 v45, v101
    v_mfma_f32_16x16x32_bf16 a[72:75], v[208:211], v[152:155], a[72:75]
    ds_read_b128 v[196:199], v16 offset:4096
    s_add_u32 m0, s26, 36864
    v_add_f32 v40, v40, v50
    v_mfma_f32_16x16x32_bf16 a[76:79], v[208:211], v[156:159], a[76:79]
    buffer_load_dwordx4 v29, s[8:11], s27 offen lds
    v_add_f32 v40, v40, v51
    v_cvt_pk_bf16_f32 v163, v50, v51
    v_mfma_f32_16x16x32_bf16 a[80:83], v[212:215], v[144:147], a[80:83]
    v_exp_f32 v46, v102
    v_mfma_f32_16x16x32_bf16 a[84:87], v[212:215], v[148:151], a[84:87]
    v_exp_f32 v47, v103
    v_mfma_f32_16x16x32_bf16 a[88:91], v[212:215], v[152:155], a[88:91]
    ds_read_b128 v[200:203], v17 offset:0
    s_add_u32 m0, s26, 40960
    v_add_f32 v41, v44, v45
    v_mfma_f32_16x16x32_bf16 a[92:95], v[212:215], v[156:159], a[92:95]
    buffer_load_dwordx4 v30, s[8:11], s27 offen lds
    v_cvt_pk_bf16_f32 v164, v44, v45
    v_exp_f32 v48, v116
    s_waitcnt lgkmcnt(3)
    v_mfma_f32_16x16x32_bf16 a[96:99], v[216:219], v[144:147], a[96:99]
    v_exp_f32 v49, v117
    v_mfma_f32_16x16x32_bf16 a[100:103], v[216:219], v[148:151], a[100:103]
    v_add_f32 v41, v41, v46
    v_mfma_f32_16x16x32_bf16 a[104:107], v[216:219], v[152:155], a[104:107]
    ds_read_b128 v[204:207], v17 offset:4096
    s_add_u32 m0, s26, 45056
    v_add_f32 v41, v41, v47
    v_cvt_pk_bf16_f32 v165, v46, v47
    v_mfma_f32_16x16x32_bf16 a[108:111], v[216:219], v[156:159], a[108:111]
    buffer_load_dwordx4 v31, s[8:11], s27 offen lds
    v_exp_f32 v50, v118
    v_mfma_f32_16x16x32_bf16 a[112:115], v[220:223], v[144:147], a[112:115]
    v_exp_f32 v51, v119
    v_mfma_f32_16x16x32_bf16 a[116:119], v[220:223], v[148:151], a[116:119]
    v_add_f32 v41, v41, v48
    v_mfma_f32_16x16x32_bf16 a[120:123], v[220:223], v[152:155], a[120:123]
    ds_read_b128 v[208:211], v18 offset:0
    s_add_u32 m0, s26, 98304
    v_add_f32 v41, v41, v49
    v_cvt_pk_bf16_f32 v166, v48, v49
    v_mfma_f32_16x16x32_bf16 a[124:127], v[220:223], v[156:159], a[124:127]
    buffer_load_dwordx4 v32, s[12:15], s27 offen lds
    v_exp_f32 v44, v104
    s_waitcnt lgkmcnt(3)
    v_mfma_f32_16x16x32_bf16 v[64:67], v[192:195], a[128:131], v[128:131]
    v_exp_f32 v45, v105
    v_mfma_f32_16x16x32_bf16 v[68:71], v[192:195], a[144:147], v[132:135]
    v_add_f32 v41, v41, v50
    v_add_f32 v41, v41, v51
    v_mfma_f32_16x16x32_bf16 v[72:75], v[192:195], a[160:163], v[136:139]
    ds_read_b128 v[212:215], v18 offset:4096
    s_add_u32 m0, s26, 102400
    v_cvt_pk_bf16_f32 v167, v50, v51
    v_exp_f32 v46, v106
    v_mfma_f32_16x16x32_bf16 v[76:79], v[192:195], a[176:179], v[140:143]
    buffer_load_dwordx4 v33, s[12:15], s27 offen lds
    v_exp_f32 v47, v107
    v_mfma_f32_16x16x32_bf16 v[80:83], v[196:199], a[128:131], v[128:131]
    v_add_f32 v42, v44, v45
    v_mfma_f32_16x16x32_bf16 v[84:87], v[196:199], a[144:147], v[132:135]
    v_cvt_pk_bf16_f32 v168, v44, v45
    v_mfma_f32_16x16x32_bf16 v[88:91], v[196:199], a[160:163], v[136:139]
    ds_read_b128 v[216:219], v19 offset:0
    s_add_u32 m0, s26, 106496
    v_exp_f32 v48, v120
    v_mfma_f32_16x16x32_bf16 v[92:95], v[196:199], a[176:179], v[140:143]
    buffer_load_dwordx4 v34, s[12:15], s27 offen lds
    v_exp_f32 v49, v121
    s_waitcnt lgkmcnt(3)
    v_mfma_f32_16x16x32_bf16 v[64:67], v[200:203], a[132:135], v[64:67]
    v_add_f32 v42, v42, v46
    v_add_f32 v42, v42, v47
    v_mfma_f32_16x16x32_bf16 v[68:71], v[200:203], a[148:151], v[68:71]
    v_cvt_pk_bf16_f32 v169, v46, v47
    v_exp_f32 v50, v122
    v_mfma_f32_16x16x32_bf16 v[72:75], v[200:203], a[164:167], v[72:75]
    ds_read_b128 v[220:223], v19 offset:4096
    s_add_u32 m0, s26, 110592
    v_exp_f32 v51, v123
    v_mfma_f32_16x16x32_bf16 v[76:79], v[200:203], a[180:183], v[76:79]
    buffer_load_dwordx4 v35, s[12:15], s27 offen lds
    v_add_f32 v42, v42, v48
    v_mfma_f32_16x16x32_bf16 v[80:83], v[204:207], a[132:135], v[80:83]
    v_add_f32 v42, v42, v49
    v_cvt_pk_bf16_f32 v170, v48, v49
    v_mfma_f32_16x16x32_bf16 v[84:87], v[204:207], a[148:151], v[84:87]
    v_exp_f32 v44, v108
    v_mfma_f32_16x16x32_bf16 v[88:91], v[204:207], a[164:167], v[88:91]
    ds_read_b64_tr_b16 v[192:193], v20 offset:57344
    v_exp_f32 v45, v109
    v_mfma_f32_16x16x32_bf16 v[92:95], v[204:207], a[180:183], v[92:95]
    v_add_f32 v42, v42, v50
    s_waitcnt lgkmcnt(3)
    v_mfma_f32_16x16x32_bf16 v[64:67], v[208:211], a[136:139], v[64:67]
    ds_read_b64_tr_b16 v[194:195], v20 offset:61440
    s_add_u32 s27, s27, 16384
    v_add_f32 v42, v42, v51
    v_cvt_pk_bf16_f32 v171, v50, v51
    v_mfma_f32_16x16x32_bf16 v[68:71], v[208:211], a[152:155], v[68:71]
    v_exp_f32 v46, v110
    v_mfma_f32_16x16x32_bf16 v[72:75], v[208:211], a[168:171], v[72:75]
    ds_read_b64_tr_b16 v[196:197], v21 offset:57344
    v_exp_f32 v47, v111
    v_mfma_f32_16x16x32_bf16 v[76:79], v[208:211], a[184:187], v[76:79]
    v_add_f32 v43, v44, v45
    v_cvt_pk_bf16_f32 v172, v44, v45
    v_mfma_f32_16x16x32_bf16 v[80:83], v[212:215], a[136:139], v[80:83]
    ds_read_b64_tr_b16 v[198:199], v21 offset:61440
    v_exp_f32 v48, v124
    v_mfma_f32_16x16x32_bf16 v[84:87], v[212:215], a[152:155], v[84:87]
    v_exp_f32 v49, v125
    v_mfma_f32_16x16x32_bf16 v[88:91], v[212:215], a[168:171], v[88:91]
    ds_read_b64_tr_b16 v[200:201], v22 offset:57344
    v_add_f32 v43, v43, v46
    v_mfma_f32_16x16x32_bf16 v[92:95], v[212:215], a[184:187], v[92:95]
    v_add_f32 v43, v43, v47
    v_cvt_pk_bf16_f32 v173, v46, v47
    s_waitcnt lgkmcnt(5)
    v_mfma_f32_16x16x32_bf16 v[64:67], v[216:219], a[140:143], v[64:67]
    ds_read_b64_tr_b16 v[202:203], v22 offset:61440
    v_exp_f32 v50, v126
    v_mfma_f32_16x16x32_bf16 v[68:71], v[216:219], a[156:159], v[68:71]
    v_exp_f32 v51, v127
    v_mfma_f32_16x16x32_bf16 v[72:75], v[216:219], a[172:175], v[72:75]
    ds_read_b64_tr_b16 v[204:205], v23 offset:57344
    v_add_f32 v43, v43, v48
    v_add_f32 v43, v43, v49
    v_mfma_f32_16x16x32_bf16 v[76:79], v[216:219], a[188:191], v[76:79]
    v_cvt_pk_bf16_f32 v174, v48, v49
    s_nop 0
    v_mfma_f32_16x16x32_bf16 v[80:83], v[220:223], a[140:143], v[80:83]
    ds_read_b64_tr_b16 v[206:207], v23 offset:61440
    v_add_f32 v43, v43, v50
    v_add_f32 v43, v43, v51
    v_mfma_f32_16x16x32_bf16 v[84:87], v[220:223], a[156:159], v[84:87]
    v_cvt_pk_bf16_f32 v175, v50, v51
    v_mfma_f32_16x16x32_bf16 v[88:91], v[220:223], a[172:175], v[88:91]
    ds_read_b64_tr_b16 v[208:209], v24 offset:57344
    v_mfma_f32_16x16x32_bf16 v[92:95], v[220:223], a[188:191], v[92:95]
    v_max3_f32 v44, v40, v41, v42
    v_max_f32 v44, v44, v43
    v_cmp_lt_f32 vcc, s29, v44
    s_cbranch_vccnz .attn_fbs7
.attn_back7:
    v_add_f32 v36, v36, v40
    v_add_f32 v37, v37, v41
    v_add_f32 v38, v38, v42
    v_add_f32 v39, v39, v43
    s_waitcnt lgkmcnt(5)
    v_mfma_f32_16x16x32_bf16 a[0:3], v[192:195], v[160:163], a[0:3]
    ds_read_b64_tr_b16 v[210:211], v24 offset:61440
    v_mfma_f32_16x16x32_bf16 a[4:7], v[192:195], v[164:167], a[4:7]
    v_mfma_f32_16x16x32_bf16 a[8:11], v[192:195], v[168:171], a[8:11]
    ds_read_b64_tr_b16 v[212:213], v25 offset:57344
    v_mfma_f32_16x16x32_bf16 a[12:15], v[192:195], v[172:175], a[12:15]
    v_mfma_f32_16x16x32_bf16 a[16:19], v[196:199], v[160:163], a[16:19]
    ds_read_b64_tr_b16 v[214:215], v25 offset:61440
    v_exp_f32 v44, v64
    v_mfma_f32_16x16x32_bf16 a[20:23], v[196:199], v[164:167], a[20:23]
    v_exp_f32 v45, v65
    v_mfma_f32_16x16x32_bf16 a[24:27], v[196:199], v[168:171], a[24:27]
    ds_read_b64_tr_b16 v[216:217], v26 offset:57344
    v_exp_f32 v46, v66
    v_mfma_f32_16x16x32_bf16 a[28:31], v[196:199], v[172:175], a[28:31]
    v_exp_f32 v47, v67
    s_waitcnt lgkmcnt(5)
    v_mfma_f32_16x16x32_bf16 a[32:35], v[200:203], v[160:163], a[32:35]
    ds_read_b64_tr_b16 v[218:219], v26 offset:61440
    v_add_f32 v40, v44, v45
    v_cvt_pk_bf16_f32 v144, v44, v45
    v_mfma_f32_16x16x32_bf16 a[36:39], v[200:203], v[164:167], a[36:39]
    v_exp_f32 v48, v80
    v_mfma_f32_16x16x32_bf16 a[40:43], v[200:203], v[168:171], a[40:43]
    ds_read_b64_tr_b16 v[220:221], v27 offset:57344
    v_exp_f32 v49, v81
    v_mfma_f32_16x16x32_bf16 a[44:47], v[200:203], v[172:175], a[44:47]
    v_add_f32 v40, v40, v46
    v_add_f32 v40, v40, v47
    v_mfma_f32_16x16x32_bf16 a[48:51], v[204:207], v[160:163], a[48:51]
    ds_read_b64_tr_b16 v[222:223], v27 offset:61440
    v_cvt_pk_bf16_f32 v145, v46, v47
    v_mfma_f32_16x16x32_bf16 a[52:55], v[204:207], v[164:167], a[52:55]
    v_exp_f32 v50, v82
    v_mfma_f32_16x16x32_bf16 a[56:59], v[204:207], v[168:171], a[56:59]
    ds_read_b128 v[192:195], v16 offset:8192
    v_exp_f32 v51, v83
    v_mfma_f32_16x16x32_bf16 a[60:63], v[204:207], v[172:175], a[60:63]
    v_add_f32 v40, v40, v48
    v_add_f32 v40, v40, v49
    s_waitcnt lgkmcnt(5)
    v_mfma_f32_16x16x32_bf16 a[64:67], v[208:211], v[160:163], a[64:67]
    v_cvt_pk_bf16_f32 v146, v48, v49
    v_exp_f32 v44, v68
    v_mfma_f32_16x16x32_bf16 a[68:71], v[208:211], v[164:167], a[68:71]
    v_exp_f32 v45, v69
    v_mfma_f32_16x16x32_bf16 a[72:75], v[208:211], v[168:171], a[72:75]
    ds_read_b128 v[196:199], v16 offset:12288
    v_add_f32 v40, v40, v50
    v_mfma_f32_16x16x32_bf16 a[76:79], v[208:211], v[172:175], a[76:79]
    v_add_f32 v40, v40, v51
    v_cvt_pk_bf16_f32 v147, v50, v51
    v_mfma_f32_16x16x32_bf16 a[80:83], v[212:215], v[160:163], a[80:83]
    v_exp_f32 v46, v70
    v_mfma_f32_16x16x32_bf16 a[84:87], v[212:215], v[164:167], a[84:87]
    v_exp_f32 v47, v71
    v_mfma_f32_16x16x32_bf16 a[88:91], v[212:215], v[168:171], a[88:91]
    ds_read_b128 v[200:203], v17 offset:8192
    v_add_f32 v41, v44, v45
    v_mfma_f32_16x16x32_bf16 a[92:95], v[212:215], v[172:175], a[92:95]
    v_cvt_pk_bf16_f32 v148, v44, v45
    v_exp_f32 v48, v84
    s_waitcnt lgkmcnt(3)
    v_mfma_f32_16x16x32_bf16 a[96:99], v[216:219], v[160:163], a[96:99]
    v_exp_f32 v49, v85
    v_mfma_f32_16x16x32_bf16 a[100:103], v[216:219], v[164:167], a[100:103]
    v_add_f32 v41, v41, v46
    v_mfma_f32_16x16x32_bf16 a[104:107], v[216:219], v[168:171], a[104:107]
    ds_read_b128 v[204:207], v17 offset:12288
    v_add_f32 v41, v41, v47
    v_cvt_pk_bf16_f32 v149, v46, v47
    v_mfma_f32_16x16x32_bf16 a[108:111], v[216:219], v[172:175], a[108:111]
    v_exp_f32 v50, v86
    v_mfma_f32_16x16x32_bf16 a[112:115], v[220:223], v[160:163], a[112:115]
    v_exp_f32 v51, v87
    v_mfma_f32_16x16x32_bf16 a[116:119], v[220:223], v[164:167], a[116:119]
    v_add_f32 v41, v41, v48
    v_mfma_f32_16x16x32_bf16 a[120:123], v[220:223], v[168:171], a[120:123]
    ds_read_b128 v[208:211], v18 offset:8192
    v_add_f32 v41, v41, v49
    v_cvt_pk_bf16_f32 v150, v48, v49
    v_mfma_f32_16x16x32_bf16 a[124:127], v[220:223], v[172:175], a[124:127]
    v_exp_f32 v44, v72
    s_sub_u32 s28, s28, 1
    s_cmp_lg_u32 s28, 0
    s_cbranch_scc1 .attn_loop
    s_nop 15
    s_nop 7
    s_waitcnt vmcnt(0) lgkmcnt(0)
    s_add_u32 s16, s34, 8388608
    s_addc_u32 s17, s35, 0
    s_mov_b32 s18, 16777216
    s_mov_b32 s19, 0x00020000
    v_add_u32 v9, s37, v3
    v_lshlrev_b32 v9, 13, v9
    v_and_b32 v10, 1, v4
    v_lshl_add_u32 v9, v10, 5, v9
    v_lshl_add_u32 v9, v5, 4, v9
    s_lshl_b32 s31, s24, 8
    v_add_u32 v9, s31, v9
    v_mov_b32 v52, v36
    s_nop 1
    v_permlane16_swap_b32 v52, v36
    s_nop 0
    v_add_f32 v36, v52, v36
    v_mov_b32 v52, v36
    s_nop 1
    v_permlane32_swap_b32 v52, v36
    s_nop 0
    v_add_f32 v36, v52, v36
    v_rcp_f32 v53, v36
    v_mov_b32 v52, v37
    s_nop 1
    v_permlane16_swap_b32 v52, v37
    s_nop 0
    v_add_f32 v37, v52, v37
    v_mov_b32 v52, v37
    s_nop 1
    v_permlane32_swap_b32 v52, v37
    s_nop 0
    v_add_f32 v37, v52, v37
    v_rcp_f32 v54, v37
    v_mov_b32 v52, v38
    s_nop 1
    v_permlane16_swap_b32 v52, v38
    s_nop 0
    v_add_f32 v38, v52, v38
    v_mov_b32 v52, v38
    s_nop 1
    v_permlane32_swap_b32 v52, v38
    s_nop 0
    v_add_f32 v38, v52, v38
    v_rcp_f32 v55, v38
    v_mov_b32 v52, v39
    s_nop 1
    v_permlane16_swap_b32 v52, v39
    s_nop 0
    v_add_f32 v39, v52, v39
    v_mov_b32 v52, v39
    s_nop 1
    v_permlane32_swap_b32 v52, v39
    s_nop 0
    v_add_f32 v39, v52, v39
    v_rcp_f32 v56, v39
    s_nop 0
    s_mov_b32 s31, 0
    v_accvgpr_read_b32 v68, a0
    v_accvgpr_read_b32 v72, a16
    v_accvgpr_read_b32 v69, a1
    v_accvgpr_read_b32 v73, a17
    v_accvgpr_read_b32 v70, a2
    v_accvgpr_read_b32 v74, a18
    v_accvgpr_read_b32 v71, a3
    v_accvgpr_read_b32 v75, a19
    v_mul_f32 v68, v68, v53
    v_mul_f32 v69, v69, v53
    v_mul_f32 v70, v70, v53
    v_mul_f32 v71, v71, v53
    v_mul_f32 v72, v72, v53
    v_mul_f32 v73, v73, v53
    v_mul_f32 v74, v74, v53
    v_mul_f32 v75, v75, v53
    v_cvt_pk_bf16_f32 v64, v68, v69
    v_cvt_pk_bf16_f32 v65, v70, v71
    v_cvt_pk_bf16_f32 v66, v72, v73
    v_cvt_pk_bf16_f32 v67, v74, v75
    s_nop 1
    v_permlane16_swap_b32 v64, v66
    v_permlane16_swap_b32 v65, v67
    buffer_store_dwordx4 v[64:67], v9, s[16:19], s31 offen offset:0 sc1
    v_accvgpr_read_b32 v80, a32
    v_accvgpr_read_b32 v84, a48
    v_accvgpr_read_b32 v81, a33
    v_accvgpr_read_b32 v85, a49
    v_accvgpr_read_b32 v82, a34
    v_accvgpr_read_b32 v86, a50
    v_accvgpr_read_b32 v83, a35
    v_accvgpr_read_b32 v87, a51
    v_mul_f32 v80, v80, v53
    v_mul_f32 v81, v81, v53
    v_mul_f32 v82, v82, v53
    v_mul_f32 v83, v83, v53
    v_mul_f32 v84, v84, v53
    v_mul_f32 v85, v85, v53
    v_mul_f32 v86, v86, v53
    v_mul_f32 v87, v87, v53
    v_cvt_pk_bf16_f32 v76, v80, v81
    v_cvt_pk_bf16_f32 v77, v82, v83
    v_cvt_pk_bf16_f32 v78, v84, v85
    v_cvt_pk_bf16_f32 v79, v86, v87
    s_nop 1
    v_permlane16_swap_b32 v76, v78
    v_permlane16_swap_b32 v77, v79
    buffer_store_dwordx4 v[76:79], v9, s[16:19], s31 offen offset:64 sc1
    v_accvgpr_read_b32 v92, a64
    v_accvgpr_read_b32 v96, a80
    v_accvgpr_read_b32 v93, a65
    v_accvgpr_read_b32 v97, a81
    v_accvgpr_read_b32 v94, a66
    v_accvgpr_read_b32 v98, a82
    v_accvgpr_read_b32 v95, a67
    v_accvgpr_read_b32 v99, a83
    v_mul_f32 v92, v92, v53
    v_mul_f32 v93, v93, v53
    v_mul_f32 v94, v94, v53
    v_mul_f32 v95, v95, v53
    v_mul_f32 v96, v96, v53
    v_mul_f32 v97, v97, v53
    v_mul_f32 v98, v98, v53
    v_mul_f32 v99, v99, v53
    v_cvt_pk_bf16_f32 v88, v92, v93
    v_cvt_pk_bf16_f32 v89, v94, v95
    v_cvt_pk_bf16_f32 v90, v96, v97
    v_cvt_pk_bf16_f32 v91, v98, v99
    s_nop 1
    v_permlane16_swap_b32 v88, v90
    v_permlane16_swap_b32 v89, v91
    buffer_store_dwordx4 v[88:91], v9, s[16:19], s31 offen offset:128 sc1
    v_accvgpr_read_b32 v104, a96
    v_accvgpr_read_b32 v108, a112
    v_accvgpr_read_b32 v105, a97
    v_accvgpr_read_b32 v109, a113
    v_accvgpr_read_b32 v106, a98
    v_accvgpr_read_b32 v110, a114
    v_accvgpr_read_b32 v107, a99
    v_accvgpr_read_b32 v111, a115
    v_mul_f32 v104, v104, v53
    v_mul_f32 v105, v105, v53
    v_mul_f32 v106, v106, v53
    v_mul_f32 v107, v107, v53
    v_mul_f32 v108, v108, v53
    v_mul_f32 v109, v109, v53
    v_mul_f32 v110, v110, v53
    v_mul_f32 v111, v111, v53
    v_cvt_pk_bf16_f32 v100, v104, v105
    v_cvt_pk_bf16_f32 v101, v106, v107
    v_cvt_pk_bf16_f32 v102, v108, v109
    v_cvt_pk_bf16_f32 v103, v110, v111
    s_nop 1
    v_permlane16_swap_b32 v100, v102
    v_permlane16_swap_b32 v101, v103
    buffer_store_dwordx4 v[100:103], v9, s[16:19], s31 offen offset:192 sc1
    s_mov_b32 s31, 131072
    v_accvgpr_read_b32 v116, a4
    v_accvgpr_read_b32 v120, a20
    v_accvgpr_read_b32 v117, a5
    v_accvgpr_read_b32 v121, a21
    v_accvgpr_read_b32 v118, a6
    v_accvgpr_read_b32 v122, a22
    v_accvgpr_read_b32 v119, a7
    v_accvgpr_read_b32 v123, a23
    v_mul_f32 v116, v116, v54
    v_mul_f32 v117, v117, v54
    v_mul_f32 v118, v118, v54
    v_mul_f32 v119, v119, v54
    v_mul_f32 v120, v120, v54
    v_mul_f32 v121, v121, v54
    v_mul_f32 v122, v122, v54
    v_mul_f32 v123, v123, v54
    v_cvt_pk_bf16_f32 v112, v116, v117
    v_cvt_pk_bf16_f32 v113, v118, v119
    v_cvt_pk_bf16_f32 v114, v120, v121
    v_cvt_pk_bf16_f32 v115, v122, v123
    s_nop 1
    v_permlane16_swap_b32 v112, v114
    v_permlane16_swap_b32 v113, v115
    buffer_store_dwordx4 v[112:115], v9, s[16:19], s31 offen offset:0 sc1
    v_accvgpr_read_b32 v128, a36
    v_accvgpr_read_b32 v132, a52
    v_accvgpr_read_b32 v129, a37
    v_accvgpr_read_b32 v133, a53
    v_accvgpr_read_b32 v130, a38
    v_accvgpr_read_b32 v134, a54
    v_accvgpr_read_b32 v131, a39
    v_accvgpr_read_b32 v135, a55
    v_mul_f32 v128, v128, v54
    v_mul_f32 v129, v129, v54
    v_mul_f32 v130, v130, v54
    v_mul_f32 v131, v131, v54
    v_mul_f32 v132, v132, v54
    v_mul_f32 v133, v133, v54
    v_mul_f32 v134, v134, v54
    v_mul_f32 v135, v135, v54
    v_cvt_pk_bf16_f32 v124, v128, v129
    v_cvt_pk_bf16_f32 v125, v130, v131
    v_cvt_pk_bf16_f32 v126, v132, v133
    v_cvt_pk_bf16_f32 v127, v134, v135
    s_nop 1
    v_permlane16_swap_b32 v124, v126
    v_permlane16_swap_b32 v125, v127
    buffer_store_dwordx4 v[124:127], v9, s[16:19], s31 offen offset:64 sc1
    v_accvgpr_read_b32 v68, a68
    v_accvgpr_read_b32 v72, a84
    v_accvgpr_read_b32 v69, a69
    v_accvgpr_read_b32 v73, a85
    v_accvgpr_read_b32 v70, a70
    v_accvgpr_read_b32 v74, a86
    v_accvgpr_read_b32 v71, a71
    v_accvgpr_read_b32 v75, a87
    v_mul_f32 v68, v68, v54
    v_mul_f32 v69, v69, v54
    v_mul_f32 v70, v70, v54
    v_mul_f32 v71, v71, v54
    v_mul_f32 v72, v72, v54
    v_mul_f32 v73, v73, v54
    v_mul_f32 v74, v74, v54
    v_mul_f32 v75, v75, v54
    v_cvt_pk_bf16_f32 v64, v68, v69
    v_cvt_pk_bf16_f32 v65, v70, v71
    v_cvt_pk_bf16_f32 v66, v72, v73
    v_cvt_pk_bf16_f32 v67, v74, v75
    s_nop 1
    v_permlane16_swap_b32 v64, v66
    v_permlane16_swap_b32 v65, v67
    buffer_store_dwordx4 v[64:67], v9, s[16:19], s31 offen offset:128 sc1
    v_accvgpr_read_b32 v80, a100
    v_accvgpr_read_b32 v84, a116
    v_accvgpr_read_b32 v81, a101
    v_accvgpr_read_b32 v85, a117
    v_accvgpr_read_b32 v82, a102
    v_accvgpr_read_b32 v86, a118
    v_accvgpr_read_b32 v83, a103
    v_accvgpr_read_b32 v87, a119
    v_mul_f32 v80, v80, v54
    v_mul_f32 v81, v81, v54
    v_mul_f32 v82, v82, v54
    v_mul_f32 v83, v83, v54
    v_mul_f32 v84, v84, v54
    v_mul_f32 v85, v85, v54
    v_mul_f32 v86, v86, v54
    v_mul_f32 v87, v87, v54
    v_cvt_pk_bf16_f32 v76, v80, v81
    v_cvt_pk_bf16_f32 v77, v82, v83
    v_cvt_pk_bf16_f32 v78, v84, v85
    v_cvt_pk_bf16_f32 v79, v86, v87
    s_nop 1
    v_permlane16_swap_b32 v76, v78
    v_permlane16_swap_b32 v77, v79
    buffer_store_dwordx4 v[76:79], v9, s[16:19], s31 offen offset:192 sc1
    s_mov_b32 s31, 262144
    v_accvgpr_read_b32 v92, a8
    v_accvgpr_read_b32 v96, a24
    v_accvgpr_read_b32 v93, a9
    v_accvgpr_read_b32 v97, a25
    v_accvgpr_read_b32 v94, a10
    v_accvgpr_read_b32 v98, a26
    v_accvgpr_read_b32 v95, a11
    v_accvgpr_read_b32 v99, a27
    v_mul_f32 v92, v92, v55
    v_mul_f32 v93, v93, v55
    v_mul_f32 v94, v94, v55
    v_mul_f32 v95, v95, v55
    v_mul_f32 v96, v96, v55
    v_mul_f32 v97, v97, v55
    v_mul_f32 v98, v98, v55
    v_mul_f32 v99, v99, v55
    v_cvt_pk_bf16_f32 v88, v92, v93
    v_cvt_pk_bf16_f32 v89, v94, v95
    v_cvt_pk_bf16_f32 v90, v96, v97
    v_cvt_pk_bf16_f32 v91, v98, v99
    s_nop 1
    v_permlane16_swap_b32 v88, v90
    v_permlane16_swap_b32 v89, v91
    buffer_store_dwordx4 v[88:91], v9, s[16:19], s31 offen offset:0 sc1
    v_accvgpr_read_b32 v104, a40
    v_accvgpr_read_b32 v108, a56
    v_accvgpr_read_b32 v105, a41
    v_accvgpr_read_b32 v109, a57
    v_accvgpr_read_b32 v106, a42
    v_accvgpr_read_b32 v110, a58
    v_accvgpr_read_b32 v107, a43
    v_accvgpr_read_b32 v111, a59
    v_mul_f32 v104, v104, v55
    v_mul_f32 v105, v105, v55
    v_mul_f32 v106, v106, v55
    v_mul_f32 v107, v107, v55
    v_mul_f32 v108, v108, v55
    v_mul_f32 v109, v109, v55
    v_mul_f32 v110, v110, v55
    v_mul_f32 v111, v111, v55
    v_cvt_pk_bf16_f32 v100, v104, v105
    v_cvt_pk_bf16_f32 v101, v106, v107
    v_cvt_pk_bf16_f32 v102, v108, v109
    v_cvt_pk_bf16_f32 v103, v110, v111
    s_nop 1
    v_permlane16_swap_b32 v100, v102
    v_permlane16_swap_b32 v101, v103
    buffer_store_dwordx4 v[100:103], v9, s[16:19], s31 offen offset:64 sc1
    v_accvgpr_read_b32 v116, a72
    v_accvgpr_read_b32 v120, a88
    v_accvgpr_read_b32 v117, a73
    v_accvgpr_read_b32 v121, a89
    v_accvgpr_read_b32 v118, a74
    v_accvgpr_read_b32 v122, a90
    v_accvgpr_read_b32 v119, a75
    v_accvgpr_read_b32 v123, a91
    v_mul_f32 v116, v116, v55
    v_mul_f32 v117, v117, v55
    v_mul_f32 v118, v118, v55
    v_mul_f32 v119, v119, v55
    v_mul_f32 v120, v120, v55
    v_mul_f32 v121, v121, v55
    v_mul_f32 v122, v122, v55
    v_mul_f32 v123, v123, v55
    v_cvt_pk_bf16_f32 v112, v116, v117
    v_cvt_pk_bf16_f32 v113, v118, v119
    v_cvt_pk_bf16_f32 v114, v120, v121
    v_cvt_pk_bf16_f32 v115, v122, v123
    s_nop 1
    v_permlane16_swap_b32 v112, v114
    v_permlane16_swap_b32 v113, v115
    buffer_store_dwordx4 v[112:115], v9, s[16:19], s31 offen offset:128 sc1
    v_accvgpr_read_b32 v128, a104
    v_accvgpr_read_b32 v132, a120
    v_accvgpr_read_b32 v129, a105
    v_accvgpr_read_b32 v133, a121
    v_accvgpr_read_b32 v130, a106
    v_accvgpr_read_b32 v134, a122
    v_accvgpr_read_b32 v131, a107
    v_accvgpr_read_b32 v135, a123
    v_mul_f32 v128, v128, v55
    v_mul_f32 v129, v129, v55
    v_mul_f32 v130, v130, v55
    v_mul_f32 v131, v131, v55
    v_mul_f32 v132, v132, v55
    v_mul_f32 v133, v133, v55
    v_mul_f32 v134, v134, v55
    v_mul_f32 v135, v135, v55
    v_cvt_pk_bf16_f32 v124, v128, v129
    v_cvt_pk_bf16_f32 v125, v130, v131
    v_cvt_pk_bf16_f32 v126, v132, v133
    v_cvt_pk_bf16_f32 v127, v134, v135
    s_nop 1
    v_permlane16_swap_b32 v124, v126
    v_permlane16_swap_b32 v125, v127
    buffer_store_dwordx4 v[124:127], v9, s[16:19], s31 offen offset:192 sc1
    s_mov_b32 s31, 393216
    v_accvgpr_read_b32 v68, a12
    v_accvgpr_read_b32 v72, a28
    v_accvgpr_read_b32 v69, a13
    v_accvgpr_read_b32 v73, a29
    v_accvgpr_read_b32 v70, a14
    v_accvgpr_read_b32 v74, a30
    v_accvgpr_read_b32 v71, a15
    v_accvgpr_read_b32 v75, a31
    v_mul_f32 v68, v68, v56
    v_mul_f32 v69, v69, v56
    v_mul_f32 v70, v70, v56
    v_mul_f32 v71, v71, v56
    v_mul_f32 v72, v72, v56
    v_mul_f32 v73, v73, v56
    v_mul_f32 v74, v74, v56
    v_mul_f32 v75, v75, v56
    v_cvt_pk_bf16_f32 v64, v68, v69
    v_cvt_pk_bf16_f32 v65, v70, v71
    v_cvt_pk_bf16_f32 v66, v72, v73
    v_cvt_pk_bf16_f32 v67, v74, v75
    s_nop 1
    v_permlane16_swap_b32 v64, v66
    v_permlane16_swap_b32 v65, v67
    buffer_store_dwordx4 v[64:67], v9, s[16:19], s31 offen offset:0 sc1
    v_accvgpr_read_b32 v80, a44
    v_accvgpr_read_b32 v84, a60
    v_accvgpr_read_b32 v81, a45
    v_accvgpr_read_b32 v85, a61
    v_accvgpr_read_b32 v82, a46
    v_accvgpr_read_b32 v86, a62
    v_accvgpr_read_b32 v83, a47
    v_accvgpr_read_b32 v87, a63
    v_mul_f32 v80, v80, v56
    v_mul_f32 v81, v81, v56
    v_mul_f32 v82, v82, v56
    v_mul_f32 v83, v83, v56
    v_mul_f32 v84, v84, v56
    v_mul_f32 v85, v85, v56
    v_mul_f32 v86, v86, v56
    v_mul_f32 v87, v87, v56
    v_cvt_pk_bf16_f32 v76, v80, v81
    v_cvt_pk_bf16_f32 v77, v82, v83
    v_cvt_pk_bf16_f32 v78, v84, v85
    v_cvt_pk_bf16_f32 v79, v86, v87
    s_nop 1
    v_permlane16_swap_b32 v76, v78
    v_permlane16_swap_b32 v77, v79
    buffer_store_dwordx4 v[76:79], v9, s[16:19], s31 offen offset:64 sc1
    v_accvgpr_read_b32 v92, a76
    v_accvgpr_read_b32 v96, a92
    v_accvgpr_read_b32 v93, a77
    v_accvgpr_read_b32 v97, a93
    v_accvgpr_read_b32 v94, a78
    v_accvgpr_read_b32 v98, a94
    v_accvgpr_read_b32 v95, a79
    v_accvgpr_read_b32 v99, a95
    v_mul_f32 v92, v92, v56
    v_mul_f32 v93, v93, v56
    v_mul_f32 v94, v94, v56
    v_mul_f32 v95, v95, v56
    v_mul_f32 v96, v96, v56
    v_mul_f32 v97, v97, v56
    v_mul_f32 v98, v98, v56
    v_mul_f32 v99, v99, v56
    v_cvt_pk_bf16_f32 v88, v92, v93
    v_cvt_pk_bf16_f32 v89, v94, v95
    v_cvt_pk_bf16_f32 v90, v96, v97
    v_cvt_pk_bf16_f32 v91, v98, v99
    s_nop 1
    v_permlane16_swap_b32 v88, v90
    v_permlane16_swap_b32 v89, v91
    buffer_store_dwordx4 v[88:91], v9, s[16:19], s31 offen offset:128 sc1
    v_accvgpr_read_b32 v104, a108
    v_accvgpr_read_b32 v108, a124
    v_accvgpr_read_b32 v105, a109
    v_accvgpr_read_b32 v109, a125
    v_accvgpr_read_b32 v106, a110
    v_accvgpr_read_b32 v110, a126
    v_accvgpr_read_b32 v107, a111
    v_accvgpr_read_b32 v111, a127
    v_mul_f32 v104, v104, v56
    v_mul_f32 v105, v105, v56
    v_mul_f32 v106, v106, v56
    v_mul_f32 v107, v107, v56
    v_mul_f32 v108, v108, v56
    v_mul_f32 v109, v109, v56
    v_mul_f32 v110, v110, v56
    v_mul_f32 v111, v111, v56
    v_cvt_pk_bf16_f32 v100, v104, v105
    v_cvt_pk_bf16_f32 v101, v106, v107
    v_cvt_pk_bf16_f32 v102, v108, v109
    v_cvt_pk_bf16_f32 v103, v110, v111
    s_nop 1
    v_permlane16_swap_b32 v100, v102
    v_permlane16_swap_b32 v101, v103
    buffer_store_dwordx4 v[100:103], v9, s[16:19], s31 offen offset:192 sc1
.attn_end:
    s_endpgm
.attn_fbs0:
    s_call_b64 s[40:41], .attn_fb0
    s_branch .attn_back0
.attn_fbs1:
    s_call_b64 s[40:41], .attn_fb1
    s_branch .attn_back1
.attn_fbs2:
    s_call_b64 s[40:41], .attn_fb0
    s_branch .attn_back2
.attn_fbs3:
    s_call_b64 s[40:41], .attn_fb1
    s_branch .attn_back3
.attn_fbs4:
    s_call_b64 s[40:41], .attn_fb0
    s_branch .attn_back4
.attn_fbs5:
    s_call_b64 s[40:41], .attn_fb1
    s_branch .attn_back5
.attn_fbs6:
    s_call_b64 s[40:41], .attn_fb0
    s_branch .attn_back6
.attn_fbs7:
    s_call_b64 s[40:41], .attn_fb1
    s_branch .attn_back7
.attn_fb0:
    s_nop 15
    s_nop 15
    v_max3_f32 v52, v64, v65, v66
    v_max3_f32 v52, v52, v67, v80
    v_max3_f32 v52, v52, v81, v82
    v_max_f32 v52, v52, v83
    v_mov_b32 v53, v52
    s_nop 1
    v_permlane16_swap_b32 v52, v53
    s_nop 0
    v_max_f32 v52, v52, v53
    v_mov_b32 v53, v52
    s_nop 1
    v_permlane32_swap_b32 v52, v53
    s_nop 0
    v_max_f32 v52, v52, v53
    v_max_f32 v52, s30, v52
    v_max_f32 v53, 0, v52
    v_sub_f32 v53, 0, v53
    v_exp_f32 v53, v53
    v_sub_f32 v128, v128, v52
    v_sub_f32 v129, v129, v52
    v_sub_f32 v130, v130, v52
    v_sub_f32 v131, v131, v52
    v_sub_f32 v64, v64, v52
    v_sub_f32 v96, v96, v52
    v_sub_f32 v65, v65, v52
    v_sub_f32 v97, v97, v52
    v_sub_f32 v66, v66, v52
    v_sub_f32 v98, v98, v52
    v_sub_f32 v67, v67, v52
    v_sub_f32 v99, v99, v52
    v_sub_f32 v80, v80, v52
    v_sub_f32 v112, v112, v52
    v_sub_f32 v81, v81, v52
    v_sub_f32 v113, v113, v52
    v_sub_f32 v82, v82, v52
    v_sub_f32 v114, v114, v52
    v_sub_f32 v83, v83, v52
    v_sub_f32 v115, v115, v52
    v_mul_f32 v36, v36, v53
    v_accvgpr_read_b32 v54, a0
    v_accvgpr_read_b32 v55, a1
    v_accvgpr_read_b32 v56, a2
    v_accvgpr_read_b32 v57, a3
    v_accvgpr_read_b32 v58, a16
    v_accvgpr_read_b32 v59, a17
    v_accvgpr_read_b32 v60, a18
    v_accvgpr_read_b32 v61, a19
    v_mul_f32 v54, v54, v53
    v_mul_f32 v55, v55, v53
    v_mul_f32 v56, v56, v53
    v_mul_f32 v57, v57, v53
    v_mul_f32 v58, v58, v53
    v_mul_f32 v59, v59, v53
    v_mul_f32 v60, v60, v53
    v_mul_f32 v61, v61, v53
    v_accvgpr_write_b32 a0, v54
    v_accvgpr_write_b32 a1, v55
    v_accvgpr_write_b32 a2, v56
    v_accvgpr_write_b32 a3, v57
    v_accvgpr_write_b32 a16, v58
    v_accvgpr_write_b32 a17, v59
    v_accvgpr_write_b32 a18, v60
    v_accvgpr_write_b32 a19, v61
    v_accvgpr_read_b32 v54, a32
    v_accvgpr_read_b32 v55, a33
    v_accvgpr_read_b32 v56, a34
    v_accvgpr_read_b32 v57, a35
    v_accvgpr_read_b32 v58, a48
    v_accvgpr_read_b32 v59, a49
    v_accvgpr_read_b32 v60, a50
    v_accvgpr_read_b32 v61, a51
    v_mul_f32 v54, v54, v53
    v_mul_f32 v55, v55, v53
    v_mul_f32 v56, v56, v53
    v_mul_f32 v57, v57, v53
    v_mul_f32 v58, v58, v53
    v_mul_f32 v59, v59, v53
    v_mul_f32 v60, v60, v53
    v_mul_f32 v61, v61, v53
    v_accvgpr_write_b32 a32, v54
    v_accvgpr_write_b32 a33, v55
    v_accvgpr_write_b32 a34, v56
    v_accvgpr_write_b32 a35, v57
    v_accvgpr_write_b32 a48, v58
    v_accvgpr_write_b32 a49, v59
    v_accvgpr_write_b32 a50, v60
    v_accvgpr_write_b32 a51, v61
    v_accvgpr_read_b32 v54, a64
    v_accvgpr_read_b32 v55, a65
    v_accvgpr_read_b32 v56, a66
    v_accvgpr_read_b32 v57, a67
    v_accvgpr_read_b32 v58, a80
    v_accvgpr_read_b32 v59, a81
    v_accvgpr_read_b32 v60, a82
    v_accvgpr_read_b32 v61, a83
    v_mul_f32 v54, v54, v53
    v_mul_f32 v55, v55, v53
    v_mul_f32 v56, v56, v53
    v_mul_f32 v57, v57, v53
    v_mul_f32 v58, v58, v53
    v_mul_f32 v59, v59, v53
    v_mul_f32 v60, v60, v53
    v_mul_f32 v61, v61, v53
    v_accvgpr_write_b32 a64, v54
    v_accvgpr_write_b32 a65, v55
    v_accvgpr_write_b32 a66, v56
    v_accvgpr_write_b32 a67, v57
    v_accvgpr_write_b32 a80, v58
    v_accvgpr_write_b32 a81, v59
    v_accvgpr_write_b32 a82, v60
    v_accvgpr_write_b32 a83, v61
    v_accvgpr_read_b32 v54, a96
    v_accvgpr_read_b32 v55, a97
    v_accvgpr_read_b32 v56, a98
    v_accvgpr_read_b32 v57, a99
    v_accvgpr_read_b32 v58, a112
    v_accvgpr_read_b32 v59, a113
    v_accvgpr_read_b32 v60, a114
    v_accvgpr_read_b32 v61, a115
    v_mul_f32 v54, v54, v53
    v_mul_f32 v55, v55, v53
    v_mul_f32 v56, v56, v53
    v_mul_f32 v57, v57, v53
    v_mul_f32 v58, v58, v53
    v_mul_f32 v59, v59, v53
    v_mul_f32 v60, v60, v53
    v_mul_f32 v61, v61, v53
    v_accvgpr_write_b32 a96, v54
    v_accvgpr_write_b32 a97, v55
    v_accvgpr_write_b32 a98, v56
    v_accvgpr_write_b32 a99, v57
    v_accvgpr_write_b32 a112, v58
    v_accvgpr_write_b32 a113, v59
    v_accvgpr_write_b32 a114, v60
    v_accvgpr_write_b32 a115, v61
    v_max3_f32 v52, v68, v69, v70
    v_max3_f32 v52, v52, v71, v84
    v_max3_f32 v52, v52, v85, v86
    v_max_f32 v52, v52, v87
    v_mov_b32 v53, v52
    s_nop 1
    v_permlane16_swap_b32 v52, v53
    s_nop 0
    v_max_f32 v52, v52, v53
    v_mov_b32 v53, v52
    s_nop 1
    v_permlane32_swap_b32 v52, v53
    s_nop 0
    v_max_f32 v52, v52, v53
    v_max_f32 v52, s30, v52
    v_max_f32 v53, 0, v52
    v_sub_f32 v53, 0, v53
    v_exp_f32 v53, v53
    v_sub_f32 v132, v132, v52
    v_sub_f32 v133, v133, v52
    v_sub_f32 v134, v134, v52
    v_sub_f32 v135, v135, v52
    v_sub_f32 v68, v68, v52
    v_sub_f32 v100, v100, v52
    v_sub_f32 v69, v69, v52
    v_sub_f32 v101, v101, v52
    v_sub_f32 v70, v70, v52
    v_sub_f32 v102, v102, v52
    v_sub_f32 v71, v71, v52
    v_sub_f32 v103, v103, v52
    v_sub_f32 v84, v84, v52
    v_sub_f32 v116, v116, v52
    v_sub_f32 v85, v85, v52
    v_sub_f32 v117, v117, v52
    v_sub_f32 v86, v86, v52
    v_sub_f32 v118, v118, v52
    v_sub_f32 v87, v87, v52
    v_sub_f32 v119, v119, v52
    v_mul_f32 v37, v37, v53
    v_accvgpr_read_b32 v54, a4
    v_accvgpr_read_b32 v55, a5
    v_accvgpr_read_b32 v56, a6
    v_accvgpr_read_b32 v57, a7
    v_accvgpr_read_b32 v58, a20
    v_accvgpr_read_b32 v59, a21
    v_accvgpr_read_b32 v60, a22
    v_accvgpr_read_b32 v61, a23
    v_mul_f32 v54, v54, v53
    v_mul_f32 v55, v55, v53
    v_mul_f32 v56, v56, v53
    v_mul_f32 v57, v57, v53
    v_mul_f32 v58, v58, v53
    v_mul_f32 v59, v59, v53
    v_mul_f32 v60, v60, v53
    v_mul_f32 v61, v61, v53
    v_accvgpr_write_b32 a4, v54
    v_accvgpr_write_b32 a5, v55
    v_accvgpr_write_b32 a6, v56
    v_accvgpr_write_b32 a7, v57
    v_accvgpr_write_b32 a20, v58
    v_accvgpr_write_b32 a21, v59
    v_accvgpr_write_b32 a22, v60
    v_accvgpr_write_b32 a23, v61
    v_accvgpr_read_b32 v54, a36
    v_accvgpr_read_b32 v55, a37
    v_accvgpr_read_b32 v56, a38
    v_accvgpr_read_b32 v57, a39
    v_accvgpr_read_b32 v58, a52
    v_accvgpr_read_b32 v59, a53
    v_accvgpr_read_b32 v60, a54
    v_accvgpr_read_b32 v61, a55
    v_mul_f32 v54, v54, v53
    v_mul_f32 v55, v55, v53
    v_mul_f32 v56, v56, v53
    v_mul_f32 v57, v57, v53
    v_mul_f32 v58, v58, v53
    v_mul_f32 v59, v59, v53
    v_mul_f32 v60, v60, v53
    v_mul_f32 v61, v61, v53
    v_accvgpr_write_b32 a36, v54
    v_accvgpr_write_b32 a37, v55
    v_accvgpr_write_b32 a38, v56
    v_accvgpr_write_b32 a39, v57
    v_accvgpr_write_b32 a52, v58
    v_accvgpr_write_b32 a53, v59
    v_accvgpr_write_b32 a54, v60
    v_accvgpr_write_b32 a55, v61
    v_accvgpr_read_b32 v54, a68
    v_accvgpr_read_b32 v55, a69
    v_accvgpr_read_b32 v56, a70
    v_accvgpr_read_b32 v57, a71
    v_accvgpr_read_b32 v58, a84
    v_accvgpr_read_b32 v59, a85
    v_accvgpr_read_b32 v60, a86
    v_accvgpr_read_b32 v61, a87
    v_mul_f32 v54, v54, v53
    v_mul_f32 v55, v55, v53
    v_mul_f32 v56, v56, v53
    v_mul_f32 v57, v57, v53
    v_mul_f32 v58, v58, v53
    v_mul_f32 v59, v59, v53
    v_mul_f32 v60, v60, v53
    v_mul_f32 v61, v61, v53
    v_accvgpr_write_b32 a68, v54
    v_accvgpr_write_b32 a69, v55
    v_accvgpr_write_b32 a70, v56
    v_accvgpr_write_b32 a71, v57
    v_accvgpr_write_b32 a84, v58
    v_accvgpr_write_b32 a85, v59
    v_accvgpr_write_b32 a86, v60
    v_accvgpr_write_b32 a87, v61
    v_accvgpr_read_b32 v54, a100
    v_accvgpr_read_b32 v55, a101
    v_accvgpr_read_b32 v56, a102
    v_accvgpr_read_b32 v57, a103
    v_accvgpr_read_b32 v58, a116
    v_accvgpr_read_b32 v59, a117
    v_accvgpr_read_b32 v60, a118
    v_accvgpr_read_b32 v61, a119
    v_mul_f32 v54, v54, v53
    v_mul_f32 v55, v55, v53
    v_mul_f32 v56, v56, v53
    v_mul_f32 v57, v57, v53
    v_mul_f32 v58, v58, v53
    v_mul_f32 v59, v59, v53
    v_mul_f32 v60, v60, v53
    v_mul_f32 v61, v61, v53
    v_accvgpr_write_b32 a100, v54
    v_accvgpr_write_b32 a101, v55
    v_accvgpr_write_b32 a102, v56
    v_accvgpr_write_b32 a103, v57
    v_accvgpr_write_b32 a116, v58
    v_accvgpr_write_b32 a117, v59
    v_accvgpr_write_b32 a118, v60
    v_accvgpr_write_b32 a119, v61
    v_max3_f32 v52, v72, v73, v74
    v_max3_f32 v52, v52, v75, v88
    v_max3_f32 v52, v52, v89, v90
    v_max_f32 v52, v52, v91
    v_mov_b32 v53, v52
    s_nop 1
    v_permlane16_swap_b32 v52, v53
    s_nop 0
    v_max_f32 v52, v52, v53
    v_mov_b32 v53, v52
    s_nop 1
    v_permlane32_swap_b32 v52, v53
    s_nop 0
    v_max_f32 v52, v52, v53
    v_max_f32 v52, s30, v52
    v_max_f32 v53, 0, v52
    v_sub_f32 v53, 0, v53
    v_exp_f32 v53, v53
    v_sub_f32 v136, v136, v52
    v_sub_f32 v137, v137, v52
    v_sub_f32 v138, v138, v52
    v_sub_f32 v139, v139, v52
    v_sub_f32 v72, v72, v52
    v_sub_f32 v104, v104, v52
    v_sub_f32 v73, v73, v52
    v_sub_f32 v105, v105, v52
    v_sub_f32 v74, v74, v52
    v_sub_f32 v106, v106, v52
    v_sub_f32 v75, v75, v52
    v_sub_f32 v107, v107, v52
    v_sub_f32 v88, v88, v52
    v_sub_f32 v120, v120, v52
    v_sub_f32 v89, v89, v52
    v_sub_f32 v121, v121, v52
    v_sub_f32 v90, v90, v52
    v_sub_f32 v122, v122, v52
    v_sub_f32 v91, v91, v52
    v_sub_f32 v123, v123, v52
    v_mul_f32 v38, v38, v53
    v_accvgpr_read_b32 v54, a8
    v_accvgpr_read_b32 v55, a9
    v_accvgpr_read_b32 v56, a10
    v_accvgpr_read_b32 v57, a11
    v_accvgpr_read_b32 v58, a24
    v_accvgpr_read_b32 v59, a25
    v_accvgpr_read_b32 v60, a26
    v_accvgpr_read_b32 v61, a27
    v_mul_f32 v54, v54, v53
    v_mul_f32 v55, v55, v53
    v_mul_f32 v56, v56, v53
    v_mul_f32 v57, v57, v53
    v_mul_f32 v58, v58, v53
    v_mul_f32 v59, v59, v53
    v_mul_f32 v60, v60, v53
    v_mul_f32 v61, v61, v53
    v_accvgpr_write_b32 a8, v54
    v_accvgpr_write_b32 a9, v55
    v_accvgpr_write_b32 a10, v56
    v_accvgpr_write_b32 a11, v57
    v_accvgpr_write_b32 a24, v58
    v_accvgpr_write_b32 a25, v59
    v_accvgpr_write_b32 a26, v60
    v_accvgpr_write_b32 a27, v61
    v_accvgpr_read_b32 v54, a40
    v_accvgpr_read_b32 v55, a41
    v_accvgpr_read_b32 v56, a42
    v_accvgpr_read_b32 v57, a43
    v_accvgpr_read_b32 v58, a56
    v_accvgpr_read_b32 v59, a57
    v_accvgpr_read_b32 v60, a58
    v_accvgpr_read_b32 v61, a59
    v_mul_f32 v54, v54, v53
    v_mul_f32 v55, v55, v53
    v_mul_f32 v56, v56, v53
    v_mul_f32 v57, v57, v53
    v_mul_f32 v58, v58, v53
    v_mul_f32 v59, v59, v53
    v_mul_f32 v60, v60, v53
    v_mul_f32 v61, v61, v53
    v_accvgpr_write_b32 a40, v54
    v_accvgpr_write_b32 a41, v55
    v_accvgpr_write_b32 a42, v56
    v_accvgpr_write_b32 a43, v57
    v_accvgpr_write_b32 a56, v58
    v_accvgpr_write_b32 a57, v59
    v_accvgpr_write_b32 a58, v60
    v_accvgpr_write_b32 a59, v61
    v_accvgpr_read_b32 v54, a72
    v_accvgpr_read_b32 v55, a73
    v_accvgpr_read_b32 v56, a74
    v_accvgpr_read_b32 v57, a75
    v_accvgpr_read_b32 v58, a88
    v_accvgpr_read_b32 v59, a89
    v_accvgpr_read_b32 v60, a90
    v_accvgpr_read_b32 v61, a91
    v_mul_f32 v54, v54, v53
    v_mul_f32 v55, v55, v53
    v_mul_f32 v56, v56, v53
    v_mul_f32 v57, v57, v53
    v_mul_f32 v58, v58, v53
    v_mul_f32 v59, v59, v53
    v_mul_f32 v60, v60, v53
    v_mul_f32 v61, v61, v53
    v_accvgpr_write_b32 a72, v54
    v_accvgpr_write_b32 a73, v55
    v_accvgpr_write_b32 a74, v56
    v_accvgpr_write_b32 a75, v57
    v_accvgpr_write_b32 a88, v58
    v_accvgpr_write_b32 a89, v59
    v_accvgpr_write_b32 a90, v60
    v_accvgpr_write_b32 a91, v61
    v_accvgpr_read_b32 v54, a104
    v_accvgpr_read_b32 v55, a105
    v_accvgpr_read_b32 v56, a106
    v_accvgpr_read_b32 v57, a107
    v_accvgpr_read_b32 v58, a120
    v_accvgpr_read_b32 v59, a121
    v_accvgpr_read_b32 v60, a122
    v_accvgpr_read_b32 v61, a123
    v_mul_f32 v54, v54, v53
    v_mul_f32 v55, v55, v53
    v_mul_f32 v56, v56, v53
    v_mul_f32 v57, v57, v53
    v_mul_f32 v58, v58, v53
    v_mul_f32 v59, v59, v53
    v_mul_f32 v60, v60, v53
    v_mul_f32 v61, v61, v53
    v_accvgpr_write_b32 a104, v54
    v_accvgpr_write_b32 a105, v55
    v_accvgpr_write_b32 a106, v56
    v_accvgpr_write_b32 a107, v57
    v_accvgpr_write_b32 a120, v58
    v_accvgpr_write_b32 a121, v59
    v_accvgpr_write_b32 a122, v60
    v_accvgpr_write_b32 a123, v61
    v_max3_f32 v52, v76, v77, v78
    v_max3_f32 v52, v52, v79, v92
    v_max3_f32 v52, v52, v93, v94
    v_max_f32 v52, v52, v95
    v_mov_b32 v53, v52
    s_nop 1
    v_permlane16_swap_b32 v52, v53
    s_nop 0
    v_max_f32 v52, v52, v53
    v_mov_b32 v53, v52
    s_nop 1
    v_permlane32_swap_b32 v52, v53
    s_nop 0
    v_max_f32 v52, v52, v53
    v_max_f32 v52, s30, v52
    v_max_f32 v53, 0, v52
    v_sub_f32 v53, 0, v53
    v_exp_f32 v53, v53
    v_sub_f32 v140, v140, v52
    v_sub_f32 v141, v141, v52
    v_sub_f32 v142, v142, v52
    v_sub_f32 v143, v143, v52
    v_sub_f32 v76, v76, v52
    v_sub_f32 v108, v108, v52
    v_sub_f32 v77, v77, v52
    v_sub_f32 v109, v109, v52
    v_sub_f32 v78, v78, v52
    v_sub_f32 v110, v110, v52
    v_sub_f32 v79, v79, v52
    v_sub_f32 v111, v111, v52
    v_sub_f32 v92, v92, v52
    v_sub_f32 v124, v124, v52
    v_sub_f32 v93, v93, v52
    v_sub_f32 v125, v125, v52
    v_sub_f32 v94, v94, v52
    v_sub_f32 v126, v126, v52
    v_sub_f32 v95, v95, v52
    v_sub_f32 v127, v127, v52
    v_mul_f32 v39, v39, v53
    v_accvgpr_read_b32 v54, a12
    v_accvgpr_read_b32 v55, a13
    v_accvgpr_read_b32 v56, a14
    v_accvgpr_read_b32 v57, a15
    v_accvgpr_read_b32 v58, a28
    v_accvgpr_read_b32 v59, a29
    v_accvgpr_read_b32 v60, a30
    v_accvgpr_read_b32 v61, a31
    v_mul_f32 v54, v54, v53
    v_mul_f32 v55, v55, v53
    v_mul_f32 v56, v56, v53
    v_mul_f32 v57, v57, v53
    v_mul_f32 v58, v58, v53
    v_mul_f32 v59, v59, v53
    v_mul_f32 v60, v60, v53
    v_mul_f32 v61, v61, v53
    v_accvgpr_write_b32 a12, v54
    v_accvgpr_write_b32 a13, v55
    v_accvgpr_write_b32 a14, v56
    v_accvgpr_write_b32 a15, v57
    v_accvgpr_write_b32 a28, v58
    v_accvgpr_write_b32 a29, v59
    v_accvgpr_write_b32 a30, v60
    v_accvgpr_write_b32 a31, v61
    v_accvgpr_read_b32 v54, a44
    v_accvgpr_read_b32 v55, a45
    v_accvgpr_read_b32 v56, a46
    v_accvgpr_read_b32 v57, a47
    v_accvgpr_read_b32 v58, a60
    v_accvgpr_read_b32 v59, a61
    v_accvgpr_read_b32 v60, a62
    v_accvgpr_read_b32 v61, a63
    v_mul_f32 v54, v54, v53
    v_mul_f32 v55, v55, v53
    v_mul_f32 v56, v56, v53
    v_mul_f32 v57, v57, v53
    v_mul_f32 v58, v58, v53
    v_mul_f32 v59, v59, v53
    v_mul_f32 v60, v60, v53
    v_mul_f32 v61, v61, v53
    v_accvgpr_write_b32 a44, v54
    v_accvgpr_write_b32 a45, v55
    v_accvgpr_write_b32 a46, v56
    v_accvgpr_write_b32 a47, v57
    v_accvgpr_write_b32 a60, v58
    v_accvgpr_write_b32 a61, v59
    v_accvgpr_write_b32 a62, v60
    v_accvgpr_write_b32 a63, v61
    v_accvgpr_read_b32 v54, a76
    v_accvgpr_read_b32 v55, a77
    v_accvgpr_read_b32 v56, a78
    v_accvgpr_read_b32 v57, a79
    v_accvgpr_read_b32 v58, a92
    v_accvgpr_read_b32 v59, a93
    v_accvgpr_read_b32 v60, a94
    v_accvgpr_read_b32 v61, a95
    v_mul_f32 v54, v54, v53
    v_mul_f32 v55, v55, v53
    v_mul_f32 v56, v56, v53
    v_mul_f32 v57, v57, v53
    v_mul_f32 v58, v58, v53
    v_mul_f32 v59, v59, v53
    v_mul_f32 v60, v60, v53
    v_mul_f32 v61, v61, v53
    v_accvgpr_write_b32 a76, v54
    v_accvgpr_write_b32 a77, v55
    v_accvgpr_write_b32 a78, v56
    v_accvgpr_write_b32 a79, v57
    v_accvgpr_write_b32 a92, v58
    v_accvgpr_write_b32 a93, v59
    v_accvgpr_write_b32 a94, v60
    v_accvgpr_write_b32 a95, v61
    v_accvgpr_read_b32 v54, a108
    v_accvgpr_read_b32 v55, a109
    v_accvgpr_read_b32 v56, a110
    v_accvgpr_read_b32 v57, a111
    v_accvgpr_read_b32 v58, a124
    v_accvgpr_read_b32 v59, a125
    v_accvgpr_read_b32 v60, a126
    v_accvgpr_read_b32 v61, a127
    v_mul_f32 v54, v54, v53
    v_mul_f32 v55, v55, v53
    v_mul_f32 v56, v56, v53
    v_mul_f32 v57, v57, v53
    v_mul_f32 v58, v58, v53
    v_mul_f32 v59, v59, v53
    v_mul_f32 v60, v60, v53
    v_mul_f32 v61, v61, v53
    v_accvgpr_write_b32 a108, v54
    v_accvgpr_write_b32 a109, v55
    v_accvgpr_write_b32 a110, v56
    v_accvgpr_write_b32 a111, v57
    v_accvgpr_write_b32 a124, v58
    v_accvgpr_write_b32 a125, v59
    v_accvgpr_write_b32 a126, v60
    v_accvgpr_write_b32 a127, v61
    v_exp_f32 v44, v64
    v_exp_f32 v45, v65
    v_exp_f32 v46, v66
    v_exp_f32 v47, v67
    v_add_f32 v40, v44, v45
    v_cvt_pk_bf16_f32 v144, v44, v45
    v_exp_f32 v48, v80
    v_exp_f32 v49, v81
    v_add_f32 v40, v40, v46
    v_add_f32 v40, v40, v47
    v_cvt_pk_bf16_f32 v145, v46, v47
    v_exp_f32 v50, v82
    v_exp_f32 v51, v83
    v_add_f32 v40, v40, v48
    v_add_f32 v40, v40, v49
    v_cvt_pk_bf16_f32 v146, v48, v49
    v_exp_f32 v44, v68
    v_exp_f32 v45, v69
    v_add_f32 v40, v40, v50
    v_add_f32 v40, v40, v51
    v_cvt_pk_bf16_f32 v147, v50, v51
    v_exp_f32 v46, v70
    v_exp_f32 v47, v71
    v_add_f32 v41, v44, v45
    v_cvt_pk_bf16_f32 v148, v44, v45
    v_exp_f32 v48, v84
    v_exp_f32 v49, v85
    v_add_f32 v41, v41, v46
    v_add_f32 v41, v41, v47
    v_cvt_pk_bf16_f32 v149, v46, v47
    v_exp_f32 v50, v86
    v_exp_f32 v51, v87
    v_add_f32 v41, v41, v48
    v_add_f32 v41, v41, v49
    v_cvt_pk_bf16_f32 v150, v48, v49
    v_exp_f32 v44, v72
    v_exp_f32 v45, v73
    v_add_f32 v41, v41, v50
    v_add_f32 v41, v41, v51
    v_cvt_pk_bf16_f32 v151, v50, v51
    v_exp_f32 v46, v74
    v_exp_f32 v47, v75
    v_add_f32 v42, v44, v45
    v_cvt_pk_bf16_f32 v152, v44, v45
    v_exp_f32 v48, v88
    v_exp_f32 v49, v89
    v_add_f32 v42, v42, v46
    v_add_f32 v42, v42, v47
    v_cvt_pk_bf16_f32 v153, v46, v47
    v_exp_f32 v50, v90
    v_exp_f32 v51, v91
    v_add_f32 v42, v42, v48
    v_add_f32 v42, v42, v49
    v_cvt_pk_bf16_f32 v154, v48, v49
    v_exp_f32 v44, v76
    v_exp_f32 v45, v77
    v_add_f32 v42, v42, v50
    v_add_f32 v42, v42, v51
    v_cvt_pk_bf16_f32 v155, v50, v51
    v_exp_f32 v46, v78
    v_exp_f32 v47, v79
    v_add_f32 v43, v44, v45
    v_cvt_pk_bf16_f32 v156, v44, v45
    v_exp_f32 v48, v92
    v_exp_f32 v49, v93
    v_add_f32 v43, v43, v46
    v_add_f32 v43, v43, v47
    v_cvt_pk_bf16_f32 v157, v46, v47
    v_exp_f32 v50, v94
    v_exp_f32 v51, v95
    v_add_f32 v43, v43, v48
    v_add_f32 v43, v43, v49
    v_cvt_pk_bf16_f32 v158, v48, v49
    s_nop 0
    v_add_f32 v43, v43, v50
    v_add_f32 v43, v43, v51
    v_cvt_pk_bf16_f32 v159, v50, v51
    s_mov_b32 s29, 0x47800000
    s_mov_b32 s30, 0
    s_nop 3
    s_setpc_b64 s[40:41]
.attn_fb1:
    s_nop 15
    s_nop 15
    v_max3_f32 v52, v96, v97, v98
    v_max3_f32 v52, v52, v99, v112
    v_max3_f32 v52, v52, v113, v114
    v_max_f32 v52, v52, v115
    v_mov_b32 v53, v52
    s_nop 1
    v_permlane16_swap_b32 v52, v53
    s_nop 0
    v_max_f32 v52, v52, v53
    v_mov_b32 v53, v52
    s_nop 1
    v_permlane32_swap_b32 v52, v53
    s_nop 0
    v_max_f32 v52, v52, v53
    v_max_f32 v52, s30, v52
    v_max_f32 v53, 0, v52
    v_sub_f32 v53, 0, v53
    v_exp_f32 v53, v53
    v_sub_f32 v128, v128, v52
    v_sub_f32 v129, v129, v52
    v_sub_f32 v130, v130, v52
    v_sub_f32 v131, v131, v52
    v_sub_f32 v96, v96, v52
    v_sub_f32 v64, v64, v52
    v_sub_f32 v97, v97, v52
    v_sub_f32 v65, v65, v52
    v_sub_f32 v98, v98, v52
    v_sub_f32 v66, v66, v52
    v_sub_f32 v99, v99, v52
    v_sub_f32 v67, v67, v52
    v_sub_f32 v112, v112, v52
    v_sub_f32 v80, v80, v52
    v_sub_f32 v113, v113, v52
    v_sub_f32 v81, v81, v52
    v_sub_f32 v114, v114, v52
    v_sub_f32 v82, v82, v52
    v_sub_f32 v115, v115, v52
    v_sub_f32 v83, v83, v52
    v_mul_f32 v36, v36, v53
    v_accvgpr_read_b32 v54, a0
    v_accvgpr_read_b32 v55, a1
    v_accvgpr_read_b32 v56, a2
    v_accvgpr_read_b32 v57, a3
    v_accvgpr_read_b32 v58, a16
    v_accvgpr_read_b32 v59, a17
    v_accvgpr_read_b32 v60, a18
    v_accvgpr_read_b32 v61, a19
    v_mul_f32 v54, v54, v53
    v_mul_f32 v55, v55, v53
    v_mul_f32 v56, v56, v53
    v_mul_f32 v57, v57, v53
    v_mul_f32 v58, v58, v53
    v_mul_f32 v59, v59, v53
    v_mul_f32 v60, v60, v53
    v_mul_f32 v61, v61, v53
    v_accvgpr_write_b32 a0, v54
    v_accvgpr_write_b32 a1, v55
    v_accvgpr_write_b32 a2, v56
    v_accvgpr_write_b32 a3, v57
    v_accvgpr_write_b32 a16, v58
    v_accvgpr_write_b32 a17, v59
    v_accvgpr_write_b32 a18, v60
    v_accvgpr_write_b32 a19, v61
    v_accvgpr_read_b32 v54, a32
    v_accvgpr_read_b32 v55, a33
    v_accvgpr_read_b32 v56, a34
    v_accvgpr_read_b32 v57, a35
    v_accvgpr_read_b32 v58, a48
    v_accvgpr_read_b32 v59, a49
    v_accvgpr_read_b32 v60, a50
    v_accvgpr_read_b32 v61, a51
    v_mul_f32 v54, v54, v53
    v_mul_f32 v55, v55, v53
    v_mul_f32 v56, v56, v53
    v_mul_f32 v57, v57, v53
    v_mul_f32 v58, v58, v53
    v_mul_f32 v59, v59, v53
    v_mul_f32 v60, v60, v53
    v_mul_f32 v61, v61, v53
    v_accvgpr_write_b32 a32, v54
    v_accvgpr_write_b32 a33, v55
    v_accvgpr_write_b32 a34, v56
    v_accvgpr_write_b32 a35, v57
    v_accvgpr_write_b32 a48, v58
    v_accvgpr_write_b32 a49, v59
    v_accvgpr_write_b32 a50, v60
    v_accvgpr_write_b32 a51, v61
    v_accvgpr_read_b32 v54, a64
    v_accvgpr_read_b32 v55, a65
    v_accvgpr_read_b32 v56, a66
    v_accvgpr_read_b32 v57, a67
    v_accvgpr_read_b32 v58, a80
    v_accvgpr_read_b32 v59, a81
    v_accvgpr_read_b32 v60, a82
    v_accvgpr_read_b32 v61, a83
    v_mul_f32 v54, v54, v53
    v_mul_f32 v55, v55, v53
    v_mul_f32 v56, v56, v53
    v_mul_f32 v57, v57, v53
    v_mul_f32 v58, v58, v53
    v_mul_f32 v59, v59, v53
    v_mul_f32 v60, v60, v53
    v_mul_f32 v61, v61, v53
    v_accvgpr_write_b32 a64, v54
    v_accvgpr_write_b32 a65, v55
    v_accvgpr_write_b32 a66, v56
    v_accvgpr_write_b32 a67, v57
    v_accvgpr_write_b32 a80, v58
    v_accvgpr_write_b32 a81, v59
    v_accvgpr_write_b32 a82, v60
    v_accvgpr_write_b32 a83, v61
    v_accvgpr_read_b32 v54, a96
    v_accvgpr_read_b32 v55, a97
    v_accvgpr_read_b32 v56, a98
    v_accvgpr_read_b32 v57, a99
    v_accvgpr_read_b32 v58, a112
    v_accvgpr_read_b32 v59, a113
    v_accvgpr_read_b32 v60, a114
    v_accvgpr_read_b32 v61, a115
    v_mul_f32 v54, v54, v53
    v_mul_f32 v55, v55, v53
    v_mul_f32 v56, v56, v53
    v_mul_f32 v57, v57, v53
    v_mul_f32 v58, v58, v53
    v_mul_f32 v59, v59, v53
    v_mul_f32 v60, v60, v53
    v_mul_f32 v61, v61, v53
    v_accvgpr_write_b32 a96, v54
    v_accvgpr_write_b32 a97, v55
    v_accvgpr_write_b32 a98, v56
    v_accvgpr_write_b32 a99, v57
    v_accvgpr_write_b32 a112, v58
    v_accvgpr_write_b32 a113, v59
    v_accvgpr_write_b32 a114, v60
    v_accvgpr_write_b32 a115, v61
    v_max3_f32 v52, v100, v101, v102
    v_max3_f32 v52, v52, v103, v116
    v_max3_f32 v52, v52, v117, v118
    v_max_f32 v52, v52, v119
    v_mov_b32 v53, v52
    s_nop 1
    v_permlane16_swap_b32 v52, v53
    s_nop 0
    v_max_f32 v52, v52, v53
    v_mov_b32 v53, v52
    s_nop 1
    v_permlane32_swap_b32 v52, v53
    s_nop 0
    v_max_f32 v52, v52, v53
    v_max_f32 v52, s30, v52
    v_max_f32 v53, 0, v52
    v_sub_f32 v53, 0, v53
    v_exp_f32 v53, v53
    v_sub_f32 v132, v132, v52
    v_sub_f32 v133, v133, v52
    v_sub_f32 v134, v134, v52
    v_sub_f32 v135, v135, v52
    v_sub_f32 v100, v100, v52
    v_sub_f32 v68, v68, v52
    v_sub_f32 v101, v101, v52
    v_sub_f32 v69, v69, v52
    v_sub_f32 v102, v102, v52
    v_sub_f32 v70, v70, v52
    v_sub_f32 v103, v103, v52
    v_sub_f32 v71, v71, v52
    v_sub_f32 v116, v116, v52
    v_sub_f32 v84, v84, v52
    v_sub_f32 v117, v117, v52
    v_sub_f32 v85, v85, v52
    v_sub_f32 v118, v118, v52
    v_sub_f32 v86, v86, v52
    v_sub_f32 v119, v119, v52
    v_sub_f32 v87, v87, v52
    v_mul_f32 v37, v37, v53
    v_accvgpr_read_b32 v54, a4
    v_accvgpr_read_b32 v55, a5
    v_accvgpr_read_b32 v56, a6
    v_accvgpr_read_b32 v57, a7
    v_accvgpr_read_b32 v58, a20
    v_accvgpr_read_b32 v59, a21
    v_accvgpr_read_b32 v60, a22
    v_accvgpr_read_b32 v61, a23
    v_mul_f32 v54, v54, v53
    v_mul_f32 v55, v55, v53
    v_mul_f32 v56, v56, v53
    v_mul_f32 v57, v57, v53
    v_mul_f32 v58, v58, v53
    v_mul_f32 v59, v59, v53
    v_mul_f32 v60, v60, v53
    v_mul_f32 v61, v61, v53
    v_accvgpr_write_b32 a4, v54
    v_accvgpr_write_b32 a5, v55
    v_accvgpr_write_b32 a6, v56
    v_accvgpr_write_b32 a7, v57
    v_accvgpr_write_b32 a20, v58
    v_accvgpr_write_b32 a21, v59
    v_accvgpr_write_b32 a22, v60
    v_accvgpr_write_b32 a23, v61
    v_accvgpr_read_b32 v54, a36
    v_accvgpr_read_b32 v55, a37
    v_accvgpr_read_b32 v56, a38
    v_accvgpr_read_b32 v57, a39
    v_accvgpr_read_b32 v58, a52
    v_accvgpr_read_b32 v59, a53
    v_accvgpr_read_b32 v60, a54
    v_accvgpr_read_b32 v61, a55
    v_mul_f32 v54, v54, v53
    v_mul_f32 v55, v55, v53
    v_mul_f32 v56, v56, v53
    v_mul_f32 v57, v57, v53
    v_mul_f32 v58, v58, v53
    v_mul_f32 v59, v59, v53
    v_mul_f32 v60, v60, v53
    v_mul_f32 v61, v61, v53
    v_accvgpr_write_b32 a36, v54
    v_accvgpr_write_b32 a37, v55
    v_accvgpr_write_b32 a38, v56
    v_accvgpr_write_b32 a39, v57
    v_accvgpr_write_b32 a52, v58
    v_accvgpr_write_b32 a53, v59
    v_accvgpr_write_b32 a54, v60
    v_accvgpr_write_b32 a55, v61
    v_accvgpr_read_b32 v54, a68
    v_accvgpr_read_b32 v55, a69
    v_accvgpr_read_b32 v56, a70
    v_accvgpr_read_b32 v57, a71
    v_accvgpr_read_b32 v58, a84
    v_accvgpr_read_b32 v59, a85
    v_accvgpr_read_b32 v60, a86
    v_accvgpr_read_b32 v61, a87
    v_mul_f32 v54, v54, v53
    v_mul_f32 v55, v55, v53
    v_mul_f32 v56, v56, v53
    v_mul_f32 v57, v57, v53
    v_mul_f32 v58, v58, v53
    v_mul_f32 v59, v59, v53
    v_mul_f32 v60, v60, v53
    v_mul_f32 v61, v61, v53
    v_accvgpr_write_b32 a68, v54
    v_accvgpr_write_b32 a69, v55
    v_accvgpr_write_b32 a70, v56
    v_accvgpr_write_b32 a71, v57
    v_accvgpr_write_b32 a84, v58
    v_accvgpr_write_b32 a85, v59
    v_accvgpr_write_b32 a86, v60
    v_accvgpr_write_b32 a87, v61
    v_accvgpr_read_b32 v54, a100
    v_accvgpr_read_b32 v55, a101
    v_accvgpr_read_b32 v56, a102
    v_accvgpr_read_b32 v57, a103
    v_accvgpr_read_b32 v58, a116
    v_accvgpr_read_b32 v59, a117
    v_accvgpr_read_b32 v60, a118
    v_accvgpr_read_b32 v61, a119
    v_mul_f32 v54, v54, v53
    v_mul_f32 v55, v55, v53
    v_mul_f32 v56, v56, v53
    v_mul_f32 v57, v57, v53
    v_mul_f32 v58, v58, v53
    v_mul_f32 v59, v59, v53
    v_mul_f32 v60, v60, v53
    v_mul_f32 v61, v61, v53
    v_accvgpr_write_b32 a100, v54
    v_accvgpr_write_b32 a101, v55
    v_accvgpr_write_b32 a102, v56
    v_accvgpr_write_b32 a103, v57
    v_accvgpr_write_b32 a116, v58
    v_accvgpr_write_b32 a117, v59
    v_accvgpr_write_b32 a118, v60
    v_accvgpr_write_b32 a119, v61
    v_max3_f32 v52, v104, v105, v106
    v_max3_f32 v52, v52, v107, v120
    v_max3_f32 v52, v52, v121, v122
    v_max_f32 v52, v52, v123
    v_mov_b32 v53, v52
    s_nop 1
    v_permlane16_swap_b32 v52, v53
    s_nop 0
    v_max_f32 v52, v52, v53
    v_mov_b32 v53, v52
    s_nop 1
    v_permlane32_swap_b32 v52, v53
    s_nop 0
    v_max_f32 v52, v52, v53
    v_max_f32 v52, s30, v52
    v_max_f32 v53, 0, v52
    v_sub_f32 v53, 0, v53
    v_exp_f32 v53, v53
    v_sub_f32 v136, v136, v52
    v_sub_f32 v137, v137, v52
    v_sub_f32 v138, v138, v52
    v_sub_f32 v139, v139, v52
    v_sub_f32 v104, v104, v52
    v_sub_f32 v72, v72, v52
    v_sub_f32 v105, v105, v52
    v_sub_f32 v73, v73, v52
    v_sub_f32 v106, v106, v52
    v_sub_f32 v74, v74, v52
    v_sub_f32 v107, v107, v52
    v_sub_f32 v75, v75, v52
    v_sub_f32 v120, v120, v52
    v_sub_f32 v88, v88, v52
    v_sub_f32 v121, v121, v52
    v_sub_f32 v89, v89, v52
    v_sub_f32 v122, v122, v52
    v_sub_f32 v90, v90, v52
    v_sub_f32 v123, v123, v52
    v_sub_f32 v91, v91, v52
    v_mul_f32 v38, v38, v53
    v_accvgpr_read_b32 v54, a8
    v_accvgpr_read_b32 v55, a9
    v_accvgpr_read_b32 v56, a10
    v_accvgpr_read_b32 v57, a11
    v_accvgpr_read_b32 v58, a24
    v_accvgpr_read_b32 v59, a25
    v_accvgpr_read_b32 v60, a26
    v_accvgpr_read_b32 v61, a27
    v_mul_f32 v54, v54, v53
    v_mul_f32 v55, v55, v53
    v_mul_f32 v56, v56, v53
    v_mul_f32 v57, v57, v53
    v_mul_f32 v58, v58, v53
    v_mul_f32 v59, v59, v53
    v_mul_f32 v60, v60, v53
    v_mul_f32 v61, v61, v53
    v_accvgpr_write_b32 a8, v54
    v_accvgpr_write_b32 a9, v55
    v_accvgpr_write_b32 a10, v56
    v_accvgpr_write_b32 a11, v57
    v_accvgpr_write_b32 a24, v58
    v_accvgpr_write_b32 a25, v59
    v_accvgpr_write_b32 a26, v60
    v_accvgpr_write_b32 a27, v61
    v_accvgpr_read_b32 v54, a40
    v_accvgpr_read_b32 v55, a41
    v_accvgpr_read_b32 v56, a42
    v_accvgpr_read_b32 v57, a43
    v_accvgpr_read_b32 v58, a56
    v_accvgpr_read_b32 v59, a57
    v_accvgpr_read_b32 v60, a58
    v_accvgpr_read_b32 v61, a59
    v_mul_f32 v54, v54, v53
    v_mul_f32 v55, v55, v53
    v_mul_f32 v56, v56, v53
    v_mul_f32 v57, v57, v53
    v_mul_f32 v58, v58, v53
    v_mul_f32 v59, v59, v53
    v_mul_f32 v60, v60, v53
    v_mul_f32 v61, v61, v53
    v_accvgpr_write_b32 a40, v54
    v_accvgpr_write_b32 a41, v55
    v_accvgpr_write_b32 a42, v56
    v_accvgpr_write_b32 a43, v57
    v_accvgpr_write_b32 a56, v58
    v_accvgpr_write_b32 a57, v59
    v_accvgpr_write_b32 a58, v60
    v_accvgpr_write_b32 a59, v61
    v_accvgpr_read_b32 v54, a72
    v_accvgpr_read_b32 v55, a73
    v_accvgpr_read_b32 v56, a74
    v_accvgpr_read_b32 v57, a75
    v_accvgpr_read_b32 v58, a88
    v_accvgpr_read_b32 v59, a89
    v_accvgpr_read_b32 v60, a90
    v_accvgpr_read_b32 v61, a91
    v_mul_f32 v54, v54, v53
    v_mul_f32 v55, v55, v53
    v_mul_f32 v56, v56, v53
    v_mul_f32 v57, v57, v53
    v_mul_f32 v58, v58, v53
    v_mul_f32 v59, v59, v53
    v_mul_f32 v60, v60, v53
    v_mul_f32 v61, v61, v53
    v_accvgpr_write_b32 a72, v54
    v_accvgpr_write_b32 a73, v55
    v_accvgpr_write_b32 a74, v56
    v_accvgpr_write_b32 a75, v57
    v_accvgpr_write_b32 a88, v58
    v_accvgpr_write_b32 a89, v59
    v_accvgpr_write_b32 a90, v60
    v_accvgpr_write_b32 a91, v61
    v_accvgpr_read_b32 v54, a104
    v_accvgpr_read_b32 v55, a105
    v_accvgpr_read_b32 v56, a106
    v_accvgpr_read_b32 v57, a107
    v_accvgpr_read_b32 v58, a120
    v_accvgpr_read_b32 v59, a121
    v_accvgpr_read_b32 v60, a122
    v_accvgpr_read_b32 v61, a123
    v_mul_f32 v54, v54, v53
    v_mul_f32 v55, v55, v53
    v_mul_f32 v56, v56, v53
    v_mul_f32 v57, v57, v53
    v_mul_f32 v58, v58, v53
    v_mul_f32 v59, v59, v53
    v_mul_f32 v60, v60, v53
    v_mul_f32 v61, v61, v53
    v_accvgpr_write_b32 a104, v54
    v_accvgpr_write_b32 a105, v55
    v_accvgpr_write_b32 a106, v56
    v_accvgpr_write_b32 a107, v57
    v_accvgpr_write_b32 a120, v58
    v_accvgpr_write_b32 a121, v59
    v_accvgpr_write_b32 a122, v60
    v_accvgpr_write_b32 a123, v61
    v_max3_f32 v52, v108, v109, v110
    v_max3_f32 v52, v52, v111, v124
    v_max3_f32 v52, v52, v125, v126
    v_max_f32 v52, v52, v127
    v_mov_b32 v53, v52
    s_nop 1
    v_permlane16_swap_b32 v52, v53
    s_nop 0
    v_max_f32 v52, v52, v53
    v_mov_b32 v53, v52
    s_nop 1
    v_permlane32_swap_b32 v52, v53
    s_nop 0
    v_max_f32 v52, v52, v53
    v_max_f32 v52, s30, v52
    v_max_f32 v53, 0, v52
    v_sub_f32 v53, 0, v53
    v_exp_f32 v53, v53
    v_sub_f32 v140, v140, v52
    v_sub_f32 v141, v141, v52
    v_sub_f32 v142, v142, v52
    v_sub_f32 v143, v143, v52
    v_sub_f32 v108, v108, v52
    v_sub_f32 v76, v76, v52
    v_sub_f32 v109, v109, v52
    v_sub_f32 v77, v77, v52
    v_sub_f32 v110, v110, v52
    v_sub_f32 v78, v78, v52
    v_sub_f32 v111, v111, v52
    v_sub_f32 v79, v79, v52
    v_sub_f32 v124, v124, v52
    v_sub_f32 v92, v92, v52
    v_sub_f32 v125, v125, v52
    v_sub_f32 v93, v93, v52
    v_sub_f32 v126, v126, v52
    v_sub_f32 v94, v94, v52
    v_sub_f32 v127, v127, v52
    v_sub_f32 v95, v95, v52
    v_mul_f32 v39, v39, v53
    v_accvgpr_read_b32 v54, a12
    v_accvgpr_read_b32 v55, a13
    v_accvgpr_read_b32 v56, a14
    v_accvgpr_read_b32 v57, a15
    v_accvgpr_read_b32 v58, a28
    v_accvgpr_read_b32 v59, a29
    v_accvgpr_read_b32 v60, a30
    v_accvgpr_read_b32 v61, a31
    v_mul_f32 v54, v54, v53
    v_mul_f32 v55, v55, v53
    v_mul_f32 v56, v56, v53
    v_mul_f32 v57, v57, v53
    v_mul_f32 v58, v58, v53
    v_mul_f32 v59, v59, v53
    v_mul_f32 v60, v60, v53
    v_mul_f32 v61, v61, v53
    v_accvgpr_write_b32 a12, v54
    v_accvgpr_write_b32 a13, v55
    v_accvgpr_write_b32 a14, v56
    v_accvgpr_write_b32 a15, v57
    v_accvgpr_write_b32 a28, v58
    v_accvgpr_write_b32 a29, v59
    v_accvgpr_write_b32 a30, v60
    v_accvgpr_write_b32 a31, v61
    v_accvgpr_read_b32 v54, a44
    v_accvgpr_read_b32 v55, a45
    v_accvgpr_read_b32 v56, a46
    v_accvgpr_read_b32 v57, a47
    v_accvgpr_read_b32 v58, a60
    v_accvgpr_read_b32 v59, a61
    v_accvgpr_read_b32 v60, a62
    v_accvgpr_read_b32 v61, a63
    v_mul_f32 v54, v54, v53
    v_mul_f32 v55, v55, v53
    v_mul_f32 v56, v56, v53
    v_mul_f32 v57, v57, v53
    v_mul_f32 v58, v58, v53
    v_mul_f32 v59, v59, v53
    v_mul_f32 v60, v60, v53
    v_mul_f32 v61, v61, v53
    v_accvgpr_write_b32 a44, v54
    v_accvgpr_write_b32 a45, v55
    v_accvgpr_write_b32 a46, v56
    v_accvgpr_write_b32 a47, v57
    v_accvgpr_write_b32 a60, v58
    v_accvgpr_write_b32 a61, v59
    v_accvgpr_write_b32 a62, v60
    v_accvgpr_write_b32 a63, v61
    v_accvgpr_read_b32 v54, a76
    v_accvgpr_read_b32 v55, a77
    v_accvgpr_read_b32 v56, a78
    v_accvgpr_read_b32 v57, a79
    v_accvgpr_read_b32 v58, a92
    v_accvgpr_read_b32 v59, a93
    v_accvgpr_read_b32 v60, a94
    v_accvgpr_read_b32 v61, a95
    v_mul_f32 v54, v54, v53
    v_mul_f32 v55, v55, v53
    v_mul_f32 v56, v56, v53
    v_mul_f32 v57, v57, v53
    v_mul_f32 v58, v58, v53
    v_mul_f32 v59, v59, v53
    v_mul_f32 v60, v60, v53
    v_mul_f32 v61, v61, v53
    v_accvgpr_write_b32 a76, v54
    v_accvgpr_write_b32 a77, v55
    v_accvgpr_write_b32 a78, v56
    v_accvgpr_write_b32 a79, v57
    v_accvgpr_write_b32 a92, v58
    v_accvgpr_write_b32 a93, v59
    v_accvgpr_write_b32 a94, v60
    v_accvgpr_write_b32 a95, v61
    v_accvgpr_read_b32 v54, a108
    v_accvgpr_read_b32 v55, a109
    v_accvgpr_read_b32 v56, a110
    v_accvgpr_read_b32 v57, a111
    v_accvgpr_read_b32 v58, a124
    v_accvgpr_read_b32 v59, a125
    v_accvgpr_read_b32 v60, a126
    v_accvgpr_read_b32 v61, a127
    v_mul_f32 v54, v54, v53
    v_mul_f32 v55, v55, v53
    v_mul_f32 v56, v56, v53
    v_mul_f32 v57, v57, v53
    v_mul_f32 v58, v58, v53
    v_mul_f32 v59, v59, v53
    v_mul_f32 v60, v60, v53
    v_mul_f32 v61, v61, v53
    v_accvgpr_write_b32 a108, v54
    v_accvgpr_write_b32 a109, v55
    v_accvgpr_write_b32 a110, v56
    v_accvgpr_write_b32 a111, v57
    v_accvgpr_write_b32 a124, v58
    v_accvgpr_write_b32 a125, v59
    v_accvgpr_write_b32 a126, v60
    v_accvgpr_write_b32 a127, v61
    v_exp_f32 v44, v96
    v_exp_f32 v45, v97
    v_exp_f32 v46, v98
    v_exp_f32 v47, v99
    v_add_f32 v40, v44, v45
    v_cvt_pk_bf16_f32 v160, v44, v45
    v_exp_f32 v48, v112
    v_exp_f32 v49, v113
    v_add_f32 v40, v40, v46
    v_add_f32 v40, v40, v47
    v_cvt_pk_bf16_f32 v161, v46, v47
    v_exp_f32 v50, v114
    v_exp_f32 v51, v115
    v_add_f32 v40, v40, v48
    v_add_f32 v40, v40, v49
    v_cvt_pk_bf16_f32 v162, v48, v49
    v_exp_f32 v44, v100
    v_exp_f32 v45, v101
    v_add_f32 v40, v40, v50
    v_add_f32 v40, v40, v51
    v_cvt_pk_bf16_f32 v163, v50, v51
    v_exp_f32 v46, v102
    v_exp_f32 v47, v103
    v_add_f32 v41, v44, v45
    v_cvt_pk_bf16_f32 v164, v44, v45
    v_exp_f32 v48, v116
    v_exp_f32 v49, v117
    v_add_f32 v41, v41, v46
    v_add_f32 v41, v41, v47
    v_cvt_pk_bf16_f32 v165, v46, v47
    v_exp_f32 v50, v118
    v_exp_f32 v51, v119
    v_add_f32 v41, v41, v48
    v_add_f32 v41, v41, v49
    v_cvt_pk_bf16_f32 v166, v48, v49
    v_exp_f32 v44, v104
    v_exp_f32 v45, v105
    v_add_f32 v41, v41, v50
    v_add_f32 v41, v41, v51
    v_cvt_pk_bf16_f32 v167, v50, v51
    v_exp_f32 v46, v106
    v_exp_f32 v47, v107
    v_add_f32 v42, v44, v45
    v_cvt_pk_bf16_f32 v168, v44, v45
    v_exp_f32 v48, v120
    v_exp_f32 v49, v121
    v_add_f32 v42, v42, v46
    v_add_f32 v42, v42, v47
    v_cvt_pk_bf16_f32 v169, v46, v47
    v_exp_f32 v50, v122
    v_exp_f32 v51, v123
    v_add_f32 v42, v42, v48
    v_add_f32 v42, v42, v49
    v_cvt_pk_bf16_f32 v170, v48, v49
    v_exp_f32 v44, v108
    v_exp_f32 v45, v109
    v_add_f32 v42, v42, v50
    v_add_f32 v42, v42, v51
    v_cvt_pk_bf16_f32 v171, v50, v51
    v_exp_f32 v46, v110
    v_exp_f32 v47, v111
    v_add_f32 v43, v44, v45
    v_cvt_pk_bf16_f32 v172, v44, v45
    v_exp_f32 v48, v124
    v_exp_f32 v49, v125
    v_add_f32 v43, v43, v46
    v_add_f32 v43, v43, v47
    v_cvt_pk_bf16_f32 v173, v46, v47
    v_exp_f32 v50, v126
    v_exp_f32 v51, v127
    v_add_f32 v43, v43, v48
    v_add_f32 v43, v43, v49
    v_cvt_pk_bf16_f32 v174, v48, v49
    s_nop 0
    v_add_f32 v43, v43, v50
    v_add_f32 v43, v43, v51
    v_cvt_pk_bf16_f32 v175, v50, v51
    s_mov_b32 s29, 0x47800000
    s_mov_b32 s30, 0
    s_nop 3
    s_setpc_b64 s[40:41]

.section .rodata,"a"
.p2align 6
.amdhsa_kernel attn_kernel
  .amdhsa_next_free_vgpr 512
  .amdhsa_next_free_sgpr 102
  .amdhsa_accum_offset 256
  .amdhsa_group_segment_fixed_size 0
  .amdhsa_kernarg_size 112
  .amdhsa_user_sgpr_count 2
  .amdhsa_user_sgpr_kernarg_segment_ptr 1
  .amdhsa_system_sgpr_workgroup_id_x 1
.end_amdhsa_kernel

.text
.globl wo_kernel
.p2align 8
.type wo_kernel,@function
wo_kernel:
    s_cmp_ge_u32 s2, 256
    s_cbranch_scc1 .wo_kernel_end_row
    s_load_dwordx2 s[4:5], s[0:1], 104
    s_load_dwordx2 s[34:35], s[0:1], 96
    s_load_dwordx2 s[36:37], s[0:1], 32
    v_lshrrev_b32 v1, 6, v0
    v_and_b32 v2, 63, v0
    s_nop 0
    v_readfirstlane_b32 s3, v1
    s_bfe_u32 s23, s2, 0x20001
    s_and_b32 s25, s2, 1
    s_lshl_b32 s25, s25, 3
    s_bfe_u32 s24, s2, 0x30003
    s_add_u32 s25, s25, s24
    s_lshl_b32 s25, s25, 7
    s_lshr_b32 s24, s2, 6
    s_and_b32 s21, s3, 1
    s_bfe_u32 s22, s3, 0x10001
    s_lshl_b32 s26, s3, 10
    s_cmp_lt_u32 s3, 2
    s_cselect_b32 s48, -1, 0
    s_mov_b32 s49, s48
    s_waitcnt lgkmcnt(0)
    s_add_u32 s8, s4, 8388608
    s_addc_u32 s9, s5, 0
    s_mov_b32 s10, 16777216
    s_mov_b32 s11, 0x00020000
    s_mov_b32 s80, s36
    s_mov_b32 s81, s37
    s_mov_b32 s82, 4718592
    s_mov_b32 s83, 0x00020000
    s_mov_b32 s84, s36
    s_mov_b32 s85, s37
    s_mov_b32 s86, 4718592
    s_mov_b32 s87, 0x00020000
    s_mov_b32 s88, s36
    s_mov_b32 s89, s37
    s_mov_b32 s90, 4718592
    s_mov_b32 s91, 0x00020000
    v_and_b32 v3, 15, v2
    v_lshrrev_b32 v4, 4, v2
    v_lshrrev_b32 v5, 2, v3
    v_and_b32 v6, 3, v2
    v_lshrrev_b32 v7, 2, v2
    v_sub_u32 v8, 0, v4
    v_and_b32 v8, 3, v8
    v_xor_b32 v8, v6, v8
    v_lshlrev_b32 v8, 4, v8
    s_mov_b32 s31, 8192
    s_mul_i32 s29, s23, 2048
    s_lshl_b32 s28, s3, 4
    s_add_u32 s28, s28, s25
    v_add_u32 v9, s28, v7
    v_mul_lo_u32 v9, v9, s31
    s_add_u32 s28, s29, 0
    v_add_u32 v9, s28, v9
    v_add_u32 v16, v9, v8
    s_lshl_b32 s28, s3, 4
    s_add_u32 s28, s28, s25
    v_add_u32 v9, s28, v7
    v_mul_lo_u32 v9, v9, s31
    s_add_u32 s28, s29, 64
    v_add_u32 v9, s28, v9
    v_add_u32 v17, v9, v8
    s_mov_b32 s31, 1152
    s_mul_i32 s29, s24, 288
    s_mul_i32 s28, s23, 1179648
    s_add_u32 s29, s29, s28
    s_add_u32 s30, s3, 0
    s_min_u32 s30, s30, 17
    s_cmp_ge_u32 s30, 9
    s_cselect_b32 s28, 9, 0
    s_sub_u32 s27, s30, s28
    s_lshl_b32 s27, s27, 6
    v_add_u32 v9, s27, v2
    s_movk_i32 s27, 3641
    v_mul_lo_u32 v10, v9, s27
    v_lshrrev_b32 v10, 16, v10
    v_mul_u32_u24 v11, 18, v10
    v_sub_u32 v11, v9, v11
    v_and_b32 v12, 0x13, v10
    v_and_b32 v13, 4, v10
    v_lshlrev_b32 v13, 1, v13
    v_or_b32 v12, v12, v13
    v_and_b32 v13, 8, v10
    v_lshrrev_b32 v13, 1, v13
    v_or_b32 v12, v12, v13
    v_mul_lo_u32 v12, v12, s31
    v_lshl_add_u32 v12, v11, 4, v12
    v_add_u32 v18, s29, v12
    s_cmp_ge_u32 s30, 9
    s_cselect_b32 s28, 36864, 0
    v_add_u32 v18, s28, v18
    s_lshl_b32 s44, s30, 10
    s_add_u32 s44, s44, 16384
    s_add_u32 s30, s3, 8
    s_min_u32 s30, s30, 17
    s_cmp_ge_u32 s30, 9
    s_cselect_b32 s28, 9, 0
    s_sub_u32 s27, s30, s28
    s_lshl_b32 s27, s27, 6
    v_add_u32 v9, s27, v2
    s_movk_i32 s27, 3641
    v_mul_lo_u32 v10, v9, s27
    v_lshrrev_b32 v10, 16, v10
    v_mul_u32_u24 v11, 18, v10
    v_sub_u32 v11, v9, v11
    v_and_b32 v12, 0x13, v10
    v_and_b32 v13, 4, v10
    v_lshlrev_b32 v13, 1, v13
    v_or_b32 v12, v12, v13
    v_and_b32 v13, 8, v10
    v_lshrrev_b32 v13, 1, v13
    v_or_b32 v12, v12, v13
    v_mul_lo_u32 v12, v12, s31
    v_lshl_add_u32 v12, v11, 4, v12
    v_add_u32 v19, s29, v12
    s_cmp_ge_u32 s30, 9
    s_cselect_b32 s28, 36864, 0
    v_add_u32 v19, s28, v19
    s_lshl_b32 s45, s30, 10
    s_add_u32 s45, s45, 16384
    s_add_u32 s30, s3, 16
    s_min_u32 s30, s30, 17
    s_cmp_ge_u32 s30, 9
    s_cselect_b32 s28, 9, 0
    s_sub_u32 s27, s30, s28
    s_lshl_b32 s27, s27, 6
    v_add_u32 v9, s27, v2
    s_movk_i32 s27, 3641
    v_mul_lo_u32 v10, v9, s27
    v_lshrrev_b32 v10, 16, v10
    v_mul_u32_u24 v11, 18, v10
    v_sub_u32 v11, v9, v11
    v_and_b32 v12, 0x13, v10
    v_and_b32 v13, 4, v10
    v_lshlrev_b32 v13, 1, v13
    v_or_b32 v12, v12, v13
    v_and_b32 v13, 8, v10
    v_lshrrev_b32 v13, 1, v13
    v_or_b32 v12, v12, v13
    v_mul_lo_u32 v12, v12, s31
    v_lshl_add_u32 v12, v11, 4, v12
    v_add_u32 v20, s29, v12
    s_cmp_ge_u32 s30, 9
    s_cselect_b32 s28, 36864, 0
    v_add_u32 v20, s28, v20
    s_lshl_b32 s46, s30, 10
    s_add_u32 s46, s46, 16384
    s_mov_b32 s27, 0
    s_mov_b32 s28, 0
    s_cmp_ge_u32 s3, 4
    s_cbranch_scc1 .wo_kernel_end_p1
    s_nop 0
    s_add_u32 m0, s26, 0
    s_nop 0
    buffer_load_dwordx4 v16, s[8:11], s27 offen lds
    s_nop 0
    s_add_u32 m0, s26, 8192
    s_nop 0
    buffer_load_dwordx4 v17, s[8:11], s27 offen lds
    s_nop 0
    s_add_u32 m0, s44, 0
    s_nop 0
    buffer_load_dwordx4 v18, s[80:83], s28 offen lds
    s_nop 0
    s_add_u32 m0, s45, 0
    s_nop 0
    buffer_load_dwordx4 v19, s[84:87], s28 offen lds
    s_nop 0
    s_add_u32 m0, s46, 0
    s_nop 0
    s_mov_b64 exec, s[48:49]
    buffer_load_dwordx4 v20, s[88:91], s28 offen lds
    s_mov_b64 exec, -1
    s_nop 0
    s_add_u32 s27, s27, 128
    s_add_u32 s28, s28, 73728
    s_nop 0
    s_add_u32 m0, s26, 34816
    s_nop 0
    buffer_load_dwordx4 v16, s[8:11], s27 offen lds
    s_nop 0
    s_add_u32 m0, s26, 43008
    s_nop 0
    buffer_load_dwordx4 v17, s[8:11], s27 offen lds
    s_nop 0
    s_add_u32 m0, s44, 34816
    s_nop 0
    buffer_load_dwordx4 v18, s[80:83], s28 offen lds
    s_nop 0
    s_add_u32 m0, s45, 34816
    s_nop 0
    buffer_load_dwordx4 v19, s[84:87], s28 offen lds
    s_nop 0
    s_add_u32 m0, s46, 34816
    s_nop 0
    s_mov_b64 exec, s[48:49]
    buffer_load_dwordx4 v20, s[88:91], s28 offen lds
    s_mov_b64 exec, -1
    s_nop 0
    s_add_u32 s27, s27, 128
    s_add_u32 s28, s28, 73728
    s_nop 0
    s_add_u32 m0, s26, 69632
    s_nop 0
    buffer_load_dwordx4 v16, s[8:11], s27 offen lds
    s_nop 0
    s_add_u32 m0, s26, 77824
    s_nop 0
    buffer_load_dwordx4 v17, s[8:11], s27 offen lds
    s_nop 0
    s_add_u32 m0, s44, 69632
    s_nop 0
    buffer_load_dwordx4 v18, s[80:83], s28 offen lds
    s_nop 0
    s_add_u32 m0, s45, 69632
    s_nop 0
    buffer_load_dwordx4 v19, s[84:87], s28 offen lds
    s_nop 0
    s_add_u32 m0, s46, 69632
    s_nop 0
    s_mov_b64 exec, s[48:49]
    buffer_load_dwordx4 v20, s[88:91], s28 offen lds
    s_mov_b64 exec, -1
    s_nop 0
    s_add_u32 s27, s27, 128
    s_add_u32 s28, s28, 73728
    s_nop 0
    v_sub_u32 v8, 0, v5
    v_and_b32 v8, 3, v8
    v_xor_b32 v8, v4, v8
    v_lshlrev_b32 v8, 4, v8
    v_lshl_add_u32 v8, v3, 6, v8
    s_lshl_b32 s30, s21, 12
    s_lshl_b32 s31, s22, 13
    s_add_u32 s30, s30, s31
    v_add_u32 v8, s30, v8
    v_lshrrev_b32 v9, 1, v4
    v_lshlrev_b32 v9, 4, v9
    v_and_b32 v10, 1, v4
    v_lshl_add_u32 v9, v10, 2, v9
    v_add_u32 v9, v9, v5
    v_mul_u32_u24 v9, 288, v9
    v_lshl_add_u32 v9, v6, 3, v9
    s_mul_i32 s31, s22, 9216
    v_add_u32 v9, s31, v9
    v_add_u32 v22, 0, v8
    v_add_u32 v26, 16384, v9
    v_add_u32 v23, 34816, v8
    v_add_u32 v27, 51200, v9
    v_add_u32 v24, 69632, v8
    v_add_u32 v28, 86016, v9
    v_add_u32 v25, 104448, v8
    v_add_u32 v29, 120832, v9
    s_nop 0
    s_waitcnt vmcnt(10)
    s_barrier
    s_nop 0
    ds_read_b128 v[32:35], v22 offset:0
    ds_read_b128 v[36:39], v22 offset:1024
    ds_read_b64_tr_b16 v[64:65], v26 offset:0
    s_nop 0
    ds_read_b128 v[40:43], v22 offset:2048
    ds_read_b128 v[44:47], v22 offset:3072
    ds_read_b64_tr_b16 v[66:67], v26 offset:2304
    s_nop 0
    ds_read_b64_tr_b16 v[68:69], v26 offset:32
    s_nop 0
    ds_read_b64_tr_b16 v[70:71], v26 offset:2336
    s_nop 0
    ds_read_b64_tr_b16 v[72:73], v26 offset:64
    s_nop 0
    ds_read_b64_tr_b16 v[74:75], v26 offset:2368
    s_waitcnt lgkmcnt(4)
    v_mfma_f32_16x16x32_bf16 a[0:3], v[64:67], v[32:35], 0
    ds_read_b64_tr_b16 v[76:77], v26 offset:96
    v_mfma_f32_16x16x32_bf16 a[4:7], v[64:67], v[36:39], 0
    ds_read_b64_tr_b16 v[78:79], v26 offset:2400
    v_mfma_f32_16x16x32_bf16 a[8:11], v[64:67], v[40:43], 0
    v_mfma_f32_16x16x32_bf16 a[12:15], v[64:67], v[44:47], 0
    s_waitcnt lgkmcnt(4)
    v_mfma_f32_16x16x32_bf16 a[16:19], v[68:71], v[32:35], 0
    ds_read_b64_tr_b16 v[80:81], v26 offset:128
    v_mfma_f32_16x16x32_bf16 a[20:23], v[68:71], v[36:39], 0
    ds_read_b64_tr_b16 v[82:83], v26 offset:2432
    v_mfma_f32_16x16x32_bf16 a[24:27], v[68:71], v[40:43], 0
    v_mfma_f32_16x16x32_bf16 a[28:31], v[68:71], v[44:47], 0
    s_waitcnt vmcnt(5)
    s_barrier
    s_waitcnt lgkmcnt(4)
    v_mfma_f32_16x16x32_bf16 a[32:35], v[72:75], v[32:35], 0
    ds_read_b128 v[48:51], v23 offset:0
    ds_read_b128 v[52:55], v23 offset:1024
    ds_read_b64_tr_b16 v[84:85], v27 offset:0
    s_add_u32 m0, s26, 104448
    v_mfma_f32_16x16x32_bf16 a[36:39], v[72:75], v[36:39], 0
    ds_read_b128 v[56:59], v23 offset:2048
    ds_read_b128 v[60:63], v23 offset:3072
    ds_read_b64_tr_b16 v[86:87], v27 offset:2304
    buffer_load_dwordx4 v16, s[8:11], s27 offen lds
    v_mfma_f32_16x16x32_bf16 a[40:43], v[72:75], v[40:43], 0
    s_add_u32 m0, s26, 112640
    v_mfma_f32_16x16x32_bf16 a[44:47], v[72:75], v[44:47], 0
    buffer_load_dwordx4 v17, s[8:11], s27 offen lds
    s_waitcnt lgkmcnt(8)
    v_mfma_f32_16x16x32_bf16 a[48:51], v[76:79], v[32:35], 0
    ds_read_b64_tr_b16 v[88:89], v27 offset:32
    s_add_u32 m0, s44, 104448
    v_mfma_f32_16x16x32_bf16 a[52:55], v[76:79], v[36:39], 0
    ds_read_b64_tr_b16 v[90:91], v27 offset:2336
    buffer_load_dwordx4 v18, s[80:83], s28 offen lds
    v_mfma_f32_16x16x32_bf16 a[56:59], v[76:79], v[40:43], 0
    s_add_u32 m0, s45, 104448
    v_mfma_f32_16x16x32_bf16 a[60:63], v[76:79], v[44:47], 0
    buffer_load_dwordx4 v19, s[84:87], s28 offen lds
    s_waitcnt lgkmcnt(8)
    v_mfma_f32_16x16x32_bf16 a[64:67], v[80:83], v[32:35], 0
    ds_read_b64_tr_b16 v[92:93], v27 offset:64
    s_add_u32 m0, s46, 104448
    v_mfma_f32_16x16x32_bf16 a[68:71], v[80:83], v[36:39], 0
    ds_read_b64_tr_b16 v[94:95], v27 offset:2368
    s_mov_b64 exec, s[48:49]
    buffer_load_dwordx4 v20, s[88:91], s28 offen lds
    s_mov_b64 exec, -1
    v_mfma_f32_16x16x32_bf16 a[72:75], v[80:83], v[40:43], 0
    s_add_u32 s27, s27, 128
    s_add_u32 s28, s28, 73728
    v_mfma_f32_16x16x32_bf16 a[76:79], v[80:83], v[44:47], 0
    s_waitcnt lgkmcnt(4)
    v_mfma_f32_16x16x32_bf16 a[0:3], v[84:87], v[48:51], a[0:3]
    ds_read_b64_tr_b16 v[64:65], v27 offset:96
    v_mfma_f32_16x16x32_bf16 a[4:7], v[84:87], v[52:55], a[4:7]
    ds_read_b64_tr_b16 v[66:67], v27 offset:2400
    v_mfma_f32_16x16x32_bf16 a[8:11], v[84:87], v[56:59], a[8:11]
    v_mfma_f32_16x16x32_bf16 a[12:15], v[84:87], v[60:63], a[12:15]
    s_waitcnt lgkmcnt(4)
    v_mfma_f32_16x16x32_bf16 a[16:19], v[88:91], v[48:51], a[16:19]
    ds_read_b64_tr_b16 v[68:69], v27 offset:128
    v_mfma_f32_16x16x32_bf16 a[20:23], v[88:91], v[52:55], a[20:23]
    ds_read_b64_tr_b16 v[70:71], v27 offset:2432
    v_mfma_f32_16x16x32_bf16 a[24:27], v[88:91], v[56:59], a[24:27]
    v_mfma_f32_16x16x32_bf16 a[28:31], v[88:91], v[60:63], a[28:31]
    s_waitcnt vmcnt(5)
    s_barrier
    s_waitcnt lgkmcnt(4)
    v_mfma_f32_16x16x32_bf16 a[32:35], v[92:95], v[48:51], a[32:35]
    ds_read_b128 v[32:35], v24 offset:0
    ds_read_b128 v[36:39], v24 offset:1024
    ds_read_b64_tr_b16 v[72:73], v28 offset:0
    s_add_u32 m0, s26, 0
    v_mfma_f32_16x16x32_bf16 a[36:39], v[92:95], v[52:55], a[36:39]
    ds_read_b128 v[40:43], v24 offset:2048
    ds_read_b128 v[44:47], v24 offset:3072
    ds_read_b64_tr_b16 v[74:75], v28 offset:2304
    buffer_load_dwordx4 v16, s[8:11], s27 offen lds
    v_mfma_f32_16x16x32_bf16 a[40:43], v[92:95], v[56:59], a[40:43]
    s_add_u32 m0, s26, 8192
    v_mfma_f32_16x16x32_bf16 a[44:47], v[92:95], v[60:63], a[44:47]
    buffer_load_dwordx4 v17, s[8:11], s27 offen lds
    s_waitcnt lgkmcnt(8)
    v_mfma_f32_16x16x32_bf16 a[48:51], v[64:67], v[48:51], a[48:51]
    ds_read_b64_tr_b16 v[76:77], v28 offset:32
    s_add_u32 m0, s44, 0
    v_mfma_f32_16x16x32_bf16 a[52:55], v[64:67], v[52:55], a[52:55]
    ds_read_b64_tr_b16 v[78:79], v28 offset:2336
    buffer_load_dwordx4 v18, s[80:83], s28 offen lds
    v_mfma_f32_16x16x32_bf16 a[56:59], v[64:67], v[56:59], a[56:59]
    s_add_u32 m0, s45, 0
    v_mfma_f32_16x16x32_bf16 a[60:63], v[64:67], v[60:63], a[60:63]
    buffer_load_dwordx4 v19, s[84:87], s28 offen lds
    s_waitcnt lgkmcnt(8)
    v_mfma_f32_16x16x32_bf16 a[64:67], v[68:71], v[48:51], a[64:67]
    ds_read_b64_tr_b16 v[80:81], v28 offset:64
    s_add_u32 m0, s46, 0
    v_mfma_f32_16x16x32_bf16 a[68:71], v[68:71], v[52:55], a[68:71]
    ds_read_b64_tr_b16 v[82:83], v28 offset:2368
    s_mov_b64 exec, s[48:49]
    buffer_load_dwordx4 v20, s[88:91], s28 offen lds
    s_mov_b64 exec, -1
    v_mfma_f32_16x16x32_bf16 a[72:75], v[68:71], v[56:59], a[72:75]
    s_add_u32 s27, s27, 128
    s_add_u32 s28, s28, 73728
    v_mfma_f32_16x16x32_bf16 a[76:79], v[68:71], v[60:63], a[76:79]
    s_waitcnt lgkmcnt(4)
    v_mfma_f32_16x16x32_bf16 a[0:3], v[72:75], v[32:35], a[0:3]
    ds_read_b64_tr_b16 v[84:85], v28 offset:96
    v_mfma_f32_16x16x32_bf16 a[4:7], v[72:75], v[36:39], a[4:7]
    ds_read_b64_tr_b16 v[86:87], v28 offset:2400
    v_mfma_f32_16x16x32_bf16 a[8:11], v[72:75], v[40:43], a[8:11]
    v_mfma_f32_16x16x32_bf16 a[12:15], v[72:75], v[44:47], a[12:15]
    s_waitcnt lgkmcnt(4)
    v_mfma_f32_16x16x32_bf16 a[16:19], v[76:79], v[32:35], a[16:19]
    ds_read_b64_tr_b16 v[88:89], v28 offset:128
    v_mfma_f32_16x16x32_bf16 a[20:23], v[76:79], v[36:39], a[20:23]
    ds_read_b64_tr_b16 v[90:91], v28 offset:2432
    v_mfma_f32_16x16x32_bf16 a[24:27], v[76:79], v[40:43], a[24:27]
    v_mfma_f32_16x16x32_bf16 a[28:31], v[76:79], v[44:47], a[28:31]
    s_waitcnt vmcnt(5)
    s_barrier
    s_waitcnt lgkmcnt(4)
    v_mfma_f32_16x16x32_bf16 a[32:35], v[80:83], v[32:35], a[32:35]
    ds_read_b128 v[48:51], v25 offset:0
    ds_read_b128 v[52:55], v25 offset:1024
    ds_read_b64_tr_b16 v[92:93], v29 offset:0
    s_add_u32 m0, s26, 34816
    v_mfma_f32_16x16x32_bf16 a[36:39], v[80:83], v[36:39], a[36:39]
    ds_read_b128 v[56:59], v25 offset:2048
    ds_read_b128 v[60:63], v25 offset:3072
    ds_read_b64_tr_b16 v[94:95], v29 offset:2304
    buffer_load_dwordx4 v16, s[8:11], s27 offen lds
    v_mfma_f32_16x16x32_bf16 a[40:43], v[80:83], v[40:43], a[40:43]
    s_add_u32 m0, s26, 43008
    v_mfma_f32_16x16x32_bf16 a[44:47], v[80:83], v[44:47], a[44:47]
    buffer_load_dwordx4 v17, s[8:11], s27 offen lds
    s_waitcnt lgkmcnt(8)
    v_mfma_f32_16x16x32_bf16 a[48:51], v[84:87], v[32:35], a[48:51]
    ds_read_b64_tr_b16 v[64:65], v29 offset:32
    s_add_u32 m0, s44, 34816
    v_mfma_f32_16x16x32_bf16 a[52:55], v[84:87], v[36:39], a[52:55]
    ds_read_b64_tr_b16 v[66:67], v29 offset:2336
    buffer_load_dwordx4 v18, s[80:83], s28 offen lds
    v_mfma_f32_16x16x32_bf16 a[56:59], v[84:87], v[40:43], a[56:59]
    s_add_u32 m0, s45, 34816
    v_mfma_f32_16x16x32_bf16 a[60:63], v[84:87], v[44:47], a[60:63]
    buffer_load_dwordx4 v19, s[84:87], s28 offen lds
    s_waitcnt lgkmcnt(8)
    v_mfma_f32_16x16x32_bf16 a[64:67], v[88:91], v[32:35], a[64:67]
    ds_read_b64_tr_b16 v[68:69], v29 offset:64
    s_add_u32 m0, s46, 34816
    v_mfma_f32_16x16x32_bf16 a[68:71], v[88:91], v[36:39], a[68:71]
    ds_read_b64_tr_b16 v[70:71], v29 offset:2368
    s_mov_b64 exec, s[48:49]
    buffer_load_dwordx4 v20, s[88:91], s28 offen lds
    s_mov_b64 exec, -1
    v_mfma_f32_16x16x32_bf16 a[72:75], v[88:91], v[40:43], a[72:75]
    s_add_u32 s27, s27, 128
    s_add_u32 s28, s28, 73728
    v_mfma_f32_16x16x32_bf16 a[76:79], v[88:91], v[44:47], a[76:79]
    s_waitcnt lgkmcnt(4)
    v_mfma_f32_16x16x32_bf16 a[0:3], v[92:95], v[48:51], a[0:3]
    ds_read_b64_tr_b16 v[72:73], v29 offset:96
    v_mfma_f32_16x16x32_bf16 a[4:7], v[92:95], v[52:55], a[4:7]
    ds_read_b64_tr_b16 v[74:75], v29 offset:2400
    v_mfma_f32_16x16x32_bf16 a[8:11], v[92:95], v[56:59], a[8:11]
    v_mfma_f32_16x16x32_bf16 a[12:15], v[92:95], v[60:63], a[12:15]
    s_waitcnt lgkmcnt(4)
    v_mfma_f32_16x16x32_bf16 a[16:19], v[64:67], v[48:51], a[16:19]
    ds_read_b64_tr_b16 v[76:77], v29 offset:128
    v_mfma_f32_16x16x32_bf16 a[20:23], v[64:67], v[52:55], a[20:23]
    ds_read_b64_tr_b16 v[78:79], v29 offset:2432
    v_mfma_f32_16x16x32_bf16 a[24:27], v[64:67], v[56:59], a[24:27]
    v_mfma_f32_16x16x32_bf16 a[28:31], v[64:67], v[60:63], a[28:31]
    s_waitcnt vmcnt(5)
    s_barrier
    s_waitcnt lgkmcnt(4)
    v_mfma_f32_16x16x32_bf16 a[32:35], v[68:71], v[48:51], a[32:35]
    ds_read_b128 v[32:35], v22 offset:0
    ds_read_b128 v[36:39], v22 offset:1024
    ds_read_b64_tr_b16 v[80:81], v26 offset:0
    s_add_u32 m0, s26, 69632
    v_mfma_f32_16x16x32_bf16 a[36:39], v[68:71], v[52:55], a[36:39]
    ds_read_b128 v[40:43], v22 offset:2048
    ds_read_b128 v[44:47], v22 offset:3072
    ds_read_b64_tr_b16 v[82:83], v26 offset:2304
    buffer_load_dwordx4 v16, s[8:11], s27 offen lds
    v_mfma_f32_16x16x32_bf16 a[40:43], v[68:71], v[56:59], a[40:43]
    s_add_u32 m0, s26, 77824
    v_mfma_f32_16x16x32_bf16 a[44:47], v[68:71], v[60:63], a[44:47]
    buffer_load_dwordx4 v17, s[8:11], s27 offen lds
    s_waitcnt lgkmcnt(8)
    v_mfma_f32_16x16x32_bf16 a[48:51], v[72:75], v[48:51], a[48:51]
    ds_read_b64_tr_b16 v[84:85], v26 offset:32
    s_add_u32 m0, s44, 69632
    v_mfma_f32_16x16x32_bf16 a[52:55], v[72:75], v[52:55], a[52:55]
    ds_read_b64_tr_b16 v[86:87], v26 offset:2336
    buffer_load_dwordx4 v18, s[80:83], s28 offen lds
    v_mfma_f32_16x16x32_bf16 a[56:59], v[72:75], v[56:59], a[56:59]
    s_add_u32 m0, s45, 69632
    v_mfma_f32_16x16x32_bf16 a[60:63], v[72:75], v[60:63], a[60:63]
    buffer_load_dwordx4 v19, s[84:87], s28 offen lds
    s_waitcnt lgkmcnt(8)
    v_mfma_f32_16x16x32_bf16 a[64:67], v[76:79], v[48:51], a[64:67]
    ds_read_b64_tr_b16 v[88:89], v26 offset:64
    s_add_u32 m0, s46, 69632
    v_mfma_f32_16x16x32_bf16 a[68:71], v[76:79], v[52:55], a[68:71]
    ds_read_b64_tr_b16 v[90:91], v26 offset:2368
    s_mov_b64 exec, s[48:49]
    buffer_load_dwordx4 v20, s[88:91], s28 offen lds
    s_mov_b64 exec, -1
    v_mfma_f32_16x16x32_bf16 a[72:75], v[76:79], v[56:59], a[72:75]
    s_add_u32 s27, s27, 128
    s_add_u32 s28, s28, 73728
    v_mfma_f32_16x16x32_bf16 a[76:79], v[76:79], v[60:63], a[76:79]
    s_waitcnt lgkmcnt(4)
    v_mfma_f32_16x16x32_bf16 a[0:3], v[80:83], v[32:35], a[0:3]
    ds_read_b64_tr_b16 v[92:93], v26 offset:96
    v_mfma_f32_16x16x32_bf16 a[4:7], v[80:83], v[36:39], a[4:7]
    ds_read_b64_tr_b16 v[94:95], v26 offset:2400
    v_mfma_f32_16x16x32_bf16 a[8:11], v[80:83], v[40:43], a[8:11]
    v_mfma_f32_16x16x32_bf16 a[12:15], v[80:83], v[44:47], a[12:15]
    s_waitcnt lgkmcnt(4)
    v_mfma_f32_16x16x32_bf16 a[16:19], v[84:87], v[32:35], a[16:19]
    ds_read_b64_tr_b16 v[64:65], v26 offset:128
    v_mfma_f32_16x16x32_bf16 a[20:23], v[84:87], v[36:39], a[20:23]
    ds_read_b64_tr_b16 v[66:67], v26 offset:2432
    v_mfma_f32_16x16x32_bf16 a[24:27], v[84:87], v[40:43], a[24:27]
    v_mfma_f32_16x16x32_bf16 a[28:31], v[84:87], v[44:47], a[28:31]
    s_waitcnt vmcnt(5)
    s_barrier
    s_waitcnt lgkmcnt(4)
    v_mfma_f32_16x16x32_bf16 a[32:35], v[88:91], v[32:35], a[32:35]
    ds_read_b128 v[48:51], v23 offset:0
    ds_read_b128 v[52:55], v23 offset:1024
    ds_read_b64_tr_b16 v[68:69], v27 offset:0
    s_add_u32 m0, s26, 104448
    v_mfma_f32_16x16x32_bf16 a[36:39], v[88:91], v[36:39], a[36:39]
    ds_read_b128 v[56:59], v23 offset:2048
    ds_read_b128 v[60:63], v23 offset:3072
    ds_read_b64_tr_b16 v[70:71], v27 offset:2304
    buffer_load_dwordx4 v16, s[8:11], s27 offen lds
    v_mfma_f32_16x16x32_bf16 a[40:43], v[88:91], v[40:43], a[40:43]
    s_add_u32 m0, s26, 112640
    v_mfma_f32_16x16x32_bf16 a[44:47], v[88:91], v[44:47], a[44:47]
    buffer_load_dwordx4 v17, s[8:11], s27 offen lds
    s_waitcnt lgkmcnt(8)
    v_mfma_f32_16x16x32_bf16 a[48:51], v[92:95], v[32:35], a[48:51]
    ds_read_b64_tr_b16 v[72:73], v27 offset:32
    s_add_u32 m0, s44, 104448
    v_mfma_f32_16x16x32_bf16 a[52:55], v[92:95], v[36:39], a[52:55]
    ds_read_b64_tr_b16 v[74:75], v27 offset:2336
    buffer_load_dwordx4 v18, s[80:83], s28 offen lds
    v_mfma_f32_16x16x32_bf16 a[56:59], v[92:95], v[40:43], a[56:59]
    s_add_u32 m0, s45, 104448
    v_mfma_f32_16x16x32_bf16 a[60:63], v[92:95], v[44:47], a[60:63]
    buffer_load_dwordx4 v19, s[84:87], s28 offen lds
    s_waitcnt lgkmcnt(8)
    v_mfma_f32_16x16x32_bf16 a[64:67], v[64:67], v[32:35], a[64:67]
    ds_read_b64_tr_b16 v[76:77], v27 offset:64
    s_add_u32 m0, s46, 104448
    v_mfma_f32_16x16x32_bf16 a[68:71], v[64:67], v[36:39], a[68:71]
    ds_read_b64_tr_b16 v[78:79], v27 offset:2368
    s_mov_b64 exec, s[48:49]
    buffer_load_dwordx4 v20, s[88:91], s28 offen lds
    s_mov_b64 exec, -1
    v_mfma_f32_16x16x32_bf16 a[72:75], v[64:67], v[40:43], a[72:75]
    s_add_u32 s27, s27, 128
    s_add_u32 s28, s28, 73728
    v_mfma_f32_16x16x32_bf16 a[76:79], v[64:67], v[44:47], a[76:79]
    s_waitcnt lgkmcnt(4)
    v_mfma_f32_16x16x32_bf16 a[0:3], v[68:71], v[48:51], a[0:3]
    ds_read_b64_tr_b16 v[80:81], v27 offset:96
    v_mfma_f32_16x16x32_bf16 a[4:7], v[68:71], v[52:55], a[4:7]
    ds_read_b64_tr_b16 v[82:83], v27 offset:2400
    v_mfma_f32_16x16x32_bf16 a[8:11], v[68:71], v[56:59], a[8:11]
    v_mfma_f32_16x16x32_bf16 a[12:15], v[68:71], v[60:63], a[12:15]
    s_waitcnt lgkmcnt(4)
    v_mfma_f32_16x16x32_bf16 a[16:19], v[72:75], v[48:51], a[16:19]
    ds_read_b64_tr_b16 v[84:85], v27 offset:128
    v_mfma_f32_16x16x32_bf16 a[20:23], v[72:75], v[52:55], a[20:23]
    ds_read_b64_tr_b16 v[86:87], v27 offset:2432
    v_mfma_f32_16x16x32_bf16 a[24:27], v[72:75], v[56:59], a[24:27]
    v_mfma_f32_16x16x32_bf16 a[28:31], v[72:75], v[60:63], a[28:31]
    s_waitcnt vmcnt(5)
    s_barrier
    s_waitcnt lgkmcnt(4)
    v_mfma_f32_16x16x32_bf16 a[32:35], v[76:79], v[48:51], a[32:35]
    ds_read_b128 v[32:35], v24 offset:0
    ds_read_b128 v[36:39], v24 offset:1024
    ds_read_b64_tr_b16 v[88:89], v28 offset:0
    s_add_u32 m0, s26, 0
    v_mfma_f32_16x16x32_bf16 a[36:39], v[76:79], v[52:55], a[36:39]
    ds_read_b128 v[40:43], v24 offset:2048
    ds_read_b128 v[44:47], v24 offset:3072
    ds_read_b64_tr_b16 v[90:91], v28 offset:2304
    buffer_load_dwordx4 v16, s[8:11], s27 offen lds
    v_mfma_f32_16x16x32_bf16 a[40:43], v[76:79], v[56:59], a[40:43]
    s_add_u32 m0, s26, 8192
    v_mfma_f32_16x16x32_bf16 a[44:47], v[76:79], v[60:63], a[44:47]
    buffer_load_dwordx4 v17, s[8:11], s27 offen lds
    s_waitcnt lgkmcnt(8)
    v_mfma_f32_16x16x32_bf16 a[48:51], v[80:83], v[48:51], a[48:51]
    ds_read_b64_tr_b16 v[92:93], v28 offset:32
    s_add_u32 m0, s44, 0
    v_mfma_f32_16x16x32_bf16 a[52:55], v[80:83], v[52:55], a[52:55]
    ds_read_b64_tr_b16 v[94:95], v28 offset:2336
    buffer_load_dwordx4 v18, s[80:83], s28 offen lds
    v_mfma_f32_16x16x32_bf16 a[56:59], v[80:83], v[56:59], a[56:59]
    s_add_u32 m0, s45, 0
    v_mfma_f32_16x16x32_bf16 a[60:63], v[80:83], v[60:63], a[60:63]
    buffer_load_dwordx4 v19, s[84:87], s28 offen lds
    s_waitcnt lgkmcnt(8)
    v_mfma_f32_16x16x32_bf16 a[64:67], v[84:87], v[48:51], a[64:67]
    ds_read_b64_tr_b16 v[64:65], v28 offset:64
    s_add_u32 m0, s46, 0
    v_mfma_f32_16x16x32_bf16 a[68:71], v[84:87], v[52:55], a[68:71]
    ds_read_b64_tr_b16 v[66:67], v28 offset:2368
    s_mov_b64 exec, s[48:49]
    buffer_load_dwordx4 v20, s[88:91], s28 offen lds
    s_mov_b64 exec, -1
    v_mfma_f32_16x16x32_bf16 a[72:75], v[84:87], v[56:59], a[72:75]
    s_add_u32 s27, s27, 128
    s_add_u32 s28, s28, 73728
    v_mfma_f32_16x16x32_bf16 a[76:79], v[84:87], v[60:63], a[76:79]
    s_waitcnt lgkmcnt(4)
    v_mfma_f32_16x16x32_bf16 a[0:3], v[88:91], v[32:35], a[0:3]
    ds_read_b64_tr_b16 v[68:69], v28 offset:96
    v_mfma_f32_16x16x32_bf16 a[4:7], v[88:91], v[36:39], a[4:7]
    ds_read_b64_tr_b16 v[70:71], v28 offset:2400
    v_mfma_f32_16x16x32_bf16 a[8:11], v[88:91], v[40:43], a[8:11]
    v_mfma_f32_16x16x32_bf16 a[12:15], v[88:91], v[44:47], a[12:15]
    s_waitcnt lgkmcnt(4)
    v_mfma_f32_16x16x32_bf16 a[16:19], v[92:95], v[32:35], a[16:19]
    ds_read_b64_tr_b16 v[72:73], v28 offset:128
    v_mfma_f32_16x16x32_bf16 a[20:23], v[92:95], v[36:39], a[20:23]
    ds_read_b64_tr_b16 v[74:75], v28 offset:2432
    v_mfma_f32_16x16x32_bf16 a[24:27], v[92:95], v[40:43], a[24:27]
    v_mfma_f32_16x16x32_bf16 a[28:31], v[92:95], v[44:47], a[28:31]
    s_waitcnt vmcnt(5)
    s_barrier
    s_waitcnt lgkmcnt(4)
    v_mfma_f32_16x16x32_bf16 a[32:35], v[64:67], v[32:35], a[32:35]
    ds_read_b128 v[48:51], v25 offset:0
    ds_read_b128 v[52:55], v25 offset:1024
    ds_read_b64_tr_b16 v[76:77], v29 offset:0
    s_add_u32 m0, s26, 34816
    v_mfma_f32_16x16x32_bf16 a[36:39], v[64:67], v[36:39], a[36:39]
    ds_read_b128 v[56:59], v25 offset:2048
    ds_read_b128 v[60:63], v25 offset:3072
    ds_read_b64_tr_b16 v[78:79], v29 offset:2304
    buffer_load_dwordx4 v16, s[8:11], s27 offen lds
    v_mfma_f32_16x16x32_bf16 a[40:43], v[64:67], v[40:43], a[40:43]
    s_add_u32 m0, s26, 43008
    v_mfma_f32_16x16x32_bf16 a[44:47], v[64:67], v[44:47], a[44:47]
    buffer_load_dwordx4 v17, s[8:11], s27 offen lds
    s_waitcnt lgkmcnt(8)
    v_mfma_f32_16x16x32_bf16 a[48:51], v[68:71], v[32:35], a[48:51]
    ds_read_b64_tr_b16 v[80:81], v29 offset:32
    s_add_u32 m0, s44, 34816
    v_mfma_f32_16x16x32_bf16 a[52:55], v[68:71], v[36:39], a[52:55]
    ds_read_b64_tr_b16 v[82:83], v29 offset:2336
    buffer_load_dwordx4 v18, s[80:83], s28 offen lds
    v_mfma_f32_16x16x32_bf16 a[56:59], v[68:71], v[40:43], a[56:59]
    s_add_u32 m0, s45, 34816
    v_mfma_f32_16x16x32_bf16 a[60:63], v[68:71], v[44:47], a[60:63]
    buffer_load_dwordx4 v19, s[84:87], s28 offen lds
    s_waitcnt lgkmcnt(8)
    v_mfma_f32_16x16x32_bf16 a[64:67], v[72:75], v[32:35], a[64:67]
    ds_read_b64_tr_b16 v[84:85], v29 offset:64
    s_add_u32 m0, s46, 34816
    v_mfma_f32_16x16x32_bf16 a[68:71], v[72:75], v[36:39], a[68:71]
    ds_read_b64_tr_b16 v[86:87], v29 offset:2368
    s_mov_b64 exec, s[48:49]
    buffer_load_dwordx4 v20, s[88:91], s28 offen lds
    s_mov_b64 exec, -1
    v_mfma_f32_16x16x32_bf16 a[72:75], v[72:75], v[40:43], a[72:75]
    s_add_u32 s27, s27, 128
    s_add_u32 s28, s28, 73728
    v_mfma_f32_16x16x32_bf16 a[76:79], v[72:75], v[44:47], a[76:79]
    s_waitcnt lgkmcnt(4)
    v_mfma_f32_16x16x32_bf16 a[0:3], v[76:79], v[48:51], a[0:3]
    ds_read_b64_tr_b16 v[88:89], v29 offset:96
    v_mfma_f32_16x16x32_bf16 a[4:7], v[76:79], v[52:55], a[4:7]
    ds_read_b64_tr_b16 v[90:91], v29 offset:2400
    v_mfma_f32_16x16x32_bf16 a[8:11], v[76:79], v[56:59], a[8:11]
    v_mfma_f32_16x16x32_bf16 a[12:15], v[76:79], v[60:63], a[12:15]
    s_waitcnt lgkmcnt(4)
    v_mfma_f32_16x16x32_bf16 a[16:19], v[80:83], v[48:51], a[16:19]
    ds_read_b64_tr_b16 v[92:93], v29 offset:128
    v_mfma_f32_16x16x32_bf16 a[20:23], v[80:83], v[52:55], a[20:23]
    ds_read_b64_tr_b16 v[94:95], v29 offset:2432
    v_mfma_f32_16x16x32_bf16 a[24:27], v[80:83], v[56:59], a[24:27]
    v_mfma_f32_16x16x32_bf16 a[28:31], v[80:83], v[60:63], a[28:31]
    s_waitcnt vmcnt(5)
    s_barrier
    s_waitcnt lgkmcnt(4)
    v_mfma_f32_16x16x32_bf16 a[32:35], v[84:87], v[48:51], a[32:35]
    ds_read_b128 v[32:35], v22 offset:0
    ds_read_b128 v[36:39], v22 offset:1024
    ds_read_b64_tr_b16 v[64:65], v26 offset:0
    s_add_u32 m0, s26, 69632
    v_mfma_f32_16x16x32_bf16 a[36:39], v[84:87], v[52:55], a[36:39]
    ds_read_b128 v[40:43], v22 offset:2048
    ds_read_b128 v[44:47], v22 offset:3072
    ds_read_b64_tr_b16 v[66:67], v26 offset:2304
    buffer_load_dwordx4 v16, s[8:11], s27 offen lds
    v_mfma_f32_16x16x32_bf16 a[40:43], v[84:87], v[56:59], a[40:43]
    s_add_u32 m0, s26, 77824
    v_mfma_f32_16x16x32_bf16 a[44:47], v[84:87], v[60:63], a[44:47]
    buffer_load_dwordx4 v17, s[8:11], s27 offen lds
    s_waitcnt lgkmcnt(8)
    v_mfma_f32_16x16x32_bf16 a[48:51], v[88:91], v[48:51], a[48:51]
    ds_read_b64_tr_b16 v[68:69], v26 offset:32
    s_add_u32 m0, s44, 69632
    v_mfma_f32_16x16x32_bf16 a[52:55], v[88:91], v[52:55], a[52:55]
    ds_read_b64_tr_b16 v[70:71], v26 offset:2336
    buffer_load_dwordx4 v18, s[80:83], s28 offen lds
    v_mfma_f32_16x16x32_bf16 a[56:59], v[88:91], v[56:59], a[56:59]
    s_add_u32 m0, s45, 69632
    v_mfma_f32_16x16x32_bf16 a[60:63], v[88:91], v[60:63], a[60:63]
    buffer_load_dwordx4 v19, s[84:87], s28 offen lds
    s_waitcnt lgkmcnt(8)
    v_mfma_f32_16x16x32_bf16 a[64:67], v[92:95], v[48:51], a[64:67]
    ds_read_b64_tr_b16 v[72:73], v26 offset:64
    s_add_u32 m0, s46, 69632
    v_mfma_f32_16x16x32_bf16 a[68:71], v[92:95], v[52:55], a[68:71]
    ds_read_b64_tr_b16 v[74:75], v26 offset:2368
    s_mov_b64 exec, s[48:49]
    buffer_load_dwordx4 v20, s[88:91], s28 offen lds
    s_mov_b64 exec, -1
    v_mfma_f32_16x16x32_bf16 a[72:75], v[92:95], v[56:59], a[72:75]
    s_add_u32 s27, s27, 128
    s_add_u32 s28, s28, 73728
    v_mfma_f32_16x16x32_bf16 a[76:79], v[92:95], v[60:63], a[76:79]
    s_waitcnt lgkmcnt(4)
    v_mfma_f32_16x16x32_bf16 a[0:3], v[64:67], v[32:35], a[0:3]
    ds_read_b64_tr_b16 v[76:77], v26 offset:96
    v_mfma_f32_16x16x32_bf16 a[4:7], v[64:67], v[36:39], a[4:7]
    ds_read_b64_tr_b16 v[78:79], v26 offset:2400
    v_mfma_f32_16x16x32_bf16 a[8:11], v[64:67], v[40:43], a[8:11]
    v_mfma_f32_16x16x32_bf16 a[12:15], v[64:67], v[44:47], a[12:15]
    s_waitcnt lgkmcnt(4)
    v_mfma_f32_16x16x32_bf16 a[16:19], v[68:71], v[32:35], a[16:19]
    ds_read_b64_tr_b16 v[80:81], v26 offset:128
    v_mfma_f32_16x16x32_bf16 a[20:23], v[68:71], v[36:39], a[20:23]
    ds_read_b64_tr_b16 v[82:83], v26 offset:2432
    v_mfma_f32_16x16x32_bf16 a[24:27], v[68:71], v[40:43], a[24:27]
    v_mfma_f32_16x16x32_bf16 a[28:31], v[68:71], v[44:47], a[28:31]
    s_waitcnt vmcnt(5)
    s_barrier
    s_waitcnt lgkmcnt(4)
    v_mfma_f32_16x16x32_bf16 a[32:35], v[72:75], v[32:35], a[32:35]
    ds_read_b128 v[48:51], v23 offset:0
    ds_read_b128 v[52:55], v23 offset:1024
    ds_read_b64_tr_b16 v[84:85], v27 offset:0
    s_add_u32 m0, s26, 104448
    v_mfma_f32_16x16x32_bf16 a[36:39], v[72:75], v[36:39], a[36:39]
    ds_read_b128 v[56:59], v23 offset:2048
    ds_read_b128 v[60:63], v23 offset:3072
    ds_read_b64_tr_b16 v[86:87], v27 offset:2304
    buffer_load_dwordx4 v16, s[8:11], s27 offen lds
    v_mfma_f32_16x16x32_bf16 a[40:43], v[72:75], v[40:43], a[40:43]
    s_add_u32 m0, s26, 112640
    v_mfma_f32_16x16x32_bf16 a[44:47], v[72:75], v[44:47], a[44:47]
    buffer_load_dwordx4 v17, s[8:11], s27 offen lds
    s_waitcnt lgkmcnt(8)
    v_mfma_f32_16x16x32_bf16 a[48:51], v[76:79], v[32:35], a[48:51]
    ds_read_b64_tr_b16 v[88:89], v27 offset:32
    s_add_u32 m0, s44, 104448
    v_mfma_f32_16x16x32_bf16 a[52:55], v[76:79], v[36:39], a[52:55]
    ds_read_b64_tr_b16 v[90:91], v27 offset:2336
    buffer_load_dwordx4 v18, s[80:83], s28 offen lds
    v_mfma_f32_16x16x32_bf16 a[56:59], v[76:79], v[40:43], a[56:59]
    s_add_u32 m0, s45, 104448
    v_mfma_f32_16x16x32_bf16 a[60:63], v[76:79], v[44:47], a[60:63]
    buffer_load_dwordx4 v19, s[84:87], s28 offen lds
    s_waitcnt lgkmcnt(8)
    v_mfma_f32_16x16x32_bf16 a[64:67], v[80:83], v[32:35], a[64:67]
    ds_read_b64_tr_b16 v[92:93], v27 offset:64
    s_add_u32 m0, s46, 104448
    v_mfma_f32_16x16x32_bf16 a[68:71], v[80:83], v[36:39], a[68:71]
    ds_read_b64_tr_b16 v[94:95], v27 offset:2368
    s_mov_b64 exec, s[48:49]
    buffer_load_dwordx4 v20, s[88:91], s28 offen lds
    s_mov_b64 exec, -1
    v_mfma_f32_16x16x32_bf16 a[72:75], v[80:83], v[40:43], a[72:75]
    s_add_u32 s27, s27, 128
    s_add_u32 s28, s28, 73728
    v_mfma_f32_16x16x32_bf16 a[76:79], v[80:83], v[44:47], a[76:79]
    s_waitcnt lgkmcnt(4)
    v_mfma_f32_16x16x32_bf16 a[0:3], v[84:87], v[48:51], a[0:3]
    ds_read_b64_tr_b16 v[64:65], v27 offset:96
    v_mfma_f32_16x16x32_bf16 a[4:7], v[84:87], v[52:55], a[4:7]
    ds_read_b64_tr_b16 v[66:67], v27 offset:2400
    v_mfma_f32_16x16x32_bf16 a[8:11], v[84:87], v[56:59], a[8:11]
    v_mfma_f32_16x16x32_bf16 a[12:15], v[84:87], v[60:63], a[12:15]
    s_waitcnt lgkmcnt(4)
    v_mfma_f32_16x16x32_bf16 a[16:19], v[88:91], v[48:51], a[16:19]
    ds_read_b64_tr_b16 v[68:69], v27 offset:128
    v_mfma_f32_16x16x32_bf16 a[20:23], v[88:91], v[52:55], a[20:23]
    ds_read_b64_tr_b16 v[70:71], v27 offset:2432
    v_mfma_f32_16x16x32_bf16 a[24:27], v[88:91], v[56:59], a[24:27]
    v_mfma_f32_16x16x32_bf16 a[28:31], v[88:91], v[60:63], a[28:31]
    s_waitcnt vmcnt(5)
    s_barrier
    s_waitcnt lgkmcnt(4)
    v_mfma_f32_16x16x32_bf16 a[32:35], v[92:95], v[48:51], a[32:35]
    ds_read_b128 v[32:35], v24 offset:0
    ds_read_b128 v[36:39], v24 offset:1024
    ds_read_b64_tr_b16 v[72:73], v28 offset:0
    s_add_u32 m0, s26, 0
    v_mfma_f32_16x16x32_bf16 a[36:39], v[92:95], v[52:55], a[36:39]
    ds_read_b128 v[40:43], v24 offset:2048
    ds_read_b128 v[44:47], v24 offset:3072
    ds_read_b64_tr_b16 v[74:75], v28 offset:2304
    buffer_load_dwordx4 v16, s[8:11], s27 offen lds
    v_mfma_f32_16x16x32_bf16 a[40:43], v[92:95], v[56:59], a[40:43]
    s_add_u32 m0, s26, 8192
    v_mfma_f32_16x16x32_bf16 a[44:47], v[92:95], v[60:63], a[44:47]
    buffer_load_dwordx4 v17, s[8:11], s27 offen lds
    s_waitcnt lgkmcnt(8)
    v_mfma_f32_16x16x32_bf16 a[48:51], v[64:67], v[48:51], a[48:51]
    ds_read_b64_tr_b16 v[76:77], v28 offset:32
    s_add_u32 m0, s44, 0
    v_mfma_f32_16x16x32_bf16 a[52:55], v[64:67], v[52:55], a[52:55]
    ds_read_b64_tr_b16 v[78:79], v28 offset:2336
    buffer_load_dwordx4 v18, s[80:83], s28 offen lds
    v_mfma_f32_16x16x32_bf16 a[56:59], v[64:67], v[56:59], a[56:59]
    s_add_u32 m0, s45, 0
    v_mfma_f32_16x16x32_bf16 a[60:63], v[64:67], v[60:63], a[60:63]
    buffer_load_dwordx4 v19, s[84:87], s28 offen lds
    s_waitcnt lgkmcnt(8)
    v_mfma_f32_16x16x32_bf16 a[64:67], v[68:71], v[48:51], a[64:67]
    ds_read_b64_tr_b16 v[80:81], v28 offset:64
    s_add_u32 m0, s46, 0
    v_mfma_f32_16x16x32_bf16 a[68:71], v[68:71], v[52:55], a[68:71]
    ds_read_b64_tr_b16 v[82:83], v28 offset:2368
    s_mov_b64 exec, s[48:49]
    buffer_load_dwordx4 v20, s[88:91], s28 offen lds
    s_mov_b64 exec, -1
    v_mfma_f32_16x16x32_bf16 a[72:75], v[68:71], v[56:59], a[72:75]
    s_add_u32 s27, s27, 128
    s_add_u32 s28, s28, 73728
    v_mfma_f32_16x16x32_bf16 a[76:79], v[68:71], v[60:63], a[76:79]
    s_waitcnt lgkmcnt(4)
    v_mfma_f32_16x16x32_bf16 a[0:3], v[72:75], v[32:35], a[0:3]
    ds_read_b64_tr_b16 v[84:85], v28 offset:96
    v_mfma_f32_16x16x32_bf16 a[4:7], v[72:75], v[36:39], a[4:7]
    ds_read_b64_tr_b16 v[86:87], v28 offset:2400
    v_mfma_f32_16x16x32_bf16 a[8:11], v[72:75], v[40:43], a[8:11]
    v_mfma_f32_16x16x32_bf16 a[12:15], v[72:75], v[44:47], a[12:15]
    s_waitcnt lgkmcnt(4)
    v_mfma_f32_16x16x32_bf16 a[16:19], v[76:79], v[32:35], a[16:19]
    ds_read_b64_tr_b16 v[88:89], v28 offset:128
    v_mfma_f32_16x16x32_bf16 a[20:23], v[76:79], v[36:39], a[20:23]
    ds_read_b64_tr_b16 v[90:91], v28 offset:2432
    v_mfma_f32_16x16x32_bf16 a[24:27], v[76:79], v[40:43], a[24:27]
    v_mfma_f32_16x16x32_bf16 a[28:31], v[76:79], v[44:47], a[28:31]
    s_waitcnt vmcnt(5)
    s_barrier
    s_waitcnt lgkmcnt(4)
    v_mfma_f32_16x16x32_bf16 a[32:35], v[80:83], v[32:35], a[32:35]
    ds_read_b128 v[48:51], v25 offset:0
    ds_read_b128 v[52:55], v25 offset:1024
    ds_read_b64_tr_b16 v[92:93], v29 offset:0
    s_add_u32 m0, s26, 34816
    v_mfma_f32_16x16x32_bf16 a[36:39], v[80:83], v[36:39], a[36:39]
    ds_read_b128 v[56:59], v25 offset:2048
    ds_read_b128 v[60:63], v25 offset:3072
    ds_read_b64_tr_b16 v[94:95], v29 offset:2304
    buffer_load_dwordx4 v16, s[8:11], s27 offen lds
    v_mfma_f32_16x16x32_bf16 a[40:43], v[80:83], v[40:43], a[40:43]
    s_add_u32 m0, s26, 43008
    v_mfma_f32_16x16x32_bf16 a[44:47], v[80:83], v[44:47], a[44:47]
    buffer_load_dwordx4 v17, s[8:11], s27 offen lds
    s_waitcnt lgkmcnt(8)
    v_mfma_f32_16x16x32_bf16 a[48:51], v[84:87], v[32:35], a[48:51]
    ds_read_b64_tr_b16 v[64:65], v29 offset:32
    s_add_u32 m0, s44, 34816
    v_mfma_f32_16x16x32_bf16 a[52:55], v[84:87], v[36:39], a[52:55]
    ds_read_b64_tr_b16 v[66:67], v29 offset:2336
    buffer_load_dwordx4 v18, s[80:83], s28 offen lds
    v_mfma_f32_16x16x32_bf16 a[56:59], v[84:87], v[40:43], a[56:59]
    s_add_u32 m0, s45, 34816
    v_mfma_f32_16x16x32_bf16 a[60:63], v[84:87], v[44:47], a[60:63]
    buffer_load_dwordx4 v19, s[84:87], s28 offen lds
    s_waitcnt lgkmcnt(8)
    v_mfma_f32_16x16x32_bf16 a[64:67], v[88:91], v[32:35], a[64:67]
    ds_read_b64_tr_b16 v[68:69], v29 offset:64
    s_add_u32 m0, s46, 34816
    v_mfma_f32_16x16x32_bf16 a[68:71], v[88:91], v[36:39], a[68:71]
    ds_read_b64_tr_b16 v[70:71], v29 offset:2368
    s_mov_b64 exec, s[48:49]
    buffer_load_dwordx4 v20, s[88:91], s28 offen lds
    s_mov_b64 exec, -1
    v_mfma_f32_16x16x32_bf16 a[72:75], v[88:91], v[40:43], a[72:75]
    s_add_u32 s27, s27, 128
    s_add_u32 s28, s28, 73728
    v_mfma_f32_16x16x32_bf16 a[76:79], v[88:91], v[44:47], a[76:79]
    s_waitcnt lgkmcnt(4)
    v_mfma_f32_16x16x32_bf16 a[0:3], v[92:95], v[48:51], a[0:3]
    ds_read_b64_tr_b16 v[72:73], v29 offset:96
    v_mfma_f32_16x16x32_bf16 a[4:7], v[92:95], v[52:55], a[4:7]
    ds_read_b64_tr_b16 v[74:75], v29 offset:2400
    v_mfma_f32_16x16x32_bf16 a[8:11], v[92:95], v[56:59], a[8:11]
    v_mfma_f32_16x16x32_bf16 a[12:15], v[92:95], v[60:63], a[12:15]
    s_waitcnt lgkmcnt(4)
    v_mfma_f32_16x16x32_bf16 a[16:19], v[64:67], v[48:51], a[16:19]
    ds_read_b64_tr_b16 v[76:77], v29 offset:128
    v_mfma_f32_16x16x32_bf16 a[20:23], v[64:67], v[52:55], a[20:23]
    ds_read_b64_tr_b16 v[78:79], v29 offset:2432
    v_mfma_f32_16x16x32_bf16 a[24:27], v[64:67], v[56:59], a[24:27]
    v_mfma_f32_16x16x32_bf16 a[28:31], v[64:67], v[60:63], a[28:31]
    s_waitcnt vmcnt(5)
    s_barrier
    s_waitcnt lgkmcnt(4)
    v_mfma_f32_16x16x32_bf16 a[32:35], v[68:71], v[48:51], a[32:35]
    ds_read_b128 v[32:35], v22 offset:0
    ds_read_b128 v[36:39], v22 offset:1024
    ds_read_b64_tr_b16 v[80:81], v26 offset:0
    s_add_u32 m0, s26, 69632
    v_mfma_f32_16x16x32_bf16 a[36:39], v[68:71], v[52:55], a[36:39]
    ds_read_b128 v[40:43], v22 offset:2048
    ds_read_b128 v[44:47], v22 offset:3072
    ds_read_b64_tr_b16 v[82:83], v26 offset:2304
    buffer_load_dwordx4 v16, s[8:11], s27 offen lds
    v_mfma_f32_16x16x32_bf16 a[40:43], v[68:71], v[56:59], a[40:43]
    s_add_u32 m0, s26, 77824
    v_mfma_f32_16x16x32_bf16 a[44:47], v[68:71], v[60:63], a[44:47]
    buffer_load_dwordx4 v17, s[8:11], s27 offen lds
    s_waitcnt lgkmcnt(8)
    v_mfma_f32_16x16x32_bf16 a[48:51], v[72:75], v[48:51], a[48:51]
    ds_read_b64_tr_b16 v[84:85], v26 offset:32
    s_add_u32 m0, s44, 69632
    v_mfma_f32_16x16x32_bf16 a[52:55], v[72:75], v[52:55], a[52:55]
    ds_read_b64_tr_b16 v[86:87], v26 offset:2336
    buffer_load_dwordx4 v18, s[80:83], s28 offen lds
    v_mfma_f32_16x16x32_bf16 a[56:59], v[72:75], v[56:59], a[56:59]
    s_add_u32 m0, s45, 69632
    v_mfma_f32_16x16x32_bf16 a[60:63], v[72:75], v[60:63], a[60:63]
    buffer_load_dwordx4 v19, s[84:87], s28 offen lds
    s_waitcnt lgkmcnt(8)
    v_mfma_f32_16x16x32_bf16 a[64:67], v[76:79], v[48:51], a[64:67]
    ds_read_b64_tr_b16 v[88:89], v26 offset:64
    s_add_u32 m0, s46, 69632
    v_mfma_f32_16x16x32_bf16 a[68:71], v[76:79], v[52:55], a[68:71]
    ds_read_b64_tr_b16 v[90:91], v26 offset:2368
    s_mov_b64 exec, s[48:49]
    buffer_load_dwordx4 v20, s[88:91], s28 offen lds
    s_mov_b64 exec, -1
    v_mfma_f32_16x16x32_bf16 a[72:75], v[76:79], v[56:59], a[72:75]
    s_add_u32 s27, s27, 128
    s_add_u32 s28, s28, 73728
    v_mfma_f32_16x16x32_bf16 a[76:79], v[76:79], v[60:63], a[76:79]
    s_waitcnt lgkmcnt(4)
    v_mfma_f32_16x16x32_bf16 a[0:3], v[80:83], v[32:35], a[0:3]
    ds_read_b64_tr_b16 v[92:93], v26 offset:96
    v_mfma_f32_16x16x32_bf16 a[4:7], v[80:83], v[36:39], a[4:7]
    ds_read_b64_tr_b16 v[94:95], v26 offset:2400
    v_mfma_f32_16x16x32_bf16 a[8:11], v[80:83], v[40:43], a[8:11]
    v_mfma_f32_16x16x32_bf16 a[12:15], v[80:83], v[44:47], a[12:15]
    s_waitcnt lgkmcnt(4)
    v_mfma_f32_16x16x32_bf16 a[16:19], v[84:87], v[32:35], a[16:19]
    ds_read_b64_tr_b16 v[64:65], v26 offset:128
    v_mfma_f32_16x16x32_bf16 a[20:23], v[84:87], v[36:39], a[20:23]
    ds_read_b64_tr_b16 v[66:67], v26 offset:2432
    v_mfma_f32_16x16x32_bf16 a[24:27], v[84:87], v[40:43], a[24:27]
    v_mfma_f32_16x16x32_bf16 a[28:31], v[84:87], v[44:47], a[28:31]
    s_waitcnt vmcnt(5)
    s_barrier
    s_waitcnt lgkmcnt(4)
    v_mfma_f32_16x16x32_bf16 a[32:35], v[88:91], v[32:35], a[32:35]
    ds_read_b128 v[48:51], v23 offset:0
    ds_read_b128 v[52:55], v23 offset:1024
    ds_read_b64_tr_b16 v[68:69], v27 offset:0
    s_add_u32 m0, s26, 104448
    v_mfma_f32_16x16x32_bf16 a[36:39], v[88:91], v[36:39], a[36:39]
    ds_read_b128 v[56:59], v23 offset:2048
    ds_read_b128 v[60:63], v23 offset:3072
    ds_read_b64_tr_b16 v[70:71], v27 offset:2304
    buffer_load_dwordx4 v16, s[8:11], s27 offen lds
    v_mfma_f32_16x16x32_bf16 a[40:43], v[88:91], v[40:43], a[40:43]
    s_add_u32 m0, s26, 112640
    v_mfma_f32_16x16x32_bf16 a[44:47], v[88:91], v[44:47], a[44:47]
    buffer_load_dwordx4 v17, s[8:11], s27 offen lds
    s_waitcnt lgkmcnt(8)
    v_mfma_f32_16x16x32_bf16 a[48:51], v[92:95], v[32:35], a[48:51]
    ds_read_b64_tr_b16 v[72:73], v27 offset:32
    s_add_u32 m0, s44, 104448
    v_mfma_f32_16x16x32_bf16 a[52:55], v[92:95], v[36:39], a[52:55]
    ds_read_b64_tr_b16 v[74:75], v27 offset:2336
    buffer_load_dwordx4 v18, s[80:83], s28 offen lds
    v_mfma_f32_16x16x32_bf16 a[56:59], v[92:95], v[40:43], a[56:59]
    s_add_u32 m0, s45, 104448
    v_mfma_f32_16x16x32_bf16 a[60:63], v[92:95], v[44:47], a[60:63]
    buffer_load_dwordx4 v19, s[84:87], s28 offen lds
    s_waitcnt lgkmcnt(8)
    v_mfma_f32_16x16x32_bf16 a[64:67], v[64:67], v[32:35], a[64:67]
    ds_read_b64_tr_b16 v[76:77], v27 offset:64
    s_add_u32 m0, s46, 104448
    v_mfma_f32_16x16x32_bf16 a[68:71], v[64:67], v[36:39], a[68:71]
    ds_read_b64_tr_b16 v[78:79], v27 offset:2368
    s_mov_b64 exec, s[48:49]
    buffer_load_dwordx4 v20, s[88:91], s28 offen lds
    s_mov_b64 exec, -1
    v_mfma_f32_16x16x32_bf16 a[72:75], v[64:67], v[40:43], a[72:75]
    s_add_u32 s27, s27, 128
    s_add_u32 s28, s28, 73728
    v_mfma_f32_16x16x32_bf16 a[76:79], v[64:67], v[44:47], a[76:79]
    s_waitcnt lgkmcnt(4)
    v_mfma_f32_16x16x32_bf16 a[0:3], v[68:71], v[48:51], a[0:3]
    ds_read_b64_tr_b16 v[80:81], v27 offset:96
    v_mfma_f32_16x16x32_bf16 a[4:7], v[68:71], v[52:55], a[4:7]
    ds_read_b64_tr_b16 v[82:83], v27 offset:2400
    v_mfma_f32_16x16x32_bf16 a[8:11], v[68:71], v[56:59], a[8:11]
    v_mfma_f32_16x16x32_bf16 a[12:15], v[68:71], v[60:63], a[12:15]
    s_waitcnt lgkmcnt(4)
    v_mfma_f32_16x16x32_bf16 a[16:19], v[72:75], v[48:51], a[16:19]
    ds_read_b64_tr_b16 v[84:85], v27 offset:128
    v_mfma_f32_16x16x32_bf16 a[20:23], v[72:75], v[52:55], a[20:23]
    ds_read_b64_tr_b16 v[86:87], v27 offset:2432
    v_mfma_f32_16x16x32_bf16 a[24:27], v[72:75], v[56:59], a[24:27]
    v_mfma_f32_16x16x32_bf16 a[28:31], v[72:75], v[60:63], a[28:31]
    s_waitcnt vmcnt(5)
    s_barrier
    s_waitcnt lgkmcnt(4)
    v_mfma_f32_16x16x32_bf16 a[32:35], v[76:79], v[48:51], a[32:35]
    ds_read_b128 v[32:35], v24 offset:0
    ds_read_b128 v[36:39], v24 offset:1024
    ds_read_b64_tr_b16 v[88:89], v28 offset:0
    v_mfma_f32_16x16x32_bf16 a[36:39], v[76:79], v[52:55], a[36:39]
    ds_read_b128 v[40:43], v24 offset:2048
    ds_read_b128 v[44:47], v24 offset:3072
    ds_read_b64_tr_b16 v[90:91], v28 offset:2304
    v_mfma_f32_16x16x32_bf16 a[40:43], v[76:79], v[56:59], a[40:43]
    v_mfma_f32_16x16x32_bf16 a[44:47], v[76:79], v[60:63], a[44:47]
    s_waitcnt lgkmcnt(8)
    v_mfma_f32_16x16x32_bf16 a[48:51], v[80:83], v[48:51], a[48:51]
    ds_read_b64_tr_b16 v[92:93], v28 offset:32
    v_mfma_f32_16x16x32_bf16 a[52:55], v[80:83], v[52:55], a[52:55]
    ds_read_b64_tr_b16 v[94:95], v28 offset:2336
    v_mfma_f32_16x16x32_bf16 a[56:59], v[80:83], v[56:59], a[56:59]
    v_mfma_f32_16x16x32_bf16 a[60:63], v[80:83], v[60:63], a[60:63]
    s_waitcnt lgkmcnt(8)
    v_mfma_f32_16x16x32_bf16 a[64:67], v[84:87], v[48:51], a[64:67]
    ds_read_b64_tr_b16 v[64:65], v28 offset:64
    v_mfma_f32_16x16x32_bf16 a[68:71], v[84:87], v[52:55], a[68:71]
    ds_read_b64_tr_b16 v[66:67], v28 offset:2368
    v_mfma_f32_16x16x32_bf16 a[72:75], v[84:87], v[56:59], a[72:75]
    v_mfma_f32_16x16x32_bf16 a[76:79], v[84:87], v[60:63], a[76:79]
    s_waitcnt lgkmcnt(4)
    v_mfma_f32_16x16x32_bf16 a[0:3], v[88:91], v[32:35], a[0:3]
    ds_read_b64_tr_b16 v[68:69], v28 offset:96
    v_mfma_f32_16x16x32_bf16 a[4:7], v[88:91], v[36:39], a[4:7]
    ds_read_b64_tr_b16 v[70:71], v28 offset:2400
    v_mfma_f32_16x16x32_bf16 a[8:11], v[88:91], v[40:43], a[8:11]
    v_mfma_f32_16x16x32_bf16 a[12:15], v[88:91], v[44:47], a[12:15]
    s_waitcnt lgkmcnt(4)
    v_mfma_f32_16x16x32_bf16 a[16:19], v[92:95], v[32:35], a[16:19]
    ds_read_b64_tr_b16 v[72:73], v28 offset:128
    v_mfma_f32_16x16x32_bf16 a[20:23], v[92:95], v[36:39], a[20:23]
    ds_read_b64_tr_b16 v[74:75], v28 offset:2432
    v_mfma_f32_16x16x32_bf16 a[24:27], v[92:95], v[40:43], a[24:27]
    v_mfma_f32_16x16x32_bf16 a[28:31], v[92:95], v[44:47], a[28:31]
    s_waitcnt vmcnt(0)
    s_barrier
    s_waitcnt lgkmcnt(4)
    v_mfma_f32_16x16x32_bf16 a[32:35], v[64:67], v[32:35], a[32:35]
    ds_read_b128 v[48:51], v25 offset:0
    ds_read_b128 v[52:55], v25 offset:1024
    ds_read_b64_tr_b16 v[76:77], v29 offset:0
    v_mfma_f32_16x16x32_bf16 a[36:39], v[64:67], v[36:39], a[36:39]
    ds_read_b128 v[56:59], v25 offset:2048
    ds_read_b128 v[60:63], v25 offset:3072
    ds_read_b64_tr_b16 v[78:79], v29 offset:2304
    v_mfma_f32_16x16x32_bf16 a[40:43], v[64:67], v[40:43], a[40:43]
    v_mfma_f32_16x16x32_bf16 a[44:47], v[64:67], v[44:47], a[44:47]
    s_waitcnt lgkmcnt(8)
    v_mfma_f32_16x16x32_bf16 a[48:51], v[68:71], v[32:35], a[48:51]
    ds_read_b64_tr_b16 v[80:81], v29 offset:32
    v_mfma_f32_16x16x32_bf16 a[52:55], v[68:71], v[36:39], a[52:55]
    ds_read_b64_tr_b16 v[82:83], v29 offset:2336
    v_mfma_f32_16x16x32_bf16 a[56:59], v[68:71], v[40:43], a[56:59]
    v_mfma_f32_16x16x32_bf16 a[60:63], v[68:71], v[44:47], a[60:63]
    s_waitcnt lgkmcnt(8)
    v_mfma_f32_16x16x32_bf16 a[64:67], v[72:75], v[32:35], a[64:67]
    ds_read_b64_tr_b16 v[84:85], v29 offset:64
    v_mfma_f32_16x16x32_bf16 a[68:71], v[72:75], v[36:39], a[68:71]
    ds_read_b64_tr_b16 v[86:87], v29 offset:2368
    v_mfma_f32_16x16x32_bf16 a[72:75], v[72:75], v[40:43], a[72:75]
    v_mfma_f32_16x16x32_bf16 a[76:79], v[72:75], v[44:47], a[76:79]
    s_waitcnt lgkmcnt(4)
    v_mfma_f32_16x16x32_bf16 a[0:3], v[76:79], v[48:51], a[0:3]
    ds_read_b64_tr_b16 v[88:89], v29 offset:96
    v_mfma_f32_16x16x32_bf16 a[4:7], v[76:79], v[52:55], a[4:7]
    ds_read_b64_tr_b16 v[90:91], v29 offset:2400
    v_mfma_f32_16x16x32_bf16 a[8:11], v[76:79], v[56:59], a[8:11]
    v_mfma_f32_16x16x32_bf16 a[12:15], v[76:79], v[60:63], a[12:15]
    s_waitcnt lgkmcnt(4)
    v_mfma_f32_16x16x32_bf16 a[16:19], v[80:83], v[48:51], a[16:19]
    ds_read_b64_tr_b16 v[92:93], v29 offset:128
    v_mfma_f32_16x16x32_bf16 a[20:23], v[80:83], v[52:55], a[20:23]
    ds_read_b64_tr_b16 v[94:95], v29 offset:2432
    v_mfma_f32_16x16x32_bf16 a[24:27], v[80:83], v[56:59], a[24:27]
    v_mfma_f32_16x16x32_bf16 a[28:31], v[80:83], v[60:63], a[28:31]
    s_waitcnt lgkmcnt(4)
    v_mfma_f32_16x16x32_bf16 a[32:35], v[84:87], v[48:51], a[32:35]
    v_mfma_f32_16x16x32_bf16 a[36:39], v[84:87], v[52:55], a[36:39]
    v_mfma_f32_16x16x32_bf16 a[40:43], v[84:87], v[56:59], a[40:43]
    v_mfma_f32_16x16x32_bf16 a[44:47], v[84:87], v[60:63], a[44:47]
    s_waitcnt lgkmcnt(2)
    v_mfma_f32_16x16x32_bf16 a[48:51], v[88:91], v[48:51], a[48:51]
    v_mfma_f32_16x16x32_bf16 a[52:55], v[88:91], v[52:55], a[52:55]
    v_mfma_f32_16x16x32_bf16 a[56:59], v[88:91], v[56:59], a[56:59]
    v_mfma_f32_16x16x32_bf16 a[60:63], v[88:91], v[60:63], a[60:63]
    s_waitcnt lgkmcnt(0)
    v_mfma_f32_16x16x32_bf16 a[64:67], v[92:95], v[48:51], a[64:67]
    v_mfma_f32_16x16x32_bf16 a[68:71], v[92:95], v[52:55], a[68:71]
    v_mfma_f32_16x16x32_bf16 a[72:75], v[92:95], v[56:59], a[72:75]
    v_mfma_f32_16x16x32_bf16 a[76:79], v[92:95], v[60:63], a[76:79]
    s_nop 15
    s_waitcnt vmcnt(0) lgkmcnt(0)
    s_add_u32 s40, s4, 32768
    s_addc_u32 s41, s5, 0
    s_mov_b32 s42, 16384
    s_mov_b32 s43, 0x00020000
    s_lshr_b32 s32, s25, 7
    s_lshl_b32 s32, s32, 8
    s_barrier
    v_lshlrev_b32 v8, 4, v2
    s_xor_b32 s30, s3, 2
    s_mul_i32 s30, s30, 10240
    s_mul_i32 s31, s3, 10240
    v_add_u32 v7, s30, v8
    v_add_u32 v8, s31, v8
    s_cmp_eq_u32 s22, 0
    s_cbranch_scc1 .wo_kernel_end_p0_w0
    ds_write_b128 v7, a[0:3] offset:0
    ds_write_b128 v7, a[16:19] offset:1024
    ds_write_b128 v7, a[32:35] offset:2048
    ds_write_b128 v7, a[48:51] offset:3072
    ds_write_b128 v7, a[64:67] offset:4096
    ds_write_b128 v7, a[4:7] offset:5120
    ds_write_b128 v7, a[20:23] offset:6144
    ds_write_b128 v7, a[36:39] offset:7168
    ds_write_b128 v7, a[52:55] offset:8192
    ds_write_b128 v7, a[68:71] offset:9216
    s_branch .wo_kernel_end_p0_w1
.wo_kernel_end_p0_w0:
    ds_write_b128 v7, a[8:11] offset:0
    ds_write_b128 v7, a[24:27] offset:1024
    ds_write_b128 v7, a[40:43] offset:2048
    ds_write_b128 v7, a[56:59] offset:3072
    ds_write_b128 v7, a[72:75] offset:4096
    ds_write_b128 v7, a[12:15] offset:5120
    ds_write_b128 v7, a[28:31] offset:6144
    ds_write_b128 v7, a[44:47] offset:7168
    ds_write_b128 v7, a[60:63] offset:8192
    ds_write_b128 v7, a[76:79] offset:9216
.wo_kernel_end_p0_w1:
    s_add_u32 s12, s4, 44040192
    s_addc_u32 s13, s5, 0
    s_mov_b32 s14, 9437184
    s_mov_b32 s15, 0x00020000
    s_lshl_b32 s30, s21, 6
    s_add_u32 s30, s30, s25
    s_lshl_b32 s31, s22, 5
    s_add_u32 s30, s30, s31
    s_lshl_b32 s31, s23, 11
    s_add_u32 s30, s30, s31
    v_add_u32 v12, s30, v3
    s_movk_i32 s31, 1152
    v_mul_lo_u32 v12, v12, s31
    s_mul_i32 s29, s24, 288
    v_add_u32 v12, s29, v12
    v_and_b32 v9, 1, v4
    v_lshrrev_b32 v10, 1, v4
    v_lshlrev_b32 v9, 5, v9
    v_lshl_add_u32 v9, v10, 4, v9
    v_add_u32 v9, v12, v9
    v_lshl_add_u32 v10, v4, 3, v12
    s_waitcnt lgkmcnt(0)
    s_barrier
    ds_read_b128 v[32:35], v8 offset:0
    ds_read_b128 v[36:39], v8 offset:1024
    ds_read_b128 v[40:43], v8 offset:2048
    ds_read_b128 v[44:47], v8 offset:3072
    ds_read_b128 v[48:51], v8 offset:4096
    ds_read_b128 v[52:55], v8 offset:5120
    ds_read_b128 v[56:59], v8 offset:6144
    ds_read_b128 v[60:63], v8 offset:7168
    ds_read_b128 v[64:67], v8 offset:8192
    ds_read_b128 v[68:71], v8 offset:9216
    s_cmp_eq_u32 s22, 0
    s_cbranch_scc1 .wo_kernel_end_p0_a0
    v_accvgpr_read_b32 v80, a8
    v_accvgpr_read_b32 v81, a9
    v_accvgpr_read_b32 v82, a10
    v_accvgpr_read_b32 v83, a11
    v_accvgpr_read_b32 v84, a24
    v_accvgpr_read_b32 v85, a25
    v_accvgpr_read_b32 v86, a26
    v_accvgpr_read_b32 v87, a27
    v_accvgpr_read_b32 v88, a40
    v_accvgpr_read_b32 v89, a41
    v_accvgpr_read_b32 v90, a42
    v_accvgpr_read_b32 v91, a43
    v_accvgpr_read_b32 v92, a56
    v_accvgpr_read_b32 v93, a57
    v_accvgpr_read_b32 v94, a58
    v_accvgpr_read_b32 v95, a59
    v_accvgpr_read_b32 v96, a72
    v_accvgpr_read_b32 v97, a73
    v_accvgpr_read_b32 v98, a74
    v_accvgpr_read_b32 v99, a75
    v_accvgpr_read_b32 v100, a12
    v_accvgpr_read_b32 v101, a13
    v_accvgpr_read_b32 v102, a14
    v_accvgpr_read_b32 v103, a15
    v_accvgpr_read_b32 v104, a28
    v_accvgpr_read_b32 v105, a29
    v_accvgpr_read_b32 v106, a30
    v_accvgpr_read_b32 v107, a31
    v_accvgpr_read_b32 v108, a44
    v_accvgpr_read_b32 v109, a45
    v_accvgpr_read_b32 v110, a46
    v_accvgpr_read_b32 v111, a47
    v_accvgpr_read_b32 v112, a60
    v_accvgpr_read_b32 v113, a61
    v_accvgpr_read_b32 v114, a62
    v_accvgpr_read_b32 v115, a63
    v_accvgpr_read_b32 v116, a76
    v_accvgpr_read_b32 v117, a77
    v_accvgpr_read_b32 v118, a78
    v_accvgpr_read_b32 v119, a79
    s_branch .wo_kernel_end_p0_a1
.wo_kernel_end_p0_a0:
    v_accvgpr_read_b32 v80, a0
    v_accvgpr_read_b32 v81, a1
    v_accvgpr_read_b32 v82, a2
    v_accvgpr_read_b32 v83, a3
    v_accvgpr_read_b32 v84, a16
    v_accvgpr_read_b32 v85, a17
    v_accvgpr_read_b32 v86, a18
    v_accvgpr_read_b32 v87, a19
    v_accvgpr_read_b32 v88, a32
    v_accvgpr_read_b32 v89, a33
    v_accvgpr_read_b32 v90, a34
    v_accvgpr_read_b32 v91, a35
    v_accvgpr_read_b32 v92, a48
    v_accvgpr_read_b32 v93, a49
    v_accvgpr_read_b32 v94, a50
    v_accvgpr_read_b32 v95, a51
    v_accvgpr_read_b32 v96, a64
    v_accvgpr_read_b32 v97, a65
    v_accvgpr_read_b32 v98, a66
    v_accvgpr_read_b32 v99, a67
    v_accvgpr_read_b32 v100, a4
    v_accvgpr_read_b32 v101, a5
    v_accvgpr_read_b32 v102, a6
    v_accvgpr_read_b32 v103, a7
    v_accvgpr_read_b32 v104, a20
    v_accvgpr_read_b32 v105, a21
    v_accvgpr_read_b32 v106, a22
    v_accvgpr_read_b32 v107, a23
    v_accvgpr_read_b32 v108, a36
    v_accvgpr_read_b32 v109, a37
    v_accvgpr_read_b32 v110, a38
    v_accvgpr_read_b32 v111, a39
    v_accvgpr_read_b32 v112, a52
    v_accvgpr_read_b32 v113, a53
    v_accvgpr_read_b32 v114, a54
    v_accvgpr_read_b32 v115, a55
    v_accvgpr_read_b32 v116, a68
    v_accvgpr_read_b32 v117, a69
    v_accvgpr_read_b32 v118, a70
    v_accvgpr_read_b32 v119, a71
.wo_kernel_end_p0_a1:
    s_mov_b32 s30, 0
    s_waitcnt lgkmcnt(9)
    v_add_f32 v32, v32, v80
    v_add_f32 v33, v33, v81
    v_add_f32 v34, v34, v82
    v_add_f32 v35, v35, v83
    v_cvt_pk_bf16_f32 v124, v32, v33
    v_cvt_pk_bf16_f32 v125, v34, v35
    s_waitcnt lgkmcnt(8)
    v_add_f32 v36, v36, v84
    v_add_f32 v37, v37, v85
    v_add_f32 v38, v38, v86
    v_add_f32 v39, v39, v87
    v_cvt_pk_bf16_f32 v126, v36, v37
    v_cvt_pk_bf16_f32 v127, v38, v39
    s_nop 1
    v_permlane16_swap_b32 v124, v126
    v_permlane16_swap_b32 v125, v127
    buffer_store_dwordx4 v[124:127], v9, s[12:15], s30 offen offset:0 sc1
    s_waitcnt lgkmcnt(7)
    v_add_f32 v40, v40, v88
    v_add_f32 v41, v41, v89
    v_add_f32 v42, v42, v90
    v_add_f32 v43, v43, v91
    v_cvt_pk_bf16_f32 v128, v40, v41
    v_cvt_pk_bf16_f32 v129, v42, v43
    s_waitcnt lgkmcnt(6)
    v_add_f32 v44, v44, v92
    v_add_f32 v45, v45, v93
    v_add_f32 v46, v46, v94
    v_add_f32 v47, v47, v95
    v_cvt_pk_bf16_f32 v130, v44, v45
    v_cvt_pk_bf16_f32 v131, v46, v47
    s_nop 1
    v_permlane16_swap_b32 v128, v130
    v_permlane16_swap_b32 v129, v131
    buffer_store_dwordx4 v[128:131], v9, s[12:15], s30 offen offset:64 sc1
    s_waitcnt lgkmcnt(5)
    v_add_f32 v48, v48, v96
    v_add_f32 v49, v49, v97
    v_add_f32 v50, v50, v98
    v_add_f32 v51, v51, v99
    v_cvt_pk_bf16_f32 v132, v48, v49
    v_cvt_pk_bf16_f32 v133, v50, v51
    buffer_store_dwordx2 v[132:133], v10, s[12:15], s30 offen offset:128 sc1
    s_mov_b32 s30, 18432
    s_waitcnt lgkmcnt(4)
    v_add_f32 v52, v52, v100
    v_add_f32 v53, v53, v101
    v_add_f32 v54, v54, v102
    v_add_f32 v55, v55, v103
    v_cvt_pk_bf16_f32 v136, v52, v53
    v_cvt_pk_bf16_f32 v137, v54, v55
    s_waitcnt lgkmcnt(3)
    v_add_f32 v56, v56, v104
    v_add_f32 v57, v57, v105
    v_add_f32 v58, v58, v106
    v_add_f32 v59, v59, v107
    v_cvt_pk_bf16_f32 v138, v56, v57
    v_cvt_pk_bf16_f32 v139, v58, v59
    s_nop 1
    v_permlane16_swap_b32 v136, v138
    v_permlane16_swap_b32 v137, v139
    buffer_store_dwordx4 v[136:139], v9, s[12:15], s30 offen offset:0 sc1
    s_waitcnt lgkmcnt(2)
    v_add_f32 v60, v60, v108
    v_add_f32 v61, v61, v109
    v_add_f32 v62, v62, v110
    v_add_f32 v63, v63, v111
    v_cvt_pk_bf16_f32 v140, v60, v61
    v_cvt_pk_bf16_f32 v141, v62, v63
    s_waitcnt lgkmcnt(1)
    v_add_f32 v64, v64, v112
    v_add_f32 v65, v65, v113
    v_add_f32 v66, v66, v114
    v_add_f32 v67, v67, v115
    v_cvt_pk_bf16_f32 v142, v64, v65
    v_cvt_pk_bf16_f32 v143, v66, v67
    s_nop 1
    v_permlane16_swap_b32 v140, v142
    v_permlane16_swap_b32 v141, v143
    buffer_store_dwordx4 v[140:143], v9, s[12:15], s30 offen offset:64 sc1
    s_waitcnt lgkmcnt(0)
    v_add_f32 v68, v68, v116
    v_add_f32 v69, v69, v117
    v_add_f32 v70, v70, v118
    v_add_f32 v71, v71, v119
    v_cvt_pk_bf16_f32 v144, v68, v69
    v_cvt_pk_bf16_f32 v145, v70, v71
    buffer_store_dwordx2 v[144:145], v10, s[12:15], s30 offen offset:128 sc1
    v_mov_b32 v1, 1
    v_mov_b32 v2, 0
    s_waitcnt vmcnt(0)
    s_barrier
    s_cmp_lg_u32 s3, 0
    s_cbranch_scc1 .wo_kernel_end_p0_x
    s_mov_b64 exec, 1
    buffer_atomic_add v1, v2, s[40:43], s32 offen sc1
.wo_kernel_end_p0_x:
    s_endpgm
.wo_kernel_end_p1:
    s_nop 0
    s_add_u32 m0, s26, 0
    s_nop 0
    buffer_load_dwordx4 v16, s[8:11], s27 offen lds
    s_nop 0
    s_add_u32 m0, s26, 8192
    s_nop 0
    buffer_load_dwordx4 v17, s[8:11], s27 offen lds
    s_nop 0
    s_add_u32 m0, s44, 0
    s_nop 0
    buffer_load_dwordx4 v18, s[80:83], s28 offen lds
    s_nop 0
    s_add_u32 m0, s45, 0
    s_nop 0
    buffer_load_dwordx4 v19, s[84:87], s28 offen lds
    s_nop 0
    s_add_u32 s27, s27, 128
    s_add_u32 s28, s28, 73728
    s_nop 0
    s_add_u32 m0, s26, 34816
    s_nop 0
    buffer_load_dwordx4 v16, s[8:11], s27 offen lds
    s_nop 0
    s_add_u32 m0, s26, 43008
    s_nop 0
    buffer_load_dwordx4 v17, s[8:11], s27 offen lds
    s_nop 0
    s_add_u32 m0, s44, 34816
    s_nop 0
    buffer_load_dwordx4 v18, s[80:83], s28 offen lds
    s_nop 0
    s_add_u32 m0, s45, 34816
    s_nop 0
    buffer_load_dwordx4 v19, s[84:87], s28 offen lds
    s_nop 0
    s_add_u32 s27, s27, 128
    s_add_u32 s28, s28, 73728
    s_nop 0
    s_add_u32 m0, s26, 69632
    s_nop 0
    buffer_load_dwordx4 v16, s[8:11], s27 offen lds
    s_nop 0
    s_add_u32 m0, s26, 77824
    s_nop 0
    buffer_load_dwordx4 v17, s[8:11], s27 offen lds
    s_nop 0
    s_add_u32 m0, s44, 69632
    s_nop 0
    buffer_load_dwordx4 v18, s[80:83], s28 offen lds
    s_nop 0
    s_add_u32 m0, s45, 69632
    s_nop 0
    buffer_load_dwordx4 v19, s[84:87], s28 offen lds
    s_nop 0
    s_add_u32 s27, s27, 128
    s_add_u32 s28, s28, 73728
    s_nop 0
    v_sub_u32 v8, 0, v5
    v_and_b32 v8, 3, v8
    v_xor_b32 v8, v4, v8
    v_lshlrev_b32 v8, 4, v8
    v_lshl_add_u32 v8, v3, 6, v8
    s_lshl_b32 s30, s21, 12
    s_lshl_b32 s31, s22, 13
    s_add_u32 s30, s30, s31
    v_add_u32 v8, s30, v8
    v_lshrrev_b32 v9, 1, v4
    v_lshlrev_b32 v9, 4, v9
    v_and_b32 v10, 1, v4
    v_lshl_add_u32 v9, v10, 2, v9
    v_add_u32 v9, v9, v5
    v_mul_u32_u24 v9, 288, v9
    v_lshl_add_u32 v9, v6, 3, v9
    s_mul_i32 s31, s22, 9216
    v_add_u32 v9, s31, v9
    v_add_u32 v22, 0, v8
    v_add_u32 v26, 16384, v9
    v_add_u32 v23, 34816, v8
    v_add_u32 v27, 51200, v9
    v_add_u32 v24, 69632, v8
    v_add_u32 v28, 86016, v9
    v_add_u32 v25, 104448, v8
    v_add_u32 v29, 120832, v9
    s_nop 0
    s_waitcnt vmcnt(8)
    s_barrier
    s_nop 0
    ds_read_b128 v[32:35], v22 offset:0
    ds_read_b128 v[36:39], v22 offset:1024
    ds_read_b64_tr_b16 v[64:65], v26 offset:160
    s_nop 0
    ds_read_b128 v[40:43], v22 offset:2048
    ds_read_b128 v[44:47], v22 offset:3072
    ds_read_b64_tr_b16 v[66:67], v26 offset:2464
    s_nop 0
    ds_read_b64_tr_b16 v[68:69], v26 offset:192
    s_nop 0
    ds_read_b64_tr_b16 v[70:71], v26 offset:2496
    s_nop 0
    ds_read_b64_tr_b16 v[72:73], v26 offset:224
    s_nop 0
    ds_read_b64_tr_b16 v[74:75], v26 offset:2528
    s_waitcnt lgkmcnt(4)
    v_mfma_f32_16x16x32_bf16 a[0:3], v[64:67], v[32:35], 0
    ds_read_b64_tr_b16 v[76:77], v26 offset:256
    v_mfma_f32_16x16x32_bf16 a[4:7], v[64:67], v[36:39], 0
    ds_read_b64_tr_b16 v[78:79], v26 offset:2560
    v_mfma_f32_16x16x32_bf16 a[8:11], v[64:67], v[40:43], 0
    v_mfma_f32_16x16x32_bf16 a[12:15], v[64:67], v[44:47], 0
    s_waitcnt vmcnt(4)
    s_barrier
    s_waitcnt lgkmcnt(4)
    v_mfma_f32_16x16x32_bf16 a[16:19], v[68:71], v[32:35], 0
    ds_read_b128 v[48:51], v23 offset:0
    ds_read_b128 v[52:55], v23 offset:1024
    ds_read_b64_tr_b16 v[80:81], v27 offset:160
    s_add_u32 m0, s26, 104448
    v_mfma_f32_16x16x32_bf16 a[20:23], v[68:71], v[36:39], 0
    ds_read_b128 v[56:59], v23 offset:2048
    ds_read_b128 v[60:63], v23 offset:3072
    ds_read_b64_tr_b16 v[82:83], v27 offset:2464
    buffer_load_dwordx4 v16, s[8:11], s27 offen lds
    v_mfma_f32_16x16x32_bf16 a[24:27], v[68:71], v[40:43], 0
    s_add_u32 m0, s26, 112640
    v_mfma_f32_16x16x32_bf16 a[28:31], v[68:71], v[44:47], 0
    buffer_load_dwordx4 v17, s[8:11], s27 offen lds
    s_waitcnt lgkmcnt(8)
    v_mfma_f32_16x16x32_bf16 a[32:35], v[72:75], v[32:35], 0
    ds_read_b64_tr_b16 v[84:85], v27 offset:192
    s_add_u32 m0, s44, 104448
    v_mfma_f32_16x16x32_bf16 a[36:39], v[72:75], v[36:39], 0
    ds_read_b64_tr_b16 v[86:87], v27 offset:2496
    buffer_load_dwordx4 v18, s[80:83], s28 offen lds
    v_mfma_f32_16x16x32_bf16 a[40:43], v[72:75], v[40:43], 0
    s_add_u32 m0, s45, 104448
    v_mfma_f32_16x16x32_bf16 a[44:47], v[72:75], v[44:47], 0
    buffer_load_dwordx4 v19, s[84:87], s28 offen lds
    s_waitcnt lgkmcnt(8)
    v_mfma_f32_16x16x32_bf16 a[48:51], v[76:79], v[32:35], 0
    ds_read_b64_tr_b16 v[88:89], v27 offset:224
    s_add_u32 s27, s27, 128
    s_add_u32 s28, s28, 73728
    v_mfma_f32_16x16x32_bf16 a[52:55], v[76:79], v[36:39], 0
    ds_read_b64_tr_b16 v[90:91], v27 offset:2528
    v_mfma_f32_16x16x32_bf16 a[56:59], v[76:79], v[40:43], 0
    v_mfma_f32_16x16x32_bf16 a[60:63], v[76:79], v[44:47], 0
    s_waitcnt lgkmcnt(4)
    v_mfma_f32_16x16x32_bf16 a[0:3], v[80:83], v[48:51], a[0:3]
    ds_read_b64_tr_b16 v[92:93], v27 offset:256
    v_mfma_f32_16x16x32_bf16 a[4:7], v[80:83], v[52:55], a[4:7]
    ds_read_b64_tr_b16 v[94:95], v27 offset:2560
    v_mfma_f32_16x16x32_bf16 a[8:11], v[80:83], v[56:59], a[8:11]
    v_mfma_f32_16x16x32_bf16 a[12:15], v[80:83], v[60:63], a[12:15]
    s_waitcnt vmcnt(4)
    s_barrier
    s_waitcnt lgkmcnt(4)
    v_mfma_f32_16x16x32_bf16 a[16:19], v[84:87], v[48:51], a[16:19]
    ds_read_b128 v[32:35], v24 offset:0
    ds_read_b128 v[36:39], v24 offset:1024
    ds_read_b64_tr_b16 v[64:65], v28 offset:160
    s_add_u32 m0, s26, 0
    v_mfma_f32_16x16x32_bf16 a[20:23], v[84:87], v[52:55], a[20:23]
    ds_read_b128 v[40:43], v24 offset:2048
    ds_read_b128 v[44:47], v24 offset:3072
    ds_read_b64_tr_b16 v[66:67], v28 offset:2464
    buffer_load_dwordx4 v16, s[8:11], s27 offen lds
    v_mfma_f32_16x16x32_bf16 a[24:27], v[84:87], v[56:59], a[24:27]
    s_add_u32 m0, s26, 8192
    v_mfma_f32_16x16x32_bf16 a[28:31], v[84:87], v[60:63], a[28:31]
    buffer_load_dwordx4 v17, s[8:11], s27 offen lds
    s_waitcnt lgkmcnt(8)
    v_mfma_f32_16x16x32_bf16 a[32:35], v[88:91], v[48:51], a[32:35]
    ds_read_b64_tr_b16 v[68:69], v28 offset:192
    s_add_u32 m0, s44, 0
    v_mfma_f32_16x16x32_bf16 a[36:39], v[88:91], v[52:55], a[36:39]
    ds_read_b64_tr_b16 v[70:71], v28 offset:2496
    buffer_load_dwordx4 v18, s[80:83], s28 offen lds
    v_mfma_f32_16x16x32_bf16 a[40:43], v[88:91], v[56:59], a[40:43]
    s_add_u32 m0, s45, 0
    v_mfma_f32_16x16x32_bf16 a[44:47], v[88:91], v[60:63], a[44:47]
    buffer_load_dwordx4 v19, s[84:87], s28 offen lds
    s_waitcnt lgkmcnt(8)
    v_mfma_f32_16x16x32_bf16 a[48:51], v[92:95], v[48:51], a[48:51]
    ds_read_b64_tr_b16 v[72:73], v28 offset:224
    s_add_u32 s27, s27, 128
    s_add_u32 s28, s28, 73728
    v_mfma_f32_16x16x32_bf16 a[52:55], v[92:95], v[52:55], a[52:55]
    ds_read_b64_tr_b16 v[74:75], v28 offset:2528
    v_mfma_f32_16x16x32_bf16 a[56:59], v[92:95], v[56:59], a[56:59]
    v_mfma_f32_16x16x32_bf16 a[60:63], v[92:95], v[60:63], a[60:63]
    s_waitcnt lgkmcnt(4)
    v_mfma_f32_16x16x32_bf16 a[0:3], v[64:67], v[32:35], a[0:3]
    ds_read_b64_tr_b16 v[76:77], v28 offset:256
    v_mfma_f32_16x16x32_bf16 a[4:7], v[64:67], v[36:39], a[4:7]
    ds_read_b64_tr_b16 v[78:79], v28 offset:2560
    v_mfma_f32_16x16x32_bf16 a[8:11], v[64:67], v[40:43], a[8:11]
    v_mfma_f32_16x16x32_bf16 a[12:15], v[64:67], v[44:47], a[12:15]
    s_waitcnt vmcnt(4)
    s_barrier
    s_waitcnt lgkmcnt(4)
    v_mfma_f32_16x16x32_bf16 a[16:19], v[68:71], v[32:35], a[16:19]
    ds_read_b128 v[48:51], v25 offset:0
    ds_read_b128 v[52:55], v25 offset:1024
    ds_read_b64_tr_b16 v[80:81], v29 offset:160
    s_add_u32 m0, s26, 34816
    v_mfma_f32_16x16x32_bf16 a[20:23], v[68:71], v[36:39], a[20:23]
    ds_read_b128 v[56:59], v25 offset:2048
    ds_read_b128 v[60:63], v25 offset:3072
    ds_read_b64_tr_b16 v[82:83], v29 offset:2464
    buffer_load_dwordx4 v16, s[8:11], s27 offen lds
    v_mfma_f32_16x16x32_bf16 a[24:27], v[68:71], v[40:43], a[24:27]
    s_add_u32 m0, s26, 43008
    v_mfma_f32_16x16x32_bf16 a[28:31], v[68:71], v[44:47], a[28:31]
    buffer_load_dwordx4 v17, s[8:11], s27 offen lds
    s_waitcnt lgkmcnt(8)
    v_mfma_f32_16x16x32_bf16 a[32:35], v[72:75], v[32:35], a[32:35]
    ds_read_b64_tr_b16 v[84:85], v29 offset:192
    s_add_u32 m0, s44, 34816
    v_mfma_f32_16x16x32_bf16 a[36:39], v[72:75], v[36:39], a[36:39]
    ds_read_b64_tr_b16 v[86:87], v29 offset:2496
    buffer_load_dwordx4 v18, s[80:83], s28 offen lds
    v_mfma_f32_16x16x32_bf16 a[40:43], v[72:75], v[40:43], a[40:43]
    s_add_u32 m0, s45, 34816
    v_mfma_f32_16x16x32_bf16 a[44:47], v[72:75], v[44:47], a[44:47]
    buffer_load_dwordx4 v19, s[84:87], s28 offen lds
    s_waitcnt lgkmcnt(8)
    v_mfma_f32_16x16x32_bf16 a[48:51], v[76:79], v[32:35], a[48:51]
    ds_read_b64_tr_b16 v[88:89], v29 offset:224
    s_add_u32 s27, s27, 128
    s_add_u32 s28, s28, 73728
    v_mfma_f32_16x16x32_bf16 a[52:55], v[76:79], v[36:39], a[52:55]
    ds_read_b64_tr_b16 v[90:91], v29 offset:2528
    v_mfma_f32_16x16x32_bf16 a[56:59], v[76:79], v[40:43], a[56:59]
    v_mfma_f32_16x16x32_bf16 a[60:63], v[76:79], v[44:47], a[60:63]
    s_waitcnt lgkmcnt(4)
    v_mfma_f32_16x16x32_bf16 a[0:3], v[80:83], v[48:51], a[0:3]
    ds_read_b64_tr_b16 v[92:93], v29 offset:256
    v_mfma_f32_16x16x32_bf16 a[4:7], v[80:83], v[52:55], a[4:7]
    ds_read_b64_tr_b16 v[94:95], v29 offset:2560
    v_mfma_f32_16x16x32_bf16 a[8:11], v[80:83], v[56:59], a[8:11]
    v_mfma_f32_16x16x32_bf16 a[12:15], v[80:83], v[60:63], a[12:15]
    s_waitcnt vmcnt(4)
    s_barrier
    s_waitcnt lgkmcnt(4)
    v_mfma_f32_16x16x32_bf16 a[16:19], v[84:87], v[48:51], a[16:19]
    ds_read_b128 v[32:35], v22 offset:0
    ds_read_b128 v[36:39], v22 offset:1024
    ds_read_b64_tr_b16 v[64:65], v26 offset:160
    s_add_u32 m0, s26, 69632
    v_mfma_f32_16x16x32_bf16 a[20:23], v[84:87], v[52:55], a[20:23]
    ds_read_b128 v[40:43], v22 offset:2048
    ds_read_b128 v[44:47], v22 offset:3072
    ds_read_b64_tr_b16 v[66:67], v26 offset:2464
    buffer_load_dwordx4 v16, s[8:11], s27 offen lds
    v_mfma_f32_16x16x32_bf16 a[24:27], v[84:87], v[56:59], a[24:27]
    s_add_u32 m0, s26, 77824
    v_mfma_f32_16x16x32_bf16 a[28:31], v[84:87], v[60:63], a[28:31]
    buffer_load_dwordx4 v17, s[8:11], s27 offen lds
    s_waitcnt lgkmcnt(8)
    v_mfma_f32_16x16x32_bf16 a[32:35], v[88:91], v[48:51], a[32:35]
    ds_read_b64_tr_b16 v[68:69], v26 offset:192
    s_add_u32 m0, s44, 69632
    v_mfma_f32_16x16x32_bf16 a[36:39], v[88:91], v[52:55], a[36:39]
    ds_read_b64_tr_b16 v[70:71], v26 offset:2496
    buffer_load_dwordx4 v18, s[80:83], s28 offen lds
    v_mfma_f32_16x16x32_bf16 a[40:43], v[88:91], v[56:59], a[40:43]
    s_add_u32 m0, s45, 69632
    v_mfma_f32_16x16x32_bf16 a[44:47], v[88:91], v[60:63], a[44:47]
    buffer_load_dwordx4 v19, s[84:87], s28 offen lds
    s_waitcnt lgkmcnt(8)
    v_mfma_f32_16x16x32_bf16 a[48:51], v[92:95], v[48:51], a[48:51]
    ds_read_b64_tr_b16 v[72:73], v26 offset:224
    s_add_u32 s27, s27, 128
    s_add_u32 s28, s28, 73728
    v_mfma_f32_16x16x32_bf16 a[52:55], v[92:95], v[52:55], a[52:55]
    ds_read_b64_tr_b16 v[74:75], v26 offset:2528
    v_mfma_f32_16x16x32_bf16 a[56:59], v[92:95], v[56:59], a[56:59]
    v_mfma_f32_16x16x32_bf16 a[60:63], v[92:95], v[60:63], a[60:63]
    s_waitcnt lgkmcnt(4)
    v_mfma_f32_16x16x32_bf16 a[0:3], v[64:67], v[32:35], a[0:3]
    ds_read_b64_tr_b16 v[76:77], v26 offset:256
    v_mfma_f32_16x16x32_bf16 a[4:7], v[64:67], v[36:39], a[4:7]
    ds_read_b64_tr_b16 v[78:79], v26 offset:2560
    v_mfma_f32_16x16x32_bf16 a[8:11], v[64:67], v[40:43], a[8:11]
    v_mfma_f32_16x16x32_bf16 a[12:15], v[64:67], v[44:47], a[12:15]
    s_waitcnt vmcnt(4)
    s_barrier
    s_waitcnt lgkmcnt(4)
    v_mfma_f32_16x16x32_bf16 a[16:19], v[68:71], v[32:35], a[16:19]
    ds_read_b128 v[48:51], v23 offset:0
    ds_read_b128 v[52:55], v23 offset:1024
    ds_read_b64_tr_b16 v[80:81], v27 offset:160
    s_add_u32 m0, s26, 104448
    v_mfma_f32_16x16x32_bf16 a[20:23], v[68:71], v[36:39], a[20:23]
    ds_read_b128 v[56:59], v23 offset:2048
    ds_read_b128 v[60:63], v23 offset:3072
    ds_read_b64_tr_b16 v[82:83], v27 offset:2464
    buffer_load_dwordx4 v16, s[8:11], s27 offen lds
    v_mfma_f32_16x16x32_bf16 a[24:27], v[68:71], v[40:43], a[24:27]
    s_add_u32 m0, s26, 112640
    v_mfma_f32_16x16x32_bf16 a[28:31], v[68:71], v[44:47], a[28:31]
    buffer_load_dwordx4 v17, s[8:11], s27 offen lds
    s_waitcnt lgkmcnt(8)
    v_mfma_f32_16x16x32_bf16 a[32:35], v[72:75], v[32:35], a[32:35]
    ds_read_b64_tr_b16 v[84:85], v27 offset:192
    s_add_u32 m0, s44, 104448
    v_mfma_f32_16x16x32_bf16 a[36:39], v[72:75], v[36:39], a[36:39]
    ds_read_b64_tr_b16 v[86:87], v27 offset:2496
    buffer_load_dwordx4 v18, s[80:83], s28 offen lds
    v_mfma_f32_16x16x32_bf16 a[40:43], v[72:75], v[40:43], a[40:43]
    s_add_u32 m0, s45, 104448
    v_mfma_f32_16x16x32_bf16 a[44:47], v[72:75], v[44:47], a[44:47]
    buffer_load_dwordx4 v19, s[84:87], s28 offen lds
    s_waitcnt lgkmcnt(8)
    v_mfma_f32_16x16x32_bf16 a[48:51], v[76:79], v[32:35], a[48:51]
    ds_read_b64_tr_b16 v[88:89], v27 offset:224
    s_add_u32 s27, s27, 128
    s_add_u32 s28, s28, 73728
    v_mfma_f32_16x16x32_bf16 a[52:55], v[76:79], v[36:39], a[52:55]
    ds_read_b64_tr_b16 v[90:91], v27 offset:2528
    v_mfma_f32_16x16x32_bf16 a[56:59], v[76:79], v[40:43], a[56:59]
    v_mfma_f32_16x16x32_bf16 a[60:63], v[76:79], v[44:47], a[60:63]
    s_waitcnt lgkmcnt(4)
    v_mfma_f32_16x16x32_bf16 a[0:3], v[80:83], v[48:51], a[0:3]
    ds_read_b64_tr_b16 v[92:93], v27 offset:256
    v_mfma_f32_16x16x32_bf16 a[4:7], v[80:83], v[52:55], a[4:7]
    ds_read_b64_tr_b16 v[94:95], v27 offset:2560
    v_mfma_f32_16x16x32_bf16 a[8:11], v[80:83], v[56:59], a[8:11]
    v_mfma_f32_16x16x32_bf16 a[12:15], v[80:83], v[60:63], a[12:15]
    s_waitcnt vmcnt(4)
    s_barrier
    s_waitcnt lgkmcnt(4)
    v_mfma_f32_16x16x32_bf16 a[16:19], v[84:87], v[48:51], a[16:19]
    ds_read_b128 v[32:35], v24 offset:0
    ds_read_b128 v[36:39], v24 offset:1024
    ds_read_b64_tr_b16 v[64:65], v28 offset:160
    s_add_u32 m0, s26, 0
    v_mfma_f32_16x16x32_bf16 a[20:23], v[84:87], v[52:55], a[20:23]
    ds_read_b128 v[40:43], v24 offset:2048
    ds_read_b128 v[44:47], v24 offset:3072
    ds_read_b64_tr_b16 v[66:67], v28 offset:2464
    buffer_load_dwordx4 v16, s[8:11], s27 offen lds
    v_mfma_f32_16x16x32_bf16 a[24:27], v[84:87], v[56:59], a[24:27]
    s_add_u32 m0, s26, 8192
    v_mfma_f32_16x16x32_bf16 a[28:31], v[84:87], v[60:63], a[28:31]
    buffer_load_dwordx4 v17, s[8:11], s27 offen lds
    s_waitcnt lgkmcnt(8)
    v_mfma_f32_16x16x32_bf16 a[32:35], v[88:91], v[48:51], a[32:35]
    ds_read_b64_tr_b16 v[68:69], v28 offset:192
    s_add_u32 m0, s44, 0
    v_mfma_f32_16x16x32_bf16 a[36:39], v[88:91], v[52:55], a[36:39]
    ds_read_b64_tr_b16 v[70:71], v28 offset:2496
    buffer_load_dwordx4 v18, s[80:83], s28 offen lds
    v_mfma_f32_16x16x32_bf16 a[40:43], v[88:91], v[56:59], a[40:43]
    s_add_u32 m0, s45, 0
    v_mfma_f32_16x16x32_bf16 a[44:47], v[88:91], v[60:63], a[44:47]
    buffer_load_dwordx4 v19, s[84:87], s28 offen lds
    s_waitcnt lgkmcnt(8)
    v_mfma_f32_16x16x32_bf16 a[48:51], v[92:95], v[48:51], a[48:51]
    ds_read_b64_tr_b16 v[72:73], v28 offset:224
    s_add_u32 s27, s27, 128
    s_add_u32 s28, s28, 73728
    v_mfma_f32_16x16x32_bf16 a[52:55], v[92:95], v[52:55], a[52:55]
    ds_read_b64_tr_b16 v[74:75], v28 offset:2528
    v_mfma_f32_16x16x32_bf16 a[56:59], v[92:95], v[56:59], a[56:59]
    v_mfma_f32_16x16x32_bf16 a[60:63], v[92:95], v[60:63], a[60:63]
    s_waitcnt lgkmcnt(4)
    v_mfma_f32_16x16x32_bf16 a[0:3], v[64:67], v[32:35], a[0:3]
    ds_read_b64_tr_b16 v[76:77], v28 offset:256
    v_mfma_f32_16x16x32_bf16 a[4:7], v[64:67], v[36:39], a[4:7]
    ds_read_b64_tr_b16 v[78:79], v28 offset:2560
    v_mfma_f32_16x16x32_bf16 a[8:11], v[64:67], v[40:43], a[8:11]
    v_mfma_f32_16x16x32_bf16 a[12:15], v[64:67], v[44:47], a[12:15]
    s_waitcnt vmcnt(4)
    s_barrier
    s_waitcnt lgkmcnt(4)
    v_mfma_f32_16x16x32_bf16 a[16:19], v[68:71], v[32:35], a[16:19]
    ds_read_b128 v[48:51], v25 offset:0
    ds_read_b128 v[52:55], v25 offset:1024
    ds_read_b64_tr_b16 v[80:81], v29 offset:160
    s_add_u32 m0, s26, 34816
    v_mfma_f32_16x16x32_bf16 a[20:23], v[68:71], v[36:39], a[20:23]
    ds_read_b128 v[56:59], v25 offset:2048
    ds_read_b128 v[60:63], v25 offset:3072
    ds_read_b64_tr_b16 v[82:83], v29 offset:2464
    buffer_load_dwordx4 v16, s[8:11], s27 offen lds
    v_mfma_f32_16x16x32_bf16 a[24:27], v[68:71], v[40:43], a[24:27]
    s_add_u32 m0, s26, 43008
    v_mfma_f32_16x16x32_bf16 a[28:31], v[68:71], v[44:47], a[28:31]
    buffer_load_dwordx4 v17, s[8:11], s27 offen lds
    s_waitcnt lgkmcnt(8)
    v_mfma_f32_16x16x32_bf16 a[32:35], v[72:75], v[32:35], a[32:35]
    ds_read_b64_tr_b16 v[84:85], v29 offset:192
    s_add_u32 m0, s44, 34816
    v_mfma_f32_16x16x32_bf16 a[36:39], v[72:75], v[36:39], a[36:39]
    ds_read_b64_tr_b16 v[86:87], v29 offset:2496
    buffer_load_dwordx4 v18, s[80:83], s28 offen lds
    v_mfma_f32_16x16x32_bf16 a[40:43], v[72:75], v[40:43], a[40:43]
    s_add_u32 m0, s45, 34816
    v_mfma_f32_16x16x32_bf16 a[44:47], v[72:75], v[44:47], a[44:47]
    buffer_load_dwordx4 v19, s[84:87], s28 offen lds
    s_waitcnt lgkmcnt(8)
    v_mfma_f32_16x16x32_bf16 a[48:51], v[76:79], v[32:35], a[48:51]
    ds_read_b64_tr_b16 v[88:89], v29 offset:224
    s_add_u32 s27, s27, 128
    s_add_u32 s28, s28, 73728
    v_mfma_f32_16x16x32_bf16 a[52:55], v[76:79], v[36:39], a[52:55]
    ds_read_b64_tr_b16 v[90:91], v29 offset:2528
    v_mfma_f32_16x16x32_bf16 a[56:59], v[76:79], v[40:43], a[56:59]
    v_mfma_f32_16x16x32_bf16 a[60:63], v[76:79], v[44:47], a[60:63]
    s_waitcnt lgkmcnt(4)
    v_mfma_f32_16x16x32_bf16 a[0:3], v[80:83], v[48:51], a[0:3]
    ds_read_b64_tr_b16 v[92:93], v29 offset:256
    v_mfma_f32_16x16x32_bf16 a[4:7], v[80:83], v[52:55], a[4:7]
    ds_read_b64_tr_b16 v[94:95], v29 offset:2560
    v_mfma_f32_16x16x32_bf16 a[8:11], v[80:83], v[56:59], a[8:11]
    v_mfma_f32_16x16x32_bf16 a[12:15], v[80:83], v[60:63], a[12:15]
    s_waitcnt vmcnt(4)
    s_barrier
    s_waitcnt lgkmcnt(4)
    v_mfma_f32_16x16x32_bf16 a[16:19], v[84:87], v[48:51], a[16:19]
    ds_read_b128 v[32:35], v22 offset:0
    ds_read_b128 v[36:39], v22 offset:1024
    ds_read_b64_tr_b16 v[64:65], v26 offset:160
    s_add_u32 m0, s26, 69632
    v_mfma_f32_16x16x32_bf16 a[20:23], v[84:87], v[52:55], a[20:23]
    ds_read_b128 v[40:43], v22 offset:2048
    ds_read_b128 v[44:47], v22 offset:3072
    ds_read_b64_tr_b16 v[66:67], v26 offset:2464
    buffer_load_dwordx4 v16, s[8:11], s27 offen lds
    v_mfma_f32_16x16x32_bf16 a[24:27], v[84:87], v[56:59], a[24:27]
    s_add_u32 m0, s26, 77824
    v_mfma_f32_16x16x32_bf16 a[28:31], v[84:87], v[60:63], a[28:31]
    buffer_load_dwordx4 v17, s[8:11], s27 offen lds
    s_waitcnt lgkmcnt(8)
    v_mfma_f32_16x16x32_bf16 a[32:35], v[88:91], v[48:51], a[32:35]
    ds_read_b64_tr_b16 v[68:69], v26 offset:192
    s_add_u32 m0, s44, 69632
    v_mfma_f32_16x16x32_bf16 a[36:39], v[88:91], v[52:55], a[36:39]
    ds_read_b64_tr_b16 v[70:71], v26 offset:2496
    buffer_load_dwordx4 v18, s[80:83], s28 offen lds
    v_mfma_f32_16x16x32_bf16 a[40:43], v[88:91], v[56:59], a[40:43]
    s_add_u32 m0, s45, 69632
    v_mfma_f32_16x16x32_bf16 a[44:47], v[88:91], v[60:63], a[44:47]
    buffer_load_dwordx4 v19, s[84:87], s28 offen lds
    s_waitcnt lgkmcnt(8)
    v_mfma_f32_16x16x32_bf16 a[48:51], v[92:95], v[48:51], a[48:51]
    ds_read_b64_tr_b16 v[72:73], v26 offset:224
    s_add_u32 s27, s27, 128
    s_add_u32 s28, s28, 73728
    v_mfma_f32_16x16x32_bf16 a[52:55], v[92:95], v[52:55], a[52:55]
    ds_read_b64_tr_b16 v[74:75], v26 offset:2528
    v_mfma_f32_16x16x32_bf16 a[56:59], v[92:95], v[56:59], a[56:59]
    v_mfma_f32_16x16x32_bf16 a[60:63], v[92:95], v[60:63], a[60:63]
    s_waitcnt lgkmcnt(4)
    v_mfma_f32_16x16x32_bf16 a[0:3], v[64:67], v[32:35], a[0:3]
    ds_read_b64_tr_b16 v[76:77], v26 offset:256
    v_mfma_f32_16x16x32_bf16 a[4:7], v[64:67], v[36:39], a[4:7]
    ds_read_b64_tr_b16 v[78:79], v26 offset:2560
    v_mfma_f32_16x16x32_bf16 a[8:11], v[64:67], v[40:43], a[8:11]
    v_mfma_f32_16x16x32_bf16 a[12:15], v[64:67], v[44:47], a[12:15]
    s_waitcnt vmcnt(4)
    s_barrier
    s_waitcnt lgkmcnt(4)
    v_mfma_f32_16x16x32_bf16 a[16:19], v[68:71], v[32:35], a[16:19]
    ds_read_b128 v[48:51], v23 offset:0
    ds_read_b128 v[52:55], v23 offset:1024
    ds_read_b64_tr_b16 v[80:81], v27 offset:160
    s_add_u32 m0, s26, 104448
    v_mfma_f32_16x16x32_bf16 a[20:23], v[68:71], v[36:39], a[20:23]
    ds_read_b128 v[56:59], v23 offset:2048
    ds_read_b128 v[60:63], v23 offset:3072
    ds_read_b64_tr_b16 v[82:83], v27 offset:2464
    buffer_load_dwordx4 v16, s[8:11], s27 offen lds
    v_mfma_f32_16x16x32_bf16 a[24:27], v[68:71], v[40:43], a[24:27]
    s_add_u32 m0, s26, 112640
    v_mfma_f32_16x16x32_bf16 a[28:31], v[68:71], v[44:47], a[28:31]
    buffer_load_dwordx4 v17, s[8:11], s27 offen lds
    s_waitcnt lgkmcnt(8)
    v_mfma_f32_16x16x32_bf16 a[32:35], v[72:75], v[32:35], a[32:35]
    ds_read_b64_tr_b16 v[84:85], v27 offset:192
    s_add_u32 m0, s44, 104448
    v_mfma_f32_16x16x32_bf16 a[36:39], v[72:75], v[36:39], a[36:39]
    ds_read_b64_tr_b16 v[86:87], v27 offset:2496
    buffer_load_dwordx4 v18, s[80:83], s28 offen lds
    v_mfma_f32_16x16x32_bf16 a[40:43], v[72:75], v[40:43], a[40:43]
    s_add_u32 m0, s45, 104448
    v_mfma_f32_16x16x32_bf16 a[44:47], v[72:75], v[44:47], a[44:47]
    buffer_load_dwordx4 v19, s[84:87], s28 offen lds
    s_waitcnt lgkmcnt(8)
    v_mfma_f32_16x16x32_bf16 a[48:51], v[76:79], v[32:35], a[48:51]
    ds_read_b64_tr_b16 v[88:89], v27 offset:224
    s_add_u32 s27, s27, 128
    s_add_u32 s28, s28, 73728
    v_mfma_f32_16x16x32_bf16 a[52:55], v[76:79], v[36:39], a[52:55]
    ds_read_b64_tr_b16 v[90:91], v27 offset:2528
    v_mfma_f32_16x16x32_bf16 a[56:59], v[76:79], v[40:43], a[56:59]
    v_mfma_f32_16x16x32_bf16 a[60:63], v[76:79], v[44:47], a[60:63]
    s_waitcnt lgkmcnt(4)
    v_mfma_f32_16x16x32_bf16 a[0:3], v[80:83], v[48:51], a[0:3]
    ds_read_b64_tr_b16 v[92:93], v27 offset:256
    v_mfma_f32_16x16x32_bf16 a[4:7], v[80:83], v[52:55], a[4:7]
    ds_read_b64_tr_b16 v[94:95], v27 offset:2560
    v_mfma_f32_16x16x32_bf16 a[8:11], v[80:83], v[56:59], a[8:11]
    v_mfma_f32_16x16x32_bf16 a[12:15], v[80:83], v[60:63], a[12:15]
    s_waitcnt vmcnt(4)
    s_barrier
    s_waitcnt lgkmcnt(4)
    v_mfma_f32_16x16x32_bf16 a[16:19], v[84:87], v[48:51], a[16:19]
    ds_read_b128 v[32:35], v24 offset:0
    ds_read_b128 v[36:39], v24 offset:1024
    ds_read_b64_tr_b16 v[64:65], v28 offset:160
    s_add_u32 m0, s26, 0
    v_mfma_f32_16x16x32_bf16 a[20:23], v[84:87], v[52:55], a[20:23]
    ds_read_b128 v[40:43], v24 offset:2048
    ds_read_b128 v[44:47], v24 offset:3072
    ds_read_b64_tr_b16 v[66:67], v28 offset:2464
    buffer_load_dwordx4 v16, s[8:11], s27 offen lds
    v_mfma_f32_16x16x32_bf16 a[24:27], v[84:87], v[56:59], a[24:27]
    s_add_u32 m0, s26, 8192
    v_mfma_f32_16x16x32_bf16 a[28:31], v[84:87], v[60:63], a[28:31]
    buffer_load_dwordx4 v17, s[8:11], s27 offen lds
    s_waitcnt lgkmcnt(8)
    v_mfma_f32_16x16x32_bf16 a[32:35], v[88:91], v[48:51], a[32:35]
    ds_read_b64_tr_b16 v[68:69], v28 offset:192
    s_add_u32 m0, s44, 0
    v_mfma_f32_16x16x32_bf16 a[36:39], v[88:91], v[52:55], a[36:39]
    ds_read_b64_tr_b16 v[70:71], v28 offset:2496
    buffer_load_dwordx4 v18, s[80:83], s28 offen lds
    v_mfma_f32_16x16x32_bf16 a[40:43], v[88:91], v[56:59], a[40:43]
    s_add_u32 m0, s45, 0
    v_mfma_f32_16x16x32_bf16 a[44:47], v[88:91], v[60:63], a[44:47]
    buffer_load_dwordx4 v19, s[84:87], s28 offen lds
    s_waitcnt lgkmcnt(8)
    v_mfma_f32_16x16x32_bf16 a[48:51], v[92:95], v[48:51], a[48:51]
    ds_read_b64_tr_b16 v[72:73], v28 offset:224
    s_add_u32 s27, s27, 128
    s_add_u32 s28, s28, 73728
    v_mfma_f32_16x16x32_bf16 a[52:55], v[92:95], v[52:55], a[52:55]
    ds_read_b64_tr_b16 v[74:75], v28 offset:2528
    v_mfma_f32_16x16x32_bf16 a[56:59], v[92:95], v[56:59], a[56:59]
    v_mfma_f32_16x16x32_bf16 a[60:63], v[92:95], v[60:63], a[60:63]
    s_waitcnt lgkmcnt(4)
    v_mfma_f32_16x16x32_bf16 a[0:3], v[64:67], v[32:35], a[0:3]
    ds_read_b64_tr_b16 v[76:77], v28 offset:256
    v_mfma_f32_16x16x32_bf16 a[4:7], v[64:67], v[36:39], a[4:7]
    ds_read_b64_tr_b16 v[78:79], v28 offset:2560
    v_mfma_f32_16x16x32_bf16 a[8:11], v[64:67], v[40:43], a[8:11]
    v_mfma_f32_16x16x32_bf16 a[12:15], v[64:67], v[44:47], a[12:15]
    s_waitcnt vmcnt(4)
    s_barrier
    s_waitcnt lgkmcnt(4)
    v_mfma_f32_16x16x32_bf16 a[16:19], v[68:71], v[32:35], a[16:19]
    ds_read_b128 v[48:51], v25 offset:0
    ds_read_b128 v[52:55], v25 offset:1024
    ds_read_b64_tr_b16 v[80:81], v29 offset:160
    s_add_u32 m0, s26, 34816
    v_mfma_f32_16x16x32_bf16 a[20:23], v[68:71], v[36:39], a[20:23]
    ds_read_b128 v[56:59], v25 offset:2048
    ds_read_b128 v[60:63], v25 offset:3072
    ds_read_b64_tr_b16 v[82:83], v29 offset:2464
    buffer_load_dwordx4 v16, s[8:11], s27 offen lds
    v_mfma_f32_16x16x32_bf16 a[24:27], v[68:71], v[40:43], a[24:27]
    s_add_u32 m0, s26, 43008
    v_mfma_f32_16x16x32_bf16 a[28:31], v[68:71], v[44:47], a[28:31]
    buffer_load_dwordx4 v17, s[8:11], s27 offen lds
    s_waitcnt lgkmcnt(8)
    v_mfma_f32_16x16x32_bf16 a[32:35], v[72:75], v[32:35], a[32:35]
    ds_read_b64_tr_b16 v[84:85], v29 offset:192
    s_add_u32 m0, s44, 34816
    v_mfma_f32_16x16x32_bf16 a[36:39], v[72:75], v[36:39], a[36:39]
    ds_read_b64_tr_b16 v[86:87], v29 offset:2496
    buffer_load_dwordx4 v18, s[80:83], s28 offen lds
    v_mfma_f32_16x16x32_bf16 a[40:43], v[72:75], v[40:43], a[40:43]
    s_add_u32 m0, s45, 34816
    v_mfma_f32_16x16x32_bf16 a[44:47], v[72:75], v[44:47], a[44:47]
    buffer_load_dwordx4 v19, s[84:87], s28 offen lds
    s_waitcnt lgkmcnt(8)
    v_mfma_f32_16x16x32_bf16 a[48:51], v[76:79], v[32:35], a[48:51]
    ds_read_b64_tr_b16 v[88:89], v29 offset:224
    s_add_u32 s27, s27, 128
    s_add_u32 s28, s28, 73728
    v_mfma_f32_16x16x32_bf16 a[52:55], v[76:79], v[36:39], a[52:55]
    ds_read_b64_tr_b16 v[90:91], v29 offset:2528
    v_mfma_f32_16x16x32_bf16 a[56:59], v[76:79], v[40:43], a[56:59]
    v_mfma_f32_16x16x32_bf16 a[60:63], v[76:79], v[44:47], a[60:63]
    s_waitcnt lgkmcnt(4)
    v_mfma_f32_16x16x32_bf16 a[0:3], v[80:83], v[48:51], a[0:3]
    ds_read_b64_tr_b16 v[92:93], v29 offset:256
    v_mfma_f32_16x16x32_bf16 a[4:7], v[80:83], v[52:55], a[4:7]
    ds_read_b64_tr_b16 v[94:95], v29 offset:2560
    v_mfma_f32_16x16x32_bf16 a[8:11], v[80:83], v[56:59], a[8:11]
    v_mfma_f32_16x16x32_bf16 a[12:15], v[80:83], v[60:63], a[12:15]
    s_waitcnt vmcnt(4)
    s_barrier
    s_waitcnt lgkmcnt(4)
    v_mfma_f32_16x16x32_bf16 a[16:19], v[84:87], v[48:51], a[16:19]
    ds_read_b128 v[32:35], v22 offset:0
    ds_read_b128 v[36:39], v22 offset:1024
    ds_read_b64_tr_b16 v[64:65], v26 offset:160
    s_add_u32 m0, s26, 69632
    v_mfma_f32_16x16x32_bf16 a[20:23], v[84:87], v[52:55], a[20:23]
    ds_read_b128 v[40:43], v22 offset:2048
    ds_read_b128 v[44:47], v22 offset:3072
    ds_read_b64_tr_b16 v[66:67], v26 offset:2464
    buffer_load_dwordx4 v16, s[8:11], s27 offen lds
    v_mfma_f32_16x16x32_bf16 a[24:27], v[84:87], v[56:59], a[24:27]
    s_add_u32 m0, s26, 77824
    v_mfma_f32_16x16x32_bf16 a[28:31], v[84:87], v[60:63], a[28:31]
    buffer_load_dwordx4 v17, s[8:11], s27 offen lds
    s_waitcnt lgkmcnt(8)
    v_mfma_f32_16x16x32_bf16 a[32:35], v[88:91], v[48:51], a[32:35]
    ds_read_b64_tr_b16 v[68:69], v26 offset:192
    s_add_u32 m0, s44, 69632
    v_mfma_f32_16x16x32_bf16 a[36:39], v[88:91], v[52:55], a[36:39]
    ds_read_b64_tr_b16 v[70:71], v26 offset:2496
    buffer_load_dwordx4 v18, s[80:83], s28 offen lds
    v_mfma_f32_16x16x32_bf16 a[40:43], v[88:91], v[56:59], a[40:43]
    s_add_u32 m0, s45, 69632
    v_mfma_f32_16x16x32_bf16 a[44:47], v[88:91], v[60:63], a[44:47]
    buffer_load_dwordx4 v19, s[84:87], s28 offen lds
    s_waitcnt lgkmcnt(8)
    v_mfma_f32_16x16x32_bf16 a[48:51], v[92:95], v[48:51], a[48:51]
    ds_read_b64_tr_b16 v[72:73], v26 offset:224
    s_add_u32 s27, s27, 128
    s_add_u32 s28, s28, 73728
    v_mfma_f32_16x16x32_bf16 a[52:55], v[92:95], v[52:55], a[52:55]
    ds_read_b64_tr_b16 v[74:75], v26 offset:2528
    v_mfma_f32_16x16x32_bf16 a[56:59], v[92:95], v[56:59], a[56:59]
    v_mfma_f32_16x16x32_bf16 a[60:63], v[92:95], v[60:63], a[60:63]
    s_waitcnt lgkmcnt(4)
    v_mfma_f32_16x16x32_bf16 a[0:3], v[64:67], v[32:35], a[0:3]
    ds_read_b64_tr_b16 v[76:77], v26 offset:256
    v_mfma_f32_16x16x32_bf16 a[4:7], v[64:67], v[36:39], a[4:7]
    ds_read_b64_tr_b16 v[78:79], v26 offset:2560
    v_mfma_f32_16x16x32_bf16 a[8:11], v[64:67], v[40:43], a[8:11]
    v_mfma_f32_16x16x32_bf16 a[12:15], v[64:67], v[44:47], a[12:15]
    s_waitcnt vmcnt(4)
    s_barrier
    s_waitcnt lgkmcnt(4)
    v_mfma_f32_16x16x32_bf16 a[16:19], v[68:71], v[32:35], a[16:19]
    ds_read_b128 v[48:51], v23 offset:0
    ds_read_b128 v[52:55], v23 offset:1024
    ds_read_b64_tr_b16 v[80:81], v27 offset:160
    s_add_u32 m0, s26, 104448
    v_mfma_f32_16x16x32_bf16 a[20:23], v[68:71], v[36:39], a[20:23]
    ds_read_b128 v[56:59], v23 offset:2048
    ds_read_b128 v[60:63], v23 offset:3072
    ds_read_b64_tr_b16 v[82:83], v27 offset:2464
    buffer_load_dwordx4 v16, s[8:11], s27 offen lds
    v_mfma_f32_16x16x32_bf16 a[24:27], v[68:71], v[40:43], a[24:27]
    s_add_u32 m0, s26, 112640
    v_mfma_f32_16x16x32_bf16 a[28:31], v[68:71], v[44:47], a[28:31]
    buffer_load_dwordx4 v17, s[8:11], s27 offen lds
    s_waitcnt lgkmcnt(8)
    v_mfma_f32_16x16x32_bf16 a[32:35], v[72:75], v[32:35], a[32:35]
    ds_read_b64_tr_b16 v[84:85], v27 offset:192
    s_add_u32 m0, s44, 104448
    v_mfma_f32_16x16x32_bf16 a[36:39], v[72:75], v[36:39], a[36:39]
    ds_read_b64_tr_b16 v[86:87], v27 offset:2496
    buffer_load_dwordx4 v18, s[80:83], s28 offen lds
    v_mfma_f32_16x16x32_bf16 a[40:43], v[72:75], v[40:43], a[40:43]
    s_add_u32 m0, s45, 104448
    v_mfma_f32_16x16x32_bf16 a[44:47], v[72:75], v[44:47], a[44:47]
    buffer_load_dwordx4 v19, s[84:87], s28 offen lds
    s_waitcnt lgkmcnt(8)
    v_mfma_f32_16x16x32_bf16 a[48:51], v[76:79], v[32:35], a[48:51]
    ds_read_b64_tr_b16 v[88:89], v27 offset:224
    s_add_u32 s27, s27, 128
    s_add_u32 s28, s28, 73728
    v_mfma_f32_16x16x32_bf16 a[52:55], v[76:79], v[36:39], a[52:55]
    ds_read_b64_tr_b16 v[90:91], v27 offset:2528
    v_mfma_f32_16x16x32_bf16 a[56:59], v[76:79], v[40:43], a[56:59]
    v_mfma_f32_16x16x32_bf16 a[60:63], v[76:79], v[44:47], a[60:63]
    s_waitcnt lgkmcnt(4)
    v_mfma_f32_16x16x32_bf16 a[0:3], v[80:83], v[48:51], a[0:3]
    ds_read_b64_tr_b16 v[92:93], v27 offset:256
    v_mfma_f32_16x16x32_bf16 a[4:7], v[80:83], v[52:55], a[4:7]
    ds_read_b64_tr_b16 v[94:95], v27 offset:2560
    v_mfma_f32_16x16x32_bf16 a[8:11], v[80:83], v[56:59], a[8:11]
    v_mfma_f32_16x16x32_bf16 a[12:15], v[80:83], v[60:63], a[12:15]
    s_waitcnt vmcnt(4)
    s_barrier
    s_waitcnt lgkmcnt(4)
    v_mfma_f32_16x16x32_bf16 a[16:19], v[84:87], v[48:51], a[16:19]
    ds_read_b128 v[32:35], v24 offset:0
    ds_read_b128 v[36:39], v24 offset:1024
    ds_read_b64_tr_b16 v[64:65], v28 offset:160
    v_mfma_f32_16x16x32_bf16 a[20:23], v[84:87], v[52:55], a[20:23]
    ds_read_b128 v[40:43], v24 offset:2048
    ds_read_b128 v[44:47], v24 offset:3072
    ds_read_b64_tr_b16 v[66:67], v28 offset:2464
    v_mfma_f32_16x16x32_bf16 a[24:27], v[84:87], v[56:59], a[24:27]
    v_mfma_f32_16x16x32_bf16 a[28:31], v[84:87], v[60:63], a[28:31]
    s_waitcnt lgkmcnt(8)
    v_mfma_f32_16x16x32_bf16 a[32:35], v[88:91], v[48:51], a[32:35]
    ds_read_b64_tr_b16 v[68:69], v28 offset:192
    v_mfma_f32_16x16x32_bf16 a[36:39], v[88:91], v[52:55], a[36:39]
    ds_read_b64_tr_b16 v[70:71], v28 offset:2496
    v_mfma_f32_16x16x32_bf16 a[40:43], v[88:91], v[56:59], a[40:43]
    v_mfma_f32_16x16x32_bf16 a[44:47], v[88:91], v[60:63], a[44:47]
    s_waitcnt lgkmcnt(8)
    v_mfma_f32_16x16x32_bf16 a[48:51], v[92:95], v[48:51], a[48:51]
    ds_read_b64_tr_b16 v[72:73], v28 offset:224
    v_mfma_f32_16x16x32_bf16 a[52:55], v[92:95], v[52:55], a[52:55]
    ds_read_b64_tr_b16 v[74:75], v28 offset:2528
    v_mfma_f32_16x16x32_bf16 a[56:59], v[92:95], v[56:59], a[56:59]
    v_mfma_f32_16x16x32_bf16 a[60:63], v[92:95], v[60:63], a[60:63]
    s_waitcnt lgkmcnt(4)
    v_mfma_f32_16x16x32_bf16 a[0:3], v[64:67], v[32:35], a[0:3]
    ds_read_b64_tr_b16 v[76:77], v28 offset:256
    v_mfma_f32_16x16x32_bf16 a[4:7], v[64:67], v[36:39], a[4:7]
    ds_read_b64_tr_b16 v[78:79], v28 offset:2560
    v_mfma_f32_16x16x32_bf16 a[8:11], v[64:67], v[40:43], a[8:11]
    v_mfma_f32_16x16x32_bf16 a[12:15], v[64:67], v[44:47], a[12:15]
    s_waitcnt vmcnt(0)
    s_barrier
    s_waitcnt lgkmcnt(4)
    v_mfma_f32_16x16x32_bf16 a[16:19], v[68:71], v[32:35], a[16:19]
    ds_read_b128 v[48:51], v25 offset:0
    ds_read_b128 v[52:55], v25 offset:1024
    ds_read_b64_tr_b16 v[80:81], v29 offset:160
    v_mfma_f32_16x16x32_bf16 a[20:23], v[68:71], v[36:39], a[20:23]
    ds_read_b128 v[56:59], v25 offset:2048
    ds_read_b128 v[60:63], v25 offset:3072
    ds_read_b64_tr_b16 v[82:83], v29 offset:2464
    v_mfma_f32_16x16x32_bf16 a[24:27], v[68:71], v[40:43], a[24:27]
    v_mfma_f32_16x16x32_bf16 a[28:31], v[68:71], v[44:47], a[28:31]
    s_waitcnt lgkmcnt(8)
    v_mfma_f32_16x16x32_bf16 a[32:35], v[72:75], v[32:35], a[32:35]
    ds_read_b64_tr_b16 v[84:85], v29 offset:192
    v_mfma_f32_16x16x32_bf16 a[36:39], v[72:75], v[36:39], a[36:39]
    ds_read_b64_tr_b16 v[86:87], v29 offset:2496
    v_mfma_f32_16x16x32_bf16 a[40:43], v[72:75], v[40:43], a[40:43]
    v_mfma_f32_16x16x32_bf16 a[44:47], v[72:75], v[44:47], a[44:47]
    s_waitcnt lgkmcnt(8)
    v_mfma_f32_16x16x32_bf16 a[48:51], v[76:79], v[32:35], a[48:51]
    ds_read_b64_tr_b16 v[88:89], v29 offset:224
    v_mfma_f32_16x16x32_bf16 a[52:55], v[76:79], v[36:39], a[52:55]
    ds_read_b64_tr_b16 v[90:91], v29 offset:2528
    v_mfma_f32_16x16x32_bf16 a[56:59], v[76:79], v[40:43], a[56:59]
    v_mfma_f32_16x16x32_bf16 a[60:63], v[76:79], v[44:47], a[60:63]
    s_waitcnt lgkmcnt(4)
    v_mfma_f32_16x16x32_bf16 a[0:3], v[80:83], v[48:51], a[0:3]
    ds_read_b64_tr_b16 v[92:93], v29 offset:256
    v_mfma_f32_16x16x32_bf16 a[4:7], v[80:83], v[52:55], a[4:7]
    ds_read_b64_tr_b16 v[94:95], v29 offset:2560
    v_mfma_f32_16x16x32_bf16 a[8:11], v[80:83], v[56:59], a[8:11]
    v_mfma_f32_16x16x32_bf16 a[12:15], v[80:83], v[60:63], a[12:15]
    s_waitcnt lgkmcnt(4)
    v_mfma_f32_16x16x32_bf16 a[16:19], v[84:87], v[48:51], a[16:19]
    v_mfma_f32_16x16x32_bf16 a[20:23], v[84:87], v[52:55], a[20:23]
    v_mfma_f32_16x16x32_bf16 a[24:27], v[84:87], v[56:59], a[24:27]
    v_mfma_f32_16x16x32_bf16 a[28:31], v[84:87], v[60:63], a[28:31]
    s_waitcnt lgkmcnt(2)
    v_mfma_f32_16x16x32_bf16 a[32:35], v[88:91], v[48:51], a[32:35]
    v_mfma_f32_16x16x32_bf16 a[36:39], v[88:91], v[52:55], a[36:39]
    v_mfma_f32_16x16x32_bf16 a[40:43], v[88:91], v[56:59], a[40:43]
    v_mfma_f32_16x16x32_bf16 a[44:47], v[88:91], v[60:63], a[44:47]
    s_waitcnt lgkmcnt(0)
    v_mfma_f32_16x16x32_bf16 a[48:51], v[92:95], v[48:51], a[48:51]
    v_mfma_f32_16x16x32_bf16 a[52:55], v[92:95], v[52:55], a[52:55]
    v_mfma_f32_16x16x32_bf16 a[56:59], v[92:95], v[56:59], a[56:59]
    v_mfma_f32_16x16x32_bf16 a[60:63], v[92:95], v[60:63], a[60:63]
    s_nop 15
    s_waitcnt vmcnt(0) lgkmcnt(0)
    s_add_u32 s40, s4, 32768
    s_addc_u32 s41, s5, 0
    s_mov_b32 s42, 16384
    s_mov_b32 s43, 0x00020000
    s_lshr_b32 s32, s25, 7
    s_lshl_b32 s32, s32, 8
    s_barrier
    v_lshlrev_b32 v8, 4, v2
    s_xor_b32 s30, s3, 2
    s_mul_i32 s30, s30, 10240
    s_mul_i32 s31, s3, 10240
    v_add_u32 v7, s30, v8
    v_add_u32 v8, s31, v8
    s_cmp_eq_u32 s22, 0
    s_cbranch_scc1 .wo_kernel_end_p1_w0
    ds_write_b128 v7, a[0:3] offset:0
    ds_write_b128 v7, a[16:19] offset:1024
    ds_write_b128 v7, a[32:35] offset:2048
    ds_write_b128 v7, a[48:51] offset:3072
    ds_write_b128 v7, a[4:7] offset:4096
    ds_write_b128 v7, a[20:23] offset:5120
    ds_write_b128 v7, a[36:39] offset:6144
    ds_write_b128 v7, a[52:55] offset:7168
    s_branch .wo_kernel_end_p1_w1
.wo_kernel_end_p1_w0:
    ds_write_b128 v7, a[8:11] offset:0
    ds_write_b128 v7, a[24:27] offset:1024
    ds_write_b128 v7, a[40:43] offset:2048
    ds_write_b128 v7, a[56:59] offset:3072
    ds_write_b128 v7, a[12:15] offset:4096
    ds_write_b128 v7, a[28:31] offset:5120
    ds_write_b128 v7, a[44:47] offset:6144
    ds_write_b128 v7, a[60:63] offset:7168
.wo_kernel_end_p1_w1:
    s_add_u32 s12, s4, 44040192
    s_addc_u32 s13, s5, 0
    s_mov_b32 s14, 9437184
    s_mov_b32 s15, 0x00020000
    s_lshl_b32 s30, s21, 6
    s_add_u32 s30, s30, s25
    s_lshl_b32 s31, s22, 5
    s_add_u32 s30, s30, s31
    s_lshl_b32 s31, s23, 11
    s_add_u32 s30, s30, s31
    v_add_u32 v12, s30, v3
    s_movk_i32 s31, 1152
    v_mul_lo_u32 v12, v12, s31
    s_mul_i32 s29, s24, 288
    v_add_u32 v12, s29, v12
    v_and_b32 v9, 1, v4
    v_lshrrev_b32 v10, 1, v4
    v_lshlrev_b32 v9, 5, v9
    v_lshl_add_u32 v9, v10, 4, v9
    v_add_u32 v9, v12, v9
    v_lshl_add_u32 v10, v4, 3, v12
    s_waitcnt lgkmcnt(0)
    s_barrier
    ds_read_b128 v[32:35], v8 offset:0
    ds_read_b128 v[36:39], v8 offset:1024
    ds_read_b128 v[40:43], v8 offset:2048
    ds_read_b128 v[44:47], v8 offset:3072
    ds_read_b128 v[48:51], v8 offset:4096
    ds_read_b128 v[52:55], v8 offset:5120
    ds_read_b128 v[56:59], v8 offset:6144
    ds_read_b128 v[60:63], v8 offset:7168
    s_cmp_eq_u32 s22, 0
    s_cbranch_scc1 .wo_kernel_end_p1_a0
    v_accvgpr_read_b32 v80, a8
    v_accvgpr_read_b32 v81, a9
    v_accvgpr_read_b32 v82, a10
    v_accvgpr_read_b32 v83, a11
    v_accvgpr_read_b32 v84, a24
    v_accvgpr_read_b32 v85, a25
    v_accvgpr_read_b32 v86, a26
    v_accvgpr_read_b32 v87, a27
    v_accvgpr_read_b32 v88, a40
    v_accvgpr_read_b32 v89, a41
    v_accvgpr_read_b32 v90, a42
    v_accvgpr_read_b32 v91, a43
    v_accvgpr_read_b32 v92, a56
    v_accvgpr_read_b32 v93, a57
    v_accvgpr_read_b32 v94, a58
    v_accvgpr_read_b32 v95, a59
    v_accvgpr_read_b32 v96, a12
    v_accvgpr_read_b32 v97, a13
    v_accvgpr_read_b32 v98, a14
    v_accvgpr_read_b32 v99, a15
    v_accvgpr_read_b32 v100, a28
    v_accvgpr_read_b32 v101, a29
    v_accvgpr_read_b32 v102, a30
    v_accvgpr_read_b32 v103, a31
    v_accvgpr_read_b32 v104, a44
    v_accvgpr_read_b32 v105, a45
    v_accvgpr_read_b32 v106, a46
    v_accvgpr_read_b32 v107, a47
    v_accvgpr_read_b32 v108, a60
    v_accvgpr_read_b32 v109, a61
    v_accvgpr_read_b32 v110, a62
    v_accvgpr_read_b32 v111, a63
    s_branch .wo_kernel_end_p1_a1
.wo_kernel_end_p1_a0:
    v_accvgpr_read_b32 v80, a0
    v_accvgpr_read_b32 v81, a1
    v_accvgpr_read_b32 v82, a2
    v_accvgpr_read_b32 v83, a3
    v_accvgpr_read_b32 v84, a16
    v_accvgpr_read_b32 v85, a17
    v_accvgpr_read_b32 v86, a18
    v_accvgpr_read_b32 v87, a19
    v_accvgpr_read_b32 v88, a32
    v_accvgpr_read_b32 v89, a33
    v_accvgpr_read_b32 v90, a34
    v_accvgpr_read_b32 v91, a35
    v_accvgpr_read_b32 v92, a48
    v_accvgpr_read_b32 v93, a49
    v_accvgpr_read_b32 v94, a50
    v_accvgpr_read_b32 v95, a51
    v_accvgpr_read_b32 v96, a4
    v_accvgpr_read_b32 v97, a5
    v_accvgpr_read_b32 v98, a6
    v_accvgpr_read_b32 v99, a7
    v_accvgpr_read_b32 v100, a20
    v_accvgpr_read_b32 v101, a21
    v_accvgpr_read_b32 v102, a22
    v_accvgpr_read_b32 v103, a23
    v_accvgpr_read_b32 v104, a36
    v_accvgpr_read_b32 v105, a37
    v_accvgpr_read_b32 v106, a38
    v_accvgpr_read_b32 v107, a39
    v_accvgpr_read_b32 v108, a52
    v_accvgpr_read_b32 v109, a53
    v_accvgpr_read_b32 v110, a54
    v_accvgpr_read_b32 v111, a55
.wo_kernel_end_p1_a1:
    s_mov_b32 s30, 0
    s_waitcnt lgkmcnt(7)
    v_add_f32 v32, v32, v80
    v_add_f32 v33, v33, v81
    v_add_f32 v34, v34, v82
    v_add_f32 v35, v35, v83
    v_cvt_pk_bf16_f32 v124, v32, v33
    v_cvt_pk_bf16_f32 v125, v34, v35
    s_waitcnt lgkmcnt(6)
    v_add_f32 v36, v36, v84
    v_add_f32 v37, v37, v85
    v_add_f32 v38, v38, v86
    v_add_f32 v39, v39, v87
    v_cvt_pk_bf16_f32 v126, v36, v37
    v_cvt_pk_bf16_f32 v127, v38, v39
    s_nop 1
    v_permlane16_swap_b32 v124, v126
    v_permlane16_swap_b32 v125, v127
    buffer_store_dwordx4 v[124:127], v9, s[12:15], s30 offen offset:160 sc1
    s_waitcnt lgkmcnt(5)
    v_add_f32 v40, v40, v88
    v_add_f32 v41, v41, v89
    v_add_f32 v42, v42, v90
    v_add_f32 v43, v43, v91
    v_cvt_pk_bf16_f32 v128, v40, v41
    v_cvt_pk_bf16_f32 v129, v42, v43
    s_waitcnt lgkmcnt(4)
    v_add_f32 v44, v44, v92
    v_add_f32 v45, v45, v93
    v_add_f32 v46, v46, v94
    v_add_f32 v47, v47, v95
    v_cvt_pk_bf16_f32 v130, v44, v45
    v_cvt_pk_bf16_f32 v131, v46, v47
    s_nop 1
    v_permlane16_swap_b32 v128, v130
    v_permlane16_swap_b32 v129, v131
    buffer_store_dwordx4 v[128:131], v9, s[12:15], s30 offen offset:224 sc1
    s_mov_b32 s30, 18432
    s_waitcnt lgkmcnt(3)
    v_add_f32 v48, v48, v96
    v_add_f32 v49, v49, v97
    v_add_f32 v50, v50, v98
    v_add_f32 v51, v51, v99
    v_cvt_pk_bf16_f32 v136, v48, v49
    v_cvt_pk_bf16_f32 v137, v50, v51
    s_waitcnt lgkmcnt(2)
    v_add_f32 v52, v52, v100
    v_add_f32 v53, v53, v101
    v_add_f32 v54, v54, v102
    v_add_f32 v55, v55, v103
    v_cvt_pk_bf16_f32 v138, v52, v53
    v_cvt_pk_bf16_f32 v139, v54, v55
    s_nop 1
    v_permlane16_swap_b32 v136, v138
    v_permlane16_swap_b32 v137, v139
    buffer_store_dwordx4 v[136:139], v9, s[12:15], s30 offen offset:160 sc1
    s_waitcnt lgkmcnt(1)
    v_add_f32 v56, v56, v104
    v_add_f32 v57, v57, v105
    v_add_f32 v58, v58, v106
    v_add_f32 v59, v59, v107
    v_cvt_pk_bf16_f32 v140, v56, v57
    v_cvt_pk_bf16_f32 v141, v58, v59
    s_waitcnt lgkmcnt(0)
    v_add_f32 v60, v60, v108
    v_add_f32 v61, v61, v109
    v_add_f32 v62, v62, v110
    v_add_f32 v63, v63, v111
    v_cvt_pk_bf16_f32 v142, v60, v61
    v_cvt_pk_bf16_f32 v143, v62, v63
    s_nop 1
    v_permlane16_swap_b32 v140, v142
    v_permlane16_swap_b32 v141, v143
    buffer_store_dwordx4 v[140:143], v9, s[12:15], s30 offen offset:224 sc1
    v_mov_b32 v1, 1
    v_mov_b32 v2, 0
    s_waitcnt vmcnt(0)
    s_barrier
    s_cmp_lg_u32 s3, 0
    s_cbranch_scc1 .wo_kernel_end_p1_x
    s_mov_b64 exec, 1
    buffer_atomic_add v1, v2, s[40:43], s32 offen sc1
.wo_kernel_end_p1_x:
    s_endpgm
.wo_kernel_end_row:
    s_cmp_ge_u32 s2, 512
    s_cbranch_scc1 .wo_kernel_end
    s_sub_u32 s36, s2, 256
    v_lshrrev_b32 v7, 6, v0
    s_nop 0
    v_readfirstlane_b32 s33, v7
    s_nop 3
    s_cmp_ge_u32 s33, 4
    s_cbranch_scc1 .wo_kernel_end
    s_load_dwordx2 s[4:5], s[0:1], 0
    s_load_dwordx2 s[6:7], s[0:1], 104
    s_load_dwordx2 s[28:29], s[0:1], 88
    s_load_dwordx2 s[34:35], s[0:1], 96
    v_lshrrev_b32 v1, 5, v0
    s_lshl_b32 s3, s36, 3
    v_add_u32 v1, s3, v1
    v_and_b32 v2, 31, v0
    s_movk_i32 s30, 1152
    v_mul_lo_u32 v3, v1, s30
    v_lshl_add_u32 v3, v2, 2, v3
    v_lshlrev_b32 v4, 3, v2
    s_waitcnt lgkmcnt(0)
    s_add_u32 s12, s6, 0
    s_addc_u32 s13, s7, 0
    s_mov_b32 s14, 13824
    s_mov_b32 s15, 0x00020000
    s_add_u32 s40, s6, 32768
    s_addc_u32 s41, s7, 0
    s_mov_b32 s42, 16384
    s_mov_b32 s43, 0x00020000
    s_mov_b32 s8, s4
    s_mov_b32 s9, s5
    s_mov_b32 s10, 2359296
    s_mov_b32 s11, 0x00020000
    s_add_u32 s16, s6, 4784128
    s_addc_u32 s17, s7, 0
    s_mov_b32 s18, 2359296
    s_mov_b32 s19, 0x00020000
    s_add_u32 s20, s6, 2424832
    s_addc_u32 s21, s7, 0
    s_mov_b32 s22, 2359296
    s_mov_b32 s23, 0x00020000
    s_add_u32 s24, s6, 44040192
    s_addc_u32 s25, s7, 0
    s_mov_b32 s26, 9437184
    s_mov_b32 s27, 0x00020000
    buffer_load_dword v8, v3, s[8:11], 0 offen offset:0
    buffer_load_dword v9, v3, s[8:11], 0 offen offset:128
    buffer_load_dword v10, v3, s[8:11], 0 offen offset:256
    buffer_load_dword v11, v3, s[8:11], 0 offen offset:384
    buffer_load_dword v12, v3, s[8:11], 0 offen offset:512
    buffer_load_dword v13, v3, s[8:11], 0 offen offset:640
    buffer_load_dword v14, v3, s[8:11], 0 offen offset:768
    buffer_load_dword v15, v3, s[8:11], 0 offen offset:896
    buffer_load_dword v16, v3, s[8:11], 0 offen offset:1024
    s_movk_i32 s31, 6912
    buffer_load_dwordx2 v[40:41], v4, s[12:15], s31 offen offset:0
    buffer_load_dwordx2 v[42:43], v4, s[12:15], s31 offen offset:256
    buffer_load_dwordx2 v[44:45], v4, s[12:15], s31 offen offset:512
    buffer_load_dwordx2 v[46:47], v4, s[12:15], s31 offen offset:768
    buffer_load_dwordx2 v[48:49], v4, s[12:15], s31 offen offset:1024
    buffer_load_dwordx2 v[50:51], v4, s[12:15], s31 offen offset:1280
    buffer_load_dwordx2 v[52:53], v4, s[12:15], s31 offen offset:1536
    buffer_load_dwordx2 v[54:55], v4, s[12:15], s31 offen offset:1792
    buffer_load_dwordx2 v[56:57], v4, s[12:15], s31 offen offset:2048
    s_movk_i32 s31, 9216
    buffer_load_dwordx2 v[60:61], v4, s[12:15], s31 offen offset:0
    buffer_load_dwordx2 v[62:63], v4, s[12:15], s31 offen offset:256
    buffer_load_dwordx2 v[64:65], v4, s[12:15], s31 offen offset:512
    buffer_load_dwordx2 v[66:67], v4, s[12:15], s31 offen offset:768
    buffer_load_dwordx2 v[68:69], v4, s[12:15], s31 offen offset:1024
    buffer_load_dwordx2 v[70:71], v4, s[12:15], s31 offen offset:1280
    buffer_load_dwordx2 v[72:73], v4, s[12:15], s31 offen offset:1536
    buffer_load_dwordx2 v[74:75], v4, s[12:15], s31 offen offset:1792
    buffer_load_dwordx2 v[76:77], v4, s[12:15], s31 offen offset:2048
    s_movk_i32 s31, 4608
    buffer_load_dwordx2 v[80:81], v4, s[12:15], s31 offen offset:0
    buffer_load_dwordx2 v[82:83], v4, s[12:15], s31 offen offset:256
    buffer_load_dwordx2 v[84:85], v4, s[12:15], s31 offen offset:512
    buffer_load_dwordx2 v[86:87], v4, s[12:15], s31 offen offset:768
    buffer_load_dwordx2 v[88:89], v4, s[12:15], s31 offen offset:1024
    buffer_load_dwordx2 v[90:91], v4, s[12:15], s31 offen offset:1280
    buffer_load_dwordx2 v[92:93], v4, s[12:15], s31 offen offset:1536
    buffer_load_dwordx2 v[94:95], v4, s[12:15], s31 offen offset:1792
    buffer_load_dwordx2 v[96:97], v4, s[12:15], s31 offen offset:2048
    s_lshr_b32 s32, s36, 4
    s_lshl_b32 s32, s32, 8
    v_lshrrev_b32 v7, 6, v0
    s_nop 0
    v_readfirstlane_b32 s33, v7
    s_nop 3
    s_cmp_lg_u32 s33, 0
    s_cbranch_scc1 .poll_ln2_done
    v_mov_b32 v7, 0
.poll_ln2:
    buffer_load_dword v6, v7, s[40:43], s32 offen sc1
    s_waitcnt vmcnt(0)
    v_readfirstlane_b32 s33, v6
    s_nop 3
    s_cmp_ge_u32 s33, 16
    s_cbranch_scc1 .poll_ln2_done
    s_sleep 2
    s_branch .poll_ln2
.poll_ln2_done:
    s_barrier
    s_mov_b32 s31, 0
    buffer_load_dword v136, v3, s[24:27], s31 offen offset:0 sc1
    buffer_load_dword v137, v3, s[24:27], s31 offen offset:128 sc1
    buffer_load_dword v138, v3, s[24:27], s31 offen offset:256 sc1
    buffer_load_dword v139, v3, s[24:27], s31 offen offset:384 sc1
    buffer_load_dword v140, v3, s[24:27], s31 offen offset:512 sc1
    buffer_load_dword v141, v3, s[24:27], s31 offen offset:640 sc1
    buffer_load_dword v142, v3, s[24:27], s31 offen offset:768 sc1
    buffer_load_dword v143, v3, s[24:27], s31 offen offset:896 sc1
    buffer_load_dword v144, v3, s[24:27], s31 offen offset:1024 sc1
    s_mov_b32 s31, 2359296
    buffer_load_dword v145, v3, s[24:27], s31 offen offset:0 sc1
    buffer_load_dword v146, v3, s[24:27], s31 offen offset:128 sc1
    buffer_load_dword v147, v3, s[24:27], s31 offen offset:256 sc1
    buffer_load_dword v148, v3, s[24:27], s31 offen offset:384 sc1
    buffer_load_dword v149, v3, s[24:27], s31 offen offset:512 sc1
    buffer_load_dword v150, v3, s[24:27], s31 offen offset:640 sc1
    buffer_load_dword v151, v3, s[24:27], s31 offen offset:768 sc1
    buffer_load_dword v152, v3, s[24:27], s31 offen offset:896 sc1
    buffer_load_dword v153, v3, s[24:27], s31 offen offset:1024 sc1
    s_mov_b32 s31, 4718592
    buffer_load_dword v154, v3, s[24:27], s31 offen offset:0 sc1
    buffer_load_dword v155, v3, s[24:27], s31 offen offset:128 sc1
    buffer_load_dword v156, v3, s[24:27], s31 offen offset:256 sc1
    buffer_load_dword v157, v3, s[24:27], s31 offen offset:384 sc1
    buffer_load_dword v158, v3, s[24:27], s31 offen offset:512 sc1
    buffer_load_dword v159, v3, s[24:27], s31 offen offset:640 sc1
    buffer_load_dword v160, v3, s[24:27], s31 offen offset:768 sc1
    buffer_load_dword v161, v3, s[24:27], s31 offen offset:896 sc1
    buffer_load_dword v162, v3, s[24:27], s31 offen offset:1024 sc1
    s_mov_b32 s31, 7077888
    buffer_load_dword v163, v3, s[24:27], s31 offen offset:0 sc1
    buffer_load_dword v164, v3, s[24:27], s31 offen offset:128 sc1
    buffer_load_dword v165, v3, s[24:27], s31 offen offset:256 sc1
    buffer_load_dword v166, v3, s[24:27], s31 offen offset:384 sc1
    buffer_load_dword v167, v3, s[24:27], s31 offen offset:512 sc1
    buffer_load_dword v168, v3, s[24:27], s31 offen offset:640 sc1
    buffer_load_dword v169, v3, s[24:27], s31 offen offset:768 sc1
    buffer_load_dword v170, v3, s[24:27], s31 offen offset:896 sc1
    buffer_load_dword v171, v3, s[24:27], s31 offen offset:1024 sc1
    s_waitcnt vmcnt(0)
    v_lshlrev_b32 v20, 16, v8
    v_and_b32 v21, 0xffff0000, v8
    v_lshlrev_b32 v22, 16, v9
    v_and_b32 v23, 0xffff0000, v9
    v_lshlrev_b32 v24, 16, v10
    v_and_b32 v25, 0xffff0000, v10
    v_lshlrev_b32 v26, 16, v11
    v_and_b32 v27, 0xffff0000, v11
    v_lshlrev_b32 v28, 16, v12
    v_and_b32 v29, 0xffff0000, v12
    v_lshlrev_b32 v30, 16, v13
    v_and_b32 v31, 0xffff0000, v13
    v_lshlrev_b32 v32, 16, v14
    v_and_b32 v33, 0xffff0000, v14
    v_lshlrev_b32 v34, 16, v15
    v_and_b32 v35, 0xffff0000, v15
    v_lshlrev_b32 v36, 16, v16
    v_and_b32 v37, 0xffff0000, v16
    v_lshlrev_b32 v100, 16, v136
    v_and_b32 v101, 0xffff0000, v136
    v_lshlrev_b32 v6, 16, v145
    v_and_b32 v7, 0xffff0000, v145
    v_add_f32 v100, v100, v6
    v_add_f32 v101, v101, v7
    v_lshlrev_b32 v6, 16, v154
    v_and_b32 v7, 0xffff0000, v154
    v_add_f32 v100, v100, v6
    v_add_f32 v101, v101, v7
    v_lshlrev_b32 v6, 16, v163
    v_and_b32 v7, 0xffff0000, v163
    v_add_f32 v100, v100, v6
    v_add_f32 v101, v101, v7
    v_lshlrev_b32 v102, 16, v137
    v_and_b32 v103, 0xffff0000, v137
    v_lshlrev_b32 v6, 16, v146
    v_and_b32 v7, 0xffff0000, v146
    v_add_f32 v102, v102, v6
    v_add_f32 v103, v103, v7
    v_lshlrev_b32 v6, 16, v155
    v_and_b32 v7, 0xffff0000, v155
    v_add_f32 v102, v102, v6
    v_add_f32 v103, v103, v7
    v_lshlrev_b32 v6, 16, v164
    v_and_b32 v7, 0xffff0000, v164
    v_add_f32 v102, v102, v6
    v_add_f32 v103, v103, v7
    v_lshlrev_b32 v104, 16, v138
    v_and_b32 v105, 0xffff0000, v138
    v_lshlrev_b32 v6, 16, v147
    v_and_b32 v7, 0xffff0000, v147
    v_add_f32 v104, v104, v6
    v_add_f32 v105, v105, v7
    v_lshlrev_b32 v6, 16, v156
    v_and_b32 v7, 0xffff0000, v156
    v_add_f32 v104, v104, v6
    v_add_f32 v105, v105, v7
    v_lshlrev_b32 v6, 16, v165
    v_and_b32 v7, 0xffff0000, v165
    v_add_f32 v104, v104, v6
    v_add_f32 v105, v105, v7
    v_lshlrev_b32 v106, 16, v139
    v_and_b32 v107, 0xffff0000, v139
    v_lshlrev_b32 v6, 16, v148
    v_and_b32 v7, 0xffff0000, v148
    v_add_f32 v106, v106, v6
    v_add_f32 v107, v107, v7
    v_lshlrev_b32 v6, 16, v157
    v_and_b32 v7, 0xffff0000, v157
    v_add_f32 v106, v106, v6
    v_add_f32 v107, v107, v7
    v_lshlrev_b32 v6, 16, v166
    v_and_b32 v7, 0xffff0000, v166
    v_add_f32 v106, v106, v6
    v_add_f32 v107, v107, v7
    v_lshlrev_b32 v108, 16, v140
    v_and_b32 v109, 0xffff0000, v140
    v_lshlrev_b32 v6, 16, v149
    v_and_b32 v7, 0xffff0000, v149
    v_add_f32 v108, v108, v6
    v_add_f32 v109, v109, v7
    v_lshlrev_b32 v6, 16, v158
    v_and_b32 v7, 0xffff0000, v158
    v_add_f32 v108, v108, v6
    v_add_f32 v109, v109, v7
    v_lshlrev_b32 v6, 16, v167
    v_and_b32 v7, 0xffff0000, v167
    v_add_f32 v108, v108, v6
    v_add_f32 v109, v109, v7
    v_lshlrev_b32 v110, 16, v141
    v_and_b32 v111, 0xffff0000, v141
    v_lshlrev_b32 v6, 16, v150
    v_and_b32 v7, 0xffff0000, v150
    v_add_f32 v110, v110, v6
    v_add_f32 v111, v111, v7
    v_lshlrev_b32 v6, 16, v159
    v_and_b32 v7, 0xffff0000, v159
    v_add_f32 v110, v110, v6
    v_add_f32 v111, v111, v7
    v_lshlrev_b32 v6, 16, v168
    v_and_b32 v7, 0xffff0000, v168
    v_add_f32 v110, v110, v6
    v_add_f32 v111, v111, v7
    v_lshlrev_b32 v112, 16, v142
    v_and_b32 v113, 0xffff0000, v142
    v_lshlrev_b32 v6, 16, v151
    v_and_b32 v7, 0xffff0000, v151
    v_add_f32 v112, v112, v6
    v_add_f32 v113, v113, v7
    v_lshlrev_b32 v6, 16, v160
    v_and_b32 v7, 0xffff0000, v160
    v_add_f32 v112, v112, v6
    v_add_f32 v113, v113, v7
    v_lshlrev_b32 v6, 16, v169
    v_and_b32 v7, 0xffff0000, v169
    v_add_f32 v112, v112, v6
    v_add_f32 v113, v113, v7
    v_lshlrev_b32 v114, 16, v143
    v_and_b32 v115, 0xffff0000, v143
    v_lshlrev_b32 v6, 16, v152
    v_and_b32 v7, 0xffff0000, v152
    v_add_f32 v114, v114, v6
    v_add_f32 v115, v115, v7
    v_lshlrev_b32 v6, 16, v161
    v_and_b32 v7, 0xffff0000, v161
    v_add_f32 v114, v114, v6
    v_add_f32 v115, v115, v7
    v_lshlrev_b32 v6, 16, v170
    v_and_b32 v7, 0xffff0000, v170
    v_add_f32 v114, v114, v6
    v_add_f32 v115, v115, v7
    v_lshlrev_b32 v116, 16, v144
    v_and_b32 v117, 0xffff0000, v144
    v_lshlrev_b32 v6, 16, v153
    v_and_b32 v7, 0xffff0000, v153
    v_add_f32 v116, v116, v6
    v_add_f32 v117, v117, v7
    v_lshlrev_b32 v6, 16, v162
    v_and_b32 v7, 0xffff0000, v162
    v_add_f32 v116, v116, v6
    v_add_f32 v117, v117, v7
    v_lshlrev_b32 v6, 16, v171
    v_and_b32 v7, 0xffff0000, v171
    v_add_f32 v116, v116, v6
    v_add_f32 v117, v117, v7
    v_cvt_pk_bf16_f32 v6, v100, v101
    v_lshlrev_b32 v100, 16, v6
    v_and_b32 v101, 0xffff0000, v6
    v_mul_f32 v100, v80, v100
    v_mul_f32 v101, v81, v101
    v_cvt_pk_bf16_f32 v6, v100, v101
    v_lshlrev_b32 v100, 16, v6
    v_and_b32 v101, 0xffff0000, v6
    v_add_f32 v20, v20, v100
    v_add_f32 v21, v21, v101
    v_cvt_pk_bf16_f32 v8, v20, v21
    v_lshlrev_b32 v20, 16, v8
    v_and_b32 v21, 0xffff0000, v8
    v_cvt_pk_bf16_f32 v6, v102, v103
    v_lshlrev_b32 v102, 16, v6
    v_and_b32 v103, 0xffff0000, v6
    v_mul_f32 v102, v82, v102
    v_mul_f32 v103, v83, v103
    v_cvt_pk_bf16_f32 v6, v102, v103
    v_lshlrev_b32 v102, 16, v6
    v_and_b32 v103, 0xffff0000, v6
    v_add_f32 v22, v22, v102
    v_add_f32 v23, v23, v103
    v_cvt_pk_bf16_f32 v9, v22, v23
    v_lshlrev_b32 v22, 16, v9
    v_and_b32 v23, 0xffff0000, v9
    v_cvt_pk_bf16_f32 v6, v104, v105
    v_lshlrev_b32 v104, 16, v6
    v_and_b32 v105, 0xffff0000, v6
    v_mul_f32 v104, v84, v104
    v_mul_f32 v105, v85, v105
    v_cvt_pk_bf16_f32 v6, v104, v105
    v_lshlrev_b32 v104, 16, v6
    v_and_b32 v105, 0xffff0000, v6
    v_add_f32 v24, v24, v104
    v_add_f32 v25, v25, v105
    v_cvt_pk_bf16_f32 v10, v24, v25
    v_lshlrev_b32 v24, 16, v10
    v_and_b32 v25, 0xffff0000, v10
    v_cvt_pk_bf16_f32 v6, v106, v107
    v_lshlrev_b32 v106, 16, v6
    v_and_b32 v107, 0xffff0000, v6
    v_mul_f32 v106, v86, v106
    v_mul_f32 v107, v87, v107
    v_cvt_pk_bf16_f32 v6, v106, v107
    v_lshlrev_b32 v106, 16, v6
    v_and_b32 v107, 0xffff0000, v6
    v_add_f32 v26, v26, v106
    v_add_f32 v27, v27, v107
    v_cvt_pk_bf16_f32 v11, v26, v27
    v_lshlrev_b32 v26, 16, v11
    v_and_b32 v27, 0xffff0000, v11
    v_cvt_pk_bf16_f32 v6, v108, v109
    v_lshlrev_b32 v108, 16, v6
    v_and_b32 v109, 0xffff0000, v6
    v_mul_f32 v108, v88, v108
    v_mul_f32 v109, v89, v109
    v_cvt_pk_bf16_f32 v6, v108, v109
    v_lshlrev_b32 v108, 16, v6
    v_and_b32 v109, 0xffff0000, v6
    v_add_f32 v28, v28, v108
    v_add_f32 v29, v29, v109
    v_cvt_pk_bf16_f32 v12, v28, v29
    v_lshlrev_b32 v28, 16, v12
    v_and_b32 v29, 0xffff0000, v12
    v_cvt_pk_bf16_f32 v6, v110, v111
    v_lshlrev_b32 v110, 16, v6
    v_and_b32 v111, 0xffff0000, v6
    v_mul_f32 v110, v90, v110
    v_mul_f32 v111, v91, v111
    v_cvt_pk_bf16_f32 v6, v110, v111
    v_lshlrev_b32 v110, 16, v6
    v_and_b32 v111, 0xffff0000, v6
    v_add_f32 v30, v30, v110
    v_add_f32 v31, v31, v111
    v_cvt_pk_bf16_f32 v13, v30, v31
    v_lshlrev_b32 v30, 16, v13
    v_and_b32 v31, 0xffff0000, v13
    v_cvt_pk_bf16_f32 v6, v112, v113
    v_lshlrev_b32 v112, 16, v6
    v_and_b32 v113, 0xffff0000, v6
    v_mul_f32 v112, v92, v112
    v_mul_f32 v113, v93, v113
    v_cvt_pk_bf16_f32 v6, v112, v113
    v_lshlrev_b32 v112, 16, v6
    v_and_b32 v113, 0xffff0000, v6
    v_add_f32 v32, v32, v112
    v_add_f32 v33, v33, v113
    v_cvt_pk_bf16_f32 v14, v32, v33
    v_lshlrev_b32 v32, 16, v14
    v_and_b32 v33, 0xffff0000, v14
    v_cvt_pk_bf16_f32 v6, v114, v115
    v_lshlrev_b32 v114, 16, v6
    v_and_b32 v115, 0xffff0000, v6
    v_mul_f32 v114, v94, v114
    v_mul_f32 v115, v95, v115
    v_cvt_pk_bf16_f32 v6, v114, v115
    v_lshlrev_b32 v114, 16, v6
    v_and_b32 v115, 0xffff0000, v6
    v_add_f32 v34, v34, v114
    v_add_f32 v35, v35, v115
    v_cvt_pk_bf16_f32 v15, v34, v35
    v_lshlrev_b32 v34, 16, v15
    v_and_b32 v35, 0xffff0000, v15
    v_cvt_pk_bf16_f32 v6, v116, v117
    v_lshlrev_b32 v116, 16, v6
    v_and_b32 v117, 0xffff0000, v6
    v_mul_f32 v116, v96, v116
    v_mul_f32 v117, v97, v117
    v_cvt_pk_bf16_f32 v6, v116, v117
    v_lshlrev_b32 v116, 16, v6
    v_and_b32 v117, 0xffff0000, v6
    v_add_f32 v36, v36, v116
    v_add_f32 v37, v37, v117
    v_cvt_pk_bf16_f32 v16, v36, v37
    v_lshlrev_b32 v36, 16, v16
    v_and_b32 v37, 0xffff0000, v16
    buffer_store_dword v8, v3, s[20:23], 0 offen offset:0
    buffer_store_dword v9, v3, s[20:23], 0 offen offset:128
    buffer_store_dword v10, v3, s[20:23], 0 offen offset:256
    buffer_store_dword v11, v3, s[20:23], 0 offen offset:384
    buffer_store_dword v12, v3, s[20:23], 0 offen offset:512
    buffer_store_dword v13, v3, s[20:23], 0 offen offset:640
    buffer_store_dword v14, v3, s[20:23], 0 offen offset:768
    buffer_store_dword v15, v3, s[20:23], 0 offen offset:896
    buffer_store_dword v16, v3, s[20:23], 0 offen offset:1024
    v_add_f32 v6, v20, v21
    v_add_f32 v6, v6, v22
    v_add_f32 v6, v6, v23
    v_add_f32 v6, v6, v24
    v_add_f32 v6, v6, v25
    v_add_f32 v6, v6, v26
    v_add_f32 v6, v6, v27
    v_add_f32 v6, v6, v28
    v_add_f32 v6, v6, v29
    v_add_f32 v6, v6, v30
    v_add_f32 v6, v6, v31
    v_add_f32 v6, v6, v32
    v_add_f32 v6, v6, v33
    v_add_f32 v6, v6, v34
    v_add_f32 v6, v6, v35
    v_add_f32 v6, v6, v36
    v_add_f32 v6, v6, v37
    s_nop 1
    v_add_f32_dpp v6, v6, v6 quad_perm:[1,0,3,2] row_mask:0xf bank_mask:0xf
    s_nop 1
    v_add_f32_dpp v6, v6, v6 quad_perm:[2,3,0,1] row_mask:0xf bank_mask:0xf
    s_nop 1
    v_add_f32_dpp v6, v6, v6 row_half_mirror row_mask:0xf bank_mask:0xf
    s_nop 1
    v_add_f32_dpp v6, v6, v6 row_mirror row_mask:0xf bank_mask:0xf
    v_mov_b32 v7, v6
    s_nop 1
    v_permlane16_swap_b32 v7, v6
    s_nop 0
    v_add_f32 v6, v6, v7
    s_mov_b32 s30, 0x3ae38e39
    v_mul_f32 v6, s30, v6
    v_sub_f32 v7, v20, v6
    v_mul_f32 v18, v7, v7
    v_sub_f32 v7, v21, v6
    v_fmac_f32 v18, v7, v7
    v_sub_f32 v7, v22, v6
    v_fmac_f32 v18, v7, v7
    v_sub_f32 v7, v23, v6
    v_fmac_f32 v18, v7, v7
    v_sub_f32 v7, v24, v6
    v_fmac_f32 v18, v7, v7
    v_sub_f32 v7, v25, v6
    v_fmac_f32 v18, v7, v7
    v_sub_f32 v7, v26, v6
    v_fmac_f32 v18, v7, v7
    v_sub_f32 v7, v27, v6
    v_fmac_f32 v18, v7, v7
    v_sub_f32 v7, v28, v6
    v_fmac_f32 v18, v7, v7
    v_sub_f32 v7, v29, v6
    v_fmac_f32 v18, v7, v7
    v_sub_f32 v7, v30, v6
    v_fmac_f32 v18, v7, v7
    v_sub_f32 v7, v31, v6
    v_fmac_f32 v18, v7, v7
    v_sub_f32 v7, v32, v6
    v_fmac_f32 v18, v7, v7
    v_sub_f32 v7, v33, v6
    v_fmac_f32 v18, v7, v7
    v_sub_f32 v7, v34, v6
    v_fmac_f32 v18, v7, v7
    v_sub_f32 v7, v35, v6
    v_fmac_f32 v18, v7, v7
    v_sub_f32 v7, v36, v6
    v_fmac_f32 v18, v7, v7
    v_sub_f32 v7, v37, v6
    v_fmac_f32 v18, v7, v7
    s_nop 1
    v_add_f32_dpp v18, v18, v18 quad_perm:[1,0,3,2] row_mask:0xf bank_mask:0xf
    s_nop 1
    v_add_f32_dpp v18, v18, v18 quad_perm:[2,3,0,1] row_mask:0xf bank_mask:0xf
    s_nop 1
    v_add_f32_dpp v18, v18, v18 row_half_mirror row_mask:0xf bank_mask:0xf
    s_nop 1
    v_add_f32_dpp v18, v18, v18 row_mirror row_mask:0xf bank_mask:0xf
    v_mov_b32 v7, v18
    s_nop 1
    v_permlane16_swap_b32 v7, v18
    s_nop 0
    v_add_f32 v18, v18, v7
    v_mul_f32 v18, s30, v18
    v_cvt_pk_bf16_f32 v7, v6, v18
    v_lshlrev_b32 v6, 16, v7
    v_and_b32 v18, 0xffff0000, v7
    s_mov_b32 s30, 0x3727c5ac
    v_add_f32 v18, s30, v18
    v_cvt_pk_bf16_f32 v7, v18, v18
    v_lshlrev_b32 v18, 16, v7
    v_sqrt_f32 v18, v18
    s_nop 0
    v_cvt_pk_bf16_f32 v7, v18, v18
    v_lshlrev_b32 v18, 16, v7
    v_rcp_f32 v18, v18
    s_nop 0
    v_sub_f32 v20, v20, v6
    v_sub_f32 v21, v21, v6
    v_cvt_pk_bf16_f32 v7, v20, v21
    v_lshlrev_b32 v20, 16, v7
    v_and_b32 v21, 0xffff0000, v7
    v_mul_f32 v20, v20, v18
    v_mul_f32 v21, v21, v18
    v_cvt_pk_bf16_f32 v7, v20, v21
    v_lshlrev_b32 v20, 16, v7
    v_and_b32 v21, 0xffff0000, v7
    v_add_f32 v60, 1.0, v60
    v_add_f32 v61, 1.0, v61
    v_cvt_pk_bf16_f32 v7, v60, v61
    v_lshlrev_b32 v60, 16, v7
    v_and_b32 v61, 0xffff0000, v7
    v_mul_f32 v20, v20, v60
    v_mul_f32 v21, v21, v61
    v_cvt_pk_bf16_f32 v7, v20, v21
    v_lshlrev_b32 v20, 16, v7
    v_and_b32 v21, 0xffff0000, v7
    v_add_f32 v20, v20, v40
    v_add_f32 v21, v21, v41
    v_cvt_pk_bf16_f32 v100, v20, v21
    v_sub_f32 v22, v22, v6
    v_sub_f32 v23, v23, v6
    v_cvt_pk_bf16_f32 v7, v22, v23
    v_lshlrev_b32 v22, 16, v7
    v_and_b32 v23, 0xffff0000, v7
    v_mul_f32 v22, v22, v18
    v_mul_f32 v23, v23, v18
    v_cvt_pk_bf16_f32 v7, v22, v23
    v_lshlrev_b32 v22, 16, v7
    v_and_b32 v23, 0xffff0000, v7
    v_add_f32 v62, 1.0, v62
    v_add_f32 v63, 1.0, v63
    v_cvt_pk_bf16_f32 v7, v62, v63
    v_lshlrev_b32 v62, 16, v7
    v_and_b32 v63, 0xffff0000, v7
    v_mul_f32 v22, v22, v62
    v_mul_f32 v23, v23, v63
    v_cvt_pk_bf16_f32 v7, v22, v23
    v_lshlrev_b32 v22, 16, v7
    v_and_b32 v23, 0xffff0000, v7
    v_add_f32 v22, v22, v42
    v_add_f32 v23, v23, v43
    v_cvt_pk_bf16_f32 v101, v22, v23
    v_sub_f32 v24, v24, v6
    v_sub_f32 v25, v25, v6
    v_cvt_pk_bf16_f32 v7, v24, v25
    v_lshlrev_b32 v24, 16, v7
    v_and_b32 v25, 0xffff0000, v7
    v_mul_f32 v24, v24, v18
    v_mul_f32 v25, v25, v18
    v_cvt_pk_bf16_f32 v7, v24, v25
    v_lshlrev_b32 v24, 16, v7
    v_and_b32 v25, 0xffff0000, v7
    v_add_f32 v64, 1.0, v64
    v_add_f32 v65, 1.0, v65
    v_cvt_pk_bf16_f32 v7, v64, v65
    v_lshlrev_b32 v64, 16, v7
    v_and_b32 v65, 0xffff0000, v7
    v_mul_f32 v24, v24, v64
    v_mul_f32 v25, v25, v65
    v_cvt_pk_bf16_f32 v7, v24, v25
    v_lshlrev_b32 v24, 16, v7
    v_and_b32 v25, 0xffff0000, v7
    v_add_f32 v24, v24, v44
    v_add_f32 v25, v25, v45
    v_cvt_pk_bf16_f32 v102, v24, v25
    v_sub_f32 v26, v26, v6
    v_sub_f32 v27, v27, v6
    v_cvt_pk_bf16_f32 v7, v26, v27
    v_lshlrev_b32 v26, 16, v7
    v_and_b32 v27, 0xffff0000, v7
    v_mul_f32 v26, v26, v18
    v_mul_f32 v27, v27, v18
    v_cvt_pk_bf16_f32 v7, v26, v27
    v_lshlrev_b32 v26, 16, v7
    v_and_b32 v27, 0xffff0000, v7
    v_add_f32 v66, 1.0, v66
    v_add_f32 v67, 1.0, v67
    v_cvt_pk_bf16_f32 v7, v66, v67
    v_lshlrev_b32 v66, 16, v7
    v_and_b32 v67, 0xffff0000, v7
    v_mul_f32 v26, v26, v66
    v_mul_f32 v27, v27, v67
    v_cvt_pk_bf16_f32 v7, v26, v27
    v_lshlrev_b32 v26, 16, v7
    v_and_b32 v27, 0xffff0000, v7
    v_add_f32 v26, v26, v46
    v_add_f32 v27, v27, v47
    v_cvt_pk_bf16_f32 v103, v26, v27
    v_sub_f32 v28, v28, v6
    v_sub_f32 v29, v29, v6
    v_cvt_pk_bf16_f32 v7, v28, v29
    v_lshlrev_b32 v28, 16, v7
    v_and_b32 v29, 0xffff0000, v7
    v_mul_f32 v28, v28, v18
    v_mul_f32 v29, v29, v18
    v_cvt_pk_bf16_f32 v7, v28, v29
    v_lshlrev_b32 v28, 16, v7
    v_and_b32 v29, 0xffff0000, v7
    v_add_f32 v68, 1.0, v68
    v_add_f32 v69, 1.0, v69
    v_cvt_pk_bf16_f32 v7, v68, v69
    v_lshlrev_b32 v68, 16, v7
    v_and_b32 v69, 0xffff0000, v7
    v_mul_f32 v28, v28, v68
    v_mul_f32 v29, v29, v69
    v_cvt_pk_bf16_f32 v7, v28, v29
    v_lshlrev_b32 v28, 16, v7
    v_and_b32 v29, 0xffff0000, v7
    v_add_f32 v28, v28, v48
    v_add_f32 v29, v29, v49
    v_cvt_pk_bf16_f32 v104, v28, v29
    v_sub_f32 v30, v30, v6
    v_sub_f32 v31, v31, v6
    v_cvt_pk_bf16_f32 v7, v30, v31
    v_lshlrev_b32 v30, 16, v7
    v_and_b32 v31, 0xffff0000, v7
    v_mul_f32 v30, v30, v18
    v_mul_f32 v31, v31, v18
    v_cvt_pk_bf16_f32 v7, v30, v31
    v_lshlrev_b32 v30, 16, v7
    v_and_b32 v31, 0xffff0000, v7
    v_add_f32 v70, 1.0, v70
    v_add_f32 v71, 1.0, v71
    v_cvt_pk_bf16_f32 v7, v70, v71
    v_lshlrev_b32 v70, 16, v7
    v_and_b32 v71, 0xffff0000, v7
    v_mul_f32 v30, v30, v70
    v_mul_f32 v31, v31, v71
    v_cvt_pk_bf16_f32 v7, v30, v31
    v_lshlrev_b32 v30, 16, v7
    v_and_b32 v31, 0xffff0000, v7
    v_add_f32 v30, v30, v50
    v_add_f32 v31, v31, v51
    v_cvt_pk_bf16_f32 v105, v30, v31
    v_sub_f32 v32, v32, v6
    v_sub_f32 v33, v33, v6
    v_cvt_pk_bf16_f32 v7, v32, v33
    v_lshlrev_b32 v32, 16, v7
    v_and_b32 v33, 0xffff0000, v7
    v_mul_f32 v32, v32, v18
    v_mul_f32 v33, v33, v18
    v_cvt_pk_bf16_f32 v7, v32, v33
    v_lshlrev_b32 v32, 16, v7
    v_and_b32 v33, 0xffff0000, v7
    v_add_f32 v72, 1.0, v72
    v_add_f32 v73, 1.0, v73
    v_cvt_pk_bf16_f32 v7, v72, v73
    v_lshlrev_b32 v72, 16, v7
    v_and_b32 v73, 0xffff0000, v7
    v_mul_f32 v32, v32, v72
    v_mul_f32 v33, v33, v73
    v_cvt_pk_bf16_f32 v7, v32, v33
    v_lshlrev_b32 v32, 16, v7
    v_and_b32 v33, 0xffff0000, v7
    v_add_f32 v32, v32, v52
    v_add_f32 v33, v33, v53
    v_cvt_pk_bf16_f32 v106, v32, v33
    v_sub_f32 v34, v34, v6
    v_sub_f32 v35, v35, v6
    v_cvt_pk_bf16_f32 v7, v34, v35
    v_lshlrev_b32 v34, 16, v7
    v_and_b32 v35, 0xffff0000, v7
    v_mul_f32 v34, v34, v18
    v_mul_f32 v35, v35, v18
    v_cvt_pk_bf16_f32 v7, v34, v35
    v_lshlrev_b32 v34, 16, v7
    v_and_b32 v35, 0xffff0000, v7
    v_add_f32 v74, 1.0, v74
    v_add_f32 v75, 1.0, v75
    v_cvt_pk_bf16_f32 v7, v74, v75
    v_lshlrev_b32 v74, 16, v7
    v_and_b32 v75, 0xffff0000, v7
    v_mul_f32 v34, v34, v74
    v_mul_f32 v35, v35, v75
    v_cvt_pk_bf16_f32 v7, v34, v35
    v_lshlrev_b32 v34, 16, v7
    v_and_b32 v35, 0xffff0000, v7
    v_add_f32 v34, v34, v54
    v_add_f32 v35, v35, v55
    v_cvt_pk_bf16_f32 v107, v34, v35
    v_sub_f32 v36, v36, v6
    v_sub_f32 v37, v37, v6
    v_cvt_pk_bf16_f32 v7, v36, v37
    v_lshlrev_b32 v36, 16, v7
    v_and_b32 v37, 0xffff0000, v7
    v_mul_f32 v36, v36, v18
    v_mul_f32 v37, v37, v18
    v_cvt_pk_bf16_f32 v7, v36, v37
    v_lshlrev_b32 v36, 16, v7
    v_and_b32 v37, 0xffff0000, v7
    v_add_f32 v76, 1.0, v76
    v_add_f32 v77, 1.0, v77
    v_cvt_pk_bf16_f32 v7, v76, v77
    v_lshlrev_b32 v76, 16, v7
    v_and_b32 v77, 0xffff0000, v7
    v_mul_f32 v36, v36, v76
    v_mul_f32 v37, v37, v77
    v_cvt_pk_bf16_f32 v7, v36, v37
    v_lshlrev_b32 v36, 16, v7
    v_and_b32 v37, 0xffff0000, v7
    v_add_f32 v36, v36, v56
    v_add_f32 v37, v37, v57
    v_cvt_pk_bf16_f32 v108, v36, v37
    buffer_store_dword v100, v3, s[16:19], 0 offen offset:0
    buffer_store_dword v101, v3, s[16:19], 0 offen offset:128
    buffer_store_dword v102, v3, s[16:19], 0 offen offset:256
    buffer_store_dword v103, v3, s[16:19], 0 offen offset:384
    buffer_store_dword v104, v3, s[16:19], 0 offen offset:512
    buffer_store_dword v105, v3, s[16:19], 0 offen offset:640
    buffer_store_dword v106, v3, s[16:19], 0 offen offset:768
    buffer_store_dword v107, v3, s[16:19], 0 offen offset:896
    buffer_store_dword v108, v3, s[16:19], 0 offen offset:1024
.wo_kernel_end:
    s_endpgm

.section .rodata,"a"
.p2align 6
.amdhsa_kernel wo_kernel
  .amdhsa_next_free_vgpr 256
  .amdhsa_next_free_sgpr 102
  .amdhsa_accum_offset 176
  .amdhsa_group_segment_fixed_size 0
  .amdhsa_kernarg_size 112
  .amdhsa_user_sgpr_count 2
  .amdhsa_user_sgpr_kernarg_segment_ptr 1
  .amdhsa_system_sgpr_workgroup_id_x 1
.end_amdhsa_kernel

.text
.globl ffn1_kernel
.p2align 8
.type ffn1_kernel,@function
ffn1_kernel:
    s_cmp_ge_u32 s2, 256
    s_cbranch_scc1 .ffn1_kernel_end
    s_load_dwordx2 s[4:5], s[0:1], 104
    s_load_dwordx2 s[34:35], s[0:1], 96
    s_load_dwordx4 s[36:39], s[0:1], 48
    v_lshrrev_b32 v1, 6, v0
    v_and_b32 v2, 63, v0
    s_nop 0
    v_readfirstlane_b32 s3, v1
    s_and_b32 s24, s2, 7
    s_lshl_b32 s24, s24, 2
    s_bfe_u32 s25, s2, 0x20003
    s_add_u32 s24, s24, s25
    s_lshr_b32 s25, s2, 5
    s_lshl_b32 s25, s25, 8
    s_mov_b32 s23, 0
    s_and_b32 s21, s3, 3
    s_mov_b32 s22, 0
    s_lshl_b32 s26, s3, 10
    s_cmp_lt_u32 s3, 2
    s_cselect_b32 s48, -1, 0
    s_mov_b32 s49, s48
    s_waitcnt lgkmcnt(0)
    s_add_u32 s8, s4, 4784128
    s_addc_u32 s9, s5, 0
    s_mov_b32 s10, 2359296
    s_mov_b32 s11, 0x00020000
    s_add_u32 s30, s3, 0
    s_cmp_ge_u32 s30, 9
    s_cselect_b32 s80, s38, s36
    s_cselect_b32 s81, s39, s37
    s_mov_b32 s82, 5308416
    s_mov_b32 s83, 0x00020000
    s_add_u32 s30, s3, 8
    s_cmp_ge_u32 s30, 9
    s_cselect_b32 s84, s38, s36
    s_cselect_b32 s85, s39, s37
    s_mov_b32 s86, 5308416
    s_mov_b32 s87, 0x00020000
    s_add_u32 s30, s3, 16
    s_cmp_ge_u32 s30, 9
    s_cselect_b32 s88, s38, s36
    s_cselect_b32 s89, s39, s37
    s_mov_b32 s90, 5308416
    s_mov_b32 s91, 0x00020000
    v_and_b32 v3, 15, v2
    v_lshrrev_b32 v4, 4, v2
    v_lshrrev_b32 v5, 2, v3
    v_and_b32 v6, 3, v2
    v_lshrrev_b32 v7, 2, v2
    v_sub_u32 v8, 0, v4
    v_and_b32 v8, 3, v8
    v_xor_b32 v8, v6, v8
    v_lshlrev_b32 v8, 4, v8
    s_mov_b32 s31, 1152
    s_add_u32 s30, s3, 0
    s_lshl_b32 s30, s30, 4
    s_add_u32 s30, s30, s25
    v_add_u32 v9, s30, v7
    v_mul_lo_u32 v9, v9, s31
    v_add_u32 v16, v9, v8
    s_add_u32 s30, s3, 8
    s_lshl_b32 s30, s30, 4
    s_add_u32 s30, s30, s25
    v_add_u32 v9, s30, v7
    v_mul_lo_u32 v9, v9, s31
    v_add_u32 v17, v9, v8
    s_mov_b32 s31, 9216
    s_mul_i32 s29, s24, 288
    s_add_u32 s30, s3, 0
    s_min_u32 s30, s30, 17
    s_cmp_ge_u32 s30, 9
    s_cselect_b32 s28, 9, 0
    s_sub_u32 s27, s30, s28
    s_lshl_b32 s27, s27, 6
    v_add_u32 v9, s27, v2
    s_movk_i32 s27, 3641
    v_mul_lo_u32 v10, v9, s27
    v_lshrrev_b32 v10, 16, v10
    v_mul_u32_u24 v11, 18, v10
    v_sub_u32 v11, v9, v11
    v_and_b32 v12, 0x13, v10
    v_and_b32 v13, 4, v10
    v_lshlrev_b32 v13, 1, v13
    v_or_b32 v12, v12, v13
    v_and_b32 v13, 8, v10
    v_lshrrev_b32 v13, 1, v13
    v_or_b32 v12, v12, v13
    v_mul_lo_u32 v12, v12, s31
    v_lshl_add_u32 v12, v11, 4, v12
    v_add_u32 v18, s29, v12
    s_lshl_b32 s44, s30, 10
    s_add_u32 s44, s44, 16384
    s_add_u32 s30, s3, 8
    s_min_u32 s30, s30, 17
    s_cmp_ge_u32 s30, 9
    s_cselect_b32 s28, 9, 0
    s_sub_u32 s27, s30, s28
    s_lshl_b32 s27, s27, 6
    v_add_u32 v9, s27, v2
    s_movk_i32 s27, 3641
    v_mul_lo_u32 v10, v9, s27
    v_lshrrev_b32 v10, 16, v10
    v_mul_u32_u24 v11, 18, v10
    v_sub_u32 v11, v9, v11
    v_and_b32 v12, 0x13, v10
    v_and_b32 v13, 4, v10
    v_lshlrev_b32 v13, 1, v13
    v_or_b32 v12, v12, v13
    v_and_b32 v13, 8, v10
    v_lshrrev_b32 v13, 1, v13
    v_or_b32 v12, v12, v13
    v_mul_lo_u32 v12, v12, s31
    v_lshl_add_u32 v12, v11, 4, v12
    v_add_u32 v19, s29, v12
    s_lshl_b32 s45, s30, 10
    s_add_u32 s45, s45, 16384
    s_add_u32 s30, s3, 16
    s_min_u32 s30, s30, 17
    s_cmp_ge_u32 s30, 9
    s_cselect_b32 s28, 9, 0
    s_sub_u32 s27, s30, s28
    s_lshl_b32 s27, s27, 6
    v_add_u32 v9, s27, v2
    s_movk_i32 s27, 3641
    v_mul_lo_u32 v10, v9, s27
    v_lshrrev_b32 v10, 16, v10
    v_mul_u32_u24 v11, 18, v10
    v_sub_u32 v11, v9, v11
    v_and_b32 v12, 0x13, v10
    v_and_b32 v13, 4, v10
    v_lshlrev_b32 v13, 1, v13
    v_or_b32 v12, v12, v13
    v_and_b32 v13, 8, v10
    v_lshrrev_b32 v13, 1, v13
    v_or_b32 v12, v12, v13
    v_mul_lo_u32 v12, v12, s31
    v_lshl_add_u32 v12, v11, 4, v12
    v_add_u32 v20, s29, v12
    s_lshl_b32 s46, s30, 10
    s_add_u32 s46, s46, 16384
    s_mov_b32 s27, 0
    s_mov_b32 s28, 0
    s_cmp_ge_u32 s3, 4
    s_cbranch_scc1 .ffn1_kernel_end_p1
    s_nop 0
    s_add_u32 m0, s26, 0
    s_nop 0
    buffer_load_dwordx4 v16, s[8:11], s27 offen lds
    s_nop 0
    s_add_u32 m0, s26, 8192
    s_nop 0
    buffer_load_dwordx4 v17, s[8:11], s27 offen lds
    s_nop 0
    s_add_u32 m0, s44, 0
    s_nop 0
    buffer_load_dwordx4 v18, s[80:83], s28 offen lds
    s_nop 0
    s_add_u32 m0, s45, 0
    s_nop 0
    buffer_load_dwordx4 v19, s[84:87], s28 offen lds
    s_nop 0
    s_add_u32 m0, s46, 0
    s_nop 0
    s_mov_b64 exec, s[48:49]
    buffer_load_dwordx4 v20, s[88:91], s28 offen lds
    s_mov_b64 exec, -1
    s_nop 0
    s_add_u32 s27, s27, 64
    s_add_u32 s28, s28, 294912
    s_nop 0
    s_add_u32 m0, s26, 34816
    s_nop 0
    buffer_load_dwordx4 v16, s[8:11], s27 offen lds
    s_nop 0
    s_add_u32 m0, s26, 43008
    s_nop 0
    buffer_load_dwordx4 v17, s[8:11], s27 offen lds
    s_nop 0
    s_add_u32 m0, s44, 34816
    s_nop 0
    buffer_load_dwordx4 v18, s[80:83], s28 offen lds
    s_nop 0
    s_add_u32 m0, s45, 34816
    s_nop 0
    buffer_load_dwordx4 v19, s[84:87], s28 offen lds
    s_nop 0
    s_add_u32 m0, s46, 34816
    s_nop 0
    s_mov_b64 exec, s[48:49]
    buffer_load_dwordx4 v20, s[88:91], s28 offen lds
    s_mov_b64 exec, -1
    s_nop 0
    s_add_u32 s27, s27, 64
    s_add_u32 s28, s28, 294912
    s_nop 0
    s_add_u32 m0, s26, 69632
    s_nop 0
    buffer_load_dwordx4 v16, s[8:11], s27 offen lds
    s_nop 0
    s_add_u32 m0, s26, 77824
    s_nop 0
    buffer_load_dwordx4 v17, s[8:11], s27 offen lds
    s_nop 0
    s_add_u32 m0, s44, 69632
    s_nop 0
    buffer_load_dwordx4 v18, s[80:83], s28 offen lds
    s_nop 0
    s_add_u32 m0, s45, 69632
    s_nop 0
    buffer_load_dwordx4 v19, s[84:87], s28 offen lds
    s_nop 0
    s_add_u32 m0, s46, 69632
    s_nop 0
    s_mov_b64 exec, s[48:49]
    buffer_load_dwordx4 v20, s[88:91], s28 offen lds
    s_mov_b64 exec, -1
    s_nop 0
    s_add_u32 s27, s27, 64
    s_add_u32 s28, s28, 294912
    s_nop 0
    v_sub_u32 v8, 0, v5
    v_and_b32 v8, 3, v8
    v_xor_b32 v8, v4, v8
    v_lshlrev_b32 v8, 4, v8
    v_lshl_add_u32 v8, v3, 6, v8
    s_lshl_b32 s30, s21, 12
    s_lshl_b32 s31, s22, 13
    s_add_u32 s30, s30, s31
    v_add_u32 v8, s30, v8
    v_lshrrev_b32 v9, 1, v4
    v_lshlrev_b32 v9, 4, v9
    v_and_b32 v10, 1, v4
    v_lshl_add_u32 v9, v10, 2, v9
    v_add_u32 v9, v9, v5
    v_mul_u32_u24 v9, 288, v9
    v_lshl_add_u32 v9, v6, 3, v9
    s_mul_i32 s31, s22, 9216
    v_add_u32 v9, s31, v9
    v_add_u32 v22, 0, v8
    v_add_u32 v26, 16384, v9
    v_add_u32 v23, 34816, v8
    v_add_u32 v27, 51200, v9
    v_add_u32 v24, 69632, v8
    v_add_u32 v28, 86016, v9
    v_add_u32 v25, 104448, v8
    v_add_u32 v29, 120832, v9
    s_nop 0
    s_waitcnt vmcnt(10)
    s_barrier
    s_nop 0
    ds_read_b128 v[32:35], v22 offset:0
    ds_read_b128 v[36:39], v22 offset:1024
    ds_read_b64_tr_b16 v[64:65], v26 offset:0
    s_nop 0
    ds_read_b128 v[40:43], v22 offset:2048
    ds_read_b128 v[44:47], v22 offset:3072
    ds_read_b64_tr_b16 v[66:67], v26 offset:2304
    s_nop 0
    ds_read_b64_tr_b16 v[68:69], v26 offset:9216
    s_nop 0
    ds_read_b64_tr_b16 v[70:71], v26 offset:11520
    s_nop 0
    ds_read_b64_tr_b16 v[72:73], v26 offset:32
    s_nop 0
    ds_read_b64_tr_b16 v[74:75], v26 offset:2336
    s_waitcnt lgkmcnt(4)
    v_mfma_f32_16x16x32_bf16 a[0:3], v[64:67], v[32:35], 0
    ds_read_b64_tr_b16 v[76:77], v26 offset:9248
    v_mfma_f32_16x16x32_bf16 a[4:7], v[64:67], v[36:39], 0
    ds_read_b64_tr_b16 v[78:79], v26 offset:11552
    v_mfma_f32_16x16x32_bf16 a[8:11], v[64:67], v[40:43], 0
    v_mfma_f32_16x16x32_bf16 a[12:15], v[64:67], v[44:47], 0
    s_waitcnt lgkmcnt(4)
    v_mfma_f32_16x16x32_bf16 a[16:19], v[68:71], v[32:35], 0
    ds_read_b64_tr_b16 v[80:81], v26 offset:64
    v_mfma_f32_16x16x32_bf16 a[20:23], v[68:71], v[36:39], 0
    ds_read_b64_tr_b16 v[82:83], v26 offset:2368
    v_mfma_f32_16x16x32_bf16 a[24:27], v[68:71], v[40:43], 0
    v_mfma_f32_16x16x32_bf16 a[28:31], v[68:71], v[44:47], 0
    s_waitcnt lgkmcnt(4)
    v_mfma_f32_16x16x32_bf16 a[32:35], v[72:75], v[32:35], 0
    ds_read_b64_tr_b16 v[84:85], v26 offset:9280
    v_mfma_f32_16x16x32_bf16 a[36:39], v[72:75], v[36:39], 0
    ds_read_b64_tr_b16 v[86:87], v26 offset:11584
    v_mfma_f32_16x16x32_bf16 a[40:43], v[72:75], v[40:43], 0
    v_mfma_f32_16x16x32_bf16 a[44:47], v[72:75], v[44:47], 0
    s_waitcnt lgkmcnt(4)
    v_mfma_f32_16x16x32_bf16 a[48:51], v[76:79], v[32:35], 0
    ds_read_b64_tr_b16 v[88:89], v26 offset:96
    v_mfma_f32_16x16x32_bf16 a[52:55], v[76:79], v[36:39], 0
    ds_read_b64_tr_b16 v[90:91], v26 offset:2400
    v_mfma_f32_16x16x32_bf16 a[56:59], v[76:79], v[40:43], 0
    v_mfma_f32_16x16x32_bf16 a[60:63], v[76:79], v[44:47], 0
    s_waitcnt lgkmcnt(4)
    v_mfma_f32_16x16x32_bf16 a[64:67], v[80:83], v[32:35], 0
    ds_read_b64_tr_b16 v[92:93], v26 offset:9312
    v_mfma_f32_16x16x32_bf16 a[68:71], v[80:83], v[36:39], 0
    ds_read_b64_tr_b16 v[94:95], v26 offset:11616
    v_mfma_f32_16x16x32_bf16 a[72:75], v[80:83], v[40:43], 0
    v_mfma_f32_16x16x32_bf16 a[76:79], v[80:83], v[44:47], 0
    s_waitcnt lgkmcnt(4)
    v_mfma_f32_16x16x32_bf16 a[80:83], v[84:87], v[32:35], 0
    ds_read_b64_tr_b16 v[64:65], v26 offset:128
    v_mfma_f32_16x16x32_bf16 a[84:87], v[84:87], v[36:39], 0
    ds_read_b64_tr_b16 v[66:67], v26 offset:2432
    v_mfma_f32_16x16x32_bf16 a[88:91], v[84:87], v[40:43], 0
    v_mfma_f32_16x16x32_bf16 a[92:95], v[84:87], v[44:47], 0
    s_waitcnt lgkmcnt(4)
    v_mfma_f32_16x16x32_bf16 a[96:99], v[88:91], v[32:35], 0
    ds_read_b64_tr_b16 v[68:69], v26 offset:9344
    v_mfma_f32_16x16x32_bf16 a[100:103], v[88:91], v[36:39], 0
    ds_read_b64_tr_b16 v[70:71], v26 offset:11648
    v_mfma_f32_16x16x32_bf16 a[104:107], v[88:91], v[40:43], 0
    v_mfma_f32_16x16x32_bf16 a[108:111], v[88:91], v[44:47], 0
    s_waitcnt vmcnt(5)
    s_barrier
    s_waitcnt lgkmcnt(4)
    v_mfma_f32_16x16x32_bf16 a[112:115], v[92:95], v[32:35], 0
    ds_read_b128 v[48:51], v23 offset:0
    ds_read_b128 v[52:55], v23 offset:1024
    ds_read_b64_tr_b16 v[72:73], v27 offset:0
    s_add_u32 m0, s26, 104448
    v_mfma_f32_16x16x32_bf16 a[116:119], v[92:95], v[36:39], 0
    ds_read_b128 v[56:59], v23 offset:2048
    ds_read_b128 v[60:63], v23 offset:3072
    ds_read_b64_tr_b16 v[74:75], v27 offset:2304
    buffer_load_dwordx4 v16, s[8:11], s27 offen lds
    v_mfma_f32_16x16x32_bf16 a[120:123], v[92:95], v[40:43], 0
    s_add_u32 m0, s26, 112640
    v_mfma_f32_16x16x32_bf16 a[124:127], v[92:95], v[44:47], 0
    buffer_load_dwordx4 v17, s[8:11], s27 offen lds
    s_waitcnt lgkmcnt(8)
    v_mfma_f32_16x16x32_bf16 a[128:131], v[64:67], v[32:35], 0
    ds_read_b64_tr_b16 v[76:77], v27 offset:9216
    s_add_u32 m0, s44, 104448
    v_mfma_f32_16x16x32_bf16 a[132:135], v[64:67], v[36:39], 0
    ds_read_b64_tr_b16 v[78:79], v27 offset:11520
    buffer_load_dwordx4 v18, s[80:83], s28 offen lds
    v_mfma_f32_16x16x32_bf16 a[136:139], v[64:67], v[40:43], 0
    s_add_u32 m0, s45, 104448
    v_mfma_f32_16x16x32_bf16 a[140:143], v[64:67], v[44:47], 0
    buffer_load_dwordx4 v19, s[84:87], s28 offen lds
    s_waitcnt lgkmcnt(8)
    v_mfma_f32_16x16x32_bf16 a[144:147], v[68:71], v[32:35], 0
    ds_read_b64_tr_b16 v[80:81], v27 offset:32
    s_add_u32 m0, s46, 104448
    v_mfma_f32_16x16x32_bf16 a[148:151], v[68:71], v[36:39], 0
    ds_read_b64_tr_b16 v[82:83], v27 offset:2336
    s_mov_b64 exec, s[48:49]
    buffer_load_dwordx4 v20, s[88:91], s28 offen lds
    s_mov_b64 exec, -1
    v_mfma_f32_16x16x32_bf16 a[152:155], v[68:71], v[40:43], 0
    s_add_u32 s27, s27, 64
    s_add_u32 s28, s28, 294912
    v_mfma_f32_16x16x32_bf16 a[156:159], v[68:71], v[44:47], 0
    s_waitcnt lgkmcnt(4)
    v_mfma_f32_16x16x32_bf16 a[0:3], v[72:75], v[48:51], a[0:3]
    ds_read_b64_tr_b16 v[84:85], v27 offset:9248
    v_mfma_f32_16x16x32_bf16 a[4:7], v[72:75], v[52:55], a[4:7]
    ds_read_b64_tr_b16 v[86:87], v27 offset:11552
    v_mfma_f32_16x16x32_bf16 a[8:11], v[72:75], v[56:59], a[8:11]
    v_mfma_f32_16x16x32_bf16 a[12:15], v[72:75], v[60:63], a[12:15]
    s_waitcnt lgkmcnt(4)
    v_mfma_f32_16x16x32_bf16 a[16:19], v[76:79], v[48:51], a[16:19]
    ds_read_b64_tr_b16 v[88:89], v27 offset:64
    v_mfma_f32_16x16x32_bf16 a[20:23], v[76:79], v[52:55], a[20:23]
    ds_read_b64_tr_b16 v[90:91], v27 offset:2368
    v_mfma_f32_16x16x32_bf16 a[24:27], v[76:79], v[56:59], a[24:27]
    v_mfma_f32_16x16x32_bf16 a[28:31], v[76:79], v[60:63], a[28:31]
    s_waitcnt lgkmcnt(4)
    v_mfma_f32_16x16x32_bf16 a[32:35], v[80:83], v[48:51], a[32:35]
    ds_read_b64_tr_b16 v[92:93], v27 offset:9280
    v_mfma_f32_16x16x32_bf16 a[36:39], v[80:83], v[52:55], a[36:39]
    ds_read_b64_tr_b16 v[94:95], v27 offset:11584
    v_mfma_f32_16x16x32_bf16 a[40:43], v[80:83], v[56:59], a[40:43]
    v_mfma_f32_16x16x32_bf16 a[44:47], v[80:83], v[60:63], a[44:47]
    s_waitcnt lgkmcnt(4)
    v_mfma_f32_16x16x32_bf16 a[48:51], v[84:87], v[48:51], a[48:51]
    ds_read_b64_tr_b16 v[64:65], v27 offset:96
    v_mfma_f32_16x16x32_bf16 a[52:55], v[84:87], v[52:55], a[52:55]
    ds_read_b64_tr_b16 v[66:67], v27 offset:2400
    v_mfma_f32_16x16x32_bf16 a[56:59], v[84:87], v[56:59], a[56:59]
    v_mfma_f32_16x16x32_bf16 a[60:63], v[84:87], v[60:63], a[60:63]
    s_waitcnt lgkmcnt(4)
    v_mfma_f32_16x16x32_bf16 a[64:67], v[88:91], v[48:51], a[64:67]
    ds_read_b64_tr_b16 v[68:69], v27 offset:9312
    v_mfma_f32_16x16x32_bf16 a[68:71], v[88:91], v[52:55], a[68:71]
    ds_read_b64_tr_b16 v[70:71], v27 offset:11616
    v_mfma_f32_16x16x32_bf16 a[72:75], v[88:91], v[56:59], a[72:75]
    v_mfma_f32_16x16x32_bf16 a[76:79], v[88:91], v[60:63], a[76:79]
    s_waitcnt lgkmcnt(4)
    v_mfma_f32_16x16x32_bf16 a[80:83], v[92:95], v[48:51], a[80:83]
    ds_read_b64_tr_b16 v[72:73], v27 offset:128
    v_mfma_f32_16x16x32_bf16 a[84:87], v[92:95], v[52:55], a[84:87]
    ds_read_b64_tr_b16 v[74:75], v27 offset:2432
    v_mfma_f32_16x16x32_bf16 a[88:91], v[92:95], v[56:59], a[88:91]
    v_mfma_f32_16x16x32_bf16 a[92:95], v[92:95], v[60:63], a[92:95]
    s_waitcnt lgkmcnt(4)
    v_mfma_f32_16x16x32_bf16 a[96:99], v[64:67], v[48:51], a[96:99]
    ds_read_b64_tr_b16 v[76:77], v27 offset:9344
    v_mfma_f32_16x16x32_bf16 a[100:103], v[64:67], v[52:55], a[100:103]
    ds_read_b64_tr_b16 v[78:79], v27 offset:11648
    v_mfma_f32_16x16x32_bf16 a[104:107], v[64:67], v[56:59], a[104:107]
    v_mfma_f32_16x16x32_bf16 a[108:111], v[64:67], v[60:63], a[108:111]
    s_waitcnt vmcnt(5)
    s_barrier
    s_waitcnt lgkmcnt(4)
    v_mfma_f32_16x16x32_bf16 a[112:115], v[68:71], v[48:51], a[112:115]
    ds_read_b128 v[32:35], v24 offset:0
    ds_read_b128 v[36:39], v24 offset:1024
    ds_read_b64_tr_b16 v[80:81], v28 offset:0
    s_add_u32 m0, s26, 0
    v_mfma_f32_16x16x32_bf16 a[116:119], v[68:71], v[52:55], a[116:119]
    ds_read_b128 v[40:43], v24 offset:2048
    ds_read_b128 v[44:47], v24 offset:3072
    ds_read_b64_tr_b16 v[82:83], v28 offset:2304
    buffer_load_dwordx4 v16, s[8:11], s27 offen lds
    v_mfma_f32_16x16x32_bf16 a[120:123], v[68:71], v[56:59], a[120:123]
    s_add_u32 m0, s26, 8192
    v_mfma_f32_16x16x32_bf16 a[124:127], v[68:71], v[60:63], a[124:127]
    buffer_load_dwordx4 v17, s[8:11], s27 offen lds
    s_waitcnt lgkmcnt(8)
    v_mfma_f32_16x16x32_bf16 a[128:131], v[72:75], v[48:51], a[128:131]
    ds_read_b64_tr_b16 v[84:85], v28 offset:9216
    s_add_u32 m0, s44, 0
    v_mfma_f32_16x16x32_bf16 a[132:135], v[72:75], v[52:55], a[132:135]
    ds_read_b64_tr_b16 v[86:87], v28 offset:11520
    buffer_load_dwordx4 v18, s[80:83], s28 offen lds
    v_mfma_f32_16x16x32_bf16 a[136:139], v[72:75], v[56:59], a[136:139]
    s_add_u32 m0, s45, 0
    v_mfma_f32_16x16x32_bf16 a[140:143], v[72:75], v[60:63], a[140:143]
    buffer_load_dwordx4 v19, s[84:87], s28 offen lds
    s_waitcnt lgkmcnt(8)
    v_mfma_f32_16x16x32_bf16 a[144:147], v[76:79], v[48:51], a[144:147]
    ds_read_b64_tr_b16 v[88:89], v28 offset:32
    s_add_u32 m0, s46, 0
    v_mfma_f32_16x16x32_bf16 a[148:151], v[76:79], v[52:55], a[148:151]
    ds_read_b64_tr_b16 v[90:91], v28 offset:2336
    s_mov_b64 exec, s[48:49]
    buffer_load_dwordx4 v20, s[88:91], s28 offen lds
    s_mov_b64 exec, -1
    v_mfma_f32_16x16x32_bf16 a[152:155], v[76:79], v[56:59], a[152:155]
    s_add_u32 s27, s27, 64
    s_add_u32 s28, s28, 294912
    v_mfma_f32_16x16x32_bf16 a[156:159], v[76:79], v[60:63], a[156:159]
    s_waitcnt lgkmcnt(4)
    v_mfma_f32_16x16x32_bf16 a[0:3], v[80:83], v[32:35], a[0:3]
    ds_read_b64_tr_b16 v[92:93], v28 offset:9248
    v_mfma_f32_16x16x32_bf16 a[4:7], v[80:83], v[36:39], a[4:7]
    ds_read_b64_tr_b16 v[94:95], v28 offset:11552
    v_mfma_f32_16x16x32_bf16 a[8:11], v[80:83], v[40:43], a[8:11]
    v_mfma_f32_16x16x32_bf16 a[12:15], v[80:83], v[44:47], a[12:15]
    s_waitcnt lgkmcnt(4)
    v_mfma_f32_16x16x32_bf16 a[16:19], v[84:87], v[32:35], a[16:19]
    ds_read_b64_tr_b16 v[64:65], v28 offset:64
    v_mfma_f32_16x16x32_bf16 a[20:23], v[84:87], v[36:39], a[20:23]
    ds_read_b64_tr_b16 v[66:67], v28 offset:2368
    v_mfma_f32_16x16x32_bf16 a[24:27], v[84:87], v[40:43], a[24:27]
    v_mfma_f32_16x16x32_bf16 a[28:31], v[84:87], v[44:47], a[28:31]
    s_waitcnt lgkmcnt(4)
    v_mfma_f32_16x16x32_bf16 a[32:35], v[88:91], v[32:35], a[32:35]
    ds_read_b64_tr_b16 v[68:69], v28 offset:9280
    v_mfma_f32_16x16x32_bf16 a[36:39], v[88:91], v[36:39], a[36:39]
    ds_read_b64_tr_b16 v[70:71], v28 offset:11584
    v_mfma_f32_16x16x32_bf16 a[40:43], v[88:91], v[40:43], a[40:43]
    v_mfma_f32_16x16x32_bf16 a[44:47], v[88:91], v[44:47], a[44:47]
    s_waitcnt lgkmcnt(4)
    v_mfma_f32_16x16x32_bf16 a[48:51], v[92:95], v[32:35], a[48:51]
    ds_read_b64_tr_b16 v[72:73], v28 offset:96
    v_mfma_f32_16x16x32_bf16 a[52:55], v[92:95], v[36:39], a[52:55]
    ds_read_b64_tr_b16 v[74:75], v28 offset:2400
    v_mfma_f32_16x16x32_bf16 a[56:59], v[92:95], v[40:43], a[56:59]
    v_mfma_f32_16x16x32_bf16 a[60:63], v[92:95], v[44:47], a[60:63]
    s_waitcnt lgkmcnt(4)
    v_mfma_f32_16x16x32_bf16 a[64:67], v[64:67], v[32:35], a[64:67]
    ds_read_b64_tr_b16 v[76:77], v28 offset:9312
    v_mfma_f32_16x16x32_bf16 a[68:71], v[64:67], v[36:39], a[68:71]
    ds_read_b64_tr_b16 v[78:79], v28 offset:11616
    v_mfma_f32_16x16x32_bf16 a[72:75], v[64:67], v[40:43], a[72:75]
    v_mfma_f32_16x16x32_bf16 a[76:79], v[64:67], v[44:47], a[76:79]
    s_waitcnt lgkmcnt(4)
    v_mfma_f32_16x16x32_bf16 a[80:83], v[68:71], v[32:35], a[80:83]
    ds_read_b64_tr_b16 v[80:81], v28 offset:128
    v_mfma_f32_16x16x32_bf16 a[84:87], v[68:71], v[36:39], a[84:87]
    ds_read_b64_tr_b16 v[82:83], v28 offset:2432
    v_mfma_f32_16x16x32_bf16 a[88:91], v[68:71], v[40:43], a[88:91]
    v_mfma_f32_16x16x32_bf16 a[92:95], v[68:71], v[44:47], a[92:95]
    s_waitcnt lgkmcnt(4)
    v_mfma_f32_16x16x32_bf16 a[96:99], v[72:75], v[32:35], a[96:99]
    ds_read_b64_tr_b16 v[84:85], v28 offset:9344
    v_mfma_f32_16x16x32_bf16 a[100:103], v[72:75], v[36:39], a[100:103]
    ds_read_b64_tr_b16 v[86:87], v28 offset:11648
    v_mfma_f32_16x16x32_bf16 a[104:107], v[72:75], v[40:43], a[104:107]
    v_mfma_f32_16x16x32_bf16 a[108:111], v[72:75], v[44:47], a[108:111]
    s_waitcnt vmcnt(5)
    s_barrier
    s_waitcnt lgkmcnt(4)
    v_mfma_f32_16x16x32_bf16 a[112:115], v[76:79], v[32:35], a[112:115]
    ds_read_b128 v[48:51], v25 offset:0
    ds_read_b128 v[52:55], v25 offset:1024
    ds_read_b64_tr_b16 v[88:89], v29 offset:0
    s_add_u32 m0, s26, 34816
    v_mfma_f32_16x16x32_bf16 a[116:119], v[76:79], v[36:39], a[116:119]
    ds_read_b128 v[56:59], v25 offset:2048
    ds_read_b128 v[60:63], v25 offset:3072
    ds_read_b64_tr_b16 v[90:91], v29 offset:2304
    buffer_load_dwordx4 v16, s[8:11], s27 offen lds
    v_mfma_f32_16x16x32_bf16 a[120:123], v[76:79], v[40:43], a[120:123]
    s_add_u32 m0, s26, 43008
    v_mfma_f32_16x16x32_bf16 a[124:127], v[76:79], v[44:47], a[124:127]
    buffer_load_dwordx4 v17, s[8:11], s27 offen lds
    s_waitcnt lgkmcnt(8)
    v_mfma_f32_16x16x32_bf16 a[128:131], v[80:83], v[32:35], a[128:131]
    ds_read_b64_tr_b16 v[92:93], v29 offset:9216
    s_add_u32 m0, s44, 34816
    v_mfma_f32_16x16x32_bf16 a[132:135], v[80:83], v[36:39], a[132:135]
    ds_read_b64_tr_b16 v[94:95], v29 offset:11520
    buffer_load_dwordx4 v18, s[80:83], s28 offen lds
    v_mfma_f32_16x16x32_bf16 a[136:139], v[80:83], v[40:43], a[136:139]
    s_add_u32 m0, s45, 34816
    v_mfma_f32_16x16x32_bf16 a[140:143], v[80:83], v[44:47], a[140:143]
    buffer_load_dwordx4 v19, s[84:87], s28 offen lds
    s_waitcnt lgkmcnt(8)
    v_mfma_f32_16x16x32_bf16 a[144:147], v[84:87], v[32:35], a[144:147]
    ds_read_b64_tr_b16 v[64:65], v29 offset:32
    s_add_u32 m0, s46, 34816
    v_mfma_f32_16x16x32_bf16 a[148:151], v[84:87], v[36:39], a[148:151]
    ds_read_b64_tr_b16 v[66:67], v29 offset:2336
    s_mov_b64 exec, s[48:49]
    buffer_load_dwordx4 v20, s[88:91], s28 offen lds
    s_mov_b64 exec, -1
    v_mfma_f32_16x16x32_bf16 a[152:155], v[84:87], v[40:43], a[152:155]
    s_add_u32 s27, s27, 64
    s_add_u32 s28, s28, 294912
    v_mfma_f32_16x16x32_bf16 a[156:159], v[84:87], v[44:47], a[156:159]
    s_waitcnt lgkmcnt(4)
    v_mfma_f32_16x16x32_bf16 a[0:3], v[88:91], v[48:51], a[0:3]
    ds_read_b64_tr_b16 v[68:69], v29 offset:9248
    v_mfma_f32_16x16x32_bf16 a[4:7], v[88:91], v[52:55], a[4:7]
    ds_read_b64_tr_b16 v[70:71], v29 offset:11552
    v_mfma_f32_16x16x32_bf16 a[8:11], v[88:91], v[56:59], a[8:11]
    v_mfma_f32_16x16x32_bf16 a[12:15], v[88:91], v[60:63], a[12:15]
    s_waitcnt lgkmcnt(4)
    v_mfma_f32_16x16x32_bf16 a[16:19], v[92:95], v[48:51], a[16:19]
    ds_read_b64_tr_b16 v[72:73], v29 offset:64
    v_mfma_f32_16x16x32_bf16 a[20:23], v[92:95], v[52:55], a[20:23]
    ds_read_b64_tr_b16 v[74:75], v29 offset:2368
    v_mfma_f32_16x16x32_bf16 a[24:27], v[92:95], v[56:59], a[24:27]
    v_mfma_f32_16x16x32_bf16 a[28:31], v[92:95], v[60:63], a[28:31]
    s_waitcnt lgkmcnt(4)
    v_mfma_f32_16x16x32_bf16 a[32:35], v[64:67], v[48:51], a[32:35]
    ds_read_b64_tr_b16 v[76:77], v29 offset:9280
    v_mfma_f32_16x16x32_bf16 a[36:39], v[64:67], v[52:55], a[36:39]
    ds_read_b64_tr_b16 v[78:79], v29 offset:11584
    v_mfma_f32_16x16x32_bf16 a[40:43], v[64:67], v[56:59], a[40:43]
    v_mfma_f32_16x16x32_bf16 a[44:47], v[64:67], v[60:63], a[44:47]
    s_waitcnt lgkmcnt(4)
    v_mfma_f32_16x16x32_bf16 a[48:51], v[68:71], v[48:51], a[48:51]
    ds_read_b64_tr_b16 v[80:81], v29 offset:96
    v_mfma_f32_16x16x32_bf16 a[52:55], v[68:71], v[52:55], a[52:55]
    ds_read_b64_tr_b16 v[82:83], v29 offset:2400
    v_mfma_f32_16x16x32_bf16 a[56:59], v[68:71], v[56:59], a[56:59]
    v_mfma_f32_16x16x32_bf16 a[60:63], v[68:71], v[60:63], a[60:63]
    s_waitcnt lgkmcnt(4)
    v_mfma_f32_16x16x32_bf16 a[64:67], v[72:75], v[48:51], a[64:67]
    ds_read_b64_tr_b16 v[84:85], v29 offset:9312
    v_mfma_f32_16x16x32_bf16 a[68:71], v[72:75], v[52:55], a[68:71]
    ds_read_b64_tr_b16 v[86:87], v29 offset:11616
    v_mfma_f32_16x16x32_bf16 a[72:75], v[72:75], v[56:59], a[72:75]
    v_mfma_f32_16x16x32_bf16 a[76:79], v[72:75], v[60:63], a[76:79]
    s_waitcnt lgkmcnt(4)
    v_mfma_f32_16x16x32_bf16 a[80:83], v[76:79], v[48:51], a[80:83]
    ds_read_b64_tr_b16 v[88:89], v29 offset:128
    v_mfma_f32_16x16x32_bf16 a[84:87], v[76:79], v[52:55], a[84:87]
    ds_read_b64_tr_b16 v[90:91], v29 offset:2432
    v_mfma_f32_16x16x32_bf16 a[88:91], v[76:79], v[56:59], a[88:91]
    v_mfma_f32_16x16x32_bf16 a[92:95], v[76:79], v[60:63], a[92:95]
    s_waitcnt lgkmcnt(4)
    v_mfma_f32_16x16x32_bf16 a[96:99], v[80:83], v[48:51], a[96:99]
    ds_read_b64_tr_b16 v[92:93], v29 offset:9344
    v_mfma_f32_16x16x32_bf16 a[100:103], v[80:83], v[52:55], a[100:103]
    ds_read_b64_tr_b16 v[94:95], v29 offset:11648
    v_mfma_f32_16x16x32_bf16 a[104:107], v[80:83], v[56:59], a[104:107]
    v_mfma_f32_16x16x32_bf16 a[108:111], v[80:83], v[60:63], a[108:111]
    s_waitcnt vmcnt(5)
    s_barrier
    s_waitcnt lgkmcnt(4)
    v_mfma_f32_16x16x32_bf16 a[112:115], v[84:87], v[48:51], a[112:115]
    ds_read_b128 v[32:35], v22 offset:0
    ds_read_b128 v[36:39], v22 offset:1024
    ds_read_b64_tr_b16 v[64:65], v26 offset:0
    s_add_u32 m0, s26, 69632
    v_mfma_f32_16x16x32_bf16 a[116:119], v[84:87], v[52:55], a[116:119]
    ds_read_b128 v[40:43], v22 offset:2048
    ds_read_b128 v[44:47], v22 offset:3072
    ds_read_b64_tr_b16 v[66:67], v26 offset:2304
    buffer_load_dwordx4 v16, s[8:11], s27 offen lds
    v_mfma_f32_16x16x32_bf16 a[120:123], v[84:87], v[56:59], a[120:123]
    s_add_u32 m0, s26, 77824
    v_mfma_f32_16x16x32_bf16 a[124:127], v[84:87], v[60:63], a[124:127]
    buffer_load_dwordx4 v17, s[8:11], s27 offen lds
    s_waitcnt lgkmcnt(8)
    v_mfma_f32_16x16x32_bf16 a[128:131], v[88:91], v[48:51], a[128:131]
    ds_read_b64_tr_b16 v[68:69], v26 offset:9216
    s_add_u32 m0, s44, 69632
    v_mfma_f32_16x16x32_bf16 a[132:135], v[88:91], v[52:55], a[132:135]
    ds_read_b64_tr_b16 v[70:71], v26 offset:11520
    buffer_load_dwordx4 v18, s[80:83], s28 offen lds
    v_mfma_f32_16x16x32_bf16 a[136:139], v[88:91], v[56:59], a[136:139]
    s_add_u32 m0, s45, 69632
    v_mfma_f32_16x16x32_bf16 a[140:143], v[88:91], v[60:63], a[140:143]
    buffer_load_dwordx4 v19, s[84:87], s28 offen lds
    s_waitcnt lgkmcnt(8)
    v_mfma_f32_16x16x32_bf16 a[144:147], v[92:95], v[48:51], a[144:147]
    ds_read_b64_tr_b16 v[72:73], v26 offset:32
    s_add_u32 m0, s46, 69632
    v_mfma_f32_16x16x32_bf16 a[148:151], v[92:95], v[52:55], a[148:151]
    ds_read_b64_tr_b16 v[74:75], v26 offset:2336
    s_mov_b64 exec, s[48:49]
    buffer_load_dwordx4 v20, s[88:91], s28 offen lds
    s_mov_b64 exec, -1
    v_mfma_f32_16x16x32_bf16 a[152:155], v[92:95], v[56:59], a[152:155]
    s_add_u32 s27, s27, 64
    s_add_u32 s28, s28, 294912
    v_mfma_f32_16x16x32_bf16 a[156:159], v[92:95], v[60:63], a[156:159]
    s_waitcnt lgkmcnt(4)
    v_mfma_f32_16x16x32_bf16 a[0:3], v[64:67], v[32:35], a[0:3]
    ds_read_b64_tr_b16 v[76:77], v26 offset:9248
    v_mfma_f32_16x16x32_bf16 a[4:7], v[64:67], v[36:39], a[4:7]
    ds_read_b64_tr_b16 v[78:79], v26 offset:11552
    v_mfma_f32_16x16x32_bf16 a[8:11], v[64:67], v[40:43], a[8:11]
    v_mfma_f32_16x16x32_bf16 a[12:15], v[64:67], v[44:47], a[12:15]
    s_waitcnt lgkmcnt(4)
    v_mfma_f32_16x16x32_bf16 a[16:19], v[68:71], v[32:35], a[16:19]
    ds_read_b64_tr_b16 v[80:81], v26 offset:64
    v_mfma_f32_16x16x32_bf16 a[20:23], v[68:71], v[36:39], a[20:23]
    ds_read_b64_tr_b16 v[82:83], v26 offset:2368
    v_mfma_f32_16x16x32_bf16 a[24:27], v[68:71], v[40:43], a[24:27]
    v_mfma_f32_16x16x32_bf16 a[28:31], v[68:71], v[44:47], a[28:31]
    s_waitcnt lgkmcnt(4)
    v_mfma_f32_16x16x32_bf16 a[32:35], v[72:75], v[32:35], a[32:35]
    ds_read_b64_tr_b16 v[84:85], v26 offset:9280
    v_mfma_f32_16x16x32_bf16 a[36:39], v[72:75], v[36:39], a[36:39]
    ds_read_b64_tr_b16 v[86:87], v26 offset:11584
    v_mfma_f32_16x16x32_bf16 a[40:43], v[72:75], v[40:43], a[40:43]
    v_mfma_f32_16x16x32_bf16 a[44:47], v[72:75], v[44:47], a[44:47]
    s_waitcnt lgkmcnt(4)
    v_mfma_f32_16x16x32_bf16 a[48:51], v[76:79], v[32:35], a[48:51]
    ds_read_b64_tr_b16 v[88:89], v26 offset:96
    v_mfma_f32_16x16x32_bf16 a[52:55], v[76:79], v[36:39], a[52:55]
    ds_read_b64_tr_b16 v[90:91], v26 offset:2400
    v_mfma_f32_16x16x32_bf16 a[56:59], v[76:79], v[40:43], a[56:59]
    v_mfma_f32_16x16x32_bf16 a[60:63], v[76:79], v[44:47], a[60:63]
    s_waitcnt lgkmcnt(4)
    v_mfma_f32_16x16x32_bf16 a[64:67], v[80:83], v[32:35], a[64:67]
    ds_read_b64_tr_b16 v[92:93], v26 offset:9312
    v_mfma_f32_16x16x32_bf16 a[68:71], v[80:83], v[36:39], a[68:71]
    ds_read_b64_tr_b16 v[94:95], v26 offset:11616
    v_mfma_f32_16x16x32_bf16 a[72:75], v[80:83], v[40:43], a[72:75]
    v_mfma_f32_16x16x32_bf16 a[76:79], v[80:83], v[44:47], a[76:79]
    s_waitcnt lgkmcnt(4)
    v_mfma_f32_16x16x32_bf16 a[80:83], v[84:87], v[32:35], a[80:83]
    ds_read_b64_tr_b16 v[64:65], v26 offset:128
    v_mfma_f32_16x16x32_bf16 a[84:87], v[84:87], v[36:39], a[84:87]
    ds_read_b64_tr_b16 v[66:67], v26 offset:2432
    v_mfma_f32_16x16x32_bf16 a[88:91], v[84:87], v[40:43], a[88:91]
    v_mfma_f32_16x16x32_bf16 a[92:95], v[84:87], v[44:47], a[92:95]
    s_waitcnt lgkmcnt(4)
    v_mfma_f32_16x16x32_bf16 a[96:99], v[88:91], v[32:35], a[96:99]
    ds_read_b64_tr_b16 v[68:69], v26 offset:9344
    v_mfma_f32_16x16x32_bf16 a[100:103], v[88:91], v[36:39], a[100:103]
    ds_read_b64_tr_b16 v[70:71], v26 offset:11648
    v_mfma_f32_16x16x32_bf16 a[104:107], v[88:91], v[40:43], a[104:107]
    v_mfma_f32_16x16x32_bf16 a[108:111], v[88:91], v[44:47], a[108:111]
    s_waitcnt vmcnt(5)
    s_barrier
    s_waitcnt lgkmcnt(4)
    v_mfma_f32_16x16x32_bf16 a[112:115], v[92:95], v[32:35], a[112:115]
    ds_read_b128 v[48:51], v23 offset:0
    ds_read_b128 v[52:55], v23 offset:1024
    ds_read_b64_tr_b16 v[72:73], v27 offset:0
    s_add_u32 m0, s26, 104448
    v_mfma_f32_16x16x32_bf16 a[116:119], v[92:95], v[36:39], a[116:119]
    ds_read_b128 v[56:59], v23 offset:2048
    ds_read_b128 v[60:63], v23 offset:3072
    ds_read_b64_tr_b16 v[74:75], v27 offset:2304
    buffer_load_dwordx4 v16, s[8:11], s27 offen lds
    v_mfma_f32_16x16x32_bf16 a[120:123], v[92:95], v[40:43], a[120:123]
    s_add_u32 m0, s26, 112640
    v_mfma_f32_16x16x32_bf16 a[124:127], v[92:95], v[44:47], a[124:127]
    buffer_load_dwordx4 v17, s[8:11], s27 offen lds
    s_waitcnt lgkmcnt(8)
    v_mfma_f32_16x16x32_bf16 a[128:131], v[64:67], v[32:35], a[128:131]
    ds_read_b64_tr_b16 v[76:77], v27 offset:9216
    s_add_u32 m0, s44, 104448
    v_mfma_f32_16x16x32_bf16 a[132:135], v[64:67], v[36:39], a[132:135]
    ds_read_b64_tr_b16 v[78:79], v27 offset:11520
    buffer_load_dwordx4 v18, s[80:83], s28 offen lds
    v_mfma_f32_16x16x32_bf16 a[136:139], v[64:67], v[40:43], a[136:139]
    s_add_u32 m0, s45, 104448
    v_mfma_f32_16x16x32_bf16 a[140:143], v[64:67], v[44:47], a[140:143]
    buffer_load_dwordx4 v19, s[84:87], s28 offen lds
    s_waitcnt lgkmcnt(8)
    v_mfma_f32_16x16x32_bf16 a[144:147], v[68:71], v[32:35], a[144:147]
    ds_read_b64_tr_b16 v[80:81], v27 offset:32
    s_add_u32 m0, s46, 104448
    v_mfma_f32_16x16x32_bf16 a[148:151], v[68:71], v[36:39], a[148:151]
    ds_read_b64_tr_b16 v[82:83], v27 offset:2336
    s_mov_b64 exec, s[48:49]
    buffer_load_dwordx4 v20, s[88:91], s28 offen lds
    s_mov_b64 exec, -1
    v_mfma_f32_16x16x32_bf16 a[152:155], v[68:71], v[40:43], a[152:155]
    s_add_u32 s27, s27, 64
    s_add_u32 s28, s28, 294912
    v_mfma_f32_16x16x32_bf16 a[156:159], v[68:71], v[44:47], a[156:159]
    s_waitcnt lgkmcnt(4)
    v_mfma_f32_16x16x32_bf16 a[0:3], v[72:75], v[48:51], a[0:3]
    ds_read_b64_tr_b16 v[84:85], v27 offset:9248
    v_mfma_f32_16x16x32_bf16 a[4:7], v[72:75], v[52:55], a[4:7]
    ds_read_b64_tr_b16 v[86:87], v27 offset:11552
    v_mfma_f32_16x16x32_bf16 a[8:11], v[72:75], v[56:59], a[8:11]
    v_mfma_f32_16x16x32_bf16 a[12:15], v[72:75], v[60:63], a[12:15]
    s_waitcnt lgkmcnt(4)
    v_mfma_f32_16x16x32_bf16 a[16:19], v[76:79], v[48:51], a[16:19]
    ds_read_b64_tr_b16 v[88:89], v27 offset:64
    v_mfma_f32_16x16x32_bf16 a[20:23], v[76:79], v[52:55], a[20:23]
    ds_read_b64_tr_b16 v[90:91], v27 offset:2368
    v_mfma_f32_16x16x32_bf16 a[24:27], v[76:79], v[56:59], a[24:27]
    v_mfma_f32_16x16x32_bf16 a[28:31], v[76:79], v[60:63], a[28:31]
    s_waitcnt lgkmcnt(4)
    v_mfma_f32_16x16x32_bf16 a[32:35], v[80:83], v[48:51], a[32:35]
    ds_read_b64_tr_b16 v[92:93], v27 offset:9280
    v_mfma_f32_16x16x32_bf16 a[36:39], v[80:83], v[52:55], a[36:39]
    ds_read_b64_tr_b16 v[94:95], v27 offset:11584
    v_mfma_f32_16x16x32_bf16 a[40:43], v[80:83], v[56:59], a[40:43]
    v_mfma_f32_16x16x32_bf16 a[44:47], v[80:83], v[60:63], a[44:47]
    s_waitcnt lgkmcnt(4)
    v_mfma_f32_16x16x32_bf16 a[48:51], v[84:87], v[48:51], a[48:51]
    ds_read_b64_tr_b16 v[64:65], v27 offset:96
    v_mfma_f32_16x16x32_bf16 a[52:55], v[84:87], v[52:55], a[52:55]
    ds_read_b64_tr_b16 v[66:67], v27 offset:2400
    v_mfma_f32_16x16x32_bf16 a[56:59], v[84:87], v[56:59], a[56:59]
    v_mfma_f32_16x16x32_bf16 a[60:63], v[84:87], v[60:63], a[60:63]
    s_waitcnt lgkmcnt(4)
    v_mfma_f32_16x16x32_bf16 a[64:67], v[88:91], v[48:51], a[64:67]
    ds_read_b64_tr_b16 v[68:69], v27 offset:9312
    v_mfma_f32_16x16x32_bf16 a[68:71], v[88:91], v[52:55], a[68:71]
    ds_read_b64_tr_b16 v[70:71], v27 offset:11616
    v_mfma_f32_16x16x32_bf16 a[72:75], v[88:91], v[56:59], a[72:75]
    v_mfma_f32_16x16x32_bf16 a[76:79], v[88:91], v[60:63], a[76:79]
    s_waitcnt lgkmcnt(4)
    v_mfma_f32_16x16x32_bf16 a[80:83], v[92:95], v[48:51], a[80:83]
    ds_read_b64_tr_b16 v[72:73], v27 offset:128
    v_mfma_f32_16x16x32_bf16 a[84:87], v[92:95], v[52:55], a[84:87]
    ds_read_b64_tr_b16 v[74:75], v27 offset:2432
    v_mfma_f32_16x16x32_bf16 a[88:91], v[92:95], v[56:59], a[88:91]
    v_mfma_f32_16x16x32_bf16 a[92:95], v[92:95], v[60:63], a[92:95]
    s_waitcnt lgkmcnt(4)
    v_mfma_f32_16x16x32_bf16 a[96:99], v[64:67], v[48:51], a[96:99]
    ds_read_b64_tr_b16 v[76:77], v27 offset:9344
    v_mfma_f32_16x16x32_bf16 a[100:103], v[64:67], v[52:55], a[100:103]
    ds_read_b64_tr_b16 v[78:79], v27 offset:11648
    v_mfma_f32_16x16x32_bf16 a[104:107], v[64:67], v[56:59], a[104:107]
    v_mfma_f32_16x16x32_bf16 a[108:111], v[64:67], v[60:63], a[108:111]
    s_waitcnt vmcnt(5)
    s_barrier
    s_waitcnt lgkmcnt(4)
    v_mfma_f32_16x16x32_bf16 a[112:115], v[68:71], v[48:51], a[112:115]
    ds_read_b128 v[32:35], v24 offset:0
    ds_read_b128 v[36:39], v24 offset:1024
    ds_read_b64_tr_b16 v[80:81], v28 offset:0
    s_add_u32 m0, s26, 0
    v_mfma_f32_16x16x32_bf16 a[116:119], v[68:71], v[52:55], a[116:119]
    ds_read_b128 v[40:43], v24 offset:2048
    ds_read_b128 v[44:47], v24 offset:3072
    ds_read_b64_tr_b16 v[82:83], v28 offset:2304
    buffer_load_dwordx4 v16, s[8:11], s27 offen lds
    v_mfma_f32_16x16x32_bf16 a[120:123], v[68:71], v[56:59], a[120:123]
    s_add_u32 m0, s26, 8192
    v_mfma_f32_16x16x32_bf16 a[124:127], v[68:71], v[60:63], a[124:127]
    buffer_load_dwordx4 v17, s[8:11], s27 offen lds
    s_waitcnt lgkmcnt(8)
    v_mfma_f32_16x16x32_bf16 a[128:131], v[72:75], v[48:51], a[128:131]
    ds_read_b64_tr_b16 v[84:85], v28 offset:9216
    s_add_u32 m0, s44, 0
    v_mfma_f32_16x16x32_bf16 a[132:135], v[72:75], v[52:55], a[132:135]
    ds_read_b64_tr_b16 v[86:87], v28 offset:11520
    buffer_load_dwordx4 v18, s[80:83], s28 offen lds
    v_mfma_f32_16x16x32_bf16 a[136:139], v[72:75], v[56:59], a[136:139]
    s_add_u32 m0, s45, 0
    v_mfma_f32_16x16x32_bf16 a[140:143], v[72:75], v[60:63], a[140:143]
    buffer_load_dwordx4 v19, s[84:87], s28 offen lds
    s_waitcnt lgkmcnt(8)
    v_mfma_f32_16x16x32_bf16 a[144:147], v[76:79], v[48:51], a[144:147]
    ds_read_b64_tr_b16 v[88:89], v28 offset:32
    s_add_u32 m0, s46, 0
    v_mfma_f32_16x16x32_bf16 a[148:151], v[76:79], v[52:55], a[148:151]
    ds_read_b64_tr_b16 v[90:91], v28 offset:2336
    s_mov_b64 exec, s[48:49]
    buffer_load_dwordx4 v20, s[88:91], s28 offen lds
    s_mov_b64 exec, -1
    v_mfma_f32_16x16x32_bf16 a[152:155], v[76:79], v[56:59], a[152:155]
    s_add_u32 s27, s27, 64
    s_add_u32 s28, s28, 294912
    v_mfma_f32_16x16x32_bf16 a[156:159], v[76:79], v[60:63], a[156:159]
    s_waitcnt lgkmcnt(4)
    v_mfma_f32_16x16x32_bf16 a[0:3], v[80:83], v[32:35], a[0:3]
    ds_read_b64_tr_b16 v[92:93], v28 offset:9248
    v_mfma_f32_16x16x32_bf16 a[4:7], v[80:83], v[36:39], a[4:7]
    ds_read_b64_tr_b16 v[94:95], v28 offset:11552
    v_mfma_f32_16x16x32_bf16 a[8:11], v[80:83], v[40:43], a[8:11]
    v_mfma_f32_16x16x32_bf16 a[12:15], v[80:83], v[44:47], a[12:15]
    s_waitcnt lgkmcnt(4)
    v_mfma_f32_16x16x32_bf16 a[16:19], v[84:87], v[32:35], a[16:19]
    ds_read_b64_tr_b16 v[64:65], v28 offset:64
    v_mfma_f32_16x16x32_bf16 a[20:23], v[84:87], v[36:39], a[20:23]
    ds_read_b64_tr_b16 v[66:67], v28 offset:2368
    v_mfma_f32_16x16x32_bf16 a[24:27], v[84:87], v[40:43], a[24:27]
    v_mfma_f32_16x16x32_bf16 a[28:31], v[84:87], v[44:47], a[28:31]
    s_waitcnt lgkmcnt(4)
    v_mfma_f32_16x16x32_bf16 a[32:35], v[88:91], v[32:35], a[32:35]
    ds_read_b64_tr_b16 v[68:69], v28 offset:9280
    v_mfma_f32_16x16x32_bf16 a[36:39], v[88:91], v[36:39], a[36:39]
    ds_read_b64_tr_b16 v[70:71], v28 offset:11584
    v_mfma_f32_16x16x32_bf16 a[40:43], v[88:91], v[40:43], a[40:43]
    v_mfma_f32_16x16x32_bf16 a[44:47], v[88:91], v[44:47], a[44:47]
    s_waitcnt lgkmcnt(4)
    v_mfma_f32_16x16x32_bf16 a[48:51], v[92:95], v[32:35], a[48:51]
    ds_read_b64_tr_b16 v[72:73], v28 offset:96
    v_mfma_f32_16x16x32_bf16 a[52:55], v[92:95], v[36:39], a[52:55]
    ds_read_b64_tr_b16 v[74:75], v28 offset:2400
    v_mfma_f32_16x16x32_bf16 a[56:59], v[92:95], v[40:43], a[56:59]
    v_mfma_f32_16x16x32_bf16 a[60:63], v[92:95], v[44:47], a[60:63]
    s_waitcnt lgkmcnt(4)
    v_mfma_f32_16x16x32_bf16 a[64:67], v[64:67], v[32:35], a[64:67]
    ds_read_b64_tr_b16 v[76:77], v28 offset:9312
    v_mfma_f32_16x16x32_bf16 a[68:71], v[64:67], v[36:39], a[68:71]
    ds_read_b64_tr_b16 v[78:79], v28 offset:11616
    v_mfma_f32_16x16x32_bf16 a[72:75], v[64:67], v[40:43], a[72:75]
    v_mfma_f32_16x16x32_bf16 a[76:79], v[64:67], v[44:47], a[76:79]
    s_waitcnt lgkmcnt(4)
    v_mfma_f32_16x16x32_bf16 a[80:83], v[68:71], v[32:35], a[80:83]
    ds_read_b64_tr_b16 v[80:81], v28 offset:128
    v_mfma_f32_16x16x32_bf16 a[84:87], v[68:71], v[36:39], a[84:87]
    ds_read_b64_tr_b16 v[82:83], v28 offset:2432
    v_mfma_f32_16x16x32_bf16 a[88:91], v[68:71], v[40:43], a[88:91]
    v_mfma_f32_16x16x32_bf16 a[92:95], v[68:71], v[44:47], a[92:95]
    s_waitcnt lgkmcnt(4)
    v_mfma_f32_16x16x32_bf16 a[96:99], v[72:75], v[32:35], a[96:99]
    ds_read_b64_tr_b16 v[84:85], v28 offset:9344
    v_mfma_f32_16x16x32_bf16 a[100:103], v[72:75], v[36:39], a[100:103]
    ds_read_b64_tr_b16 v[86:87], v28 offset:11648
    v_mfma_f32_16x16x32_bf16 a[104:107], v[72:75], v[40:43], a[104:107]
    v_mfma_f32_16x16x32_bf16 a[108:111], v[72:75], v[44:47], a[108:111]
    s_waitcnt vmcnt(5)
    s_barrier
    s_waitcnt lgkmcnt(4)
    v_mfma_f32_16x16x32_bf16 a[112:115], v[76:79], v[32:35], a[112:115]
    ds_read_b128 v[48:51], v25 offset:0
    ds_read_b128 v[52:55], v25 offset:1024
    ds_read_b64_tr_b16 v[88:89], v29 offset:0
    s_add_u32 m0, s26, 34816
    v_mfma_f32_16x16x32_bf16 a[116:119], v[76:79], v[36:39], a[116:119]
    ds_read_b128 v[56:59], v25 offset:2048
    ds_read_b128 v[60:63], v25 offset:3072
    ds_read_b64_tr_b16 v[90:91], v29 offset:2304
    buffer_load_dwordx4 v16, s[8:11], s27 offen lds
    v_mfma_f32_16x16x32_bf16 a[120:123], v[76:79], v[40:43], a[120:123]
    s_add_u32 m0, s26, 43008
    v_mfma_f32_16x16x32_bf16 a[124:127], v[76:79], v[44:47], a[124:127]
    buffer_load_dwordx4 v17, s[8:11], s27 offen lds
    s_waitcnt lgkmcnt(8)
    v_mfma_f32_16x16x32_bf16 a[128:131], v[80:83], v[32:35], a[128:131]
    ds_read_b64_tr_b16 v[92:93], v29 offset:9216
    s_add_u32 m0, s44, 34816
    v_mfma_f32_16x16x32_bf16 a[132:135], v[80:83], v[36:39], a[132:135]
    ds_read_b64_tr_b16 v[94:95], v29 offset:11520
    buffer_load_dwordx4 v18, s[80:83], s28 offen lds
    v_mfma_f32_16x16x32_bf16 a[136:139], v[80:83], v[40:43], a[136:139]
    s_add_u32 m0, s45, 34816
    v_mfma_f32_16x16x32_bf16 a[140:143], v[80:83], v[44:47], a[140:143]
    buffer_load_dwordx4 v19, s[84:87], s28 offen lds
    s_waitcnt lgkmcnt(8)
    v_mfma_f32_16x16x32_bf16 a[144:147], v[84:87], v[32:35], a[144:147]
    ds_read_b64_tr_b16 v[64:65], v29 offset:32
    s_add_u32 m0, s46, 34816
    v_mfma_f32_16x16x32_bf16 a[148:151], v[84:87], v[36:39], a[148:151]
    ds_read_b64_tr_b16 v[66:67], v29 offset:2336
    s_mov_b64 exec, s[48:49]
    buffer_load_dwordx4 v20, s[88:91], s28 offen lds
    s_mov_b64 exec, -1
    v_mfma_f32_16x16x32_bf16 a[152:155], v[84:87], v[40:43], a[152:155]
    s_add_u32 s27, s27, 64
    s_add_u32 s28, s28, 294912
    v_mfma_f32_16x16x32_bf16 a[156:159], v[84:87], v[44:47], a[156:159]
    s_waitcnt lgkmcnt(4)
    v_mfma_f32_16x16x32_bf16 a[0:3], v[88:91], v[48:51], a[0:3]
    ds_read_b64_tr_b16 v[68:69], v29 offset:9248
    v_mfma_f32_16x16x32_bf16 a[4:7], v[88:91], v[52:55], a[4:7]
    ds_read_b64_tr_b16 v[70:71], v29 offset:11552
    v_mfma_f32_16x16x32_bf16 a[8:11], v[88:91], v[56:59], a[8:11]
    v_mfma_f32_16x16x32_bf16 a[12:15], v[88:91], v[60:63], a[12:15]
    s_waitcnt lgkmcnt(4)
    v_mfma_f32_16x16x32_bf16 a[16:19], v[92:95], v[48:51], a[16:19]
    ds_read_b64_tr_b16 v[72:73], v29 offset:64
    v_mfma_f32_16x16x32_bf16 a[20:23], v[92:95], v[52:55], a[20:23]
    ds_read_b64_tr_b16 v[74:75], v29 offset:2368
    v_mfma_f32_16x16x32_bf16 a[24:27], v[92:95], v[56:59], a[24:27]
    v_mfma_f32_16x16x32_bf16 a[28:31], v[92:95], v[60:63], a[28:31]
    s_waitcnt lgkmcnt(4)
    v_mfma_f32_16x16x32_bf16 a[32:35], v[64:67], v[48:51], a[32:35]
    ds_read_b64_tr_b16 v[76:77], v29 offset:9280
    v_mfma_f32_16x16x32_bf16 a[36:39], v[64:67], v[52:55], a[36:39]
    ds_read_b64_tr_b16 v[78:79], v29 offset:11584
    v_mfma_f32_16x16x32_bf16 a[40:43], v[64:67], v[56:59], a[40:43]
    v_mfma_f32_16x16x32_bf16 a[44:47], v[64:67], v[60:63], a[44:47]
    s_waitcnt lgkmcnt(4)
    v_mfma_f32_16x16x32_bf16 a[48:51], v[68:71], v[48:51], a[48:51]
    ds_read_b64_tr_b16 v[80:81], v29 offset:96
    v_mfma_f32_16x16x32_bf16 a[52:55], v[68:71], v[52:55], a[52:55]
    ds_read_b64_tr_b16 v[82:83], v29 offset:2400
    v_mfma_f32_16x16x32_bf16 a[56:59], v[68:71], v[56:59], a[56:59]
    v_mfma_f32_16x16x32_bf16 a[60:63], v[68:71], v[60:63], a[60:63]
    s_waitcnt lgkmcnt(4)
    v_mfma_f32_16x16x32_bf16 a[64:67], v[72:75], v[48:51], a[64:67]
    ds_read_b64_tr_b16 v[84:85], v29 offset:9312
    v_mfma_f32_16x16x32_bf16 a[68:71], v[72:75], v[52:55], a[68:71]
    ds_read_b64_tr_b16 v[86:87], v29 offset:11616
    v_mfma_f32_16x16x32_bf16 a[72:75], v[72:75], v[56:59], a[72:75]
    v_mfma_f32_16x16x32_bf16 a[76:79], v[72:75], v[60:63], a[76:79]
    s_waitcnt lgkmcnt(4)
    v_mfma_f32_16x16x32_bf16 a[80:83], v[76:79], v[48:51], a[80:83]
    ds_read_b64_tr_b16 v[88:89], v29 offset:128
    v_mfma_f32_16x16x32_bf16 a[84:87], v[76:79], v[52:55], a[84:87]
    ds_read_b64_tr_b16 v[90:91], v29 offset:2432
    v_mfma_f32_16x16x32_bf16 a[88:91], v[76:79], v[56:59], a[88:91]
    v_mfma_f32_16x16x32_bf16 a[92:95], v[76:79], v[60:63], a[92:95]
    s_waitcnt lgkmcnt(4)
    v_mfma_f32_16x16x32_bf16 a[96:99], v[80:83], v[48:51], a[96:99]
    ds_read_b64_tr_b16 v[92:93], v29 offset:9344
    v_mfma_f32_16x16x32_bf16 a[100:103], v[80:83], v[52:55], a[100:103]
    ds_read_b64_tr_b16 v[94:95], v29 offset:11648
    v_mfma_f32_16x16x32_bf16 a[104:107], v[80:83], v[56:59], a[104:107]
    v_mfma_f32_16x16x32_bf16 a[108:111], v[80:83], v[60:63], a[108:111]
    s_waitcnt vmcnt(5)
    s_barrier
    s_waitcnt lgkmcnt(4)
    v_mfma_f32_16x16x32_bf16 a[112:115], v[84:87], v[48:51], a[112:115]
    ds_read_b128 v[32:35], v22 offset:0
    ds_read_b128 v[36:39], v22 offset:1024
    ds_read_b64_tr_b16 v[64:65], v26 offset:0
    s_add_u32 m0, s26, 69632
    v_mfma_f32_16x16x32_bf16 a[116:119], v[84:87], v[52:55], a[116:119]
    ds_read_b128 v[40:43], v22 offset:2048
    ds_read_b128 v[44:47], v22 offset:3072
    ds_read_b64_tr_b16 v[66:67], v26 offset:2304
    buffer_load_dwordx4 v16, s[8:11], s27 offen lds
    v_mfma_f32_16x16x32_bf16 a[120:123], v[84:87], v[56:59], a[120:123]
    s_add_u32 m0, s26, 77824
    v_mfma_f32_16x16x32_bf16 a[124:127], v[84:87], v[60:63], a[124:127]
    buffer_load_dwordx4 v17, s[8:11], s27 offen lds
    s_waitcnt lgkmcnt(8)
    v_mfma_f32_16x16x32_bf16 a[128:131], v[88:91], v[48:51], a[128:131]
    ds_read_b64_tr_b16 v[68:69], v26 offset:9216
    s_add_u32 m0, s44, 69632
    v_mfma_f32_16x16x32_bf16 a[132:135], v[88:91], v[52:55], a[132:135]
    ds_read_b64_tr_b16 v[70:71], v26 offset:11520
    buffer_load_dwordx4 v18, s[80:83], s28 offen lds
    v_mfma_f32_16x16x32_bf16 a[136:139], v[88:91], v[56:59], a[136:139]
    s_add_u32 m0, s45, 69632
    v_mfma_f32_16x16x32_bf16 a[140:143], v[88:91], v[60:63], a[140:143]
    buffer_load_dwordx4 v19, s[84:87], s28 offen lds
    s_waitcnt lgkmcnt(8)
    v_mfma_f32_16x16x32_bf16 a[144:147], v[92:95], v[48:51], a[144:147]
    ds_read_b64_tr_b16 v[72:73], v26 offset:32
    s_add_u32 m0, s46, 69632
    v_mfma_f32_16x16x32_bf16 a[148:151], v[92:95], v[52:55], a[148:151]
    ds_read_b64_tr_b16 v[74:75], v26 offset:2336
    s_mov_b64 exec, s[48:49]
    buffer_load_dwordx4 v20, s[88:91], s28 offen lds
    s_mov_b64 exec, -1
    v_mfma_f32_16x16x32_bf16 a[152:155], v[92:95], v[56:59], a[152:155]
    s_add_u32 s27, s27, 64
    s_add_u32 s28, s28, 294912
    v_mfma_f32_16x16x32_bf16 a[156:159], v[92:95], v[60:63], a[156:159]
    s_waitcnt lgkmcnt(4)
    v_mfma_f32_16x16x32_bf16 a[0:3], v[64:67], v[32:35], a[0:3]
    ds_read_b64_tr_b16 v[76:77], v26 offset:9248
    v_mfma_f32_16x16x32_bf16 a[4:7], v[64:67], v[36:39], a[4:7]
    ds_read_b64_tr_b16 v[78:79], v26 offset:11552
    v_mfma_f32_16x16x32_bf16 a[8:11], v[64:67], v[40:43], a[8:11]
    v_mfma_f32_16x16x32_bf16 a[12:15], v[64:67], v[44:47], a[12:15]
    s_waitcnt lgkmcnt(4)
    v_mfma_f32_16x16x32_bf16 a[16:19], v[68:71], v[32:35], a[16:19]
    ds_read_b64_tr_b16 v[80:81], v26 offset:64
    v_mfma_f32_16x16x32_bf16 a[20:23], v[68:71], v[36:39], a[20:23]
    ds_read_b64_tr_b16 v[82:83], v26 offset:2368
    v_mfma_f32_16x16x32_bf16 a[24:27], v[68:71], v[40:43], a[24:27]
    v_mfma_f32_16x16x32_bf16 a[28:31], v[68:71], v[44:47], a[28:31]
    s_waitcnt lgkmcnt(4)
    v_mfma_f32_16x16x32_bf16 a[32:35], v[72:75], v[32:35], a[32:35]
    ds_read_b64_tr_b16 v[84:85], v26 offset:9280
    v_mfma_f32_16x16x32_bf16 a[36:39], v[72:75], v[36:39], a[36:39]
    ds_read_b64_tr_b16 v[86:87], v26 offset:11584
    v_mfma_f32_16x16x32_bf16 a[40:43], v[72:75], v[40:43], a[40:43]
    v_mfma_f32_16x16x32_bf16 a[44:47], v[72:75], v[44:47], a[44:47]
    s_waitcnt lgkmcnt(4)
    v_mfma_f32_16x16x32_bf16 a[48:51], v[76:79], v[32:35], a[48:51]
    ds_read_b64_tr_b16 v[88:89], v26 offset:96
    v_mfma_f32_16x16x32_bf16 a[52:55], v[76:79], v[36:39], a[52:55]
    ds_read_b64_tr_b16 v[90:91], v26 offset:2400
    v_mfma_f32_16x16x32_bf16 a[56:59], v[76:79], v[40:43], a[56:59]
    v_mfma_f32_16x16x32_bf16 a[60:63], v[76:79], v[44:47], a[60:63]
    s_waitcnt lgkmcnt(4)
    v_mfma_f32_16x16x32_bf16 a[64:67], v[80:83], v[32:35], a[64:67]
    ds_read_b64_tr_b16 v[92:93], v26 offset:9312
    v_mfma_f32_16x16x32_bf16 a[68:71], v[80:83], v[36:39], a[68:71]
    ds_read_b64_tr_b16 v[94:95], v26 offset:11616
    v_mfma_f32_16x16x32_bf16 a[72:75], v[80:83], v[40:43], a[72:75]
    v_mfma_f32_16x16x32_bf16 a[76:79], v[80:83], v[44:47], a[76:79]
    s_waitcnt lgkmcnt(4)
    v_mfma_f32_16x16x32_bf16 a[80:83], v[84:87], v[32:35], a[80:83]
    ds_read_b64_tr_b16 v[64:65], v26 offset:128
    v_mfma_f32_16x16x32_bf16 a[84:87], v[84:87], v[36:39], a[84:87]
    ds_read_b64_tr_b16 v[66:67], v26 offset:2432
    v_mfma_f32_16x16x32_bf16 a[88:91], v[84:87], v[40:43], a[88:91]
    v_mfma_f32_16x16x32_bf16 a[92:95], v[84:87], v[44:47], a[92:95]
    s_waitcnt lgkmcnt(4)
    v_mfma_f32_16x16x32_bf16 a[96:99], v[88:91], v[32:35], a[96:99]
    ds_read_b64_tr_b16 v[68:69], v26 offset:9344
    v_mfma_f32_16x16x32_bf16 a[100:103], v[88:91], v[36:39], a[100:103]
    ds_read_b64_tr_b16 v[70:71], v26 offset:11648
    v_mfma_f32_16x16x32_bf16 a[104:107], v[88:91], v[40:43], a[104:107]
    v_mfma_f32_16x16x32_bf16 a[108:111], v[88:91], v[44:47], a[108:111]
    s_waitcnt vmcnt(5)
    s_barrier
    s_waitcnt lgkmcnt(4)
    v_mfma_f32_16x16x32_bf16 a[112:115], v[92:95], v[32:35], a[112:115]
    ds_read_b128 v[48:51], v23 offset:0
    ds_read_b128 v[52:55], v23 offset:1024
    ds_read_b64_tr_b16 v[72:73], v27 offset:0
    s_add_u32 m0, s26, 104448
    v_mfma_f32_16x16x32_bf16 a[116:119], v[92:95], v[36:39], a[116:119]
    ds_read_b128 v[56:59], v23 offset:2048
    ds_read_b128 v[60:63], v23 offset:3072
    ds_read_b64_tr_b16 v[74:75], v27 offset:2304
    buffer_load_dwordx4 v16, s[8:11], s27 offen lds
    v_mfma_f32_16x16x32_bf16 a[120:123], v[92:95], v[40:43], a[120:123]
    s_add_u32 m0, s26, 112640
    v_mfma_f32_16x16x32_bf16 a[124:127], v[92:95], v[44:47], a[124:127]
    buffer_load_dwordx4 v17, s[8:11], s27 offen lds
    s_waitcnt lgkmcnt(8)
    v_mfma_f32_16x16x32_bf16 a[128:131], v[64:67], v[32:35], a[128:131]
    ds_read_b64_tr_b16 v[76:77], v27 offset:9216
    s_add_u32 m0, s44, 104448
    v_mfma_f32_16x16x32_bf16 a[132:135], v[64:67], v[36:39], a[132:135]
    ds_read_b64_tr_b16 v[78:79], v27 offset:11520
    buffer_load_dwordx4 v18, s[80:83], s28 offen lds
    v_mfma_f32_16x16x32_bf16 a[136:139], v[64:67], v[40:43], a[136:139]
    s_add_u32 m0, s45, 104448
    v_mfma_f32_16x16x32_bf16 a[140:143], v[64:67], v[44:47], a[140:143]
    buffer_load_dwordx4 v19, s[84:87], s28 offen lds
    s_waitcnt lgkmcnt(8)
    v_mfma_f32_16x16x32_bf16 a[144:147], v[68:71], v[32:35], a[144:147]
    ds_read_b64_tr_b16 v[80:81], v27 offset:32
    s_add_u32 m0, s46, 104448
    v_mfma_f32_16x16x32_bf16 a[148:151], v[68:71], v[36:39], a[148:151]
    ds_read_b64_tr_b16 v[82:83], v27 offset:2336
    s_mov_b64 exec, s[48:49]
    buffer_load_dwordx4 v20, s[88:91], s28 offen lds
    s_mov_b64 exec, -1
    v_mfma_f32_16x16x32_bf16 a[152:155], v[68:71], v[40:43], a[152:155]
    s_add_u32 s27, s27, 64
    s_add_u32 s28, s28, 294912
    v_mfma_f32_16x16x32_bf16 a[156:159], v[68:71], v[44:47], a[156:159]
    s_waitcnt lgkmcnt(4)
    v_mfma_f32_16x16x32_bf16 a[0:3], v[72:75], v[48:51], a[0:3]
    ds_read_b64_tr_b16 v[84:85], v27 offset:9248
    v_mfma_f32_16x16x32_bf16 a[4:7], v[72:75], v[52:55], a[4:7]
    ds_read_b64_tr_b16 v[86:87], v27 offset:11552
    v_mfma_f32_16x16x32_bf16 a[8:11], v[72:75], v[56:59], a[8:11]
    v_mfma_f32_16x16x32_bf16 a[12:15], v[72:75], v[60:63], a[12:15]
    s_waitcnt lgkmcnt(4)
    v_mfma_f32_16x16x32_bf16 a[16:19], v[76:79], v[48:51], a[16:19]
    ds_read_b64_tr_b16 v[88:89], v27 offset:64
    v_mfma_f32_16x16x32_bf16 a[20:23], v[76:79], v[52:55], a[20:23]
    ds_read_b64_tr_b16 v[90:91], v27 offset:2368
    v_mfma_f32_16x16x32_bf16 a[24:27], v[76:79], v[56:59], a[24:27]
    v_mfma_f32_16x16x32_bf16 a[28:31], v[76:79], v[60:63], a[28:31]
    s_waitcnt lgkmcnt(4)
    v_mfma_f32_16x16x32_bf16 a[32:35], v[80:83], v[48:51], a[32:35]
    ds_read_b64_tr_b16 v[92:93], v27 offset:9280
    v_mfma_f32_16x16x32_bf16 a[36:39], v[80:83], v[52:55], a[36:39]
    ds_read_b64_tr_b16 v[94:95], v27 offset:11584
    v_mfma_f32_16x16x32_bf16 a[40:43], v[80:83], v[56:59], a[40:43]
    v_mfma_f32_16x16x32_bf16 a[44:47], v[80:83], v[60:63], a[44:47]
    s_waitcnt lgkmcnt(4)
    v_mfma_f32_16x16x32_bf16 a[48:51], v[84:87], v[48:51], a[48:51]
    ds_read_b64_tr_b16 v[64:65], v27 offset:96
    v_mfma_f32_16x16x32_bf16 a[52:55], v[84:87], v[52:55], a[52:55]
    ds_read_b64_tr_b16 v[66:67], v27 offset:2400
    v_mfma_f32_16x16x32_bf16 a[56:59], v[84:87], v[56:59], a[56:59]
    v_mfma_f32_16x16x32_bf16 a[60:63], v[84:87], v[60:63], a[60:63]
    s_waitcnt lgkmcnt(4)
    v_mfma_f32_16x16x32_bf16 a[64:67], v[88:91], v[48:51], a[64:67]
    ds_read_b64_tr_b16 v[68:69], v27 offset:9312
    v_mfma_f32_16x16x32_bf16 a[68:71], v[88:91], v[52:55], a[68:71]
    ds_read_b64_tr_b16 v[70:71], v27 offset:11616
    v_mfma_f32_16x16x32_bf16 a[72:75], v[88:91], v[56:59], a[72:75]
    v_mfma_f32_16x16x32_bf16 a[76:79], v[88:91], v[60:63], a[76:79]
    s_waitcnt lgkmcnt(4)
    v_mfma_f32_16x16x32_bf16 a[80:83], v[92:95], v[48:51], a[80:83]
    ds_read_b64_tr_b16 v[72:73], v27 offset:128
    v_mfma_f32_16x16x32_bf16 a[84:87], v[92:95], v[52:55], a[84:87]
    ds_read_b64_tr_b16 v[74:75], v27 offset:2432
    v_mfma_f32_16x16x32_bf16 a[88:91], v[92:95], v[56:59], a[88:91]
    v_mfma_f32_16x16x32_bf16 a[92:95], v[92:95], v[60:63], a[92:95]
    s_waitcnt lgkmcnt(4)
    v_mfma_f32_16x16x32_bf16 a[96:99], v[64:67], v[48:51], a[96:99]
    ds_read_b64_tr_b16 v[76:77], v27 offset:9344
    v_mfma_f32_16x16x32_bf16 a[100:103], v[64:67], v[52:55], a[100:103]
    ds_read_b64_tr_b16 v[78:79], v27 offset:11648
    v_mfma_f32_16x16x32_bf16 a[104:107], v[64:67], v[56:59], a[104:107]
    v_mfma_f32_16x16x32_bf16 a[108:111], v[64:67], v[60:63], a[108:111]
    s_waitcnt vmcnt(5)
    s_barrier
    s_waitcnt lgkmcnt(4)
    v_mfma_f32_16x16x32_bf16 a[112:115], v[68:71], v[48:51], a[112:115]
    ds_read_b128 v[32:35], v24 offset:0
    ds_read_b128 v[36:39], v24 offset:1024
    ds_read_b64_tr_b16 v[80:81], v28 offset:0
    s_add_u32 m0, s26, 0
    v_mfma_f32_16x16x32_bf16 a[116:119], v[68:71], v[52:55], a[116:119]
    ds_read_b128 v[40:43], v24 offset:2048
    ds_read_b128 v[44:47], v24 offset:3072
    ds_read_b64_tr_b16 v[82:83], v28 offset:2304
    buffer_load_dwordx4 v16, s[8:11], s27 offen lds
    v_mfma_f32_16x16x32_bf16 a[120:123], v[68:71], v[56:59], a[120:123]
    s_add_u32 m0, s26, 8192
    v_mfma_f32_16x16x32_bf16 a[124:127], v[68:71], v[60:63], a[124:127]
    buffer_load_dwordx4 v17, s[8:11], s27 offen lds
    s_waitcnt lgkmcnt(8)
    v_mfma_f32_16x16x32_bf16 a[128:131], v[72:75], v[48:51], a[128:131]
    ds_read_b64_tr_b16 v[84:85], v28 offset:9216
    s_add_u32 m0, s44, 0
    v_mfma_f32_16x16x32_bf16 a[132:135], v[72:75], v[52:55], a[132:135]
    ds_read_b64_tr_b16 v[86:87], v28 offset:11520
    buffer_load_dwordx4 v18, s[80:83], s28 offen lds
    v_mfma_f32_16x16x32_bf16 a[136:139], v[72:75], v[56:59], a[136:139]
    s_add_u32 m0, s45, 0
    v_mfma_f32_16x16x32_bf16 a[140:143], v[72:75], v[60:63], a[140:143]
    buffer_load_dwordx4 v19, s[84:87], s28 offen lds
    s_waitcnt lgkmcnt(8)
    v_mfma_f32_16x16x32_bf16 a[144:147], v[76:79], v[48:51], a[144:147]
    ds_read_b64_tr_b16 v[88:89], v28 offset:32
    s_add_u32 m0, s46, 0
    v_mfma_f32_16x16x32_bf16 a[148:151], v[76:79], v[52:55], a[148:151]
    ds_read_b64_tr_b16 v[90:91], v28 offset:2336
    s_mov_b64 exec, s[48:49]
    buffer_load_dwordx4 v20, s[88:91], s28 offen lds
    s_mov_b64 exec, -1
    v_mfma_f32_16x16x32_bf16 a[152:155], v[76:79], v[56:59], a[152:155]
    s_add_u32 s27, s27, 64
    s_add_u32 s28, s28, 294912
    v_mfma_f32_16x16x32_bf16 a[156:159], v[76:79], v[60:63], a[156:159]
    s_waitcnt lgkmcnt(4)
    v_mfma_f32_16x16x32_bf16 a[0:3], v[80:83], v[32:35], a[0:3]
    ds_read_b64_tr_b16 v[92:93], v28 offset:9248
    v_mfma_f32_16x16x32_bf16 a[4:7], v[80:83], v[36:39], a[4:7]
    ds_read_b64_tr_b16 v[94:95], v28 offset:11552
    v_mfma_f32_16x16x32_bf16 a[8:11], v[80:83], v[40:43], a[8:11]
    v_mfma_f32_16x16x32_bf16 a[12:15], v[80:83], v[44:47], a[12:15]
    s_waitcnt lgkmcnt(4)
    v_mfma_f32_16x16x32_bf16 a[16:19], v[84:87], v[32:35], a[16:19]
    ds_read_b64_tr_b16 v[64:65], v28 offset:64
    v_mfma_f32_16x16x32_bf16 a[20:23], v[84:87], v[36:39], a[20:23]
    ds_read_b64_tr_b16 v[66:67], v28 offset:2368
    v_mfma_f32_16x16x32_bf16 a[24:27], v[84:87], v[40:43], a[24:27]
    v_mfma_f32_16x16x32_bf16 a[28:31], v[84:87], v[44:47], a[28:31]
    s_waitcnt lgkmcnt(4)
    v_mfma_f32_16x16x32_bf16 a[32:35], v[88:91], v[32:35], a[32:35]
    ds_read_b64_tr_b16 v[68:69], v28 offset:9280
    v_mfma_f32_16x16x32_bf16 a[36:39], v[88:91], v[36:39], a[36:39]
    ds_read_b64_tr_b16 v[70:71], v28 offset:11584
    v_mfma_f32_16x16x32_bf16 a[40:43], v[88:91], v[40:43], a[40:43]
    v_mfma_f32_16x16x32_bf16 a[44:47], v[88:91], v[44:47], a[44:47]
    s_waitcnt lgkmcnt(4)
    v_mfma_f32_16x16x32_bf16 a[48:51], v[92:95], v[32:35], a[48:51]
    ds_read_b64_tr_b16 v[72:73], v28 offset:96
    v_mfma_f32_16x16x32_bf16 a[52:55], v[92:95], v[36:39], a[52:55]
    ds_read_b64_tr_b16 v[74:75], v28 offset:2400
    v_mfma_f32_16x16x32_bf16 a[56:59], v[92:95], v[40:43], a[56:59]
    v_mfma_f32_16x16x32_bf16 a[60:63], v[92:95], v[44:47], a[60:63]
    s_waitcnt lgkmcnt(4)
    v_mfma_f32_16x16x32_bf16 a[64:67], v[64:67], v[32:35], a[64:67]
    ds_read_b64_tr_b16 v[76:77], v28 offset:9312
    v_mfma_f32_16x16x32_bf16 a[68:71], v[64:67], v[36:39], a[68:71]
    ds_read_b64_tr_b16 v[78:79], v28 offset:11616
    v_mfma_f32_16x16x32_bf16 a[72:75], v[64:67], v[40:43], a[72:75]
    v_mfma_f32_16x16x32_bf16 a[76:79], v[64:67], v[44:47], a[76:79]
    s_waitcnt lgkmcnt(4)
    v_mfma_f32_16x16x32_bf16 a[80:83], v[68:71], v[32:35], a[80:83]
    ds_read_b64_tr_b16 v[80:81], v28 offset:128
    v_mfma_f32_16x16x32_bf16 a[84:87], v[68:71], v[36:39], a[84:87]
    ds_read_b64_tr_b16 v[82:83], v28 offset:2432
    v_mfma_f32_16x16x32_bf16 a[88:91], v[68:71], v[40:43], a[88:91]
    v_mfma_f32_16x16x32_bf16 a[92:95], v[68:71], v[44:47], a[92:95]
    s_waitcnt lgkmcnt(4)
    v_mfma_f32_16x16x32_bf16 a[96:99], v[72:75], v[32:35], a[96:99]
    ds_read_b64_tr_b16 v[84:85], v28 offset:9344
    v_mfma_f32_16x16x32_bf16 a[100:103], v[72:75], v[36:39], a[100:103]
    ds_read_b64_tr_b16 v[86:87], v28 offset:11648
    v_mfma_f32_16x16x32_bf16 a[104:107], v[72:75], v[40:43], a[104:107]
    v_mfma_f32_16x16x32_bf16 a[108:111], v[72:75], v[44:47], a[108:111]
    s_waitcnt vmcnt(5)
    s_barrier
    s_waitcnt lgkmcnt(4)
    v_mfma_f32_16x16x32_bf16 a[112:115], v[76:79], v[32:35], a[112:115]
    ds_read_b128 v[48:51], v25 offset:0
    ds_read_b128 v[52:55], v25 offset:1024
    ds_read_b64_tr_b16 v[88:89], v29 offset:0
    s_add_u32 m0, s26, 34816
    v_mfma_f32_16x16x32_bf16 a[116:119], v[76:79], v[36:39], a[116:119]
    ds_read_b128 v[56:59], v25 offset:2048
    ds_read_b128 v[60:63], v25 offset:3072
    ds_read_b64_tr_b16 v[90:91], v29 offset:2304
    buffer_load_dwordx4 v16, s[8:11], s27 offen lds
    v_mfma_f32_16x16x32_bf16 a[120:123], v[76:79], v[40:43], a[120:123]
    s_add_u32 m0, s26, 43008
    v_mfma_f32_16x16x32_bf16 a[124:127], v[76:79], v[44:47], a[124:127]
    buffer_load_dwordx4 v17, s[8:11], s27 offen lds
    s_waitcnt lgkmcnt(8)
    v_mfma_f32_16x16x32_bf16 a[128:131], v[80:83], v[32:35], a[128:131]
    ds_read_b64_tr_b16 v[92:93], v29 offset:9216
    s_add_u32 m0, s44, 34816
    v_mfma_f32_16x16x32_bf16 a[132:135], v[80:83], v[36:39], a[132:135]
    ds_read_b64_tr_b16 v[94:95], v29 offset:11520
    buffer_load_dwordx4 v18, s[80:83], s28 offen lds
    v_mfma_f32_16x16x32_bf16 a[136:139], v[80:83], v[40:43], a[136:139]
    s_add_u32 m0, s45, 34816
    v_mfma_f32_16x16x32_bf16 a[140:143], v[80:83], v[44:47], a[140:143]
    buffer_load_dwordx4 v19, s[84:87], s28 offen lds
    s_waitcnt lgkmcnt(8)
    v_mfma_f32_16x16x32_bf16 a[144:147], v[84:87], v[32:35], a[144:147]
    ds_read_b64_tr_b16 v[64:65], v29 offset:32
    s_add_u32 m0, s46, 34816
    v_mfma_f32_16x16x32_bf16 a[148:151], v[84:87], v[36:39], a[148:151]
    ds_read_b64_tr_b16 v[66:67], v29 offset:2336
    s_mov_b64 exec, s[48:49]
    buffer_load_dwordx4 v20, s[88:91], s28 offen lds
    s_mov_b64 exec, -1
    v_mfma_f32_16x16x32_bf16 a[152:155], v[84:87], v[40:43], a[152:155]
    s_add_u32 s27, s27, 64
    s_add_u32 s28, s28, 294912
    v_mfma_f32_16x16x32_bf16 a[156:159], v[84:87], v[44:47], a[156:159]
    s_waitcnt lgkmcnt(4)
    v_mfma_f32_16x16x32_bf16 a[0:3], v[88:91], v[48:51], a[0:3]
    ds_read_b64_tr_b16 v[68:69], v29 offset:9248
    v_mfma_f32_16x16x32_bf16 a[4:7], v[88:91], v[52:55], a[4:7]
    ds_read_b64_tr_b16 v[70:71], v29 offset:11552
    v_mfma_f32_16x16x32_bf16 a[8:11], v[88:91], v[56:59], a[8:11]
    v_mfma_f32_16x16x32_bf16 a[12:15], v[88:91], v[60:63], a[12:15]
    s_waitcnt lgkmcnt(4)
    v_mfma_f32_16x16x32_bf16 a[16:19], v[92:95], v[48:51], a[16:19]
    ds_read_b64_tr_b16 v[72:73], v29 offset:64
    v_mfma_f32_16x16x32_bf16 a[20:23], v[92:95], v[52:55], a[20:23]
    ds_read_b64_tr_b16 v[74:75], v29 offset:2368
    v_mfma_f32_16x16x32_bf16 a[24:27], v[92:95], v[56:59], a[24:27]
    v_mfma_f32_16x16x32_bf16 a[28:31], v[92:95], v[60:63], a[28:31]
    s_waitcnt lgkmcnt(4)
    v_mfma_f32_16x16x32_bf16 a[32:35], v[64:67], v[48:51], a[32:35]
    ds_read_b64_tr_b16 v[76:77], v29 offset:9280
    v_mfma_f32_16x16x32_bf16 a[36:39], v[64:67], v[52:55], a[36:39]
    ds_read_b64_tr_b16 v[78:79], v29 offset:11584
    v_mfma_f32_16x16x32_bf16 a[40:43], v[64:67], v[56:59], a[40:43]
    v_mfma_f32_16x16x32_bf16 a[44:47], v[64:67], v[60:63], a[44:47]
    s_waitcnt lgkmcnt(4)
    v_mfma_f32_16x16x32_bf16 a[48:51], v[68:71], v[48:51], a[48:51]
    ds_read_b64_tr_b16 v[80:81], v29 offset:96
    v_mfma_f32_16x16x32_bf16 a[52:55], v[68:71], v[52:55], a[52:55]
    ds_read_b64_tr_b16 v[82:83], v29 offset:2400
    v_mfma_f32_16x16x32_bf16 a[56:59], v[68:71], v[56:59], a[56:59]
    v_mfma_f32_16x16x32_bf16 a[60:63], v[68:71], v[60:63], a[60:63]
    s_waitcnt lgkmcnt(4)
    v_mfma_f32_16x16x32_bf16 a[64:67], v[72:75], v[48:51], a[64:67]
    ds_read_b64_tr_b16 v[84:85], v29 offset:9312
    v_mfma_f32_16x16x32_bf16 a[68:71], v[72:75], v[52:55], a[68:71]
    ds_read_b64_tr_b16 v[86:87], v29 offset:11616
    v_mfma_f32_16x16x32_bf16 a[72:75], v[72:75], v[56:59], a[72:75]
    v_mfma_f32_16x16x32_bf16 a[76:79], v[72:75], v[60:63], a[76:79]
    s_waitcnt lgkmcnt(4)
    v_mfma_f32_16x16x32_bf16 a[80:83], v[76:79], v[48:51], a[80:83]
    ds_read_b64_tr_b16 v[88:89], v29 offset:128
    v_mfma_f32_16x16x32_bf16 a[84:87], v[76:79], v[52:55], a[84:87]
    ds_read_b64_tr_b16 v[90:91], v29 offset:2432
    v_mfma_f32_16x16x32_bf16 a[88:91], v[76:79], v[56:59], a[88:91]
    v_mfma_f32_16x16x32_bf16 a[92:95], v[76:79], v[60:63], a[92:95]
    s_waitcnt lgkmcnt(4)
    v_mfma_f32_16x16x32_bf16 a[96:99], v[80:83], v[48:51], a[96:99]
    ds_read_b64_tr_b16 v[92:93], v29 offset:9344
    v_mfma_f32_16x16x32_bf16 a[100:103], v[80:83], v[52:55], a[100:103]
    ds_read_b64_tr_b16 v[94:95], v29 offset:11648
    v_mfma_f32_16x16x32_bf16 a[104:107], v[80:83], v[56:59], a[104:107]
    v_mfma_f32_16x16x32_bf16 a[108:111], v[80:83], v[60:63], a[108:111]
    s_waitcnt vmcnt(5)
    s_barrier
    s_waitcnt lgkmcnt(4)
    v_mfma_f32_16x16x32_bf16 a[112:115], v[84:87], v[48:51], a[112:115]
    ds_read_b128 v[32:35], v22 offset:0
    ds_read_b128 v[36:39], v22 offset:1024
    ds_read_b64_tr_b16 v[64:65], v26 offset:0
    s_add_u32 m0, s26, 69632
    v_mfma_f32_16x16x32_bf16 a[116:119], v[84:87], v[52:55], a[116:119]
    ds_read_b128 v[40:43], v22 offset:2048
    ds_read_b128 v[44:47], v22 offset:3072
    ds_read_b64_tr_b16 v[66:67], v26 offset:2304
    buffer_load_dwordx4 v16, s[8:11], s27 offen lds
    v_mfma_f32_16x16x32_bf16 a[120:123], v[84:87], v[56:59], a[120:123]
    s_add_u32 m0, s26, 77824
    v_mfma_f32_16x16x32_bf16 a[124:127], v[84:87], v[60:63], a[124:127]
    buffer_load_dwordx4 v17, s[8:11], s27 offen lds
    s_waitcnt lgkmcnt(8)
    v_mfma_f32_16x16x32_bf16 a[128:131], v[88:91], v[48:51], a[128:131]
    ds_read_b64_tr_b16 v[68:69], v26 offset:9216
    s_add_u32 m0, s44, 69632
    v_mfma_f32_16x16x32_bf16 a[132:135], v[88:91], v[52:55], a[132:135]
    ds_read_b64_tr_b16 v[70:71], v26 offset:11520
    buffer_load_dwordx4 v18, s[80:83], s28 offen lds
    v_mfma_f32_16x16x32_bf16 a[136:139], v[88:91], v[56:59], a[136:139]
    s_add_u32 m0, s45, 69632
    v_mfma_f32_16x16x32_bf16 a[140:143], v[88:91], v[60:63], a[140:143]
    buffer_load_dwordx4 v19, s[84:87], s28 offen lds
    s_waitcnt lgkmcnt(8)
    v_mfma_f32_16x16x32_bf16 a[144:147], v[92:95], v[48:51], a[144:147]
    ds_read_b64_tr_b16 v[72:73], v26 offset:32
    s_add_u32 m0, s46, 69632
    v_mfma_f32_16x16x32_bf16 a[148:151], v[92:95], v[52:55], a[148:151]
    ds_read_b64_tr_b16 v[74:75], v26 offset:2336
    s_mov_b64 exec, s[48:49]
    buffer_load_dwordx4 v20, s[88:91], s28 offen lds
    s_mov_b64 exec, -1
    v_mfma_f32_16x16x32_bf16 a[152:155], v[92:95], v[56:59], a[152:155]
    s_add_u32 s27, s27, 64
    s_add_u32 s28, s28, 294912
    v_mfma_f32_16x16x32_bf16 a[156:159], v[92:95], v[60:63], a[156:159]
    s_waitcnt lgkmcnt(4)
    v_mfma_f32_16x16x32_bf16 a[0:3], v[64:67], v[32:35], a[0:3]
    ds_read_b64_tr_b16 v[76:77], v26 offset:9248
    v_mfma_f32_16x16x32_bf16 a[4:7], v[64:67], v[36:39], a[4:7]
    ds_read_b64_tr_b16 v[78:79], v26 offset:11552
    v_mfma_f32_16x16x32_bf16 a[8:11], v[64:67], v[40:43], a[8:11]
    v_mfma_f32_16x16x32_bf16 a[12:15], v[64:67], v[44:47], a[12:15]
    s_waitcnt lgkmcnt(4)
    v_mfma_f32_16x16x32_bf16 a[16:19], v[68:71], v[32:35], a[16:19]
    ds_read_b64_tr_b16 v[80:81], v26 offset:64
    v_mfma_f32_16x16x32_bf16 a[20:23], v[68:71], v[36:39], a[20:23]
    ds_read_b64_tr_b16 v[82:83], v26 offset:2368
    v_mfma_f32_16x16x32_bf16 a[24:27], v[68:71], v[40:43], a[24:27]
    v_mfma_f32_16x16x32_bf16 a[28:31], v[68:71], v[44:47], a[28:31]
    s_waitcnt lgkmcnt(4)
    v_mfma_f32_16x16x32_bf16 a[32:35], v[72:75], v[32:35], a[32:35]
    ds_read_b64_tr_b16 v[84:85], v26 offset:9280
    v_mfma_f32_16x16x32_bf16 a[36:39], v[72:75], v[36:39], a[36:39]
    ds_read_b64_tr_b16 v[86:87], v26 offset:11584
    v_mfma_f32_16x16x32_bf16 a[40:43], v[72:75], v[40:43], a[40:43]
    v_mfma_f32_16x16x32_bf16 a[44:47], v[72:75], v[44:47], a[44:47]
    s_waitcnt lgkmcnt(4)
    v_mfma_f32_16x16x32_bf16 a[48:51], v[76:79], v[32:35], a[48:51]
    ds_read_b64_tr_b16 v[88:89], v26 offset:96
    v_mfma_f32_16x16x32_bf16 a[52:55], v[76:79], v[36:39], a[52:55]
    ds_read_b64_tr_b16 v[90:91], v26 offset:2400
    v_mfma_f32_16x16x32_bf16 a[56:59], v[76:79], v[40:43], a[56:59]
    v_mfma_f32_16x16x32_bf16 a[60:63], v[76:79], v[44:47], a[60:63]
    s_waitcnt lgkmcnt(4)
    v_mfma_f32_16x16x32_bf16 a[64:67], v[80:83], v[32:35], a[64:67]
    ds_read_b64_tr_b16 v[92:93], v26 offset:9312
    v_mfma_f32_16x16x32_bf16 a[68:71], v[80:83], v[36:39], a[68:71]
    ds_read_b64_tr_b16 v[94:95], v26 offset:11616
    v_mfma_f32_16x16x32_bf16 a[72:75], v[80:83], v[40:43], a[72:75]
    v_mfma_f32_16x16x32_bf16 a[76:79], v[80:83], v[44:47], a[76:79]
    s_waitcnt lgkmcnt(4)
    v_mfma_f32_16x16x32_bf16 a[80:83], v[84:87], v[32:35], a[80:83]
    ds_read_b64_tr_b16 v[64:65], v26 offset:128
    v_mfma_f32_16x16x32_bf16 a[84:87], v[84:87], v[36:39], a[84:87]
    ds_read_b64_tr_b16 v[66:67], v26 offset:2432
    v_mfma_f32_16x16x32_bf16 a[88:91], v[84:87], v[40:43], a[88:91]
    v_mfma_f32_16x16x32_bf16 a[92:95], v[84:87], v[44:47], a[92:95]
    s_waitcnt lgkmcnt(4)
    v_mfma_f32_16x16x32_bf16 a[96:99], v[88:91], v[32:35], a[96:99]
    ds_read_b64_tr_b16 v[68:69], v26 offset:9344
    v_mfma_f32_16x16x32_bf16 a[100:103], v[88:91], v[36:39], a[100:103]
    ds_read_b64_tr_b16 v[70:71], v26 offset:11648
    v_mfma_f32_16x16x32_bf16 a[104:107], v[88:91], v[40:43], a[104:107]
    v_mfma_f32_16x16x32_bf16 a[108:111], v[88:91], v[44:47], a[108:111]
    s_waitcnt vmcnt(5)
    s_barrier
    s_waitcnt lgkmcnt(4)
    v_mfma_f32_16x16x32_bf16 a[112:115], v[92:95], v[32:35], a[112:115]
    ds_read_b128 v[48:51], v23 offset:0
    ds_read_b128 v[52:55], v23 offset:1024
    ds_read_b64_tr_b16 v[72:73], v27 offset:0
    s_add_u32 m0, s26, 104448
    v_mfma_f32_16x16x32_bf16 a[116:119], v[92:95], v[36:39], a[116:119]
    ds_read_b128 v[56:59], v23 offset:2048
    ds_read_b128 v[60:63], v23 offset:3072
    ds_read_b64_tr_b16 v[74:75], v27 offset:2304
    buffer_load_dwordx4 v16, s[8:11], s27 offen lds
    v_mfma_f32_16x16x32_bf16 a[120:123], v[92:95], v[40:43], a[120:123]
    s_add_u32 m0, s26, 112640
    v_mfma_f32_16x16x32_bf16 a[124:127], v[92:95], v[44:47], a[124:127]
    buffer_load_dwordx4 v17, s[8:11], s27 offen lds
    s_waitcnt lgkmcnt(8)
    v_mfma_f32_16x16x32_bf16 a[128:131], v[64:67], v[32:35], a[128:131]
    ds_read_b64_tr_b16 v[76:77], v27 offset:9216
    s_add_u32 m0, s44, 104448
    v_mfma_f32_16x16x32_bf16 a[132:135], v[64:67], v[36:39], a[132:135]
    ds_read_b64_tr_b16 v[78:79], v27 offset:11520
    buffer_load_dwordx4 v18, s[80:83], s28 offen lds
    v_mfma_f32_16x16x32_bf16 a[136:139], v[64:67], v[40:43], a[136:139]
    s_add_u32 m0, s45, 104448
    v_mfma_f32_16x16x32_bf16 a[140:143], v[64:67], v[44:47], a[140:143]
    buffer_load_dwordx4 v19, s[84:87], s28 offen lds
    s_waitcnt lgkmcnt(8)
    v_mfma_f32_16x16x32_bf16 a[144:147], v[68:71], v[32:35], a[144:147]
    ds_read_b64_tr_b16 v[80:81], v27 offset:32
    s_add_u32 m0, s46, 104448
    v_mfma_f32_16x16x32_bf16 a[148:151], v[68:71], v[36:39], a[148:151]
    ds_read_b64_tr_b16 v[82:83], v27 offset:2336
    s_mov_b64 exec, s[48:49]
    buffer_load_dwordx4 v20, s[88:91], s28 offen lds
    s_mov_b64 exec, -1
    v_mfma_f32_16x16x32_bf16 a[152:155], v[68:71], v[40:43], a[152:155]
    s_add_u32 s27, s27, 64
    s_add_u32 s28, s28, 294912
    v_mfma_f32_16x16x32_bf16 a[156:159], v[68:71], v[44:47], a[156:159]
    s_waitcnt lgkmcnt(4)
    v_mfma_f32_16x16x32_bf16 a[0:3], v[72:75], v[48:51], a[0:3]
    ds_read_b64_tr_b16 v[84:85], v27 offset:9248
    v_mfma_f32_16x16x32_bf16 a[4:7], v[72:75], v[52:55], a[4:7]
    ds_read_b64_tr_b16 v[86:87], v27 offset:11552
    v_mfma_f32_16x16x32_bf16 a[8:11], v[72:75], v[56:59], a[8:11]
    v_mfma_f32_16x16x32_bf16 a[12:15], v[72:75], v[60:63], a[12:15]
    s_waitcnt lgkmcnt(4)
    v_mfma_f32_16x16x32_bf16 a[16:19], v[76:79], v[48:51], a[16:19]
    ds_read_b64_tr_b16 v[88:89], v27 offset:64
    v_mfma_f32_16x16x32_bf16 a[20:23], v[76:79], v[52:55], a[20:23]
    ds_read_b64_tr_b16 v[90:91], v27 offset:2368
    v_mfma_f32_16x16x32_bf16 a[24:27], v[76:79], v[56:59], a[24:27]
    v_mfma_f32_16x16x32_bf16 a[28:31], v[76:79], v[60:63], a[28:31]
    s_waitcnt lgkmcnt(4)
    v_mfma_f32_16x16x32_bf16 a[32:35], v[80:83], v[48:51], a[32:35]
    ds_read_b64_tr_b16 v[92:93], v27 offset:9280
    v_mfma_f32_16x16x32_bf16 a[36:39], v[80:83], v[52:55], a[36:39]
    ds_read_b64_tr_b16 v[94:95], v27 offset:11584
    v_mfma_f32_16x16x32_bf16 a[40:43], v[80:83], v[56:59], a[40:43]
    v_mfma_f32_16x16x32_bf16 a[44:47], v[80:83], v[60:63], a[44:47]
    s_waitcnt lgkmcnt(4)
    v_mfma_f32_16x16x32_bf16 a[48:51], v[84:87], v[48:51], a[48:51]
    ds_read_b64_tr_b16 v[64:65], v27 offset:96
    v_mfma_f32_16x16x32_bf16 a[52:55], v[84:87], v[52:55], a[52:55]
    ds_read_b64_tr_b16 v[66:67], v27 offset:2400
    v_mfma_f32_16x16x32_bf16 a[56:59], v[84:87], v[56:59], a[56:59]
    v_mfma_f32_16x16x32_bf16 a[60:63], v[84:87], v[60:63], a[60:63]
    s_waitcnt lgkmcnt(4)
    v_mfma_f32_16x16x32_bf16 a[64:67], v[88:91], v[48:51], a[64:67]
    ds_read_b64_tr_b16 v[68:69], v27 offset:9312
    v_mfma_f32_16x16x32_bf16 a[68:71], v[88:91], v[52:55], a[68:71]
    ds_read_b64_tr_b16 v[70:71], v27 offset:11616
    v_mfma_f32_16x16x32_bf16 a[72:75], v[88:91], v[56:59], a[72:75]
    v_mfma_f32_16x16x32_bf16 a[76:79], v[88:91], v[60:63], a[76:79]
    s_waitcnt lgkmcnt(4)
    v_mfma_f32_16x16x32_bf16 a[80:83], v[92:95], v[48:51], a[80:83]
    ds_read_b64_tr_b16 v[72:73], v27 offset:128
    v_mfma_f32_16x16x32_bf16 a[84:87], v[92:95], v[52:55], a[84:87]
    ds_read_b64_tr_b16 v[74:75], v27 offset:2432
    v_mfma_f32_16x16x32_bf16 a[88:91], v[92:95], v[56:59], a[88:91]
    v_mfma_f32_16x16x32_bf16 a[92:95], v[92:95], v[60:63], a[92:95]
    s_waitcnt lgkmcnt(4)
    v_mfma_f32_16x16x32_bf16 a[96:99], v[64:67], v[48:51], a[96:99]
    ds_read_b64_tr_b16 v[76:77], v27 offset:9344
    v_mfma_f32_16x16x32_bf16 a[100:103], v[64:67], v[52:55], a[100:103]
    ds_read_b64_tr_b16 v[78:79], v27 offset:11648
    v_mfma_f32_16x16x32_bf16 a[104:107], v[64:67], v[56:59], a[104:107]
    v_mfma_f32_16x16x32_bf16 a[108:111], v[64:67], v[60:63], a[108:111]
    s_waitcnt vmcnt(5)
    s_barrier
    s_waitcnt lgkmcnt(4)
    v_mfma_f32_16x16x32_bf16 a[112:115], v[68:71], v[48:51], a[112:115]
    ds_read_b128 v[32:35], v24 offset:0
    ds_read_b128 v[36:39], v24 offset:1024
    ds_read_b64_tr_b16 v[80:81], v28 offset:0
    s_add_u32 m0, s26, 0
    v_mfma_f32_16x16x32_bf16 a[116:119], v[68:71], v[52:55], a[116:119]
    ds_read_b128 v[40:43], v24 offset:2048
    ds_read_b128 v[44:47], v24 offset:3072
    ds_read_b64_tr_b16 v[82:83], v28 offset:2304
    buffer_load_dwordx4 v16, s[8:11], s27 offen lds
    v_mfma_f32_16x16x32_bf16 a[120:123], v[68:71], v[56:59], a[120:123]
    s_add_u32 m0, s26, 8192
    v_mfma_f32_16x16x32_bf16 a[124:127], v[68:71], v[60:63], a[124:127]
    buffer_load_dwordx4 v17, s[8:11], s27 offen lds
    s_waitcnt lgkmcnt(8)
    v_mfma_f32_16x16x32_bf16 a[128:131], v[72:75], v[48:51], a[128:131]
    ds_read_b64_tr_b16 v[84:85], v28 offset:9216
    s_add_u32 m0, s44, 0
    v_mfma_f32_16x16x32_bf16 a[132:135], v[72:75], v[52:55], a[132:135]
    ds_read_b64_tr_b16 v[86:87], v28 offset:11520
    buffer_load_dwordx4 v18, s[80:83], s28 offen lds
    v_mfma_f32_16x16x32_bf16 a[136:139], v[72:75], v[56:59], a[136:139]
    s_add_u32 m0, s45, 0
    v_mfma_f32_16x16x32_bf16 a[140:143], v[72:75], v[60:63], a[140:143]
    buffer_load_dwordx4 v19, s[84:87], s28 offen lds
    s_waitcnt lgkmcnt(8)
    v_mfma_f32_16x16x32_bf16 a[144:147], v[76:79], v[48:51], a[144:147]
    ds_read_b64_tr_b16 v[88:89], v28 offset:32
    s_add_u32 m0, s46, 0
    v_mfma_f32_16x16x32_bf16 a[148:151], v[76:79], v[52:55], a[148:151]
    ds_read_b64_tr_b16 v[90:91], v28 offset:2336
    s_mov_b64 exec, s[48:49]
    buffer_load_dwordx4 v20, s[88:91], s28 offen lds
    s_mov_b64 exec, -1
    v_mfma_f32_16x16x32_bf16 a[152:155], v[76:79], v[56:59], a[152:155]
    s_add_u32 s27, s27, 64
    s_add_u32 s28, s28, 294912
    v_mfma_f32_16x16x32_bf16 a[156:159], v[76:79], v[60:63], a[156:159]
    s_waitcnt lgkmcnt(4)
    v_mfma_f32_16x16x32_bf16 a[0:3], v[80:83], v[32:35], a[0:3]
    ds_read_b64_tr_b16 v[92:93], v28 offset:9248
    v_mfma_f32_16x16x32_bf16 a[4:7], v[80:83], v[36:39], a[4:7]
    ds_read_b64_tr_b16 v[94:95], v28 offset:11552
    v_mfma_f32_16x16x32_bf16 a[8:11], v[80:83], v[40:43], a[8:11]
    v_mfma_f32_16x16x32_bf16 a[12:15], v[80:83], v[44:47], a[12:15]
    s_waitcnt lgkmcnt(4)
    v_mfma_f32_16x16x32_bf16 a[16:19], v[84:87], v[32:35], a[16:19]
    ds_read_b64_tr_b16 v[64:65], v28 offset:64
    v_mfma_f32_16x16x32_bf16 a[20:23], v[84:87], v[36:39], a[20:23]
    ds_read_b64_tr_b16 v[66:67], v28 offset:2368
    v_mfma_f32_16x16x32_bf16 a[24:27], v[84:87], v[40:43], a[24:27]
    v_mfma_f32_16x16x32_bf16 a[28:31], v[84:87], v[44:47], a[28:31]
    s_waitcnt lgkmcnt(4)
    v_mfma_f32_16x16x32_bf16 a[32:35], v[88:91], v[32:35], a[32:35]
    ds_read_b64_tr_b16 v[68:69], v28 offset:9280
    v_mfma_f32_16x16x32_bf16 a[36:39], v[88:91], v[36:39], a[36:39]
    ds_read_b64_tr_b16 v[70:71], v28 offset:11584
    v_mfma_f32_16x16x32_bf16 a[40:43], v[88:91], v[40:43], a[40:43]
    v_mfma_f32_16x16x32_bf16 a[44:47], v[88:91], v[44:47], a[44:47]
    s_waitcnt lgkmcnt(4)
    v_mfma_f32_16x16x32_bf16 a[48:51], v[92:95], v[32:35], a[48:51]
    ds_read_b64_tr_b16 v[72:73], v28 offset:96
    v_mfma_f32_16x16x32_bf16 a[52:55], v[92:95], v[36:39], a[52:55]
    ds_read_b64_tr_b16 v[74:75], v28 offset:2400
    v_mfma_f32_16x16x32_bf16 a[56:59], v[92:95], v[40:43], a[56:59]
    v_mfma_f32_16x16x32_bf16 a[60:63], v[92:95], v[44:47], a[60:63]
    s_waitcnt lgkmcnt(4)
    v_mfma_f32_16x16x32_bf16 a[64:67], v[64:67], v[32:35], a[64:67]
    ds_read_b64_tr_b16 v[76:77], v28 offset:9312
    v_mfma_f32_16x16x32_bf16 a[68:71], v[64:67], v[36:39], a[68:71]
    ds_read_b64_tr_b16 v[78:79], v28 offset:11616
    v_mfma_f32_16x16x32_bf16 a[72:75], v[64:67], v[40:43], a[72:75]
    v_mfma_f32_16x16x32_bf16 a[76:79], v[64:67], v[44:47], a[76:79]
    s_waitcnt lgkmcnt(4)
    v_mfma_f32_16x16x32_bf16 a[80:83], v[68:71], v[32:35], a[80:83]
    ds_read_b64_tr_b16 v[80:81], v28 offset:128
    v_mfma_f32_16x16x32_bf16 a[84:87], v[68:71], v[36:39], a[84:87]
    ds_read_b64_tr_b16 v[82:83], v28 offset:2432
    v_mfma_f32_16x16x32_bf16 a[88:91], v[68:71], v[40:43], a[88:91]
    v_mfma_f32_16x16x32_bf16 a[92:95], v[68:71], v[44:47], a[92:95]
    s_waitcnt lgkmcnt(4)
    v_mfma_f32_16x16x32_bf16 a[96:99], v[72:75], v[32:35], a[96:99]
    ds_read_b64_tr_b16 v[84:85], v28 offset:9344
    v_mfma_f32_16x16x32_bf16 a[100:103], v[72:75], v[36:39], a[100:103]
    ds_read_b64_tr_b16 v[86:87], v28 offset:11648
    v_mfma_f32_16x16x32_bf16 a[104:107], v[72:75], v[40:43], a[104:107]
    v_mfma_f32_16x16x32_bf16 a[108:111], v[72:75], v[44:47], a[108:111]
    s_waitcnt vmcnt(5)
    s_barrier
    s_waitcnt lgkmcnt(4)
    v_mfma_f32_16x16x32_bf16 a[112:115], v[76:79], v[32:35], a[112:115]
    ds_read_b128 v[48:51], v25 offset:0
    ds_read_b128 v[52:55], v25 offset:1024
    ds_read_b64_tr_b16 v[88:89], v29 offset:0
    s_add_u32 m0, s26, 34816
    v_mfma_f32_16x16x32_bf16 a[116:119], v[76:79], v[36:39], a[116:119]
    ds_read_b128 v[56:59], v25 offset:2048
    ds_read_b128 v[60:63], v25 offset:3072
    ds_read_b64_tr_b16 v[90:91], v29 offset:2304
    buffer_load_dwordx4 v16, s[8:11], s27 offen lds
    v_mfma_f32_16x16x32_bf16 a[120:123], v[76:79], v[40:43], a[120:123]
    s_add_u32 m0, s26, 43008
    v_mfma_f32_16x16x32_bf16 a[124:127], v[76:79], v[44:47], a[124:127]
    buffer_load_dwordx4 v17, s[8:11], s27 offen lds
    s_waitcnt lgkmcnt(8)
    v_mfma_f32_16x16x32_bf16 a[128:131], v[80:83], v[32:35], a[128:131]
    ds_read_b64_tr_b16 v[92:93], v29 offset:9216
    s_add_u32 m0, s44, 34816
    v_mfma_f32_16x16x32_bf16 a[132:135], v[80:83], v[36:39], a[132:135]
    ds_read_b64_tr_b16 v[94:95], v29 offset:11520
    buffer_load_dwordx4 v18, s[80:83], s28 offen lds
    v_mfma_f32_16x16x32_bf16 a[136:139], v[80:83], v[40:43], a[136:139]
    s_add_u32 m0, s45, 34816
    v_mfma_f32_16x16x32_bf16 a[140:143], v[80:83], v[44:47], a[140:143]
    buffer_load_dwordx4 v19, s[84:87], s28 offen lds
    s_waitcnt lgkmcnt(8)
    v_mfma_f32_16x16x32_bf16 a[144:147], v[84:87], v[32:35], a[144:147]
    ds_read_b64_tr_b16 v[64:65], v29 offset:32
    s_add_u32 m0, s46, 34816
    v_mfma_f32_16x16x32_bf16 a[148:151], v[84:87], v[36:39], a[148:151]
    ds_read_b64_tr_b16 v[66:67], v29 offset:2336
    s_mov_b64 exec, s[48:49]
    buffer_load_dwordx4 v20, s[88:91], s28 offen lds
    s_mov_b64 exec, -1
    v_mfma_f32_16x16x32_bf16 a[152:155], v[84:87], v[40:43], a[152:155]
    s_add_u32 s27, s27, 64
    s_add_u32 s28, s28, 294912
    v_mfma_f32_16x16x32_bf16 a[156:159], v[84:87], v[44:47], a[156:159]
    s_waitcnt lgkmcnt(4)
    v_mfma_f32_16x16x32_bf16 a[0:3], v[88:91], v[48:51], a[0:3]
    ds_read_b64_tr_b16 v[68:69], v29 offset:9248
    v_mfma_f32_16x16x32_bf16 a[4:7], v[88:91], v[52:55], a[4:7]
    ds_read_b64_tr_b16 v[70:71], v29 offset:11552
    v_mfma_f32_16x16x32_bf16 a[8:11], v[88:91], v[56:59], a[8:11]
    v_mfma_f32_16x16x32_bf16 a[12:15], v[88:91], v[60:63], a[12:15]
    s_waitcnt lgkmcnt(4)
    v_mfma_f32_16x16x32_bf16 a[16:19], v[92:95], v[48:51], a[16:19]
    ds_read_b64_tr_b16 v[72:73], v29 offset:64
    v_mfma_f32_16x16x32_bf16 a[20:23], v[92:95], v[52:55], a[20:23]
    ds_read_b64_tr_b16 v[74:75], v29 offset:2368
    v_mfma_f32_16x16x32_bf16 a[24:27], v[92:95], v[56:59], a[24:27]
    v_mfma_f32_16x16x32_bf16 a[28:31], v[92:95], v[60:63], a[28:31]
    s_waitcnt lgkmcnt(4)
    v_mfma_f32_16x16x32_bf16 a[32:35], v[64:67], v[48:51], a[32:35]
    ds_read_b64_tr_b16 v[76:77], v29 offset:9280
    v_mfma_f32_16x16x32_bf16 a[36:39], v[64:67], v[52:55], a[36:39]
    ds_read_b64_tr_b16 v[78:79], v29 offset:11584
    v_mfma_f32_16x16x32_bf16 a[40:43], v[64:67], v[56:59], a[40:43]
    v_mfma_f32_16x16x32_bf16 a[44:47], v[64:67], v[60:63], a[44:47]
    s_waitcnt lgkmcnt(4)
    v_mfma_f32_16x16x32_bf16 a[48:51], v[68:71], v[48:51], a[48:51]
    ds_read_b64_tr_b16 v[80:81], v29 offset:96
    v_mfma_f32_16x16x32_bf16 a[52:55], v[68:71], v[52:55], a[52:55]
    ds_read_b64_tr_b16 v[82:83], v29 offset:2400
    v_mfma_f32_16x16x32_bf16 a[56:59], v[68:71], v[56:59], a[56:59]
    v_mfma_f32_16x16x32_bf16 a[60:63], v[68:71], v[60:63], a[60:63]
    s_waitcnt lgkmcnt(4)
    v_mfma_f32_16x16x32_bf16 a[64:67], v[72:75], v[48:51], a[64:67]
    ds_read_b64_tr_b16 v[84:85], v29 offset:9312
    v_mfma_f32_16x16x32_bf16 a[68:71], v[72:75], v[52:55], a[68:71]
    ds_read_b64_tr_b16 v[86:87], v29 offset:11616
    v_mfma_f32_16x16x32_bf16 a[72:75], v[72:75], v[56:59], a[72:75]
    v_mfma_f32_16x16x32_bf16 a[76:79], v[72:75], v[60:63], a[76:79]
    s_waitcnt lgkmcnt(4)
    v_mfma_f32_16x16x32_bf16 a[80:83], v[76:79], v[48:51], a[80:83]
    ds_read_b64_tr_b16 v[88:89], v29 offset:128
    v_mfma_f32_16x16x32_bf16 a[84:87], v[76:79], v[52:55], a[84:87]
    ds_read_b64_tr_b16 v[90:91], v29 offset:2432
    v_mfma_f32_16x16x32_bf16 a[88:91], v[76:79], v[56:59], a[88:91]
    v_mfma_f32_16x16x32_bf16 a[92:95], v[76:79], v[60:63], a[92:95]
    s_waitcnt lgkmcnt(4)
    v_mfma_f32_16x16x32_bf16 a[96:99], v[80:83], v[48:51], a[96:99]
    ds_read_b64_tr_b16 v[92:93], v29 offset:9344
    v_mfma_f32_16x16x32_bf16 a[100:103], v[80:83], v[52:55], a[100:103]
    ds_read_b64_tr_b16 v[94:95], v29 offset:11648
    v_mfma_f32_16x16x32_bf16 a[104:107], v[80:83], v[56:59], a[104:107]
    v_mfma_f32_16x16x32_bf16 a[108:111], v[80:83], v[60:63], a[108:111]
    s_waitcnt vmcnt(5)
    s_barrier
    s_waitcnt lgkmcnt(4)
    v_mfma_f32_16x16x32_bf16 a[112:115], v[84:87], v[48:51], a[112:115]
    ds_read_b128 v[32:35], v22 offset:0
    ds_read_b128 v[36:39], v22 offset:1024
    ds_read_b64_tr_b16 v[64:65], v26 offset:0
    v_mfma_f32_16x16x32_bf16 a[116:119], v[84:87], v[52:55], a[116:119]
    ds_read_b128 v[40:43], v22 offset:2048
    ds_read_b128 v[44:47], v22 offset:3072
    ds_read_b64_tr_b16 v[66:67], v26 offset:2304
    v_mfma_f32_16x16x32_bf16 a[120:123], v[84:87], v[56:59], a[120:123]
    v_mfma_f32_16x16x32_bf16 a[124:127], v[84:87], v[60:63], a[124:127]
    s_waitcnt lgkmcnt(8)
    v_mfma_f32_16x16x32_bf16 a[128:131], v[88:91], v[48:51], a[128:131]
    ds_read_b64_tr_b16 v[68:69], v26 offset:9216
    v_mfma_f32_16x16x32_bf16 a[132:135], v[88:91], v[52:55], a[132:135]
    ds_read_b64_tr_b16 v[70:71], v26 offset:11520
    v_mfma_f32_16x16x32_bf16 a[136:139], v[88:91], v[56:59], a[136:139]
    v_mfma_f32_16x16x32_bf16 a[140:143], v[88:91], v[60:63], a[140:143]
    s_waitcnt lgkmcnt(8)
    v_mfma_f32_16x16x32_bf16 a[144:147], v[92:95], v[48:51], a[144:147]
    ds_read_b64_tr_b16 v[72:73], v26 offset:32
    v_mfma_f32_16x16x32_bf16 a[148:151], v[92:95], v[52:55], a[148:151]
    ds_read_b64_tr_b16 v[74:75], v26 offset:2336
    v_mfma_f32_16x16x32_bf16 a[152:155], v[92:95], v[56:59], a[152:155]
    v_mfma_f32_16x16x32_bf16 a[156:159], v[92:95], v[60:63], a[156:159]
    s_waitcnt lgkmcnt(4)
    v_mfma_f32_16x16x32_bf16 a[0:3], v[64:67], v[32:35], a[0:3]
    ds_read_b64_tr_b16 v[76:77], v26 offset:9248
    v_mfma_f32_16x16x32_bf16 a[4:7], v[64:67], v[36:39], a[4:7]
    ds_read_b64_tr_b16 v[78:79], v26 offset:11552
    v_mfma_f32_16x16x32_bf16 a[8:11], v[64:67], v[40:43], a[8:11]
    v_mfma_f32_16x16x32_bf16 a[12:15], v[64:67], v[44:47], a[12:15]
    s_waitcnt lgkmcnt(4)
    v_mfma_f32_16x16x32_bf16 a[16:19], v[68:71], v[32:35], a[16:19]
    ds_read_b64_tr_b16 v[80:81], v26 offset:64
    v_mfma_f32_16x16x32_bf16 a[20:23], v[68:71], v[36:39], a[20:23]
    ds_read_b64_tr_b16 v[82:83], v26 offset:2368
    v_mfma_f32_16x16x32_bf16 a[24:27], v[68:71], v[40:43], a[24:27]
    v_mfma_f32_16x16x32_bf16 a[28:31], v[68:71], v[44:47], a[28:31]
    s_waitcnt lgkmcnt(4)
    v_mfma_f32_16x16x32_bf16 a[32:35], v[72:75], v[32:35], a[32:35]
    ds_read_b64_tr_b16 v[84:85], v26 offset:9280
    v_mfma_f32_16x16x32_bf16 a[36:39], v[72:75], v[36:39], a[36:39]
    ds_read_b64_tr_b16 v[86:87], v26 offset:11584
    v_mfma_f32_16x16x32_bf16 a[40:43], v[72:75], v[40:43], a[40:43]
    v_mfma_f32_16x16x32_bf16 a[44:47], v[72:75], v[44:47], a[44:47]
    s_waitcnt lgkmcnt(4)
    v_mfma_f32_16x16x32_bf16 a[48:51], v[76:79], v[32:35], a[48:51]
    ds_read_b64_tr_b16 v[88:89], v26 offset:96
    v_mfma_f32_16x16x32_bf16 a[52:55], v[76:79], v[36:39], a[52:55]
    ds_read_b64_tr_b16 v[90:91], v26 offset:2400
    v_mfma_f32_16x16x32_bf16 a[56:59], v[76:79], v[40:43], a[56:59]
    v_mfma_f32_16x16x32_bf16 a[60:63], v[76:79], v[44:47], a[60:63]
    s_waitcnt lgkmcnt(4)
    v_mfma_f32_16x16x32_bf16 a[64:67], v[80:83], v[32:35], a[64:67]
    ds_read_b64_tr_b16 v[92:93], v26 offset:9312
    v_mfma_f32_16x16x32_bf16 a[68:71], v[80:83], v[36:39], a[68:71]
    ds_read_b64_tr_b16 v[94:95], v26 offset:11616
    v_mfma_f32_16x16x32_bf16 a[72:75], v[80:83], v[40:43], a[72:75]
    v_mfma_f32_16x16x32_bf16 a[76:79], v[80:83], v[44:47], a[76:79]
    s_waitcnt lgkmcnt(4)
    v_mfma_f32_16x16x32_bf16 a[80:83], v[84:87], v[32:35], a[80:83]
    ds_read_b64_tr_b16 v[64:65], v26 offset:128
    v_mfma_f32_16x16x32_bf16 a[84:87], v[84:87], v[36:39], a[84:87]
    ds_read_b64_tr_b16 v[66:67], v26 offset:2432
    v_mfma_f32_16x16x32_bf16 a[88:91], v[84:87], v[40:43], a[88:91]
    v_mfma_f32_16x16x32_bf16 a[92:95], v[84:87], v[44:47], a[92:95]
    s_waitcnt lgkmcnt(4)
    v_mfma_f32_16x16x32_bf16 a[96:99], v[88:91], v[32:35], a[96:99]
    ds_read_b64_tr_b16 v[68:69], v26 offset:9344
    v_mfma_f32_16x16x32_bf16 a[100:103], v[88:91], v[36:39], a[100:103]
    ds_read_b64_tr_b16 v[70:71], v26 offset:11648
    v_mfma_f32_16x16x32_bf16 a[104:107], v[88:91], v[40:43], a[104:107]
    v_mfma_f32_16x16x32_bf16 a[108:111], v[88:91], v[44:47], a[108:111]
    s_waitcnt vmcnt(0)
    s_barrier
    s_waitcnt lgkmcnt(4)
    v_mfma_f32_16x16x32_bf16 a[112:115], v[92:95], v[32:35], a[112:115]
    ds_read_b128 v[48:51], v23 offset:0
    ds_read_b128 v[52:55], v23 offset:1024
    ds_read_b64_tr_b16 v[72:73], v27 offset:0
    v_mfma_f32_16x16x32_bf16 a[116:119], v[92:95], v[36:39], a[116:119]
    ds_read_b128 v[56:59], v23 offset:2048
    ds_read_b128 v[60:63], v23 offset:3072
    ds_read_b64_tr_b16 v[74:75], v27 offset:2304
    v_mfma_f32_16x16x32_bf16 a[120:123], v[92:95], v[40:43], a[120:123]
    v_mfma_f32_16x16x32_bf16 a[124:127], v[92:95], v[44:47], a[124:127]
    s_waitcnt lgkmcnt(8)
    v_mfma_f32_16x16x32_bf16 a[128:131], v[64:67], v[32:35], a[128:131]
    ds_read_b64_tr_b16 v[76:77], v27 offset:9216
    v_mfma_f32_16x16x32_bf16 a[132:135], v[64:67], v[36:39], a[132:135]
    ds_read_b64_tr_b16 v[78:79], v27 offset:11520
    v_mfma_f32_16x16x32_bf16 a[136:139], v[64:67], v[40:43], a[136:139]
    v_mfma_f32_16x16x32_bf16 a[140:143], v[64:67], v[44:47], a[140:143]
    s_waitcnt lgkmcnt(8)
    v_mfma_f32_16x16x32_bf16 a[144:147], v[68:71], v[32:35], a[144:147]
    ds_read_b64_tr_b16 v[80:81], v27 offset:32
    v_mfma_f32_16x16x32_bf16 a[148:151], v[68:71], v[36:39], a[148:151]
    ds_read_b64_tr_b16 v[82:83], v27 offset:2336
    v_mfma_f32_16x16x32_bf16 a[152:155], v[68:71], v[40:43], a[152:155]
    v_mfma_f32_16x16x32_bf16 a[156:159], v[68:71], v[44:47], a[156:159]
    s_waitcnt lgkmcnt(4)
    v_mfma_f32_16x16x32_bf16 a[0:3], v[72:75], v[48:51], a[0:3]
    ds_read_b64_tr_b16 v[84:85], v27 offset:9248
    v_mfma_f32_16x16x32_bf16 a[4:7], v[72:75], v[52:55], a[4:7]
    ds_read_b64_tr_b16 v[86:87], v27 offset:11552
    v_mfma_f32_16x16x32_bf16 a[8:11], v[72:75], v[56:59], a[8:11]
    v_mfma_f32_16x16x32_bf16 a[12:15], v[72:75], v[60:63], a[12:15]
    s_waitcnt lgkmcnt(4)
    v_mfma_f32_16x16x32_bf16 a[16:19], v[76:79], v[48:51], a[16:19]
    ds_read_b64_tr_b16 v[88:89], v27 offset:64
    v_mfma_f32_16x16x32_bf16 a[20:23], v[76:79], v[52:55], a[20:23]
    ds_read_b64_tr_b16 v[90:91], v27 offset:2368
    v_mfma_f32_16x16x32_bf16 a[24:27], v[76:79], v[56:59], a[24:27]
    v_mfma_f32_16x16x32_bf16 a[28:31], v[76:79], v[60:63], a[28:31]
    s_waitcnt lgkmcnt(4)
    v_mfma_f32_16x16x32_bf16 a[32:35], v[80:83], v[48:51], a[32:35]
    ds_read_b64_tr_b16 v[92:93], v27 offset:9280
    v_mfma_f32_16x16x32_bf16 a[36:39], v[80:83], v[52:55], a[36:39]
    ds_read_b64_tr_b16 v[94:95], v27 offset:11584
    v_mfma_f32_16x16x32_bf16 a[40:43], v[80:83], v[56:59], a[40:43]
    v_mfma_f32_16x16x32_bf16 a[44:47], v[80:83], v[60:63], a[44:47]
    s_waitcnt lgkmcnt(4)
    v_mfma_f32_16x16x32_bf16 a[48:51], v[84:87], v[48:51], a[48:51]
    ds_read_b64_tr_b16 v[64:65], v27 offset:96
    v_mfma_f32_16x16x32_bf16 a[52:55], v[84:87], v[52:55], a[52:55]
    ds_read_b64_tr_b16 v[66:67], v27 offset:2400
    v_mfma_f32_16x16x32_bf16 a[56:59], v[84:87], v[56:59], a[56:59]
    v_mfma_f32_16x16x32_bf16 a[60:63], v[84:87], v[60:63], a[60:63]
    s_waitcnt lgkmcnt(4)
    v_mfma_f32_16x16x32_bf16 a[64:67], v[88:91], v[48:51], a[64:67]
    ds_read_b64_tr_b16 v[68:69], v27 offset:9312
    v_mfma_f32_16x16x32_bf16 a[68:71], v[88:91], v[52:55], a[68:71]
    ds_read_b64_tr_b16 v[70:71], v27 offset:11616
    v_mfma_f32_16x16x32_bf16 a[72:75], v[88:91], v[56:59], a[72:75]
    v_mfma_f32_16x16x32_bf16 a[76:79], v[88:91], v[60:63], a[76:79]
    s_waitcnt lgkmcnt(4)
    v_mfma_f32_16x16x32_bf16 a[80:83], v[92:95], v[48:51], a[80:83]
    ds_read_b64_tr_b16 v[72:73], v27 offset:128
    v_mfma_f32_16x16x32_bf16 a[84:87], v[92:95], v[52:55], a[84:87]
    ds_read_b64_tr_b16 v[74:75], v27 offset:2432
    v_mfma_f32_16x16x32_bf16 a[88:91], v[92:95], v[56:59], a[88:91]
    v_mfma_f32_16x16x32_bf16 a[92:95], v[92:95], v[60:63], a[92:95]
    s_waitcnt lgkmcnt(4)
    v_mfma_f32_16x16x32_bf16 a[96:99], v[64:67], v[48:51], a[96:99]
    ds_read_b64_tr_b16 v[76:77], v27 offset:9344
    v_mfma_f32_16x16x32_bf16 a[100:103], v[64:67], v[52:55], a[100:103]
    ds_read_b64_tr_b16 v[78:79], v27 offset:11648
    v_mfma_f32_16x16x32_bf16 a[104:107], v[64:67], v[56:59], a[104:107]
    v_mfma_f32_16x16x32_bf16 a[108:111], v[64:67], v[60:63], a[108:111]
    s_waitcnt lgkmcnt(4)
    v_mfma_f32_16x16x32_bf16 a[112:115], v[68:71], v[48:51], a[112:115]
    v_mfma_f32_16x16x32_bf16 a[116:119], v[68:71], v[52:55], a[116:119]
    v_mfma_f32_16x16x32_bf16 a[120:123], v[68:71], v[56:59], a[120:123]
    v_mfma_f32_16x16x32_bf16 a[124:127], v[68:71], v[60:63], a[124:127]
    s_waitcnt lgkmcnt(2)
    v_mfma_f32_16x16x32_bf16 a[128:131], v[72:75], v[48:51], a[128:131]
    v_mfma_f32_16x16x32_bf16 a[132:135], v[72:75], v[52:55], a[132:135]
    v_mfma_f32_16x16x32_bf16 a[136:139], v[72:75], v[56:59], a[136:139]
    v_mfma_f32_16x16x32_bf16 a[140:143], v[72:75], v[60:63], a[140:143]
    s_waitcnt lgkmcnt(0)
    v_mfma_f32_16x16x32_bf16 a[144:147], v[76:79], v[48:51], a[144:147]
    v_mfma_f32_16x16x32_bf16 a[148:151], v[76:79], v[52:55], a[148:151]
    v_mfma_f32_16x16x32_bf16 a[152:155], v[76:79], v[56:59], a[152:155]
    v_mfma_f32_16x16x32_bf16 a[156:159], v[76:79], v[60:63], a[156:159]
    s_nop 15
    s_waitcnt vmcnt(0) lgkmcnt(0)
    s_add_u32 s12, s4, 25165824
    s_addc_u32 s13, s5, 0
    s_mov_b32 s14, 18874368
    s_mov_b32 s15, 0x00020000
    s_lshl_b32 s30, s21, 6
    s_add_u32 s30, s30, s25
    v_add_u32 v8, s30, v3
    s_movk_i32 s31, 9216
    v_mul_lo_u32 v8, v8, s31
    s_mul_i32 s29, s24, 288
    v_add_u32 v8, s29, v8
    v_and_b32 v9, 1, v4
    v_lshrrev_b32 v10, 1, v4
    v_lshlrev_b32 v9, 5, v9
    v_lshl_add_u32 v9, v10, 4, v9
    v_add_u32 v9, v8, v9
    v_lshl_add_u32 v10, v4, 3, v8
    s_mov_b32 s30, 0
    v_accvgpr_read_b32 v36, a0
    v_accvgpr_read_b32 v40, a16
    v_accvgpr_read_b32 v37, a1
    v_accvgpr_read_b32 v41, a17
    v_accvgpr_read_b32 v38, a2
    v_accvgpr_read_b32 v42, a18
    v_accvgpr_read_b32 v39, a3
    v_accvgpr_read_b32 v43, a19
    v_max_f32 v36, 0, v36
    v_max_f32 v37, 0, v37
    v_max_f32 v38, 0, v38
    v_max_f32 v39, 0, v39
    v_cvt_pk_bf16_f32 v36, v36, v37
    v_cvt_pk_bf16_f32 v38, v38, v39
    v_cvt_pk_bf16_f32 v40, v40, v41
    v_cvt_pk_bf16_f32 v42, v42, v43
    v_and_b32 v37, 0xffff0000, v36
    v_lshlrev_b32 v36, 16, v36
    v_and_b32 v39, 0xffff0000, v38
    v_lshlrev_b32 v38, 16, v38
    v_and_b32 v41, 0xffff0000, v40
    v_lshlrev_b32 v40, 16, v40
    v_and_b32 v43, 0xffff0000, v42
    v_lshlrev_b32 v42, 16, v42
    v_mul_f32 v36, v36, v40
    v_mul_f32 v37, v37, v41
    v_mul_f32 v38, v38, v42
    v_mul_f32 v39, v39, v43
    v_cvt_pk_bf16_f32 v32, v36, v37
    v_cvt_pk_bf16_f32 v33, v38, v39
    v_accvgpr_read_b32 v44, a32
    v_accvgpr_read_b32 v48, a48
    v_accvgpr_read_b32 v45, a33
    v_accvgpr_read_b32 v49, a49
    v_accvgpr_read_b32 v46, a34
    v_accvgpr_read_b32 v50, a50
    v_accvgpr_read_b32 v47, a35
    v_accvgpr_read_b32 v51, a51
    v_max_f32 v44, 0, v44
    v_max_f32 v45, 0, v45
    v_max_f32 v46, 0, v46
    v_max_f32 v47, 0, v47
    v_cvt_pk_bf16_f32 v44, v44, v45
    v_cvt_pk_bf16_f32 v46, v46, v47
    v_cvt_pk_bf16_f32 v48, v48, v49
    v_cvt_pk_bf16_f32 v50, v50, v51
    v_and_b32 v45, 0xffff0000, v44
    v_lshlrev_b32 v44, 16, v44
    v_and_b32 v47, 0xffff0000, v46
    v_lshlrev_b32 v46, 16, v46
    v_and_b32 v49, 0xffff0000, v48
    v_lshlrev_b32 v48, 16, v48
    v_and_b32 v51, 0xffff0000, v50
    v_lshlrev_b32 v50, 16, v50
    v_mul_f32 v44, v44, v48
    v_mul_f32 v45, v45, v49
    v_mul_f32 v46, v46, v50
    v_mul_f32 v47, v47, v51
    v_cvt_pk_bf16_f32 v34, v44, v45
    v_cvt_pk_bf16_f32 v35, v46, v47
    s_nop 1
    v_permlane16_swap_b32 v32, v34
    v_permlane16_swap_b32 v33, v35
    buffer_store_dwordx4 v[32:35], v9, s[12:15], s30 offen offset:0
    v_accvgpr_read_b32 v56, a64
    v_accvgpr_read_b32 v60, a80
    v_accvgpr_read_b32 v57, a65
    v_accvgpr_read_b32 v61, a81
    v_accvgpr_read_b32 v58, a66
    v_accvgpr_read_b32 v62, a82
    v_accvgpr_read_b32 v59, a67
    v_accvgpr_read_b32 v63, a83
    v_max_f32 v56, 0, v56
    v_max_f32 v57, 0, v57
    v_max_f32 v58, 0, v58
    v_max_f32 v59, 0, v59
    v_cvt_pk_bf16_f32 v56, v56, v57
    v_cvt_pk_bf16_f32 v58, v58, v59
    v_cvt_pk_bf16_f32 v60, v60, v61
    v_cvt_pk_bf16_f32 v62, v62, v63
    v_and_b32 v57, 0xffff0000, v56
    v_lshlrev_b32 v56, 16, v56
    v_and_b32 v59, 0xffff0000, v58
    v_lshlrev_b32 v58, 16, v58
    v_and_b32 v61, 0xffff0000, v60
    v_lshlrev_b32 v60, 16, v60
    v_and_b32 v63, 0xffff0000, v62
    v_lshlrev_b32 v62, 16, v62
    v_mul_f32 v56, v56, v60
    v_mul_f32 v57, v57, v61
    v_mul_f32 v58, v58, v62
    v_mul_f32 v59, v59, v63
    v_cvt_pk_bf16_f32 v52, v56, v57
    v_cvt_pk_bf16_f32 v53, v58, v59
    v_accvgpr_read_b32 v64, a96
    v_accvgpr_read_b32 v68, a112
    v_accvgpr_read_b32 v65, a97
    v_accvgpr_read_b32 v69, a113
    v_accvgpr_read_b32 v66, a98
    v_accvgpr_read_b32 v70, a114
    v_accvgpr_read_b32 v67, a99
    v_accvgpr_read_b32 v71, a115
    v_max_f32 v64, 0, v64
    v_max_f32 v65, 0, v65
    v_max_f32 v66, 0, v66
    v_max_f32 v67, 0, v67
    v_cvt_pk_bf16_f32 v64, v64, v65
    v_cvt_pk_bf16_f32 v66, v66, v67
    v_cvt_pk_bf16_f32 v68, v68, v69
    v_cvt_pk_bf16_f32 v70, v70, v71
    v_and_b32 v65, 0xffff0000, v64
    v_lshlrev_b32 v64, 16, v64
    v_and_b32 v67, 0xffff0000, v66
    v_lshlrev_b32 v66, 16, v66
    v_and_b32 v69, 0xffff0000, v68
    v_lshlrev_b32 v68, 16, v68
    v_and_b32 v71, 0xffff0000, v70
    v_lshlrev_b32 v70, 16, v70
    v_mul_f32 v64, v64, v68
    v_mul_f32 v65, v65, v69
    v_mul_f32 v66, v66, v70
    v_mul_f32 v67, v67, v71
    v_cvt_pk_bf16_f32 v54, v64, v65
    v_cvt_pk_bf16_f32 v55, v66, v67
    s_nop 1
    v_permlane16_swap_b32 v52, v54
    v_permlane16_swap_b32 v53, v55
    buffer_store_dwordx4 v[52:55], v9, s[12:15], s30 offen offset:64
    v_accvgpr_read_b32 v76, a128
    v_accvgpr_read_b32 v80, a144
    v_accvgpr_read_b32 v77, a129
    v_accvgpr_read_b32 v81, a145
    v_accvgpr_read_b32 v78, a130
    v_accvgpr_read_b32 v82, a146
    v_accvgpr_read_b32 v79, a131
    v_accvgpr_read_b32 v83, a147
    v_max_f32 v76, 0, v76
    v_max_f32 v77, 0, v77
    v_max_f32 v78, 0, v78
    v_max_f32 v79, 0, v79
    v_cvt_pk_bf16_f32 v76, v76, v77
    v_cvt_pk_bf16_f32 v78, v78, v79
    v_cvt_pk_bf16_f32 v80, v80, v81
    v_cvt_pk_bf16_f32 v82, v82, v83
    v_and_b32 v77, 0xffff0000, v76
    v_lshlrev_b32 v76, 16, v76
    v_and_b32 v79, 0xffff0000, v78
    v_lshlrev_b32 v78, 16, v78
    v_and_b32 v81, 0xffff0000, v80
    v_lshlrev_b32 v80, 16, v80
    v_and_b32 v83, 0xffff0000, v82
    v_lshlrev_b32 v82, 16, v82
    v_mul_f32 v76, v76, v80
    v_mul_f32 v77, v77, v81
    v_mul_f32 v78, v78, v82
    v_mul_f32 v79, v79, v83
    v_cvt_pk_bf16_f32 v72, v76, v77
    v_cvt_pk_bf16_f32 v73, v78, v79
    buffer_store_dwordx2 v[72:73], v10, s[12:15], s30 offen offset:128
    s_mov_b32 s30, 147456
    v_accvgpr_read_b32 v36, a4
    v_accvgpr_read_b32 v40, a20
    v_accvgpr_read_b32 v37, a5
    v_accvgpr_read_b32 v41, a21
    v_accvgpr_read_b32 v38, a6
    v_accvgpr_read_b32 v42, a22
    v_accvgpr_read_b32 v39, a7
    v_accvgpr_read_b32 v43, a23
    v_max_f32 v36, 0, v36
    v_max_f32 v37, 0, v37
    v_max_f32 v38, 0, v38
    v_max_f32 v39, 0, v39
    v_cvt_pk_bf16_f32 v36, v36, v37
    v_cvt_pk_bf16_f32 v38, v38, v39
    v_cvt_pk_bf16_f32 v40, v40, v41
    v_cvt_pk_bf16_f32 v42, v42, v43
    v_and_b32 v37, 0xffff0000, v36
    v_lshlrev_b32 v36, 16, v36
    v_and_b32 v39, 0xffff0000, v38
    v_lshlrev_b32 v38, 16, v38
    v_and_b32 v41, 0xffff0000, v40
    v_lshlrev_b32 v40, 16, v40
    v_and_b32 v43, 0xffff0000, v42
    v_lshlrev_b32 v42, 16, v42
    v_mul_f32 v36, v36, v40
    v_mul_f32 v37, v37, v41
    v_mul_f32 v38, v38, v42
    v_mul_f32 v39, v39, v43
    v_cvt_pk_bf16_f32 v32, v36, v37
    v_cvt_pk_bf16_f32 v33, v38, v39
    v_accvgpr_read_b32 v44, a36
    v_accvgpr_read_b32 v48, a52
    v_accvgpr_read_b32 v45, a37
    v_accvgpr_read_b32 v49, a53
    v_accvgpr_read_b32 v46, a38
    v_accvgpr_read_b32 v50, a54
    v_accvgpr_read_b32 v47, a39
    v_accvgpr_read_b32 v51, a55
    v_max_f32 v44, 0, v44
    v_max_f32 v45, 0, v45
    v_max_f32 v46, 0, v46
    v_max_f32 v47, 0, v47
    v_cvt_pk_bf16_f32 v44, v44, v45
    v_cvt_pk_bf16_f32 v46, v46, v47
    v_cvt_pk_bf16_f32 v48, v48, v49
    v_cvt_pk_bf16_f32 v50, v50, v51
    v_and_b32 v45, 0xffff0000, v44
    v_lshlrev_b32 v44, 16, v44
    v_and_b32 v47, 0xffff0000, v46
    v_lshlrev_b32 v46, 16, v46
    v_and_b32 v49, 0xffff0000, v48
    v_lshlrev_b32 v48, 16, v48
    v_and_b32 v51, 0xffff0000, v50
    v_lshlrev_b32 v50, 16, v50
    v_mul_f32 v44, v44, v48
    v_mul_f32 v45, v45, v49
    v_mul_f32 v46, v46, v50
    v_mul_f32 v47, v47, v51
    v_cvt_pk_bf16_f32 v34, v44, v45
    v_cvt_pk_bf16_f32 v35, v46, v47
    s_nop 1
    v_permlane16_swap_b32 v32, v34
    v_permlane16_swap_b32 v33, v35
    buffer_store_dwordx4 v[32:35], v9, s[12:15], s30 offen offset:0
    v_accvgpr_read_b32 v56, a68
    v_accvgpr_read_b32 v60, a84
    v_accvgpr_read_b32 v57, a69
    v_accvgpr_read_b32 v61, a85
    v_accvgpr_read_b32 v58, a70
    v_accvgpr_read_b32 v62, a86
    v_accvgpr_read_b32 v59, a71
    v_accvgpr_read_b32 v63, a87
    v_max_f32 v56, 0, v56
    v_max_f32 v57, 0, v57
    v_max_f32 v58, 0, v58
    v_max_f32 v59, 0, v59
    v_cvt_pk_bf16_f32 v56, v56, v57
    v_cvt_pk_bf16_f32 v58, v58, v59
    v_cvt_pk_bf16_f32 v60, v60, v61
    v_cvt_pk_bf16_f32 v62, v62, v63
    v_and_b32 v57, 0xffff0000, v56
    v_lshlrev_b32 v56, 16, v56
    v_and_b32 v59, 0xffff0000, v58
    v_lshlrev_b32 v58, 16, v58
    v_and_b32 v61, 0xffff0000, v60
    v_lshlrev_b32 v60, 16, v60
    v_and_b32 v63, 0xffff0000, v62
    v_lshlrev_b32 v62, 16, v62
    v_mul_f32 v56, v56, v60
    v_mul_f32 v57, v57, v61
    v_mul_f32 v58, v58, v62
    v_mul_f32 v59, v59, v63
    v_cvt_pk_bf16_f32 v52, v56, v57
    v_cvt_pk_bf16_f32 v53, v58, v59
    v_accvgpr_read_b32 v64, a100
    v_accvgpr_read_b32 v68, a116
    v_accvgpr_read_b32 v65, a101
    v_accvgpr_read_b32 v69, a117
    v_accvgpr_read_b32 v66, a102
    v_accvgpr_read_b32 v70, a118
    v_accvgpr_read_b32 v67, a103
    v_accvgpr_read_b32 v71, a119
    v_max_f32 v64, 0, v64
    v_max_f32 v65, 0, v65
    v_max_f32 v66, 0, v66
    v_max_f32 v67, 0, v67
    v_cvt_pk_bf16_f32 v64, v64, v65
    v_cvt_pk_bf16_f32 v66, v66, v67
    v_cvt_pk_bf16_f32 v68, v68, v69
    v_cvt_pk_bf16_f32 v70, v70, v71
    v_and_b32 v65, 0xffff0000, v64
    v_lshlrev_b32 v64, 16, v64
    v_and_b32 v67, 0xffff0000, v66
    v_lshlrev_b32 v66, 16, v66
    v_and_b32 v69, 0xffff0000, v68
    v_lshlrev_b32 v68, 16, v68
    v_and_b32 v71, 0xffff0000, v70
    v_lshlrev_b32 v70, 16, v70
    v_mul_f32 v64, v64, v68
    v_mul_f32 v65, v65, v69
    v_mul_f32 v66, v66, v70
    v_mul_f32 v67, v67, v71
    v_cvt_pk_bf16_f32 v54, v64, v65
    v_cvt_pk_bf16_f32 v55, v66, v67
    s_nop 1
    v_permlane16_swap_b32 v52, v54
    v_permlane16_swap_b32 v53, v55
    buffer_store_dwordx4 v[52:55], v9, s[12:15], s30 offen offset:64
    v_accvgpr_read_b32 v76, a132
    v_accvgpr_read_b32 v80, a148
    v_accvgpr_read_b32 v77, a133
    v_accvgpr_read_b32 v81, a149
    v_accvgpr_read_b32 v78, a134
    v_accvgpr_read_b32 v82, a150
    v_accvgpr_read_b32 v79, a135
    v_accvgpr_read_b32 v83, a151
    v_max_f32 v76, 0, v76
    v_max_f32 v77, 0, v77
    v_max_f32 v78, 0, v78
    v_max_f32 v79, 0, v79
    v_cvt_pk_bf16_f32 v76, v76, v77
    v_cvt_pk_bf16_f32 v78, v78, v79
    v_cvt_pk_bf16_f32 v80, v80, v81
    v_cvt_pk_bf16_f32 v82, v82, v83
    v_and_b32 v77, 0xffff0000, v76
    v_lshlrev_b32 v76, 16, v76
    v_and_b32 v79, 0xffff0000, v78
    v_lshlrev_b32 v78, 16, v78
    v_and_b32 v81, 0xffff0000, v80
    v_lshlrev_b32 v80, 16, v80
    v_and_b32 v83, 0xffff0000, v82
    v_lshlrev_b32 v82, 16, v82
    v_mul_f32 v76, v76, v80
    v_mul_f32 v77, v77, v81
    v_mul_f32 v78, v78, v82
    v_mul_f32 v79, v79, v83
    v_cvt_pk_bf16_f32 v72, v76, v77
    v_cvt_pk_bf16_f32 v73, v78, v79
    buffer_store_dwordx2 v[72:73], v10, s[12:15], s30 offen offset:128
    s_mov_b32 s30, 294912
    v_accvgpr_read_b32 v36, a8
    v_accvgpr_read_b32 v40, a24
    v_accvgpr_read_b32 v37, a9
    v_accvgpr_read_b32 v41, a25
    v_accvgpr_read_b32 v38, a10
    v_accvgpr_read_b32 v42, a26
    v_accvgpr_read_b32 v39, a11
    v_accvgpr_read_b32 v43, a27
    v_max_f32 v36, 0, v36
    v_max_f32 v37, 0, v37
    v_max_f32 v38, 0, v38
    v_max_f32 v39, 0, v39
    v_cvt_pk_bf16_f32 v36, v36, v37
    v_cvt_pk_bf16_f32 v38, v38, v39
    v_cvt_pk_bf16_f32 v40, v40, v41
    v_cvt_pk_bf16_f32 v42, v42, v43
    v_and_b32 v37, 0xffff0000, v36
    v_lshlrev_b32 v36, 16, v36
    v_and_b32 v39, 0xffff0000, v38
    v_lshlrev_b32 v38, 16, v38
    v_and_b32 v41, 0xffff0000, v40
    v_lshlrev_b32 v40, 16, v40
    v_and_b32 v43, 0xffff0000, v42
    v_lshlrev_b32 v42, 16, v42
    v_mul_f32 v36, v36, v40
    v_mul_f32 v37, v37, v41
    v_mul_f32 v38, v38, v42
    v_mul_f32 v39, v39, v43
    v_cvt_pk_bf16_f32 v32, v36, v37
    v_cvt_pk_bf16_f32 v33, v38, v39
    v_accvgpr_read_b32 v44, a40
    v_accvgpr_read_b32 v48, a56
    v_accvgpr_read_b32 v45, a41
    v_accvgpr_read_b32 v49, a57
    v_accvgpr_read_b32 v46, a42
    v_accvgpr_read_b32 v50, a58
    v_accvgpr_read_b32 v47, a43
    v_accvgpr_read_b32 v51, a59
    v_max_f32 v44, 0, v44
    v_max_f32 v45, 0, v45
    v_max_f32 v46, 0, v46
    v_max_f32 v47, 0, v47
    v_cvt_pk_bf16_f32 v44, v44, v45
    v_cvt_pk_bf16_f32 v46, v46, v47
    v_cvt_pk_bf16_f32 v48, v48, v49
    v_cvt_pk_bf16_f32 v50, v50, v51
    v_and_b32 v45, 0xffff0000, v44
    v_lshlrev_b32 v44, 16, v44
    v_and_b32 v47, 0xffff0000, v46
    v_lshlrev_b32 v46, 16, v46
    v_and_b32 v49, 0xffff0000, v48
    v_lshlrev_b32 v48, 16, v48
    v_and_b32 v51, 0xffff0000, v50
    v_lshlrev_b32 v50, 16, v50
    v_mul_f32 v44, v44, v48
    v_mul_f32 v45, v45, v49
    v_mul_f32 v46, v46, v50
    v_mul_f32 v47, v47, v51
    v_cvt_pk_bf16_f32 v34, v44, v45
    v_cvt_pk_bf16_f32 v35, v46, v47
    s_nop 1
    v_permlane16_swap_b32 v32, v34
    v_permlane16_swap_b32 v33, v35
    buffer_store_dwordx4 v[32:35], v9, s[12:15], s30 offen offset:0
    v_accvgpr_read_b32 v56, a72
    v_accvgpr_read_b32 v60, a88
    v_accvgpr_read_b32 v57, a73
    v_accvgpr_read_b32 v61, a89
    v_accvgpr_read_b32 v58, a74
    v_accvgpr_read_b32 v62, a90
    v_accvgpr_read_b32 v59, a75
    v_accvgpr_read_b32 v63, a91
    v_max_f32 v56, 0, v56
    v_max_f32 v57, 0, v57
    v_max_f32 v58, 0, v58
    v_max_f32 v59, 0, v59
    v_cvt_pk_bf16_f32 v56, v56, v57
    v_cvt_pk_bf16_f32 v58, v58, v59
    v_cvt_pk_bf16_f32 v60, v60, v61
    v_cvt_pk_bf16_f32 v62, v62, v63
    v_and_b32 v57, 0xffff0000, v56
    v_lshlrev_b32 v56, 16, v56
    v_and_b32 v59, 0xffff0000, v58
    v_lshlrev_b32 v58, 16, v58
    v_and_b32 v61, 0xffff0000, v60
    v_lshlrev_b32 v60, 16, v60
    v_and_b32 v63, 0xffff0000, v62
    v_lshlrev_b32 v62, 16, v62
    v_mul_f32 v56, v56, v60
    v_mul_f32 v57, v57, v61
    v_mul_f32 v58, v58, v62
    v_mul_f32 v59, v59, v63
    v_cvt_pk_bf16_f32 v52, v56, v57
    v_cvt_pk_bf16_f32 v53, v58, v59
    v_accvgpr_read_b32 v64, a104
    v_accvgpr_read_b32 v68, a120
    v_accvgpr_read_b32 v65, a105
    v_accvgpr_read_b32 v69, a121
    v_accvgpr_read_b32 v66, a106
    v_accvgpr_read_b32 v70, a122
    v_accvgpr_read_b32 v67, a107
    v_accvgpr_read_b32 v71, a123
    v_max_f32 v64, 0, v64
    v_max_f32 v65, 0, v65
    v_max_f32 v66, 0, v66
    v_max_f32 v67, 0, v67
    v_cvt_pk_bf16_f32 v64, v64, v65
    v_cvt_pk_bf16_f32 v66, v66, v67
    v_cvt_pk_bf16_f32 v68, v68, v69
    v_cvt_pk_bf16_f32 v70, v70, v71
    v_and_b32 v65, 0xffff0000, v64
    v_lshlrev_b32 v64, 16, v64
    v_and_b32 v67, 0xffff0000, v66
    v_lshlrev_b32 v66, 16, v66
    v_and_b32 v69, 0xffff0000, v68
    v_lshlrev_b32 v68, 16, v68
    v_and_b32 v71, 0xffff0000, v70
    v_lshlrev_b32 v70, 16, v70
    v_mul_f32 v64, v64, v68
    v_mul_f32 v65, v65, v69
    v_mul_f32 v66, v66, v70
    v_mul_f32 v67, v67, v71
    v_cvt_pk_bf16_f32 v54, v64, v65
    v_cvt_pk_bf16_f32 v55, v66, v67
    s_nop 1
    v_permlane16_swap_b32 v52, v54
    v_permlane16_swap_b32 v53, v55
    buffer_store_dwordx4 v[52:55], v9, s[12:15], s30 offen offset:64
    v_accvgpr_read_b32 v76, a136
    v_accvgpr_read_b32 v80, a152
    v_accvgpr_read_b32 v77, a137
    v_accvgpr_read_b32 v81, a153
    v_accvgpr_read_b32 v78, a138
    v_accvgpr_read_b32 v82, a154
    v_accvgpr_read_b32 v79, a139
    v_accvgpr_read_b32 v83, a155
    v_max_f32 v76, 0, v76
    v_max_f32 v77, 0, v77
    v_max_f32 v78, 0, v78
    v_max_f32 v79, 0, v79
    v_cvt_pk_bf16_f32 v76, v76, v77
    v_cvt_pk_bf16_f32 v78, v78, v79
    v_cvt_pk_bf16_f32 v80, v80, v81
    v_cvt_pk_bf16_f32 v82, v82, v83
    v_and_b32 v77, 0xffff0000, v76
    v_lshlrev_b32 v76, 16, v76
    v_and_b32 v79, 0xffff0000, v78
    v_lshlrev_b32 v78, 16, v78
    v_and_b32 v81, 0xffff0000, v80
    v_lshlrev_b32 v80, 16, v80
    v_and_b32 v83, 0xffff0000, v82
    v_lshlrev_b32 v82, 16, v82
    v_mul_f32 v76, v76, v80
    v_mul_f32 v77, v77, v81
    v_mul_f32 v78, v78, v82
    v_mul_f32 v79, v79, v83
    v_cvt_pk_bf16_f32 v72, v76, v77
    v_cvt_pk_bf16_f32 v73, v78, v79
    buffer_store_dwordx2 v[72:73], v10, s[12:15], s30 offen offset:128
    s_mov_b32 s30, 442368
    v_accvgpr_read_b32 v36, a12
    v_accvgpr_read_b32 v40, a28
    v_accvgpr_read_b32 v37, a13
    v_accvgpr_read_b32 v41, a29
    v_accvgpr_read_b32 v38, a14
    v_accvgpr_read_b32 v42, a30
    v_accvgpr_read_b32 v39, a15
    v_accvgpr_read_b32 v43, a31
    v_max_f32 v36, 0, v36
    v_max_f32 v37, 0, v37
    v_max_f32 v38, 0, v38
    v_max_f32 v39, 0, v39
    v_cvt_pk_bf16_f32 v36, v36, v37
    v_cvt_pk_bf16_f32 v38, v38, v39
    v_cvt_pk_bf16_f32 v40, v40, v41
    v_cvt_pk_bf16_f32 v42, v42, v43
    v_and_b32 v37, 0xffff0000, v36
    v_lshlrev_b32 v36, 16, v36
    v_and_b32 v39, 0xffff0000, v38
    v_lshlrev_b32 v38, 16, v38
    v_and_b32 v41, 0xffff0000, v40
    v_lshlrev_b32 v40, 16, v40
    v_and_b32 v43, 0xffff0000, v42
    v_lshlrev_b32 v42, 16, v42
    v_mul_f32 v36, v36, v40
    v_mul_f32 v37, v37, v41
    v_mul_f32 v38, v38, v42
    v_mul_f32 v39, v39, v43
    v_cvt_pk_bf16_f32 v32, v36, v37
    v_cvt_pk_bf16_f32 v33, v38, v39
    v_accvgpr_read_b32 v44, a44
    v_accvgpr_read_b32 v48, a60
    v_accvgpr_read_b32 v45, a45
    v_accvgpr_read_b32 v49, a61
    v_accvgpr_read_b32 v46, a46
    v_accvgpr_read_b32 v50, a62
    v_accvgpr_read_b32 v47, a47
    v_accvgpr_read_b32 v51, a63
    v_max_f32 v44, 0, v44
    v_max_f32 v45, 0, v45
    v_max_f32 v46, 0, v46
    v_max_f32 v47, 0, v47
    v_cvt_pk_bf16_f32 v44, v44, v45
    v_cvt_pk_bf16_f32 v46, v46, v47
    v_cvt_pk_bf16_f32 v48, v48, v49
    v_cvt_pk_bf16_f32 v50, v50, v51
    v_and_b32 v45, 0xffff0000, v44
    v_lshlrev_b32 v44, 16, v44
    v_and_b32 v47, 0xffff0000, v46
    v_lshlrev_b32 v46, 16, v46
    v_and_b32 v49, 0xffff0000, v48
    v_lshlrev_b32 v48, 16, v48
    v_and_b32 v51, 0xffff0000, v50
    v_lshlrev_b32 v50, 16, v50
    v_mul_f32 v44, v44, v48
    v_mul_f32 v45, v45, v49
    v_mul_f32 v46, v46, v50
    v_mul_f32 v47, v47, v51
    v_cvt_pk_bf16_f32 v34, v44, v45
    v_cvt_pk_bf16_f32 v35, v46, v47
    s_nop 1
    v_permlane16_swap_b32 v32, v34
    v_permlane16_swap_b32 v33, v35
    buffer_store_dwordx4 v[32:35], v9, s[12:15], s30 offen offset:0
    v_accvgpr_read_b32 v56, a76
    v_accvgpr_read_b32 v60, a92
    v_accvgpr_read_b32 v57, a77
    v_accvgpr_read_b32 v61, a93
    v_accvgpr_read_b32 v58, a78
    v_accvgpr_read_b32 v62, a94
    v_accvgpr_read_b32 v59, a79
    v_accvgpr_read_b32 v63, a95
    v_max_f32 v56, 0, v56
    v_max_f32 v57, 0, v57
    v_max_f32 v58, 0, v58
    v_max_f32 v59, 0, v59
    v_cvt_pk_bf16_f32 v56, v56, v57
    v_cvt_pk_bf16_f32 v58, v58, v59
    v_cvt_pk_bf16_f32 v60, v60, v61
    v_cvt_pk_bf16_f32 v62, v62, v63
    v_and_b32 v57, 0xffff0000, v56
    v_lshlrev_b32 v56, 16, v56
    v_and_b32 v59, 0xffff0000, v58
    v_lshlrev_b32 v58, 16, v58
    v_and_b32 v61, 0xffff0000, v60
    v_lshlrev_b32 v60, 16, v60
    v_and_b32 v63, 0xffff0000, v62
    v_lshlrev_b32 v62, 16, v62
    v_mul_f32 v56, v56, v60
    v_mul_f32 v57, v57, v61
    v_mul_f32 v58, v58, v62
    v_mul_f32 v59, v59, v63
    v_cvt_pk_bf16_f32 v52, v56, v57
    v_cvt_pk_bf16_f32 v53, v58, v59
    v_accvgpr_read_b32 v64, a108
    v_accvgpr_read_b32 v68, a124
    v_accvgpr_read_b32 v65, a109
    v_accvgpr_read_b32 v69, a125
    v_accvgpr_read_b32 v66, a110
    v_accvgpr_read_b32 v70, a126
    v_accvgpr_read_b32 v67, a111
    v_accvgpr_read_b32 v71, a127
    v_max_f32 v64, 0, v64
    v_max_f32 v65, 0, v65
    v_max_f32 v66, 0, v66
    v_max_f32 v67, 0, v67
    v_cvt_pk_bf16_f32 v64, v64, v65
    v_cvt_pk_bf16_f32 v66, v66, v67
    v_cvt_pk_bf16_f32 v68, v68, v69
    v_cvt_pk_bf16_f32 v70, v70, v71
    v_and_b32 v65, 0xffff0000, v64
    v_lshlrev_b32 v64, 16, v64
    v_and_b32 v67, 0xffff0000, v66
    v_lshlrev_b32 v66, 16, v66
    v_and_b32 v69, 0xffff0000, v68
    v_lshlrev_b32 v68, 16, v68
    v_and_b32 v71, 0xffff0000, v70
    v_lshlrev_b32 v70, 16, v70
    v_mul_f32 v64, v64, v68
    v_mul_f32 v65, v65, v69
    v_mul_f32 v66, v66, v70
    v_mul_f32 v67, v67, v71
    v_cvt_pk_bf16_f32 v54, v64, v65
    v_cvt_pk_bf16_f32 v55, v66, v67
    s_nop 1
    v_permlane16_swap_b32 v52, v54
    v_permlane16_swap_b32 v53, v55
    buffer_store_dwordx4 v[52:55], v9, s[12:15], s30 offen offset:64
    v_accvgpr_read_b32 v76, a140
    v_accvgpr_read_b32 v80, a156
    v_accvgpr_read_b32 v77, a141
    v_accvgpr_read_b32 v81, a157
    v_accvgpr_read_b32 v78, a142
    v_accvgpr_read_b32 v82, a158
    v_accvgpr_read_b32 v79, a143
    v_accvgpr_read_b32 v83, a159
    v_max_f32 v76, 0, v76
    v_max_f32 v77, 0, v77
    v_max_f32 v78, 0, v78
    v_max_f32 v79, 0, v79
    v_cvt_pk_bf16_f32 v76, v76, v77
    v_cvt_pk_bf16_f32 v78, v78, v79
    v_cvt_pk_bf16_f32 v80, v80, v81
    v_cvt_pk_bf16_f32 v82, v82, v83
    v_and_b32 v77, 0xffff0000, v76
    v_lshlrev_b32 v76, 16, v76
    v_and_b32 v79, 0xffff0000, v78
    v_lshlrev_b32 v78, 16, v78
    v_and_b32 v81, 0xffff0000, v80
    v_lshlrev_b32 v80, 16, v80
    v_and_b32 v83, 0xffff0000, v82
    v_lshlrev_b32 v82, 16, v82
    v_mul_f32 v76, v76, v80
    v_mul_f32 v77, v77, v81
    v_mul_f32 v78, v78, v82
    v_mul_f32 v79, v79, v83
    v_cvt_pk_bf16_f32 v72, v76, v77
    v_cvt_pk_bf16_f32 v73, v78, v79
    buffer_store_dwordx2 v[72:73], v10, s[12:15], s30 offen offset:128
    s_endpgm
.ffn1_kernel_end_p1:
    s_nop 0
    s_add_u32 m0, s26, 0
    s_nop 0
    buffer_load_dwordx4 v16, s[8:11], s27 offen lds
    s_nop 0
    s_add_u32 m0, s26, 8192
    s_nop 0
    buffer_load_dwordx4 v17, s[8:11], s27 offen lds
    s_nop 0
    s_add_u32 m0, s44, 0
    s_nop 0
    buffer_load_dwordx4 v18, s[80:83], s28 offen lds
    s_nop 0
    s_add_u32 m0, s45, 0
    s_nop 0
    buffer_load_dwordx4 v19, s[84:87], s28 offen lds
    s_nop 0
    s_add_u32 s27, s27, 64
    s_add_u32 s28, s28, 294912
    s_nop 0
    s_add_u32 m0, s26, 34816
    s_nop 0
    buffer_load_dwordx4 v16, s[8:11], s27 offen lds
    s_nop 0
    s_add_u32 m0, s26, 43008
    s_nop 0
    buffer_load_dwordx4 v17, s[8:11], s27 offen lds
    s_nop 0
    s_add_u32 m0, s44, 34816
    s_nop 0
    buffer_load_dwordx4 v18, s[80:83], s28 offen lds
    s_nop 0
    s_add_u32 m0, s45, 34816
    s_nop 0
    buffer_load_dwordx4 v19, s[84:87], s28 offen lds
    s_nop 0
    s_add_u32 s27, s27, 64
    s_add_u32 s28, s28, 294912
    s_nop 0
    s_add_u32 m0, s26, 69632
    s_nop 0
    buffer_load_dwordx4 v16, s[8:11], s27 offen lds
    s_nop 0
    s_add_u32 m0, s26, 77824
    s_nop 0
    buffer_load_dwordx4 v17, s[8:11], s27 offen lds
    s_nop 0
    s_add_u32 m0, s44, 69632
    s_nop 0
    buffer_load_dwordx4 v18, s[80:83], s28 offen lds
    s_nop 0
    s_add_u32 m0, s45, 69632
    s_nop 0
    buffer_load_dwordx4 v19, s[84:87], s28 offen lds
    s_nop 0
    s_add_u32 s27, s27, 64
    s_add_u32 s28, s28, 294912
    s_nop 0
    v_sub_u32 v8, 0, v5
    v_and_b32 v8, 3, v8
    v_xor_b32 v8, v4, v8
    v_lshlrev_b32 v8, 4, v8
    v_lshl_add_u32 v8, v3, 6, v8
    s_lshl_b32 s30, s21, 12
    s_lshl_b32 s31, s22, 13
    s_add_u32 s30, s30, s31
    v_add_u32 v8, s30, v8
    v_lshrrev_b32 v9, 1, v4
    v_lshlrev_b32 v9, 4, v9
    v_and_b32 v10, 1, v4
    v_lshl_add_u32 v9, v10, 2, v9
    v_add_u32 v9, v9, v5
    v_mul_u32_u24 v9, 288, v9
    v_lshl_add_u32 v9, v6, 3, v9
    s_mul_i32 s31, s22, 9216
    v_add_u32 v9, s31, v9
    v_add_u32 v22, 0, v8
    v_add_u32 v26, 16384, v9
    v_add_u32 v23, 34816, v8
    v_add_u32 v27, 51200, v9
    v_add_u32 v24, 69632, v8
    v_add_u32 v28, 86016, v9
    v_add_u32 v25, 104448, v8
    v_add_u32 v29, 120832, v9
    s_nop 0
    s_waitcnt vmcnt(8)
    s_barrier
    s_nop 0
    ds_read_b128 v[32:35], v22 offset:0
    ds_read_b128 v[36:39], v22 offset:1024
    ds_read_b64_tr_b16 v[64:65], v26 offset:160
    s_nop 0
    ds_read_b128 v[40:43], v22 offset:2048
    ds_read_b128 v[44:47], v22 offset:3072
    ds_read_b64_tr_b16 v[66:67], v26 offset:2464
    s_nop 0
    ds_read_b64_tr_b16 v[68:69], v26 offset:9376
    s_nop 0
    ds_read_b64_tr_b16 v[70:71], v26 offset:11680
    s_nop 0
    ds_read_b64_tr_b16 v[72:73], v26 offset:192
    s_nop 0
    ds_read_b64_tr_b16 v[74:75], v26 offset:2496
    s_waitcnt lgkmcnt(4)
    v_mfma_f32_16x16x32_bf16 a[0:3], v[64:67], v[32:35], 0
    ds_read_b64_tr_b16 v[76:77], v26 offset:9408
    v_mfma_f32_16x16x32_bf16 a[4:7], v[64:67], v[36:39], 0
    ds_read_b64_tr_b16 v[78:79], v26 offset:11712
    v_mfma_f32_16x16x32_bf16 a[8:11], v[64:67], v[40:43], 0
    v_mfma_f32_16x16x32_bf16 a[12:15], v[64:67], v[44:47], 0
    s_waitcnt lgkmcnt(4)
    v_mfma_f32_16x16x32_bf16 a[16:19], v[68:71], v[32:35], 0
    ds_read_b64_tr_b16 v[80:81], v26 offset:224
    v_mfma_f32_16x16x32_bf16 a[20:23], v[68:71], v[36:39], 0
    ds_read_b64_tr_b16 v[82:83], v26 offset:2528
    v_mfma_f32_16x16x32_bf16 a[24:27], v[68:71], v[40:43], 0
    v_mfma_f32_16x16x32_bf16 a[28:31], v[68:71], v[44:47], 0
    s_waitcnt lgkmcnt(4)
    v_mfma_f32_16x16x32_bf16 a[32:35], v[72:75], v[32:35], 0
    ds_read_b64_tr_b16 v[84:85], v26 offset:9440
    v_mfma_f32_16x16x32_bf16 a[36:39], v[72:75], v[36:39], 0
    ds_read_b64_tr_b16 v[86:87], v26 offset:11744
    v_mfma_f32_16x16x32_bf16 a[40:43], v[72:75], v[40:43], 0
    v_mfma_f32_16x16x32_bf16 a[44:47], v[72:75], v[44:47], 0
    s_waitcnt lgkmcnt(4)
    v_mfma_f32_16x16x32_bf16 a[48:51], v[76:79], v[32:35], 0
    ds_read_b64_tr_b16 v[88:89], v26 offset:256
    v_mfma_f32_16x16x32_bf16 a[52:55], v[76:79], v[36:39], 0
    ds_read_b64_tr_b16 v[90:91], v26 offset:2560
    v_mfma_f32_16x16x32_bf16 a[56:59], v[76:79], v[40:43], 0
    v_mfma_f32_16x16x32_bf16 a[60:63], v[76:79], v[44:47], 0
    s_waitcnt lgkmcnt(4)
    v_mfma_f32_16x16x32_bf16 a[64:67], v[80:83], v[32:35], 0
    ds_read_b64_tr_b16 v[92:93], v26 offset:9472
    v_mfma_f32_16x16x32_bf16 a[68:71], v[80:83], v[36:39], 0
    ds_read_b64_tr_b16 v[94:95], v26 offset:11776
    v_mfma_f32_16x16x32_bf16 a[72:75], v[80:83], v[40:43], 0
    v_mfma_f32_16x16x32_bf16 a[76:79], v[80:83], v[44:47], 0
    s_waitcnt vmcnt(4)
    s_barrier
    s_waitcnt lgkmcnt(4)
    v_mfma_f32_16x16x32_bf16 a[80:83], v[84:87], v[32:35], 0
    ds_read_b128 v[48:51], v23 offset:0
    ds_read_b128 v[52:55], v23 offset:1024
    ds_read_b64_tr_b16 v[64:65], v27 offset:160
    s_add_u32 m0, s26, 104448
    v_mfma_f32_16x16x32_bf16 a[84:87], v[84:87], v[36:39], 0
    ds_read_b128 v[56:59], v23 offset:2048
    ds_read_b128 v[60:63], v23 offset:3072
    ds_read_b64_tr_b16 v[66:67], v27 offset:2464
    buffer_load_dwordx4 v16, s[8:11], s27 offen lds
    v_mfma_f32_16x16x32_bf16 a[88:91], v[84:87], v[40:43], 0
    s_add_u32 m0, s26, 112640
    v_mfma_f32_16x16x32_bf16 a[92:95], v[84:87], v[44:47], 0
    buffer_load_dwordx4 v17, s[8:11], s27 offen lds
    s_waitcnt lgkmcnt(8)
    v_mfma_f32_16x16x32_bf16 a[96:99], v[88:91], v[32:35], 0
    ds_read_b64_tr_b16 v[68:69], v27 offset:9376
    s_add_u32 m0, s44, 104448
    v_mfma_f32_16x16x32_bf16 a[100:103], v[88:91], v[36:39], 0
    ds_read_b64_tr_b16 v[70:71], v27 offset:11680
    buffer_load_dwordx4 v18, s[80:83], s28 offen lds
    v_mfma_f32_16x16x32_bf16 a[104:107], v[88:91], v[40:43], 0
    s_add_u32 m0, s45, 104448
    v_mfma_f32_16x16x32_bf16 a[108:111], v[88:91], v[44:47], 0
    buffer_load_dwordx4 v19, s[84:87], s28 offen lds
    s_waitcnt lgkmcnt(8)
    v_mfma_f32_16x16x32_bf16 a[112:115], v[92:95], v[32:35], 0
    ds_read_b64_tr_b16 v[72:73], v27 offset:192
    s_add_u32 s27, s27, 64
    s_add_u32 s28, s28, 294912
    v_mfma_f32_16x16x32_bf16 a[116:119], v[92:95], v[36:39], 0
    ds_read_b64_tr_b16 v[74:75], v27 offset:2496
    v_mfma_f32_16x16x32_bf16 a[120:123], v[92:95], v[40:43], 0
    v_mfma_f32_16x16x32_bf16 a[124:127], v[92:95], v[44:47], 0
    s_waitcnt lgkmcnt(4)
    v_mfma_f32_16x16x32_bf16 a[0:3], v[64:67], v[48:51], a[0:3]
    ds_read_b64_tr_b16 v[76:77], v27 offset:9408
    v_mfma_f32_16x16x32_bf16 a[4:7], v[64:67], v[52:55], a[4:7]
    ds_read_b64_tr_b16 v[78:79], v27 offset:11712
    v_mfma_f32_16x16x32_bf16 a[8:11], v[64:67], v[56:59], a[8:11]
    v_mfma_f32_16x16x32_bf16 a[12:15], v[64:67], v[60:63], a[12:15]
    s_waitcnt lgkmcnt(4)
    v_mfma_f32_16x16x32_bf16 a[16:19], v[68:71], v[48:51], a[16:19]
    ds_read_b64_tr_b16 v[80:81], v27 offset:224
    v_mfma_f32_16x16x32_bf16 a[20:23], v[68:71], v[52:55], a[20:23]
    ds_read_b64_tr_b16 v[82:83], v27 offset:2528
    v_mfma_f32_16x16x32_bf16 a[24:27], v[68:71], v[56:59], a[24:27]
    v_mfma_f32_16x16x32_bf16 a[28:31], v[68:71], v[60:63], a[28:31]
    s_waitcnt lgkmcnt(4)
    v_mfma_f32_16x16x32_bf16 a[32:35], v[72:75], v[48:51], a[32:35]
    ds_read_b64_tr_b16 v[84:85], v27 offset:9440
    v_mfma_f32_16x16x32_bf16 a[36:39], v[72:75], v[52:55], a[36:39]
    ds_read_b64_tr_b16 v[86:87], v27 offset:11744
    v_mfma_f32_16x16x32_bf16 a[40:43], v[72:75], v[56:59], a[40:43]
    v_mfma_f32_16x16x32_bf16 a[44:47], v[72:75], v[60:63], a[44:47]
    s_waitcnt lgkmcnt(4)
    v_mfma_f32_16x16x32_bf16 a[48:51], v[76:79], v[48:51], a[48:51]
    ds_read_b64_tr_b16 v[88:89], v27 offset:256
    v_mfma_f32_16x16x32_bf16 a[52:55], v[76:79], v[52:55], a[52:55]
    ds_read_b64_tr_b16 v[90:91], v27 offset:2560
    v_mfma_f32_16x16x32_bf16 a[56:59], v[76:79], v[56:59], a[56:59]
    v_mfma_f32_16x16x32_bf16 a[60:63], v[76:79], v[60:63], a[60:63]
    s_waitcnt lgkmcnt(4)
    v_mfma_f32_16x16x32_bf16 a[64:67], v[80:83], v[48:51], a[64:67]
    ds_read_b64_tr_b16 v[92:93], v27 offset:9472
    v_mfma_f32_16x16x32_bf16 a[68:71], v[80:83], v[52:55], a[68:71]
    ds_read_b64_tr_b16 v[94:95], v27 offset:11776
    v_mfma_f32_16x16x32_bf16 a[72:75], v[80:83], v[56:59], a[72:75]
    v_mfma_f32_16x16x32_bf16 a[76:79], v[80:83], v[60:63], a[76:79]
    s_waitcnt vmcnt(4)
    s_barrier
    s_waitcnt lgkmcnt(4)
    v_mfma_f32_16x16x32_bf16 a[80:83], v[84:87], v[48:51], a[80:83]
    ds_read_b128 v[32:35], v24 offset:0
    ds_read_b128 v[36:39], v24 offset:1024
    ds_read_b64_tr_b16 v[64:65], v28 offset:160
    s_add_u32 m0, s26, 0
    v_mfma_f32_16x16x32_bf16 a[84:87], v[84:87], v[52:55], a[84:87]
    ds_read_b128 v[40:43], v24 offset:2048
    ds_read_b128 v[44:47], v24 offset:3072
    ds_read_b64_tr_b16 v[66:67], v28 offset:2464
    buffer_load_dwordx4 v16, s[8:11], s27 offen lds
    v_mfma_f32_16x16x32_bf16 a[88:91], v[84:87], v[56:59], a[88:91]
    s_add_u32 m0, s26, 8192
    v_mfma_f32_16x16x32_bf16 a[92:95], v[84:87], v[60:63], a[92:95]
    buffer_load_dwordx4 v17, s[8:11], s27 offen lds
    s_waitcnt lgkmcnt(8)
    v_mfma_f32_16x16x32_bf16 a[96:99], v[88:91], v[48:51], a[96:99]
    ds_read_b64_tr_b16 v[68:69], v28 offset:9376
    s_add_u32 m0, s44, 0
    v_mfma_f32_16x16x32_bf16 a[100:103], v[88:91], v[52:55], a[100:103]
    ds_read_b64_tr_b16 v[70:71], v28 offset:11680
    buffer_load_dwordx4 v18, s[80:83], s28 offen lds
    v_mfma_f32_16x16x32_bf16 a[104:107], v[88:91], v[56:59], a[104:107]
    s_add_u32 m0, s45, 0
    v_mfma_f32_16x16x32_bf16 a[108:111], v[88:91], v[60:63], a[108:111]
    buffer_load_dwordx4 v19, s[84:87], s28 offen lds
    s_waitcnt lgkmcnt(8)
    v_mfma_f32_16x16x32_bf16 a[112:115], v[92:95], v[48:51], a[112:115]
    ds_read_b64_tr_b16 v[72:73], v28 offset:192
    s_add_u32 s27, s27, 64
    s_add_u32 s28, s28, 294912
    v_mfma_f32_16x16x32_bf16 a[116:119], v[92:95], v[52:55], a[116:119]
    ds_read_b64_tr_b16 v[74:75], v28 offset:2496
    v_mfma_f32_16x16x32_bf16 a[120:123], v[92:95], v[56:59], a[120:123]
    v_mfma_f32_16x16x32_bf16 a[124:127], v[92:95], v[60:63], a[124:127]
    s_waitcnt lgkmcnt(4)
    v_mfma_f32_16x16x32_bf16 a[0:3], v[64:67], v[32:35], a[0:3]
    ds_read_b64_tr_b16 v[76:77], v28 offset:9408
    v_mfma_f32_16x16x32_bf16 a[4:7], v[64:67], v[36:39], a[4:7]
    ds_read_b64_tr_b16 v[78:79], v28 offset:11712
    v_mfma_f32_16x16x32_bf16 a[8:11], v[64:67], v[40:43], a[8:11]
    v_mfma_f32_16x16x32_bf16 a[12:15], v[64:67], v[44:47], a[12:15]
    s_waitcnt lgkmcnt(4)
    v_mfma_f32_16x16x32_bf16 a[16:19], v[68:71], v[32:35], a[16:19]
    ds_read_b64_tr_b16 v[80:81], v28 offset:224
    v_mfma_f32_16x16x32_bf16 a[20:23], v[68:71], v[36:39], a[20:23]
    ds_read_b64_tr_b16 v[82:83], v28 offset:2528
    v_mfma_f32_16x16x32_bf16 a[24:27], v[68:71], v[40:43], a[24:27]
    v_mfma_f32_16x16x32_bf16 a[28:31], v[68:71], v[44:47], a[28:31]
    s_waitcnt lgkmcnt(4)
    v_mfma_f32_16x16x32_bf16 a[32:35], v[72:75], v[32:35], a[32:35]
    ds_read_b64_tr_b16 v[84:85], v28 offset:9440
    v_mfma_f32_16x16x32_bf16 a[36:39], v[72:75], v[36:39], a[36:39]
    ds_read_b64_tr_b16 v[86:87], v28 offset:11744
    v_mfma_f32_16x16x32_bf16 a[40:43], v[72:75], v[40:43], a[40:43]
    v_mfma_f32_16x16x32_bf16 a[44:47], v[72:75], v[44:47], a[44:47]
    s_waitcnt lgkmcnt(4)
    v_mfma_f32_16x16x32_bf16 a[48:51], v[76:79], v[32:35], a[48:51]
    ds_read_b64_tr_b16 v[88:89], v28 offset:256
    v_mfma_f32_16x16x32_bf16 a[52:55], v[76:79], v[36:39], a[52:55]
    ds_read_b64_tr_b16 v[90:91], v28 offset:2560
    v_mfma_f32_16x16x32_bf16 a[56:59], v[76:79], v[40:43], a[56:59]
    v_mfma_f32_16x16x32_bf16 a[60:63], v[76:79], v[44:47], a[60:63]
    s_waitcnt lgkmcnt(4)
    v_mfma_f32_16x16x32_bf16 a[64:67], v[80:83], v[32:35], a[64:67]
    ds_read_b64_tr_b16 v[92:93], v28 offset:9472
    v_mfma_f32_16x16x32_bf16 a[68:71], v[80:83], v[36:39], a[68:71]
    ds_read_b64_tr_b16 v[94:95], v28 offset:11776
    v_mfma_f32_16x16x32_bf16 a[72:75], v[80:83], v[40:43], a[72:75]
    v_mfma_f32_16x16x32_bf16 a[76:79], v[80:83], v[44:47], a[76:79]
    s_waitcnt vmcnt(4)
    s_barrier
    s_waitcnt lgkmcnt(4)
    v_mfma_f32_16x16x32_bf16 a[80:83], v[84:87], v[32:35], a[80:83]
    ds_read_b128 v[48:51], v25 offset:0
    ds_read_b128 v[52:55], v25 offset:1024
    ds_read_b64_tr_b16 v[64:65], v29 offset:160
    s_add_u32 m0, s26, 34816
    v_mfma_f32_16x16x32_bf16 a[84:87], v[84:87], v[36:39], a[84:87]
    ds_read_b128 v[56:59], v25 offset:2048
    ds_read_b128 v[60:63], v25 offset:3072
    ds_read_b64_tr_b16 v[66:67], v29 offset:2464
    buffer_load_dwordx4 v16, s[8:11], s27 offen lds
    v_mfma_f32_16x16x32_bf16 a[88:91], v[84:87], v[40:43], a[88:91]
    s_add_u32 m0, s26, 43008
    v_mfma_f32_16x16x32_bf16 a[92:95], v[84:87], v[44:47], a[92:95]
    buffer_load_dwordx4 v17, s[8:11], s27 offen lds
    s_waitcnt lgkmcnt(8)
    v_mfma_f32_16x16x32_bf16 a[96:99], v[88:91], v[32:35], a[96:99]
    ds_read_b64_tr_b16 v[68:69], v29 offset:9376
    s_add_u32 m0, s44, 34816
    v_mfma_f32_16x16x32_bf16 a[100:103], v[88:91], v[36:39], a[100:103]
    ds_read_b64_tr_b16 v[70:71], v29 offset:11680
    buffer_load_dwordx4 v18, s[80:83], s28 offen lds
    v_mfma_f32_16x16x32_bf16 a[104:107], v[88:91], v[40:43], a[104:107]
    s_add_u32 m0, s45, 34816
    v_mfma_f32_16x16x32_bf16 a[108:111], v[88:91], v[44:47], a[108:111]
    buffer_load_dwordx4 v19, s[84:87], s28 offen lds
    s_waitcnt lgkmcnt(8)
    v_mfma_f32_16x16x32_bf16 a[112:115], v[92:95], v[32:35], a[112:115]
    ds_read_b64_tr_b16 v[72:73], v29 offset:192
    s_add_u32 s27, s27, 64
    s_add_u32 s28, s28, 294912
    v_mfma_f32_16x16x32_bf16 a[116:119], v[92:95], v[36:39], a[116:119]
    ds_read_b64_tr_b16 v[74:75], v29 offset:2496
    v_mfma_f32_16x16x32_bf16 a[120:123], v[92:95], v[40:43], a[120:123]
    v_mfma_f32_16x16x32_bf16 a[124:127], v[92:95], v[44:47], a[124:127]
    s_waitcnt lgkmcnt(4)
    v_mfma_f32_16x16x32_bf16 a[0:3], v[64:67], v[48:51], a[0:3]
    ds_read_b64_tr_b16 v[76:77], v29 offset:9408
    v_mfma_f32_16x16x32_bf16 a[4:7], v[64:67], v[52:55], a[4:7]
    ds_read_b64_tr_b16 v[78:79], v29 offset:11712
    v_mfma_f32_16x16x32_bf16 a[8:11], v[64:67], v[56:59], a[8:11]
    v_mfma_f32_16x16x32_bf16 a[12:15], v[64:67], v[60:63], a[12:15]
    s_waitcnt lgkmcnt(4)
    v_mfma_f32_16x16x32_bf16 a[16:19], v[68:71], v[48:51], a[16:19]
    ds_read_b64_tr_b16 v[80:81], v29 offset:224
    v_mfma_f32_16x16x32_bf16 a[20:23], v[68:71], v[52:55], a[20:23]
    ds_read_b64_tr_b16 v[82:83], v29 offset:2528
    v_mfma_f32_16x16x32_bf16 a[24:27], v[68:71], v[56:59], a[24:27]
    v_mfma_f32_16x16x32_bf16 a[28:31], v[68:71], v[60:63], a[28:31]
    s_waitcnt lgkmcnt(4)
    v_mfma_f32_16x16x32_bf16 a[32:35], v[72:75], v[48:51], a[32:35]
    ds_read_b64_tr_b16 v[84:85], v29 offset:9440
    v_mfma_f32_16x16x32_bf16 a[36:39], v[72:75], v[52:55], a[36:39]
    ds_read_b64_tr_b16 v[86:87], v29 offset:11744
    v_mfma_f32_16x16x32_bf16 a[40:43], v[72:75], v[56:59], a[40:43]
    v_mfma_f32_16x16x32_bf16 a[44:47], v[72:75], v[60:63], a[44:47]
    s_waitcnt lgkmcnt(4)
    v_mfma_f32_16x16x32_bf16 a[48:51], v[76:79], v[48:51], a[48:51]
    ds_read_b64_tr_b16 v[88:89], v29 offset:256
    v_mfma_f32_16x16x32_bf16 a[52:55], v[76:79], v[52:55], a[52:55]
    ds_read_b64_tr_b16 v[90:91], v29 offset:2560
    v_mfma_f32_16x16x32_bf16 a[56:59], v[76:79], v[56:59], a[56:59]
    v_mfma_f32_16x16x32_bf16 a[60:63], v[76:79], v[60:63], a[60:63]
    s_waitcnt lgkmcnt(4)
    v_mfma_f32_16x16x32_bf16 a[64:67], v[80:83], v[48:51], a[64:67]
    ds_read_b64_tr_b16 v[92:93], v29 offset:9472
    v_mfma_f32_16x16x32_bf16 a[68:71], v[80:83], v[52:55], a[68:71]
    ds_read_b64_tr_b16 v[94:95], v29 offset:11776
    v_mfma_f32_16x16x32_bf16 a[72:75], v[80:83], v[56:59], a[72:75]
    v_mfma_f32_16x16x32_bf16 a[76:79], v[80:83], v[60:63], a[76:79]
    s_waitcnt vmcnt(4)
    s_barrier
    s_waitcnt lgkmcnt(4)
    v_mfma_f32_16x16x32_bf16 a[80:83], v[84:87], v[48:51], a[80:83]
    ds_read_b128 v[32:35], v22 offset:0
    ds_read_b128 v[36:39], v22 offset:1024
    ds_read_b64_tr_b16 v[64:65], v26 offset:160
    s_add_u32 m0, s26, 69632
    v_mfma_f32_16x16x32_bf16 a[84:87], v[84:87], v[52:55], a[84:87]
    ds_read_b128 v[40:43], v22 offset:2048
    ds_read_b128 v[44:47], v22 offset:3072
    ds_read_b64_tr_b16 v[66:67], v26 offset:2464
    buffer_load_dwordx4 v16, s[8:11], s27 offen lds
    v_mfma_f32_16x16x32_bf16 a[88:91], v[84:87], v[56:59], a[88:91]
    s_add_u32 m0, s26, 77824
    v_mfma_f32_16x16x32_bf16 a[92:95], v[84:87], v[60:63], a[92:95]
    buffer_load_dwordx4 v17, s[8:11], s27 offen lds
    s_waitcnt lgkmcnt(8)
    v_mfma_f32_16x16x32_bf16 a[96:99], v[88:91], v[48:51], a[96:99]
    ds_read_b64_tr_b16 v[68:69], v26 offset:9376
    s_add_u32 m0, s44, 69632
    v_mfma_f32_16x16x32_bf16 a[100:103], v[88:91], v[52:55], a[100:103]
    ds_read_b64_tr_b16 v[70:71], v26 offset:11680
    buffer_load_dwordx4 v18, s[80:83], s28 offen lds
    v_mfma_f32_16x16x32_bf16 a[104:107], v[88:91], v[56:59], a[104:107]
    s_add_u32 m0, s45, 69632
    v_mfma_f32_16x16x32_bf16 a[108:111], v[88:91], v[60:63], a[108:111]
    buffer_load_dwordx4 v19, s[84:87], s28 offen lds
    s_waitcnt lgkmcnt(8)
    v_mfma_f32_16x16x32_bf16 a[112:115], v[92:95], v[48:51], a[112:115]
    ds_read_b64_tr_b16 v[72:73], v26 offset:192
    s_add_u32 s27, s27, 64
    s_add_u32 s28, s28, 294912
    v_mfma_f32_16x16x32_bf16 a[116:119], v[92:95], v[52:55], a[116:119]
    ds_read_b64_tr_b16 v[74:75], v26 offset:2496
    v_mfma_f32_16x16x32_bf16 a[120:123], v[92:95], v[56:59], a[120:123]
    v_mfma_f32_16x16x32_bf16 a[124:127], v[92:95], v[60:63], a[124:127]
    s_waitcnt lgkmcnt(4)
    v_mfma_f32_16x16x32_bf16 a[0:3], v[64:67], v[32:35], a[0:3]
    ds_read_b64_tr_b16 v[76:77], v26 offset:9408
    v_mfma_f32_16x16x32_bf16 a[4:7], v[64:67], v[36:39], a[4:7]
    ds_read_b64_tr_b16 v[78:79], v26 offset:11712
    v_mfma_f32_16x16x32_bf16 a[8:11], v[64:67], v[40:43], a[8:11]
    v_mfma_f32_16x16x32_bf16 a[12:15], v[64:67], v[44:47], a[12:15]
    s_waitcnt lgkmcnt(4)
    v_mfma_f32_16x16x32_bf16 a[16:19], v[68:71], v[32:35], a[16:19]
    ds_read_b64_tr_b16 v[80:81], v26 offset:224
    v_mfma_f32_16x16x32_bf16 a[20:23], v[68:71], v[36:39], a[20:23]
    ds_read_b64_tr_b16 v[82:83], v26 offset:2528
    v_mfma_f32_16x16x32_bf16 a[24:27], v[68:71], v[40:43], a[24:27]
    v_mfma_f32_16x16x32_bf16 a[28:31], v[68:71], v[44:47], a[28:31]
    s_waitcnt lgkmcnt(4)
    v_mfma_f32_16x16x32_bf16 a[32:35], v[72:75], v[32:35], a[32:35]
    ds_read_b64_tr_b16 v[84:85], v26 offset:9440
    v_mfma_f32_16x16x32_bf16 a[36:39], v[72:75], v[36:39], a[36:39]
    ds_read_b64_tr_b16 v[86:87], v26 offset:11744
    v_mfma_f32_16x16x32_bf16 a[40:43], v[72:75], v[40:43], a[40:43]
    v_mfma_f32_16x16x32_bf16 a[44:47], v[72:75], v[44:47], a[44:47]
    s_waitcnt lgkmcnt(4)
    v_mfma_f32_16x16x32_bf16 a[48:51], v[76:79], v[32:35], a[48:51]
    ds_read_b64_tr_b16 v[88:89], v26 offset:256
    v_mfma_f32_16x16x32_bf16 a[52:55], v[76:79], v[36:39], a[52:55]
    ds_read_b64_tr_b16 v[90:91], v26 offset:2560
    v_mfma_f32_16x16x32_bf16 a[56:59], v[76:79], v[40:43], a[56:59]
    v_mfma_f32_16x16x32_bf16 a[60:63], v[76:79], v[44:47], a[60:63]
    s_waitcnt lgkmcnt(4)
    v_mfma_f32_16x16x32_bf16 a[64:67], v[80:83], v[32:35], a[64:67]
    ds_read_b64_tr_b16 v[92:93], v26 offset:9472
    v_mfma_f32_16x16x32_bf16 a[68:71], v[80:83], v[36:39], a[68:71]
    ds_read_b64_tr_b16 v[94:95], v26 offset:11776
    v_mfma_f32_16x16x32_bf16 a[72:75], v[80:83], v[40:43], a[72:75]
    v_mfma_f32_16x16x32_bf16 a[76:79], v[80:83], v[44:47], a[76:79]
    s_waitcnt vmcnt(4)
    s_barrier
    s_waitcnt lgkmcnt(4)
    v_mfma_f32_16x16x32_bf16 a[80:83], v[84:87], v[32:35], a[80:83]
    ds_read_b128 v[48:51], v23 offset:0
    ds_read_b128 v[52:55], v23 offset:1024
    ds_read_b64_tr_b16 v[64:65], v27 offset:160
    s_add_u32 m0, s26, 104448
    v_mfma_f32_16x16x32_bf16 a[84:87], v[84:87], v[36:39], a[84:87]
    ds_read_b128 v[56:59], v23 offset:2048
    ds_read_b128 v[60:63], v23 offset:3072
    ds_read_b64_tr_b16 v[66:67], v27 offset:2464
    buffer_load_dwordx4 v16, s[8:11], s27 offen lds
    v_mfma_f32_16x16x32_bf16 a[88:91], v[84:87], v[40:43], a[88:91]
    s_add_u32 m0, s26, 112640
    v_mfma_f32_16x16x32_bf16 a[92:95], v[84:87], v[44:47], a[92:95]
    buffer_load_dwordx4 v17, s[8:11], s27 offen lds
    s_waitcnt lgkmcnt(8)
    v_mfma_f32_16x16x32_bf16 a[96:99], v[88:91], v[32:35], a[96:99]
    ds_read_b64_tr_b16 v[68:69], v27 offset:9376
    s_add_u32 m0, s44, 104448
    v_mfma_f32_16x16x32_bf16 a[100:103], v[88:91], v[36:39], a[100:103]
    ds_read_b64_tr_b16 v[70:71], v27 offset:11680
    buffer_load_dwordx4 v18, s[80:83], s28 offen lds
    v_mfma_f32_16x16x32_bf16 a[104:107], v[88:91], v[40:43], a[104:107]
    s_add_u32 m0, s45, 104448
    v_mfma_f32_16x16x32_bf16 a[108:111], v[88:91], v[44:47], a[108:111]
    buffer_load_dwordx4 v19, s[84:87], s28 offen lds
    s_waitcnt lgkmcnt(8)
    v_mfma_f32_16x16x32_bf16 a[112:115], v[92:95], v[32:35], a[112:115]
    ds_read_b64_tr_b16 v[72:73], v27 offset:192
    s_add_u32 s27, s27, 64
    s_add_u32 s28, s28, 294912
    v_mfma_f32_16x16x32_bf16 a[116:119], v[92:95], v[36:39], a[116:119]
    ds_read_b64_tr_b16 v[74:75], v27 offset:2496
    v_mfma_f32_16x16x32_bf16 a[120:123], v[92:95], v[40:43], a[120:123]
    v_mfma_f32_16x16x32_bf16 a[124:127], v[92:95], v[44:47], a[124:127]
    s_waitcnt lgkmcnt(4)
    v_mfma_f32_16x16x32_bf16 a[0:3], v[64:67], v[48:51], a[0:3]
    ds_read_b64_tr_b16 v[76:77], v27 offset:9408
    v_mfma_f32_16x16x32_bf16 a[4:7], v[64:67], v[52:55], a[4:7]
    ds_read_b64_tr_b16 v[78:79], v27 offset:11712
    v_mfma_f32_16x16x32_bf16 a[8:11], v[64:67], v[56:59], a[8:11]
    v_mfma_f32_16x16x32_bf16 a[12:15], v[64:67], v[60:63], a[12:15]
    s_waitcnt lgkmcnt(4)
    v_mfma_f32_16x16x32_bf16 a[16:19], v[68:71], v[48:51], a[16:19]
    ds_read_b64_tr_b16 v[80:81], v27 offset:224
    v_mfma_f32_16x16x32_bf16 a[20:23], v[68:71], v[52:55], a[20:23]
    ds_read_b64_tr_b16 v[82:83], v27 offset:2528
    v_mfma_f32_16x16x32_bf16 a[24:27], v[68:71], v[56:59], a[24:27]
    v_mfma_f32_16x16x32_bf16 a[28:31], v[68:71], v[60:63], a[28:31]
    s_waitcnt lgkmcnt(4)
    v_mfma_f32_16x16x32_bf16 a[32:35], v[72:75], v[48:51], a[32:35]
    ds_read_b64_tr_b16 v[84:85], v27 offset:9440
    v_mfma_f32_16x16x32_bf16 a[36:39], v[72:75], v[52:55], a[36:39]
    ds_read_b64_tr_b16 v[86:87], v27 offset:11744
    v_mfma_f32_16x16x32_bf16 a[40:43], v[72:75], v[56:59], a[40:43]
    v_mfma_f32_16x16x32_bf16 a[44:47], v[72:75], v[60:63], a[44:47]
    s_waitcnt lgkmcnt(4)
    v_mfma_f32_16x16x32_bf16 a[48:51], v[76:79], v[48:51], a[48:51]
    ds_read_b64_tr_b16 v[88:89], v27 offset:256
    v_mfma_f32_16x16x32_bf16 a[52:55], v[76:79], v[52:55], a[52:55]
    ds_read_b64_tr_b16 v[90:91], v27 offset:2560
    v_mfma_f32_16x16x32_bf16 a[56:59], v[76:79], v[56:59], a[56:59]
    v_mfma_f32_16x16x32_bf16 a[60:63], v[76:79], v[60:63], a[60:63]
    s_waitcnt lgkmcnt(4)
    v_mfma_f32_16x16x32_bf16 a[64:67], v[80:83], v[48:51], a[64:67]
    ds_read_b64_tr_b16 v[92:93], v27 offset:9472
    v_mfma_f32_16x16x32_bf16 a[68:71], v[80:83], v[52:55], a[68:71]
    ds_read_b64_tr_b16 v[94:95], v27 offset:11776
    v_mfma_f32_16x16x32_bf16 a[72:75], v[80:83], v[56:59], a[72:75]
    v_mfma_f32_16x16x32_bf16 a[76:79], v[80:83], v[60:63], a[76:79]
    s_waitcnt vmcnt(4)
    s_barrier
    s_waitcnt lgkmcnt(4)
    v_mfma_f32_16x16x32_bf16 a[80:83], v[84:87], v[48:51], a[80:83]
    ds_read_b128 v[32:35], v24 offset:0
    ds_read_b128 v[36:39], v24 offset:1024
    ds_read_b64_tr_b16 v[64:65], v28 offset:160
    s_add_u32 m0, s26, 0
    v_mfma_f32_16x16x32_bf16 a[84:87], v[84:87], v[52:55], a[84:87]
    ds_read_b128 v[40:43], v24 offset:2048
    ds_read_b128 v[44:47], v24 offset:3072
    ds_read_b64_tr_b16 v[66:67], v28 offset:2464
    buffer_load_dwordx4 v16, s[8:11], s27 offen lds
    v_mfma_f32_16x16x32_bf16 a[88:91], v[84:87], v[56:59], a[88:91]
    s_add_u32 m0, s26, 8192
    v_mfma_f32_16x16x32_bf16 a[92:95], v[84:87], v[60:63], a[92:95]
    buffer_load_dwordx4 v17, s[8:11], s27 offen lds
    s_waitcnt lgkmcnt(8)
    v_mfma_f32_16x16x32_bf16 a[96:99], v[88:91], v[48:51], a[96:99]
    ds_read_b64_tr_b16 v[68:69], v28 offset:9376
    s_add_u32 m0, s44, 0
    v_mfma_f32_16x16x32_bf16 a[100:103], v[88:91], v[52:55], a[100:103]
    ds_read_b64_tr_b16 v[70:71], v28 offset:11680
    buffer_load_dwordx4 v18, s[80:83], s28 offen lds
    v_mfma_f32_16x16x32_bf16 a[104:107], v[88:91], v[56:59], a[104:107]
    s_add_u32 m0, s45, 0
    v_mfma_f32_16x16x32_bf16 a[108:111], v[88:91], v[60:63], a[108:111]
    buffer_load_dwordx4 v19, s[84:87], s28 offen lds
    s_waitcnt lgkmcnt(8)
    v_mfma_f32_16x16x32_bf16 a[112:115], v[92:95], v[48:51], a[112:115]
    ds_read_b64_tr_b16 v[72:73], v28 offset:192
    s_add_u32 s27, s27, 64
    s_add_u32 s28, s28, 294912
    v_mfma_f32_16x16x32_bf16 a[116:119], v[92:95], v[52:55], a[116:119]
    ds_read_b64_tr_b16 v[74:75], v28 offset:2496
    v_mfma_f32_16x16x32_bf16 a[120:123], v[92:95], v[56:59], a[120:123]
    v_mfma_f32_16x16x32_bf16 a[124:127], v[92:95], v[60:63], a[124:127]
    s_waitcnt lgkmcnt(4)
    v_mfma_f32_16x16x32_bf16 a[0:3], v[64:67], v[32:35], a[0:3]
    ds_read_b64_tr_b16 v[76:77], v28 offset:9408
    v_mfma_f32_16x16x32_bf16 a[4:7], v[64:67], v[36:39], a[4:7]
    ds_read_b64_tr_b16 v[78:79], v28 offset:11712
    v_mfma_f32_16x16x32_bf16 a[8:11], v[64:67], v[40:43], a[8:11]
    v_mfma_f32_16x16x32_bf16 a[12:15], v[64:67], v[44:47], a[12:15]
    s_waitcnt lgkmcnt(4)
    v_mfma_f32_16x16x32_bf16 a[16:19], v[68:71], v[32:35], a[16:19]
    ds_read_b64_tr_b16 v[80:81], v28 offset:224
    v_mfma_f32_16x16x32_bf16 a[20:23], v[68:71], v[36:39], a[20:23]
    ds_read_b64_tr_b16 v[82:83], v28 offset:2528
    v_mfma_f32_16x16x32_bf16 a[24:27], v[68:71], v[40:43], a[24:27]
    v_mfma_f32_16x16x32_bf16 a[28:31], v[68:71], v[44:47], a[28:31]
    s_waitcnt lgkmcnt(4)
    v_mfma_f32_16x16x32_bf16 a[32:35], v[72:75], v[32:35], a[32:35]
    ds_read_b64_tr_b16 v[84:85], v28 offset:9440
    v_mfma_f32_16x16x32_bf16 a[36:39], v[72:75], v[36:39], a[36:39]
    ds_read_b64_tr_b16 v[86:87], v28 offset:11744
    v_mfma_f32_16x16x32_bf16 a[40:43], v[72:75], v[40:43], a[40:43]
    v_mfma_f32_16x16x32_bf16 a[44:47], v[72:75], v[44:47], a[44:47]
    s_waitcnt lgkmcnt(4)
    v_mfma_f32_16x16x32_bf16 a[48:51], v[76:79], v[32:35], a[48:51]
    ds_read_b64_tr_b16 v[88:89], v28 offset:256
    v_mfma_f32_16x16x32_bf16 a[52:55], v[76:79], v[36:39], a[52:55]
    ds_read_b64_tr_b16 v[90:91], v28 offset:2560
    v_mfma_f32_16x16x32_bf16 a[56:59], v[76:79], v[40:43], a[56:59]
    v_mfma_f32_16x16x32_bf16 a[60:63], v[76:79], v[44:47], a[60:63]
    s_waitcnt lgkmcnt(4)
    v_mfma_f32_16x16x32_bf16 a[64:67], v[80:83], v[32:35], a[64:67]
    ds_read_b64_tr_b16 v[92:93], v28 offset:9472
    v_mfma_f32_16x16x32_bf16 a[68:71], v[80:83], v[36:39], a[68:71]
    ds_read_b64_tr_b16 v[94:95], v28 offset:11776
    v_mfma_f32_16x16x32_bf16 a[72:75], v[80:83], v[40:43], a[72:75]
    v_mfma_f32_16x16x32_bf16 a[76:79], v[80:83], v[44:47], a[76:79]
    s_waitcnt vmcnt(4)
    s_barrier
    s_waitcnt lgkmcnt(4)
    v_mfma_f32_16x16x32_bf16 a[80:83], v[84:87], v[32:35], a[80:83]
    ds_read_b128 v[48:51], v25 offset:0
    ds_read_b128 v[52:55], v25 offset:1024
    ds_read_b64_tr_b16 v[64:65], v29 offset:160
    s_add_u32 m0, s26, 34816
    v_mfma_f32_16x16x32_bf16 a[84:87], v[84:87], v[36:39], a[84:87]
    ds_read_b128 v[56:59], v25 offset:2048
    ds_read_b128 v[60:63], v25 offset:3072
    ds_read_b64_tr_b16 v[66:67], v29 offset:2464
    buffer_load_dwordx4 v16, s[8:11], s27 offen lds
    v_mfma_f32_16x16x32_bf16 a[88:91], v[84:87], v[40:43], a[88:91]
    s_add_u32 m0, s26, 43008
    v_mfma_f32_16x16x32_bf16 a[92:95], v[84:87], v[44:47], a[92:95]
    buffer_load_dwordx4 v17, s[8:11], s27 offen lds
    s_waitcnt lgkmcnt(8)
    v_mfma_f32_16x16x32_bf16 a[96:99], v[88:91], v[32:35], a[96:99]
    ds_read_b64_tr_b16 v[68:69], v29 offset:9376
    s_add_u32 m0, s44, 34816
    v_mfma_f32_16x16x32_bf16 a[100:103], v[88:91], v[36:39], a[100:103]
    ds_read_b64_tr_b16 v[70:71], v29 offset:11680
    buffer_load_dwordx4 v18, s[80:83], s28 offen lds
    v_mfma_f32_16x16x32_bf16 a[104:107], v[88:91], v[40:43], a[104:107]
    s_add_u32 m0, s45, 34816
    v_mfma_f32_16x16x32_bf16 a[108:111], v[88:91], v[44:47], a[108:111]
    buffer_load_dwordx4 v19, s[84:87], s28 offen lds
    s_waitcnt lgkmcnt(8)
    v_mfma_f32_16x16x32_bf16 a[112:115], v[92:95], v[32:35], a[112:115]
    ds_read_b64_tr_b16 v[72:73], v29 offset:192
    s_add_u32 s27, s27, 64
    s_add_u32 s28, s28, 294912
    v_mfma_f32_16x16x32_bf16 a[116:119], v[92:95], v[36:39], a[116:119]
    ds_read_b64_tr_b16 v[74:75], v29 offset:2496
    v_mfma_f32_16x16x32_bf16 a[120:123], v[92:95], v[40:43], a[120:123]
    v_mfma_f32_16x16x32_bf16 a[124:127], v[92:95], v[44:47], a[124:127]
    s_waitcnt lgkmcnt(4)
    v_mfma_f32_16x16x32_bf16 a[0:3], v[64:67], v[48:51], a[0:3]
    ds_read_b64_tr_b16 v[76:77], v29 offset:9408
    v_mfma_f32_16x16x32_bf16 a[4:7], v[64:67], v[52:55], a[4:7]
    ds_read_b64_tr_b16 v[78:79], v29 offset:11712
    v_mfma_f32_16x16x32_bf16 a[8:11], v[64:67], v[56:59], a[8:11]
    v_mfma_f32_16x16x32_bf16 a[12:15], v[64:67], v[60:63], a[12:15]
    s_waitcnt lgkmcnt(4)
    v_mfma_f32_16x16x32_bf16 a[16:19], v[68:71], v[48:51], a[16:19]
    ds_read_b64_tr_b16 v[80:81], v29 offset:224
    v_mfma_f32_16x16x32_bf16 a[20:23], v[68:71], v[52:55], a[20:23]
    ds_read_b64_tr_b16 v[82:83], v29 offset:2528
    v_mfma_f32_16x16x32_bf16 a[24:27], v[68:71], v[56:59], a[24:27]
    v_mfma_f32_16x16x32_bf16 a[28:31], v[68:71], v[60:63], a[28:31]
    s_waitcnt lgkmcnt(4)
    v_mfma_f32_16x16x32_bf16 a[32:35], v[72:75], v[48:51], a[32:35]
    ds_read_b64_tr_b16 v[84:85], v29 offset:9440
    v_mfma_f32_16x16x32_bf16 a[36:39], v[72:75], v[52:55], a[36:39]
    ds_read_b64_tr_b16 v[86:87], v29 offset:11744
    v_mfma_f32_16x16x32_bf16 a[40:43], v[72:75], v[56:59], a[40:43]
    v_mfma_f32_16x16x32_bf16 a[44:47], v[72:75], v[60:63], a[44:47]
    s_waitcnt lgkmcnt(4)
    v_mfma_f32_16x16x32_bf16 a[48:51], v[76:79], v[48:51], a[48:51]
    ds_read_b64_tr_b16 v[88:89], v29 offset:256
    v_mfma_f32_16x16x32_bf16 a[52:55], v[76:79], v[52:55], a[52:55]
    ds_read_b64_tr_b16 v[90:91], v29 offset:2560
    v_mfma_f32_16x16x32_bf16 a[56:59], v[76:79], v[56:59], a[56:59]
    v_mfma_f32_16x16x32_bf16 a[60:63], v[76:79], v[60:63], a[60:63]
    s_waitcnt lgkmcnt(4)
    v_mfma_f32_16x16x32_bf16 a[64:67], v[80:83], v[48:51], a[64:67]
    ds_read_b64_tr_b16 v[92:93], v29 offset:9472
    v_mfma_f32_16x16x32_bf16 a[68:71], v[80:83], v[52:55], a[68:71]
    ds_read_b64_tr_b16 v[94:95], v29 offset:11776
    v_mfma_f32_16x16x32_bf16 a[72:75], v[80:83], v[56:59], a[72:75]
    v_mfma_f32_16x16x32_bf16 a[76:79], v[80:83], v[60:63], a[76:79]
    s_waitcnt vmcnt(4)
    s_barrier
    s_waitcnt lgkmcnt(4)
    v_mfma_f32_16x16x32_bf16 a[80:83], v[84:87], v[48:51], a[80:83]
    ds_read_b128 v[32:35], v22 offset:0
    ds_read_b128 v[36:39], v22 offset:1024
    ds_read_b64_tr_b16 v[64:65], v26 offset:160
    s_add_u32 m0, s26, 69632
    v_mfma_f32_16x16x32_bf16 a[84:87], v[84:87], v[52:55], a[84:87]
    ds_read_b128 v[40:43], v22 offset:2048
    ds_read_b128 v[44:47], v22 offset:3072
    ds_read_b64_tr_b16 v[66:67], v26 offset:2464
    buffer_load_dwordx4 v16, s[8:11], s27 offen lds
    v_mfma_f32_16x16x32_bf16 a[88:91], v[84:87], v[56:59], a[88:91]
    s_add_u32 m0, s26, 77824
    v_mfma_f32_16x16x32_bf16 a[92:95], v[84:87], v[60:63], a[92:95]
    buffer_load_dwordx4 v17, s[8:11], s27 offen lds
    s_waitcnt lgkmcnt(8)
    v_mfma_f32_16x16x32_bf16 a[96:99], v[88:91], v[48:51], a[96:99]
    ds_read_b64_tr_b16 v[68:69], v26 offset:9376
    s_add_u32 m0, s44, 69632
    v_mfma_f32_16x16x32_bf16 a[100:103], v[88:91], v[52:55], a[100:103]
    ds_read_b64_tr_b16 v[70:71], v26 offset:11680
    buffer_load_dwordx4 v18, s[80:83], s28 offen lds
    v_mfma_f32_16x16x32_bf16 a[104:107], v[88:91], v[56:59], a[104:107]
    s_add_u32 m0, s45, 69632
    v_mfma_f32_16x16x32_bf16 a[108:111], v[88:91], v[60:63], a[108:111]
    buffer_load_dwordx4 v19, s[84:87], s28 offen lds
    s_waitcnt lgkmcnt(8)
    v_mfma_f32_16x16x32_bf16 a[112:115], v[92:95], v[48:51], a[112:115]
    ds_read_b64_tr_b16 v[72:73], v26 offset:192
    s_add_u32 s27, s27, 64
    s_add_u32 s28, s28, 294912
    v_mfma_f32_16x16x32_bf16 a[116:119], v[92:95], v[52:55], a[116:119]
    ds_read_b64_tr_b16 v[74:75], v26 offset:2496
    v_mfma_f32_16x16x32_bf16 a[120:123], v[92:95], v[56:59], a[120:123]
    v_mfma_f32_16x16x32_bf16 a[124:127], v[92:95], v[60:63], a[124:127]
    s_waitcnt lgkmcnt(4)
    v_mfma_f32_16x16x32_bf16 a[0:3], v[64:67], v[32:35], a[0:3]
    ds_read_b64_tr_b16 v[76:77], v26 offset:9408
    v_mfma_f32_16x16x32_bf16 a[4:7], v[64:67], v[36:39], a[4:7]
    ds_read_b64_tr_b16 v[78:79], v26 offset:11712
    v_mfma_f32_16x16x32_bf16 a[8:11], v[64:67], v[40:43], a[8:11]
    v_mfma_f32_16x16x32_bf16 a[12:15], v[64:67], v[44:47], a[12:15]
    s_waitcnt lgkmcnt(4)
    v_mfma_f32_16x16x32_bf16 a[16:19], v[68:71], v[32:35], a[16:19]
    ds_read_b64_tr_b16 v[80:81], v26 offset:224
    v_mfma_f32_16x16x32_bf16 a[20:23], v[68:71], v[36:39], a[20:23]
    ds_read_b64_tr_b16 v[82:83], v26 offset:2528
    v_mfma_f32_16x16x32_bf16 a[24:27], v[68:71], v[40:43], a[24:27]
    v_mfma_f32_16x16x32_bf16 a[28:31], v[68:71], v[44:47], a[28:31]
    s_waitcnt lgkmcnt(4)
    v_mfma_f32_16x16x32_bf16 a[32:35], v[72:75], v[32:35], a[32:35]
    ds_read_b64_tr_b16 v[84:85], v26 offset:9440
    v_mfma_f32_16x16x32_bf16 a[36:39], v[72:75], v[36:39], a[36:39]
    ds_read_b64_tr_b16 v[86:87], v26 offset:11744
    v_mfma_f32_16x16x32_bf16 a[40:43], v[72:75], v[40:43], a[40:43]
    v_mfma_f32_16x16x32_bf16 a[44:47], v[72:75], v[44:47], a[44:47]
    s_waitcnt lgkmcnt(4)
    v_mfma_f32_16x16x32_bf16 a[48:51], v[76:79], v[32:35], a[48:51]
    ds_read_b64_tr_b16 v[88:89], v26 offset:256
    v_mfma_f32_16x16x32_bf16 a[52:55], v[76:79], v[36:39], a[52:55]
    ds_read_b64_tr_b16 v[90:91], v26 offset:2560
    v_mfma_f32_16x16x32_bf16 a[56:59], v[76:79], v[40:43], a[56:59]
    v_mfma_f32_16x16x32_bf16 a[60:63], v[76:79], v[44:47], a[60:63]
    s_waitcnt lgkmcnt(4)
    v_mfma_f32_16x16x32_bf16 a[64:67], v[80:83], v[32:35], a[64:67]
    ds_read_b64_tr_b16 v[92:93], v26 offset:9472
    v_mfma_f32_16x16x32_bf16 a[68:71], v[80:83], v[36:39], a[68:71]
    ds_read_b64_tr_b16 v[94:95], v26 offset:11776
    v_mfma_f32_16x16x32_bf16 a[72:75], v[80:83], v[40:43], a[72:75]
    v_mfma_f32_16x16x32_bf16 a[76:79], v[80:83], v[44:47], a[76:79]
    s_waitcnt vmcnt(4)
    s_barrier
    s_waitcnt lgkmcnt(4)
    v_mfma_f32_16x16x32_bf16 a[80:83], v[84:87], v[32:35], a[80:83]
    ds_read_b128 v[48:51], v23 offset:0
    ds_read_b128 v[52:55], v23 offset:1024
    ds_read_b64_tr_b16 v[64:65], v27 offset:160
    s_add_u32 m0, s26, 104448
    v_mfma_f32_16x16x32_bf16 a[84:87], v[84:87], v[36:39], a[84:87]
    ds_read_b128 v[56:59], v23 offset:2048
    ds_read_b128 v[60:63], v23 offset:3072
    ds_read_b64_tr_b16 v[66:67], v27 offset:2464
    buffer_load_dwordx4 v16, s[8:11], s27 offen lds
    v_mfma_f32_16x16x32_bf16 a[88:91], v[84:87], v[40:43], a[88:91]
    s_add_u32 m0, s26, 112640
    v_mfma_f32_16x16x32_bf16 a[92:95], v[84:87], v[44:47], a[92:95]
    buffer_load_dwordx4 v17, s[8:11], s27 offen lds
    s_waitcnt lgkmcnt(8)
    v_mfma_f32_16x16x32_bf16 a[96:99], v[88:91], v[32:35], a[96:99]
    ds_read_b64_tr_b16 v[68:69], v27 offset:9376
    s_add_u32 m0, s44, 104448
    v_mfma_f32_16x16x32_bf16 a[100:103], v[88:91], v[36:39], a[100:103]
    ds_read_b64_tr_b16 v[70:71], v27 offset:11680
    buffer_load_dwordx4 v18, s[80:83], s28 offen lds
    v_mfma_f32_16x16x32_bf16 a[104:107], v[88:91], v[40:43], a[104:107]
    s_add_u32 m0, s45, 104448
    v_mfma_f32_16x16x32_bf16 a[108:111], v[88:91], v[44:47], a[108:111]
    buffer_load_dwordx4 v19, s[84:87], s28 offen lds
    s_waitcnt lgkmcnt(8)
    v_mfma_f32_16x16x32_bf16 a[112:115], v[92:95], v[32:35], a[112:115]
    ds_read_b64_tr_b16 v[72:73], v27 offset:192
    s_add_u32 s27, s27, 64
    s_add_u32 s28, s28, 294912
    v_mfma_f32_16x16x32_bf16 a[116:119], v[92:95], v[36:39], a[116:119]
    ds_read_b64_tr_b16 v[74:75], v27 offset:2496
    v_mfma_f32_16x16x32_bf16 a[120:123], v[92:95], v[40:43], a[120:123]
    v_mfma_f32_16x16x32_bf16 a[124:127], v[92:95], v[44:47], a[124:127]
    s_waitcnt lgkmcnt(4)
    v_mfma_f32_16x16x32_bf16 a[0:3], v[64:67], v[48:51], a[0:3]
    ds_read_b64_tr_b16 v[76:77], v27 offset:9408
    v_mfma_f32_16x16x32_bf16 a[4:7], v[64:67], v[52:55], a[4:7]
    ds_read_b64_tr_b16 v[78:79], v27 offset:11712
    v_mfma_f32_16x16x32_bf16 a[8:11], v[64:67], v[56:59], a[8:11]
    v_mfma_f32_16x16x32_bf16 a[12:15], v[64:67], v[60:63], a[12:15]
    s_waitcnt lgkmcnt(4)
    v_mfma_f32_16x16x32_bf16 a[16:19], v[68:71], v[48:51], a[16:19]
    ds_read_b64_tr_b16 v[80:81], v27 offset:224
    v_mfma_f32_16x16x32_bf16 a[20:23], v[68:71], v[52:55], a[20:23]
    ds_read_b64_tr_b16 v[82:83], v27 offset:2528
    v_mfma_f32_16x16x32_bf16 a[24:27], v[68:71], v[56:59], a[24:27]
    v_mfma_f32_16x16x32_bf16 a[28:31], v[68:71], v[60:63], a[28:31]
    s_waitcnt lgkmcnt(4)
    v_mfma_f32_16x16x32_bf16 a[32:35], v[72:75], v[48:51], a[32:35]
    ds_read_b64_tr_b16 v[84:85], v27 offset:9440
    v_mfma_f32_16x16x32_bf16 a[36:39], v[72:75], v[52:55], a[36:39]
    ds_read_b64_tr_b16 v[86:87], v27 offset:11744
    v_mfma_f32_16x16x32_bf16 a[40:43], v[72:75], v[56:59], a[40:43]
    v_mfma_f32_16x16x32_bf16 a[44:47], v[72:75], v[60:63], a[44:47]
    s_waitcnt lgkmcnt(4)
    v_mfma_f32_16x16x32_bf16 a[48:51], v[76:79], v[48:51], a[48:51]
    ds_read_b64_tr_b16 v[88:89], v27 offset:256
    v_mfma_f32_16x16x32_bf16 a[52:55], v[76:79], v[52:55], a[52:55]
    ds_read_b64_tr_b16 v[90:91], v27 offset:2560
    v_mfma_f32_16x16x32_bf16 a[56:59], v[76:79], v[56:59], a[56:59]
    v_mfma_f32_16x16x32_bf16 a[60:63], v[76:79], v[60:63], a[60:63]
    s_waitcnt lgkmcnt(4)
    v_mfma_f32_16x16x32_bf16 a[64:67], v[80:83], v[48:51], a[64:67]
    ds_read_b64_tr_b16 v[92:93], v27 offset:9472
    v_mfma_f32_16x16x32_bf16 a[68:71], v[80:83], v[52:55], a[68:71]
    ds_read_b64_tr_b16 v[94:95], v27 offset:11776
    v_mfma_f32_16x16x32_bf16 a[72:75], v[80:83], v[56:59], a[72:75]
    v_mfma_f32_16x16x32_bf16 a[76:79], v[80:83], v[60:63], a[76:79]
    s_waitcnt vmcnt(4)
    s_barrier
    s_waitcnt lgkmcnt(4)
    v_mfma_f32_16x16x32_bf16 a[80:83], v[84:87], v[48:51], a[80:83]
    ds_read_b128 v[32:35], v24 offset:0
    ds_read_b128 v[36:39], v24 offset:1024
    ds_read_b64_tr_b16 v[64:65], v28 offset:160
    s_add_u32 m0, s26, 0
    v_mfma_f32_16x16x32_bf16 a[84:87], v[84:87], v[52:55], a[84:87]
    ds_read_b128 v[40:43], v24 offset:2048
    ds_read_b128 v[44:47], v24 offset:3072
    ds_read_b64_tr_b16 v[66:67], v28 offset:2464
    buffer_load_dwordx4 v16, s[8:11], s27 offen lds
    v_mfma_f32_16x16x32_bf16 a[88:91], v[84:87], v[56:59], a[88:91]
    s_add_u32 m0, s26, 8192
    v_mfma_f32_16x16x32_bf16 a[92:95], v[84:87], v[60:63], a[92:95]
    buffer_load_dwordx4 v17, s[8:11], s27 offen lds
    s_waitcnt lgkmcnt(8)
    v_mfma_f32_16x16x32_bf16 a[96:99], v[88:91], v[48:51], a[96:99]
    ds_read_b64_tr_b16 v[68:69], v28 offset:9376
    s_add_u32 m0, s44, 0
    v_mfma_f32_16x16x32_bf16 a[100:103], v[88:91], v[52:55], a[100:103]
    ds_read_b64_tr_b16 v[70:71], v28 offset:11680
    buffer_load_dwordx4 v18, s[80:83], s28 offen lds
    v_mfma_f32_16x16x32_bf16 a[104:107], v[88:91], v[56:59], a[104:107]
    s_add_u32 m0, s45, 0
    v_mfma_f32_16x16x32_bf16 a[108:111], v[88:91], v[60:63], a[108:111]
    buffer_load_dwordx4 v19, s[84:87], s28 offen lds
    s_waitcnt lgkmcnt(8)
    v_mfma_f32_16x16x32_bf16 a[112:115], v[92:95], v[48:51], a[112:115]
    ds_read_b64_tr_b16 v[72:73], v28 offset:192
    s_add_u32 s27, s27, 64
    s_add_u32 s28, s28, 294912
    v_mfma_f32_16x16x32_bf16 a[116:119], v[92:95], v[52:55], a[116:119]
    ds_read_b64_tr_b16 v[74:75], v28 offset:2496
    v_mfma_f32_16x16x32_bf16 a[120:123], v[92:95], v[56:59], a[120:123]
    v_mfma_f32_16x16x32_bf16 a[124:127], v[92:95], v[60:63], a[124:127]
    s_waitcnt lgkmcnt(4)
    v_mfma_f32_16x16x32_bf16 a[0:3], v[64:67], v[32:35], a[0:3]
    ds_read_b64_tr_b16 v[76:77], v28 offset:9408
    v_mfma_f32_16x16x32_bf16 a[4:7], v[64:67], v[36:39], a[4:7]
    ds_read_b64_tr_b16 v[78:79], v28 offset:11712
    v_mfma_f32_16x16x32_bf16 a[8:11], v[64:67], v[40:43], a[8:11]
    v_mfma_f32_16x16x32_bf16 a[12:15], v[64:67], v[44:47], a[12:15]
    s_waitcnt lgkmcnt(4)
    v_mfma_f32_16x16x32_bf16 a[16:19], v[68:71], v[32:35], a[16:19]
    ds_read_b64_tr_b16 v[80:81], v28 offset:224
    v_mfma_f32_16x16x32_bf16 a[20:23], v[68:71], v[36:39], a[20:23]
    ds_read_b64_tr_b16 v[82:83], v28 offset:2528
    v_mfma_f32_16x16x32_bf16 a[24:27], v[68:71], v[40:43], a[24:27]
    v_mfma_f32_16x16x32_bf16 a[28:31], v[68:71], v[44:47], a[28:31]
    s_waitcnt lgkmcnt(4)
    v_mfma_f32_16x16x32_bf16 a[32:35], v[72:75], v[32:35], a[32:35]
    ds_read_b64_tr_b16 v[84:85], v28 offset:9440
    v_mfma_f32_16x16x32_bf16 a[36:39], v[72:75], v[36:39], a[36:39]
    ds_read_b64_tr_b16 v[86:87], v28 offset:11744
    v_mfma_f32_16x16x32_bf16 a[40:43], v[72:75], v[40:43], a[40:43]
    v_mfma_f32_16x16x32_bf16 a[44:47], v[72:75], v[44:47], a[44:47]
    s_waitcnt lgkmcnt(4)
    v_mfma_f32_16x16x32_bf16 a[48:51], v[76:79], v[32:35], a[48:51]
    ds_read_b64_tr_b16 v[88:89], v28 offset:256
    v_mfma_f32_16x16x32_bf16 a[52:55], v[76:79], v[36:39], a[52:55]
    ds_read_b64_tr_b16 v[90:91], v28 offset:2560
    v_mfma_f32_16x16x32_bf16 a[56:59], v[76:79], v[40:43], a[56:59]
    v_mfma_f32_16x16x32_bf16 a[60:63], v[76:79], v[44:47], a[60:63]
    s_waitcnt lgkmcnt(4)
    v_mfma_f32_16x16x32_bf16 a[64:67], v[80:83], v[32:35], a[64:67]
    ds_read_b64_tr_b16 v[92:93], v28 offset:9472
    v_mfma_f32_16x16x32_bf16 a[68:71], v[80:83], v[36:39], a[68:71]
    ds_read_b64_tr_b16 v[94:95], v28 offset:11776
    v_mfma_f32_16x16x32_bf16 a[72:75], v[80:83], v[40:43], a[72:75]
    v_mfma_f32_16x16x32_bf16 a[76:79], v[80:83], v[44:47], a[76:79]
    s_waitcnt vmcnt(4)
    s_barrier
    s_waitcnt lgkmcnt(4)
    v_mfma_f32_16x16x32_bf16 a[80:83], v[84:87], v[32:35], a[80:83]
    ds_read_b128 v[48:51], v25 offset:0
    ds_read_b128 v[52:55], v25 offset:1024
    ds_read_b64_tr_b16 v[64:65], v29 offset:160
    s_add_u32 m0, s26, 34816
    v_mfma_f32_16x16x32_bf16 a[84:87], v[84:87], v[36:39], a[84:87]
    ds_read_b128 v[56:59], v25 offset:2048
    ds_read_b128 v[60:63], v25 offset:3072
    ds_read_b64_tr_b16 v[66:67], v29 offset:2464
    buffer_load_dwordx4 v16, s[8:11], s27 offen lds
    v_mfma_f32_16x16x32_bf16 a[88:91], v[84:87], v[40:43], a[88:91]
    s_add_u32 m0, s26, 43008
    v_mfma_f32_16x16x32_bf16 a[92:95], v[84:87], v[44:47], a[92:95]
    buffer_load_dwordx4 v17, s[8:11], s27 offen lds
    s_waitcnt lgkmcnt(8)
    v_mfma_f32_16x16x32_bf16 a[96:99], v[88:91], v[32:35], a[96:99]
    ds_read_b64_tr_b16 v[68:69], v29 offset:9376
    s_add_u32 m0, s44, 34816
    v_mfma_f32_16x16x32_bf16 a[100:103], v[88:91], v[36:39], a[100:103]
    ds_read_b64_tr_b16 v[70:71], v29 offset:11680
    buffer_load_dwordx4 v18, s[80:83], s28 offen lds
    v_mfma_f32_16x16x32_bf16 a[104:107], v[88:91], v[40:43], a[104:107]
    s_add_u32 m0, s45, 34816
    v_mfma_f32_16x16x32_bf16 a[108:111], v[88:91], v[44:47], a[108:111]
    buffer_load_dwordx4 v19, s[84:87], s28 offen lds
    s_waitcnt lgkmcnt(8)
    v_mfma_f32_16x16x32_bf16 a[112:115], v[92:95], v[32:35], a[112:115]
    ds_read_b64_tr_b16 v[72:73], v29 offset:192
    s_add_u32 s27, s27, 64
    s_add_u32 s28, s28, 294912
    v_mfma_f32_16x16x32_bf16 a[116:119], v[92:95], v[36:39], a[116:119]
    ds_read_b64_tr_b16 v[74:75], v29 offset:2496
    v_mfma_f32_16x16x32_bf16 a[120:123], v[92:95], v[40:43], a[120:123]
    v_mfma_f32_16x16x32_bf16 a[124:127], v[92:95], v[44:47], a[124:127]
    s_waitcnt lgkmcnt(4)
    v_mfma_f32_16x16x32_bf16 a[0:3], v[64:67], v[48:51], a[0:3]
    ds_read_b64_tr_b16 v[76:77], v29 offset:9408
    v_mfma_f32_16x16x32_bf16 a[4:7], v[64:67], v[52:55], a[4:7]
    ds_read_b64_tr_b16 v[78:79], v29 offset:11712
    v_mfma_f32_16x16x32_bf16 a[8:11], v[64:67], v[56:59], a[8:11]
    v_mfma_f32_16x16x32_bf16 a[12:15], v[64:67], v[60:63], a[12:15]
    s_waitcnt lgkmcnt(4)
    v_mfma_f32_16x16x32_bf16 a[16:19], v[68:71], v[48:51], a[16:19]
    ds_read_b64_tr_b16 v[80:81], v29 offset:224
    v_mfma_f32_16x16x32_bf16 a[20:23], v[68:71], v[52:55], a[20:23]
    ds_read_b64_tr_b16 v[82:83], v29 offset:2528
    v_mfma_f32_16x16x32_bf16 a[24:27], v[68:71], v[56:59], a[24:27]
    v_mfma_f32_16x16x32_bf16 a[28:31], v[68:71], v[60:63], a[28:31]
    s_waitcnt lgkmcnt(4)
    v_mfma_f32_16x16x32_bf16 a[32:35], v[72:75], v[48:51], a[32:35]
    ds_read_b64_tr_b16 v[84:85], v29 offset:9440
    v_mfma_f32_16x16x32_bf16 a[36:39], v[72:75], v[52:55], a[36:39]
    ds_read_b64_tr_b16 v[86:87], v29 offset:11744
    v_mfma_f32_16x16x32_bf16 a[40:43], v[72:75], v[56:59], a[40:43]
    v_mfma_f32_16x16x32_bf16 a[44:47], v[72:75], v[60:63], a[44:47]
    s_waitcnt lgkmcnt(4)
    v_mfma_f32_16x16x32_bf16 a[48:51], v[76:79], v[48:51], a[48:51]
    ds_read_b64_tr_b16 v[88:89], v29 offset:256
    v_mfma_f32_16x16x32_bf16 a[52:55], v[76:79], v[52:55], a[52:55]
    ds_read_b64_tr_b16 v[90:91], v29 offset:2560
    v_mfma_f32_16x16x32_bf16 a[56:59], v[76:79], v[56:59], a[56:59]
    v_mfma_f32_16x16x32_bf16 a[60:63], v[76:79], v[60:63], a[60:63]
    s_waitcnt lgkmcnt(4)
    v_mfma_f32_16x16x32_bf16 a[64:67], v[80:83], v[48:51], a[64:67]
    ds_read_b64_tr_b16 v[92:93], v29 offset:9472
    v_mfma_f32_16x16x32_bf16 a[68:71], v[80:83], v[52:55], a[68:71]
    ds_read_b64_tr_b16 v[94:95], v29 offset:11776
    v_mfma_f32_16x16x32_bf16 a[72:75], v[80:83], v[56:59], a[72:75]
    v_mfma_f32_16x16x32_bf16 a[76:79], v[80:83], v[60:63], a[76:79]
    s_waitcnt vmcnt(4)
    s_barrier
    s_waitcnt lgkmcnt(4)
    v_mfma_f32_16x16x32_bf16 a[80:83], v[84:87], v[48:51], a[80:83]
    ds_read_b128 v[32:35], v22 offset:0
    ds_read_b128 v[36:39], v22 offset:1024
    ds_read_b64_tr_b16 v[64:65], v26 offset:160
    s_add_u32 m0, s26, 69632
    v_mfma_f32_16x16x32_bf16 a[84:87], v[84:87], v[52:55], a[84:87]
    ds_read_b128 v[40:43], v22 offset:2048
    ds_read_b128 v[44:47], v22 offset:3072
    ds_read_b64_tr_b16 v[66:67], v26 offset:2464
    buffer_load_dwordx4 v16, s[8:11], s27 offen lds
    v_mfma_f32_16x16x32_bf16 a[88:91], v[84:87], v[56:59], a[88:91]
    s_add_u32 m0, s26, 77824
    v_mfma_f32_16x16x32_bf16 a[92:95], v[84:87], v[60:63], a[92:95]
    buffer_load_dwordx4 v17, s[8:11], s27 offen lds
    s_waitcnt lgkmcnt(8)
    v_mfma_f32_16x16x32_bf16 a[96:99], v[88:91], v[48:51], a[96:99]
    ds_read_b64_tr_b16 v[68:69], v26 offset:9376
    s_add_u32 m0, s44, 69632
    v_mfma_f32_16x16x32_bf16 a[100:103], v[88:91], v[52:55], a[100:103]
    ds_read_b64_tr_b16 v[70:71], v26 offset:11680
    buffer_load_dwordx4 v18, s[80:83], s28 offen lds
    v_mfma_f32_16x16x32_bf16 a[104:107], v[88:91], v[56:59], a[104:107]
    s_add_u32 m0, s45, 69632
    v_mfma_f32_16x16x32_bf16 a[108:111], v[88:91], v[60:63], a[108:111]
    buffer_load_dwordx4 v19, s[84:87], s28 offen lds
    s_waitcnt lgkmcnt(8)
    v_mfma_f32_16x16x32_bf16 a[112:115], v[92:95], v[48:51], a[112:115]
    ds_read_b64_tr_b16 v[72:73], v26 offset:192
    s_add_u32 s27, s27, 64
    s_add_u32 s28, s28, 294912
    v_mfma_f32_16x16x32_bf16 a[116:119], v[92:95], v[52:55], a[116:119]
    ds_read_b64_tr_b16 v[74:75], v26 offset:2496
    v_mfma_f32_16x16x32_bf16 a[120:123], v[92:95], v[56:59], a[120:123]
    v_mfma_f32_16x16x32_bf16 a[124:127], v[92:95], v[60:63], a[124:127]
    s_waitcnt lgkmcnt(4)
    v_mfma_f32_16x16x32_bf16 a[0:3], v[64:67], v[32:35], a[0:3]
    ds_read_b64_tr_b16 v[76:77], v26 offset:9408
    v_mfma_f32_16x16x32_bf16 a[4:7], v[64:67], v[36:39], a[4:7]
    ds_read_b64_tr_b16 v[78:79], v26 offset:11712
    v_mfma_f32_16x16x32_bf16 a[8:11], v[64:67], v[40:43], a[8:11]
    v_mfma_f32_16x16x32_bf16 a[12:15], v[64:67], v[44:47], a[12:15]
    s_waitcnt lgkmcnt(4)
    v_mfma_f32_16x16x32_bf16 a[16:19], v[68:71], v[32:35], a[16:19]
    ds_read_b64_tr_b16 v[80:81], v26 offset:224
    v_mfma_f32_16x16x32_bf16 a[20:23], v[68:71], v[36:39], a[20:23]
    ds_read_b64_tr_b16 v[82:83], v26 offset:2528
    v_mfma_f32_16x16x32_bf16 a[24:27], v[68:71], v[40:43], a[24:27]
    v_mfma_f32_16x16x32_bf16 a[28:31], v[68:71], v[44:47], a[28:31]
    s_waitcnt lgkmcnt(4)
    v_mfma_f32_16x16x32_bf16 a[32:35], v[72:75], v[32:35], a[32:35]
    ds_read_b64_tr_b16 v[84:85], v26 offset:9440
    v_mfma_f32_16x16x32_bf16 a[36:39], v[72:75], v[36:39], a[36:39]
    ds_read_b64_tr_b16 v[86:87], v26 offset:11744
    v_mfma_f32_16x16x32_bf16 a[40:43], v[72:75], v[40:43], a[40:43]
    v_mfma_f32_16x16x32_bf16 a[44:47], v[72:75], v[44:47], a[44:47]
    s_waitcnt lgkmcnt(4)
    v_mfma_f32_16x16x32_bf16 a[48:51], v[76:79], v[32:35], a[48:51]
    ds_read_b64_tr_b16 v[88:89], v26 offset:256
    v_mfma_f32_16x16x32_bf16 a[52:55], v[76:79], v[36:39], a[52:55]
    ds_read_b64_tr_b16 v[90:91], v26 offset:2560
    v_mfma_f32_16x16x32_bf16 a[56:59], v[76:79], v[40:43], a[56:59]
    v_mfma_f32_16x16x32_bf16 a[60:63], v[76:79], v[44:47], a[60:63]
    s_waitcnt lgkmcnt(4)
    v_mfma_f32_16x16x32_bf16 a[64:67], v[80:83], v[32:35], a[64:67]
    ds_read_b64_tr_b16 v[92:93], v26 offset:9472
    v_mfma_f32_16x16x32_bf16 a[68:71], v[80:83], v[36:39], a[68:71]
    ds_read_b64_tr_b16 v[94:95], v26 offset:11776
    v_mfma_f32_16x16x32_bf16 a[72:75], v[80:83], v[40:43], a[72:75]
    v_mfma_f32_16x16x32_bf16 a[76:79], v[80:83], v[44:47], a[76:79]
    s_waitcnt vmcnt(4)
    s_barrier
    s_waitcnt lgkmcnt(4)
    v_mfma_f32_16x16x32_bf16 a[80:83], v[84:87], v[32:35], a[80:83]
    ds_read_b128 v[48:51], v23 offset:0
    ds_read_b128 v[52:55], v23 offset:1024
    ds_read_b64_tr_b16 v[64:65], v27 offset:160
    s_add_u32 m0, s26, 104448
    v_mfma_f32_16x16x32_bf16 a[84:87], v[84:87], v[36:39], a[84:87]
    ds_read_b128 v[56:59], v23 offset:2048
    ds_read_b128 v[60:63], v23 offset:3072
    ds_read_b64_tr_b16 v[66:67], v27 offset:2464
    buffer_load_dwordx4 v16, s[8:11], s27 offen lds
    v_mfma_f32_16x16x32_bf16 a[88:91], v[84:87], v[40:43], a[88:91]
    s_add_u32 m0, s26, 112640
    v_mfma_f32_16x16x32_bf16 a[92:95], v[84:87], v[44:47], a[92:95]
    buffer_load_dwordx4 v17, s[8:11], s27 offen lds
    s_waitcnt lgkmcnt(8)
    v_mfma_f32_16x16x32_bf16 a[96:99], v[88:91], v[32:35], a[96:99]
    ds_read_b64_tr_b16 v[68:69], v27 offset:9376
    s_add_u32 m0, s44, 104448
    v_mfma_f32_16x16x32_bf16 a[100:103], v[88:91], v[36:39], a[100:103]
    ds_read_b64_tr_b16 v[70:71], v27 offset:11680
    buffer_load_dwordx4 v18, s[80:83], s28 offen lds
    v_mfma_f32_16x16x32_bf16 a[104:107], v[88:91], v[40:43], a[104:107]
    s_add_u32 m0, s45, 104448
    v_mfma_f32_16x16x32_bf16 a[108:111], v[88:91], v[44:47], a[108:111]
    buffer_load_dwordx4 v19, s[84:87], s28 offen lds
    s_waitcnt lgkmcnt(8)
    v_mfma_f32_16x16x32_bf16 a[112:115], v[92:95], v[32:35], a[112:115]
    ds_read_b64_tr_b16 v[72:73], v27 offset:192
    s_add_u32 s27, s27, 64
    s_add_u32 s28, s28, 294912
    v_mfma_f32_16x16x32_bf16 a[116:119], v[92:95], v[36:39], a[116:119]
    ds_read_b64_tr_b16 v[74:75], v27 offset:2496
    v_mfma_f32_16x16x32_bf16 a[120:123], v[92:95], v[40:43], a[120:123]
    v_mfma_f32_16x16x32_bf16 a[124:127], v[92:95], v[44:47], a[124:127]
    s_waitcnt lgkmcnt(4)
    v_mfma_f32_16x16x32_bf16 a[0:3], v[64:67], v[48:51], a[0:3]
    ds_read_b64_tr_b16 v[76:77], v27 offset:9408
    v_mfma_f32_16x16x32_bf16 a[4:7], v[64:67], v[52:55], a[4:7]
    ds_read_b64_tr_b16 v[78:79], v27 offset:11712
    v_mfma_f32_16x16x32_bf16 a[8:11], v[64:67], v[56:59], a[8:11]
    v_mfma_f32_16x16x32_bf16 a[12:15], v[64:67], v[60:63], a[12:15]
    s_waitcnt lgkmcnt(4)
    v_mfma_f32_16x16x32_bf16 a[16:19], v[68:71], v[48:51], a[16:19]
    ds_read_b64_tr_b16 v[80:81], v27 offset:224
    v_mfma_f32_16x16x32_bf16 a[20:23], v[68:71], v[52:55], a[20:23]
    ds_read_b64_tr_b16 v[82:83], v27 offset:2528
    v_mfma_f32_16x16x32_bf16 a[24:27], v[68:71], v[56:59], a[24:27]
    v_mfma_f32_16x16x32_bf16 a[28:31], v[68:71], v[60:63], a[28:31]
    s_waitcnt lgkmcnt(4)
    v_mfma_f32_16x16x32_bf16 a[32:35], v[72:75], v[48:51], a[32:35]
    ds_read_b64_tr_b16 v[84:85], v27 offset:9440
    v_mfma_f32_16x16x32_bf16 a[36:39], v[72:75], v[52:55], a[36:39]
    ds_read_b64_tr_b16 v[86:87], v27 offset:11744
    v_mfma_f32_16x16x32_bf16 a[40:43], v[72:75], v[56:59], a[40:43]
    v_mfma_f32_16x16x32_bf16 a[44:47], v[72:75], v[60:63], a[44:47]
    s_waitcnt lgkmcnt(4)
    v_mfma_f32_16x16x32_bf16 a[48:51], v[76:79], v[48:51], a[48:51]
    ds_read_b64_tr_b16 v[88:89], v27 offset:256
    v_mfma_f32_16x16x32_bf16 a[52:55], v[76:79], v[52:55], a[52:55]
    ds_read_b64_tr_b16 v[90:91], v27 offset:2560
    v_mfma_f32_16x16x32_bf16 a[56:59], v[76:79], v[56:59], a[56:59]
    v_mfma_f32_16x16x32_bf16 a[60:63], v[76:79], v[60:63], a[60:63]
    s_waitcnt lgkmcnt(4)
    v_mfma_f32_16x16x32_bf16 a[64:67], v[80:83], v[48:51], a[64:67]
    ds_read_b64_tr_b16 v[92:93], v27 offset:9472
    v_mfma_f32_16x16x32_bf16 a[68:71], v[80:83], v[52:55], a[68:71]
    ds_read_b64_tr_b16 v[94:95], v27 offset:11776
    v_mfma_f32_16x16x32_bf16 a[72:75], v[80:83], v[56:59], a[72:75]
    v_mfma_f32_16x16x32_bf16 a[76:79], v[80:83], v[60:63], a[76:79]
    s_waitcnt vmcnt(4)
    s_barrier
    s_waitcnt lgkmcnt(4)
    v_mfma_f32_16x16x32_bf16 a[80:83], v[84:87], v[48:51], a[80:83]
    ds_read_b128 v[32:35], v24 offset:0
    ds_read_b128 v[36:39], v24 offset:1024
    ds_read_b64_tr_b16 v[64:65], v28 offset:160
    s_add_u32 m0, s26, 0
    v_mfma_f32_16x16x32_bf16 a[84:87], v[84:87], v[52:55], a[84:87]
    ds_read_b128 v[40:43], v24 offset:2048
    ds_read_b128 v[44:47], v24 offset:3072
    ds_read_b64_tr_b16 v[66:67], v28 offset:2464
    buffer_load_dwordx4 v16, s[8:11], s27 offen lds
    v_mfma_f32_16x16x32_bf16 a[88:91], v[84:87], v[56:59], a[88:91]
    s_add_u32 m0, s26, 8192
    v_mfma_f32_16x16x32_bf16 a[92:95], v[84:87], v[60:63], a[92:95]
    buffer_load_dwordx4 v17, s[8:11], s27 offen lds
    s_waitcnt lgkmcnt(8)
    v_mfma_f32_16x16x32_bf16 a[96:99], v[88:91], v[48:51], a[96:99]
    ds_read_b64_tr_b16 v[68:69], v28 offset:9376
    s_add_u32 m0, s44, 0
    v_mfma_f32_16x16x32_bf16 a[100:103], v[88:91], v[52:55], a[100:103]
    ds_read_b64_tr_b16 v[70:71], v28 offset:11680
    buffer_load_dwordx4 v18, s[80:83], s28 offen lds
    v_mfma_f32_16x16x32_bf16 a[104:107], v[88:91], v[56:59], a[104:107]
    s_add_u32 m0, s45, 0
    v_mfma_f32_16x16x32_bf16 a[108:111], v[88:91], v[60:63], a[108:111]
    buffer_load_dwordx4 v19, s[84:87], s28 offen lds
    s_waitcnt lgkmcnt(8)
    v_mfma_f32_16x16x32_bf16 a[112:115], v[92:95], v[48:51], a[112:115]
    ds_read_b64_tr_b16 v[72:73], v28 offset:192
    s_add_u32 s27, s27, 64
    s_add_u32 s28, s28, 294912
    v_mfma_f32_16x16x32_bf16 a[116:119], v[92:95], v[52:55], a[116:119]
    ds_read_b64_tr_b16 v[74:75], v28 offset:2496
    v_mfma_f32_16x16x32_bf16 a[120:123], v[92:95], v[56:59], a[120:123]
    v_mfma_f32_16x16x32_bf16 a[124:127], v[92:95], v[60:63], a[124:127]
    s_waitcnt lgkmcnt(4)
    v_mfma_f32_16x16x32_bf16 a[0:3], v[64:67], v[32:35], a[0:3]
    ds_read_b64_tr_b16 v[76:77], v28 offset:9408
    v_mfma_f32_16x16x32_bf16 a[4:7], v[64:67], v[36:39], a[4:7]
    ds_read_b64_tr_b16 v[78:79], v28 offset:11712
    v_mfma_f32_16x16x32_bf16 a[8:11], v[64:67], v[40:43], a[8:11]
    v_mfma_f32_16x16x32_bf16 a[12:15], v[64:67], v[44:47], a[12:15]
    s_waitcnt lgkmcnt(4)
    v_mfma_f32_16x16x32_bf16 a[16:19], v[68:71], v[32:35], a[16:19]
    ds_read_b64_tr_b16 v[80:81], v28 offset:224
    v_mfma_f32_16x16x32_bf16 a[20:23], v[68:71], v[36:39], a[20:23]
    ds_read_b64_tr_b16 v[82:83], v28 offset:2528
    v_mfma_f32_16x16x32_bf16 a[24:27], v[68:71], v[40:43], a[24:27]
    v_mfma_f32_16x16x32_bf16 a[28:31], v[68:71], v[44:47], a[28:31]
    s_waitcnt lgkmcnt(4)
    v_mfma_f32_16x16x32_bf16 a[32:35], v[72:75], v[32:35], a[32:35]
    ds_read_b64_tr_b16 v[84:85], v28 offset:9440
    v_mfma_f32_16x16x32_bf16 a[36:39], v[72:75], v[36:39], a[36:39]
    ds_read_b64_tr_b16 v[86:87], v28 offset:11744
    v_mfma_f32_16x16x32_bf16 a[40:43], v[72:75], v[40:43], a[40:43]
    v_mfma_f32_16x16x32_bf16 a[44:47], v[72:75], v[44:47], a[44:47]
    s_waitcnt lgkmcnt(4)
    v_mfma_f32_16x16x32_bf16 a[48:51], v[76:79], v[32:35], a[48:51]
    ds_read_b64_tr_b16 v[88:89], v28 offset:256
    v_mfma_f32_16x16x32_bf16 a[52:55], v[76:79], v[36:39], a[52:55]
    ds_read_b64_tr_b16 v[90:91], v28 offset:2560
    v_mfma_f32_16x16x32_bf16 a[56:59], v[76:79], v[40:43], a[56:59]
    v_mfma_f32_16x16x32_bf16 a[60:63], v[76:79], v[44:47], a[60:63]
    s_waitcnt lgkmcnt(4)
    v_mfma_f32_16x16x32_bf16 a[64:67], v[80:83], v[32:35], a[64:67]
    ds_read_b64_tr_b16 v[92:93], v28 offset:9472
    v_mfma_f32_16x16x32_bf16 a[68:71], v[80:83], v[36:39], a[68:71]
    ds_read_b64_tr_b16 v[94:95], v28 offset:11776
    v_mfma_f32_16x16x32_bf16 a[72:75], v[80:83], v[40:43], a[72:75]
    v_mfma_f32_16x16x32_bf16 a[76:79], v[80:83], v[44:47], a[76:79]
    s_waitcnt vmcnt(4)
    s_barrier
    s_waitcnt lgkmcnt(4)
    v_mfma_f32_16x16x32_bf16 a[80:83], v[84:87], v[32:35], a[80:83]
    ds_read_b128 v[48:51], v25 offset:0
    ds_read_b128 v[52:55], v25 offset:1024
    ds_read_b64_tr_b16 v[64:65], v29 offset:160
    s_add_u32 m0, s26, 34816
    v_mfma_f32_16x16x32_bf16 a[84:87], v[84:87], v[36:39], a[84:87]
    ds_read_b128 v[56:59], v25 offset:2048
    ds_read_b128 v[60:63], v25 offset:3072
    ds_read_b64_tr_b16 v[66:67], v29 offset:2464
    buffer_load_dwordx4 v16, s[8:11], s27 offen lds
    v_mfma_f32_16x16x32_bf16 a[88:91], v[84:87], v[40:43], a[88:91]
    s_add_u32 m0, s26, 43008
    v_mfma_f32_16x16x32_bf16 a[92:95], v[84:87], v[44:47], a[92:95]
    buffer_load_dwordx4 v17, s[8:11], s27 offen lds
    s_waitcnt lgkmcnt(8)
    v_mfma_f32_16x16x32_bf16 a[96:99], v[88:91], v[32:35], a[96:99]
    ds_read_b64_tr_b16 v[68:69], v29 offset:9376
    s_add_u32 m0, s44, 34816
    v_mfma_f32_16x16x32_bf16 a[100:103], v[88:91], v[36:39], a[100:103]
    ds_read_b64_tr_b16 v[70:71], v29 offset:11680
    buffer_load_dwordx4 v18, s[80:83], s28 offen lds
    v_mfma_f32_16x16x32_bf16 a[104:107], v[88:91], v[40:43], a[104:107]
    s_add_u32 m0, s45, 34816
    v_mfma_f32_16x16x32_bf16 a[108:111], v[88:91], v[44:47], a[108:111]
    buffer_load_dwordx4 v19, s[84:87], s28 offen lds
    s_waitcnt lgkmcnt(8)
    v_mfma_f32_16x16x32_bf16 a[112:115], v[92:95], v[32:35], a[112:115]
    ds_read_b64_tr_b16 v[72:73], v29 offset:192
    s_add_u32 s27, s27, 64
    s_add_u32 s28, s28, 294912
    v_mfma_f32_16x16x32_bf16 a[116:119], v[92:95], v[36:39], a[116:119]
    ds_read_b64_tr_b16 v[74:75], v29 offset:2496
    v_mfma_f32_16x16x32_bf16 a[120:123], v[92:95], v[40:43], a[120:123]
    v_mfma_f32_16x16x32_bf16 a[124:127], v[92:95], v[44:47], a[124:127]
    s_waitcnt lgkmcnt(4)
    v_mfma_f32_16x16x32_bf16 a[0:3], v[64:67], v[48:51], a[0:3]
    ds_read_b64_tr_b16 v[76:77], v29 offset:9408
    v_mfma_f32_16x16x32_bf16 a[4:7], v[64:67], v[52:55], a[4:7]
    ds_read_b64_tr_b16 v[78:79], v29 offset:11712
    v_mfma_f32_16x16x32_bf16 a[8:11], v[64:67], v[56:59], a[8:11]
    v_mfma_f32_16x16x32_bf16 a[12:15], v[64:67], v[60:63], a[12:15]
    s_waitcnt lgkmcnt(4)
    v_mfma_f32_16x16x32_bf16 a[16:19], v[68:71], v[48:51], a[16:19]
    ds_read_b64_tr_b16 v[80:81], v29 offset:224
    v_mfma_f32_16x16x32_bf16 a[20:23], v[68:71], v[52:55], a[20:23]
    ds_read_b64_tr_b16 v[82:83], v29 offset:2528
    v_mfma_f32_16x16x32_bf16 a[24:27], v[68:71], v[56:59], a[24:27]
    v_mfma_f32_16x16x32_bf16 a[28:31], v[68:71], v[60:63], a[28:31]
    s_waitcnt lgkmcnt(4)
    v_mfma_f32_16x16x32_bf16 a[32:35], v[72:75], v[48:51], a[32:35]
    ds_read_b64_tr_b16 v[84:85], v29 offset:9440
    v_mfma_f32_16x16x32_bf16 a[36:39], v[72:75], v[52:55], a[36:39]
    ds_read_b64_tr_b16 v[86:87], v29 offset:11744
    v_mfma_f32_16x16x32_bf16 a[40:43], v[72:75], v[56:59], a[40:43]
    v_mfma_f32_16x16x32_bf16 a[44:47], v[72:75], v[60:63], a[44:47]
    s_waitcnt lgkmcnt(4)
    v_mfma_f32_16x16x32_bf16 a[48:51], v[76:79], v[48:51], a[48:51]
    ds_read_b64_tr_b16 v[88:89], v29 offset:256
    v_mfma_f32_16x16x32_bf16 a[52:55], v[76:79], v[52:55], a[52:55]
    ds_read_b64_tr_b16 v[90:91], v29 offset:2560
    v_mfma_f32_16x16x32_bf16 a[56:59], v[76:79], v[56:59], a[56:59]
    v_mfma_f32_16x16x32_bf16 a[60:63], v[76:79], v[60:63], a[60:63]
    s_waitcnt lgkmcnt(4)
    v_mfma_f32_16x16x32_bf16 a[64:67], v[80:83], v[48:51], a[64:67]
    ds_read_b64_tr_b16 v[92:93], v29 offset:9472
    v_mfma_f32_16x16x32_bf16 a[68:71], v[80:83], v[52:55], a[68:71]
    ds_read_b64_tr_b16 v[94:95], v29 offset:11776
    v_mfma_f32_16x16x32_bf16 a[72:75], v[80:83], v[56:59], a[72:75]
    v_mfma_f32_16x16x32_bf16 a[76:79], v[80:83], v[60:63], a[76:79]
    s_waitcnt vmcnt(4)
    s_barrier
    s_waitcnt lgkmcnt(4)
    v_mfma_f32_16x16x32_bf16 a[80:83], v[84:87], v[48:51], a[80:83]
    ds_read_b128 v[32:35], v22 offset:0
    ds_read_b128 v[36:39], v22 offset:1024
    ds_read_b64_tr_b16 v[64:65], v26 offset:160
    v_mfma_f32_16x16x32_bf16 a[84:87], v[84:87], v[52:55], a[84:87]
    ds_read_b128 v[40:43], v22 offset:2048
    ds_read_b128 v[44:47], v22 offset:3072
    ds_read_b64_tr_b16 v[66:67], v26 offset:2464
    v_mfma_f32_16x16x32_bf16 a[88:91], v[84:87], v[56:59], a[88:91]
    v_mfma_f32_16x16x32_bf16 a[92:95], v[84:87], v[60:63], a[92:95]
    s_waitcnt lgkmcnt(8)
    v_mfma_f32_16x16x32_bf16 a[96:99], v[88:91], v[48:51], a[96:99]
    ds_read_b64_tr_b16 v[68:69], v26 offset:9376
    v_mfma_f32_16x16x32_bf16 a[100:103], v[88:91], v[52:55], a[100:103]
    ds_read_b64_tr_b16 v[70:71], v26 offset:11680
    v_mfma_f32_16x16x32_bf16 a[104:107], v[88:91], v[56:59], a[104:107]
    v_mfma_f32_16x16x32_bf16 a[108:111], v[88:91], v[60:63], a[108:111]
    s_waitcnt lgkmcnt(8)
    v_mfma_f32_16x16x32_bf16 a[112:115], v[92:95], v[48:51], a[112:115]
    ds_read_b64_tr_b16 v[72:73], v26 offset:192
    v_mfma_f32_16x16x32_bf16 a[116:119], v[92:95], v[52:55], a[116:119]
    ds_read_b64_tr_b16 v[74:75], v26 offset:2496
    v_mfma_f32_16x16x32_bf16 a[120:123], v[92:95], v[56:59], a[120:123]
    v_mfma_f32_16x16x32_bf16 a[124:127], v[92:95], v[60:63], a[124:127]
    s_waitcnt lgkmcnt(4)
    v_mfma_f32_16x16x32_bf16 a[0:3], v[64:67], v[32:35], a[0:3]
    ds_read_b64_tr_b16 v[76:77], v26 offset:9408
    v_mfma_f32_16x16x32_bf16 a[4:7], v[64:67], v[36:39], a[4:7]
    ds_read_b64_tr_b16 v[78:79], v26 offset:11712
    v_mfma_f32_16x16x32_bf16 a[8:11], v[64:67], v[40:43], a[8:11]
    v_mfma_f32_16x16x32_bf16 a[12:15], v[64:67], v[44:47], a[12:15]
    s_waitcnt lgkmcnt(4)
    v_mfma_f32_16x16x32_bf16 a[16:19], v[68:71], v[32:35], a[16:19]
    ds_read_b64_tr_b16 v[80:81], v26 offset:224
    v_mfma_f32_16x16x32_bf16 a[20:23], v[68:71], v[36:39], a[20:23]
    ds_read_b64_tr_b16 v[82:83], v26 offset:2528
    v_mfma_f32_16x16x32_bf16 a[24:27], v[68:71], v[40:43], a[24:27]
    v_mfma_f32_16x16x32_bf16 a[28:31], v[68:71], v[44:47], a[28:31]
    s_waitcnt lgkmcnt(4)
    v_mfma_f32_16x16x32_bf16 a[32:35], v[72:75], v[32:35], a[32:35]
    ds_read_b64_tr_b16 v[84:85], v26 offset:9440
    v_mfma_f32_16x16x32_bf16 a[36:39], v[72:75], v[36:39], a[36:39]
    ds_read_b64_tr_b16 v[86:87], v26 offset:11744
    v_mfma_f32_16x16x32_bf16 a[40:43], v[72:75], v[40:43], a[40:43]
    v_mfma_f32_16x16x32_bf16 a[44:47], v[72:75], v[44:47], a[44:47]
    s_waitcnt lgkmcnt(4)
    v_mfma_f32_16x16x32_bf16 a[48:51], v[76:79], v[32:35], a[48:51]
    ds_read_b64_tr_b16 v[88:89], v26 offset:256
    v_mfma_f32_16x16x32_bf16 a[52:55], v[76:79], v[36:39], a[52:55]
    ds_read_b64_tr_b16 v[90:91], v26 offset:2560
    v_mfma_f32_16x16x32_bf16 a[56:59], v[76:79], v[40:43], a[56:59]
    v_mfma_f32_16x16x32_bf16 a[60:63], v[76:79], v[44:47], a[60:63]
    s_waitcnt lgkmcnt(4)
    v_mfma_f32_16x16x32_bf16 a[64:67], v[80:83], v[32:35], a[64:67]
    ds_read_b64_tr_b16 v[92:93], v26 offset:9472
    v_mfma_f32_16x16x32_bf16 a[68:71], v[80:83], v[36:39], a[68:71]
    ds_read_b64_tr_b16 v[94:95], v26 offset:11776
    v_mfma_f32_16x16x32_bf16 a[72:75], v[80:83], v[40:43], a[72:75]
    v_mfma_f32_16x16x32_bf16 a[76:79], v[80:83], v[44:47], a[76:79]
    s_waitcnt vmcnt(0)
    s_barrier
    s_waitcnt lgkmcnt(4)
    v_mfma_f32_16x16x32_bf16 a[80:83], v[84:87], v[32:35], a[80:83]
    ds_read_b128 v[48:51], v23 offset:0
    ds_read_b128 v[52:55], v23 offset:1024
    ds_read_b64_tr_b16 v[64:65], v27 offset:160
    v_mfma_f32_16x16x32_bf16 a[84:87], v[84:87], v[36:39], a[84:87]
    ds_read_b128 v[56:59], v23 offset:2048
    ds_read_b128 v[60:63], v23 offset:3072
    ds_read_b64_tr_b16 v[66:67], v27 offset:2464
    v_mfma_f32_16x16x32_bf16 a[88:91], v[84:87], v[40:43], a[88:91]
    v_mfma_f32_16x16x32_bf16 a[92:95], v[84:87], v[44:47], a[92:95]
    s_waitcnt lgkmcnt(8)
    v_mfma_f32_16x16x32_bf16 a[96:99], v[88:91], v[32:35], a[96:99]
    ds_read_b64_tr_b16 v[68:69], v27 offset:9376
    v_mfma_f32_16x16x32_bf16 a[100:103], v[88:91], v[36:39], a[100:103]
    ds_read_b64_tr_b16 v[70:71], v27 offset:11680
    v_mfma_f32_16x16x32_bf16 a[104:107], v[88:91], v[40:43], a[104:107]
    v_mfma_f32_16x16x32_bf16 a[108:111], v[88:91], v[44:47], a[108:111]
    s_waitcnt lgkmcnt(8)
    v_mfma_f32_16x16x32_bf16 a[112:115], v[92:95], v[32:35], a[112:115]
    ds_read_b64_tr_b16 v[72:73], v27 offset:192
    v_mfma_f32_16x16x32_bf16 a[116:119], v[92:95], v[36:39], a[116:119]
    ds_read_b64_tr_b16 v[74:75], v27 offset:2496
    v_mfma_f32_16x16x32_bf16 a[120:123], v[92:95], v[40:43], a[120:123]
    v_mfma_f32_16x16x32_bf16 a[124:127], v[92:95], v[44:47], a[124:127]
    s_waitcnt lgkmcnt(4)
    v_mfma_f32_16x16x32_bf16 a[0:3], v[64:67], v[48:51], a[0:3]
    ds_read_b64_tr_b16 v[76:77], v27 offset:9408
    v_mfma_f32_16x16x32_bf16 a[4:7], v[64:67], v[52:55], a[4:7]
    ds_read_b64_tr_b16 v[78:79], v27 offset:11712
    v_mfma_f32_16x16x32_bf16 a[8:11], v[64:67], v[56:59], a[8:11]
    v_mfma_f32_16x16x32_bf16 a[12:15], v[64:67], v[60:63], a[12:15]
    s_waitcnt lgkmcnt(4)
    v_mfma_f32_16x16x32_bf16 a[16:19], v[68:71], v[48:51], a[16:19]
    ds_read_b64_tr_b16 v[80:81], v27 offset:224
    v_mfma_f32_16x16x32_bf16 a[20:23], v[68:71], v[52:55], a[20:23]
    ds_read_b64_tr_b16 v[82:83], v27 offset:2528
    v_mfma_f32_16x16x32_bf16 a[24:27], v[68:71], v[56:59], a[24:27]
    v_mfma_f32_16x16x32_bf16 a[28:31], v[68:71], v[60:63], a[28:31]
    s_waitcnt lgkmcnt(4)
    v_mfma_f32_16x16x32_bf16 a[32:35], v[72:75], v[48:51], a[32:35]
    ds_read_b64_tr_b16 v[84:85], v27 offset:9440
    v_mfma_f32_16x16x32_bf16 a[36:39], v[72:75], v[52:55], a[36:39]
    ds_read_b64_tr_b16 v[86:87], v27 offset:11744
    v_mfma_f32_16x16x32_bf16 a[40:43], v[72:75], v[56:59], a[40:43]
    v_mfma_f32_16x16x32_bf16 a[44:47], v[72:75], v[60:63], a[44:47]
    s_waitcnt lgkmcnt(4)
    v_mfma_f32_16x16x32_bf16 a[48:51], v[76:79], v[48:51], a[48:51]
    ds_read_b64_tr_b16 v[88:89], v27 offset:256
    v_mfma_f32_16x16x32_bf16 a[52:55], v[76:79], v[52:55], a[52:55]
    ds_read_b64_tr_b16 v[90:91], v27 offset:2560
    v_mfma_f32_16x16x32_bf16 a[56:59], v[76:79], v[56:59], a[56:59]
    v_mfma_f32_16x16x32_bf16 a[60:63], v[76:79], v[60:63], a[60:63]
    s_waitcnt lgkmcnt(4)
    v_mfma_f32_16x16x32_bf16 a[64:67], v[80:83], v[48:51], a[64:67]
    ds_read_b64_tr_b16 v[92:93], v27 offset:9472
    v_mfma_f32_16x16x32_bf16 a[68:71], v[80:83], v[52:55], a[68:71]
    ds_read_b64_tr_b16 v[94:95], v27 offset:11776
    v_mfma_f32_16x16x32_bf16 a[72:75], v[80:83], v[56:59], a[72:75]
    v_mfma_f32_16x16x32_bf16 a[76:79], v[80:83], v[60:63], a[76:79]
    s_waitcnt lgkmcnt(4)
    v_mfma_f32_16x16x32_bf16 a[80:83], v[84:87], v[48:51], a[80:83]
    v_mfma_f32_16x16x32_bf16 a[84:87], v[84:87], v[52:55], a[84:87]
    v_mfma_f32_16x16x32_bf16 a[88:91], v[84:87], v[56:59], a[88:91]
    v_mfma_f32_16x16x32_bf16 a[92:95], v[84:87], v[60:63], a[92:95]
    s_waitcnt lgkmcnt(2)
    v_mfma_f32_16x16x32_bf16 a[96:99], v[88:91], v[48:51], a[96:99]
    v_mfma_f32_16x16x32_bf16 a[100:103], v[88:91], v[52:55], a[100:103]
    v_mfma_f32_16x16x32_bf16 a[104:107], v[88:91], v[56:59], a[104:107]
    v_mfma_f32_16x16x32_bf16 a[108:111], v[88:91], v[60:63], a[108:111]
    s_waitcnt lgkmcnt(0)
    v_mfma_f32_16x16x32_bf16 a[112:115], v[92:95], v[48:51], a[112:115]
    v_mfma_f32_16x16x32_bf16 a[116:119], v[92:95], v[52:55], a[116:119]
    v_mfma_f32_16x16x32_bf16 a[120:123], v[92:95], v[56:59], a[120:123]
    v_mfma_f32_16x16x32_bf16 a[124:127], v[92:95], v[60:63], a[124:127]
    s_nop 15
    s_waitcnt vmcnt(0) lgkmcnt(0)
    s_add_u32 s12, s4, 25165824
    s_addc_u32 s13, s5, 0
    s_mov_b32 s14, 18874368
    s_mov_b32 s15, 0x00020000
    s_lshl_b32 s30, s21, 6
    s_add_u32 s30, s30, s25
    v_add_u32 v8, s30, v3
    s_movk_i32 s31, 9216
    v_mul_lo_u32 v8, v8, s31
    s_mul_i32 s29, s24, 288
    v_add_u32 v8, s29, v8
    v_and_b32 v9, 1, v4
    v_lshrrev_b32 v10, 1, v4
    v_lshlrev_b32 v9, 5, v9
    v_lshl_add_u32 v9, v10, 4, v9
    v_add_u32 v9, v8, v9
    v_lshl_add_u32 v10, v4, 3, v8
    s_mov_b32 s30, 0
    v_accvgpr_read_b32 v36, a0
    v_accvgpr_read_b32 v40, a16
    v_accvgpr_read_b32 v37, a1
    v_accvgpr_read_b32 v41, a17
    v_accvgpr_read_b32 v38, a2
    v_accvgpr_read_b32 v42, a18
    v_accvgpr_read_b32 v39, a3
    v_accvgpr_read_b32 v43, a19
    v_max_f32 v36, 0, v36
    v_max_f32 v37, 0, v37
    v_max_f32 v38, 0, v38
    v_max_f32 v39, 0, v39
    v_cvt_pk_bf16_f32 v36, v36, v37
    v_cvt_pk_bf16_f32 v38, v38, v39
    v_cvt_pk_bf16_f32 v40, v40, v41
    v_cvt_pk_bf16_f32 v42, v42, v43
    v_and_b32 v37, 0xffff0000, v36
    v_lshlrev_b32 v36, 16, v36
    v_and_b32 v39, 0xffff0000, v38
    v_lshlrev_b32 v38, 16, v38
    v_and_b32 v41, 0xffff0000, v40
    v_lshlrev_b32 v40, 16, v40
    v_and_b32 v43, 0xffff0000, v42
    v_lshlrev_b32 v42, 16, v42
    v_mul_f32 v36, v36, v40
    v_mul_f32 v37, v37, v41
    v_mul_f32 v38, v38, v42
    v_mul_f32 v39, v39, v43
    v_cvt_pk_bf16_f32 v32, v36, v37
    v_cvt_pk_bf16_f32 v33, v38, v39
    v_accvgpr_read_b32 v44, a32
    v_accvgpr_read_b32 v48, a48
    v_accvgpr_read_b32 v45, a33
    v_accvgpr_read_b32 v49, a49
    v_accvgpr_read_b32 v46, a34
    v_accvgpr_read_b32 v50, a50
    v_accvgpr_read_b32 v47, a35
    v_accvgpr_read_b32 v51, a51
    v_max_f32 v44, 0, v44
    v_max_f32 v45, 0, v45
    v_max_f32 v46, 0, v46
    v_max_f32 v47, 0, v47
    v_cvt_pk_bf16_f32 v44, v44, v45
    v_cvt_pk_bf16_f32 v46, v46, v47
    v_cvt_pk_bf16_f32 v48, v48, v49
    v_cvt_pk_bf16_f32 v50, v50, v51
    v_and_b32 v45, 0xffff0000, v44
    v_lshlrev_b32 v44, 16, v44
    v_and_b32 v47, 0xffff0000, v46
    v_lshlrev_b32 v46, 16, v46
    v_and_b32 v49, 0xffff0000, v48
    v_lshlrev_b32 v48, 16, v48
    v_and_b32 v51, 0xffff0000, v50
    v_lshlrev_b32 v50, 16, v50
    v_mul_f32 v44, v44, v48
    v_mul_f32 v45, v45, v49
    v_mul_f32 v46, v46, v50
    v_mul_f32 v47, v47, v51
    v_cvt_pk_bf16_f32 v34, v44, v45
    v_cvt_pk_bf16_f32 v35, v46, v47
    s_nop 1
    v_permlane16_swap_b32 v32, v34
    v_permlane16_swap_b32 v33, v35
    buffer_store_dwordx4 v[32:35], v9, s[12:15], s30 offen offset:160
    v_accvgpr_read_b32 v56, a64
    v_accvgpr_read_b32 v60, a80
    v_accvgpr_read_b32 v57, a65
    v_accvgpr_read_b32 v61, a81
    v_accvgpr_read_b32 v58, a66
    v_accvgpr_read_b32 v62, a82
    v_accvgpr_read_b32 v59, a67
    v_accvgpr_read_b32 v63, a83
    v_max_f32 v56, 0, v56
    v_max_f32 v57, 0, v57
    v_max_f32 v58, 0, v58
    v_max_f32 v59, 0, v59
    v_cvt_pk_bf16_f32 v56, v56, v57
    v_cvt_pk_bf16_f32 v58, v58, v59
    v_cvt_pk_bf16_f32 v60, v60, v61
    v_cvt_pk_bf16_f32 v62, v62, v63
    v_and_b32 v57, 0xffff0000, v56
    v_lshlrev_b32 v56, 16, v56
    v_and_b32 v59, 0xffff0000, v58
    v_lshlrev_b32 v58, 16, v58
    v_and_b32 v61, 0xffff0000, v60
    v_lshlrev_b32 v60, 16, v60
    v_and_b32 v63, 0xffff0000, v62
    v_lshlrev_b32 v62, 16, v62
    v_mul_f32 v56, v56, v60
    v_mul_f32 v57, v57, v61
    v_mul_f32 v58, v58, v62
    v_mul_f32 v59, v59, v63
    v_cvt_pk_bf16_f32 v52, v56, v57
    v_cvt_pk_bf16_f32 v53, v58, v59
    v_accvgpr_read_b32 v64, a96
    v_accvgpr_read_b32 v68, a112
    v_accvgpr_read_b32 v65, a97
    v_accvgpr_read_b32 v69, a113
    v_accvgpr_read_b32 v66, a98
    v_accvgpr_read_b32 v70, a114
    v_accvgpr_read_b32 v67, a99
    v_accvgpr_read_b32 v71, a115
    v_max_f32 v64, 0, v64
    v_max_f32 v65, 0, v65
    v_max_f32 v66, 0, v66
    v_max_f32 v67, 0, v67
    v_cvt_pk_bf16_f32 v64, v64, v65
    v_cvt_pk_bf16_f32 v66, v66, v67
    v_cvt_pk_bf16_f32 v68, v68, v69
    v_cvt_pk_bf16_f32 v70, v70, v71
    v_and_b32 v65, 0xffff0000, v64
    v_lshlrev_b32 v64, 16, v64
    v_and_b32 v67, 0xffff0000, v66
    v_lshlrev_b32 v66, 16, v66
    v_and_b32 v69, 0xffff0000, v68
    v_lshlrev_b32 v68, 16, v68
    v_and_b32 v71, 0xffff0000, v70
    v_lshlrev_b32 v70, 16, v70
    v_mul_f32 v64, v64, v68
    v_mul_f32 v65, v65, v69
    v_mul_f32 v66, v66, v70
    v_mul_f32 v67, v67, v71
    v_cvt_pk_bf16_f32 v54, v64, v65
    v_cvt_pk_bf16_f32 v55, v66, v67
    s_nop 1
    v_permlane16_swap_b32 v52, v54
    v_permlane16_swap_b32 v53, v55
    buffer_store_dwordx4 v[52:55], v9, s[12:15], s30 offen offset:224
    s_mov_b32 s30, 147456
    v_accvgpr_read_b32 v76, a4
    v_accvgpr_read_b32 v80, a20
    v_accvgpr_read_b32 v77, a5
    v_accvgpr_read_b32 v81, a21
    v_accvgpr_read_b32 v78, a6
    v_accvgpr_read_b32 v82, a22
    v_accvgpr_read_b32 v79, a7
    v_accvgpr_read_b32 v83, a23
    v_max_f32 v76, 0, v76
    v_max_f32 v77, 0, v77
    v_max_f32 v78, 0, v78
    v_max_f32 v79, 0, v79
    v_cvt_pk_bf16_f32 v76, v76, v77
    v_cvt_pk_bf16_f32 v78, v78, v79
    v_cvt_pk_bf16_f32 v80, v80, v81
    v_cvt_pk_bf16_f32 v82, v82, v83
    v_and_b32 v77, 0xffff0000, v76
    v_lshlrev_b32 v76, 16, v76
    v_and_b32 v79, 0xffff0000, v78
    v_lshlrev_b32 v78, 16, v78
    v_and_b32 v81, 0xffff0000, v80
    v_lshlrev_b32 v80, 16, v80
    v_and_b32 v83, 0xffff0000, v82
    v_lshlrev_b32 v82, 16, v82
    v_mul_f32 v76, v76, v80
    v_mul_f32 v77, v77, v81
    v_mul_f32 v78, v78, v82
    v_mul_f32 v79, v79, v83
    v_cvt_pk_bf16_f32 v72, v76, v77
    v_cvt_pk_bf16_f32 v73, v78, v79
    v_accvgpr_read_b32 v84, a36
    v_accvgpr_read_b32 v88, a52
    v_accvgpr_read_b32 v85, a37
    v_accvgpr_read_b32 v89, a53
    v_accvgpr_read_b32 v86, a38
    v_accvgpr_read_b32 v90, a54
    v_accvgpr_read_b32 v87, a39
    v_accvgpr_read_b32 v91, a55
    v_max_f32 v84, 0, v84
    v_max_f32 v85, 0, v85
    v_max_f32 v86, 0, v86
    v_max_f32 v87, 0, v87
    v_cvt_pk_bf16_f32 v84, v84, v85
    v_cvt_pk_bf16_f32 v86, v86, v87
    v_cvt_pk_bf16_f32 v88, v88, v89
    v_cvt_pk_bf16_f32 v90, v90, v91
    v_and_b32 v85, 0xffff0000, v84
    v_lshlrev_b32 v84, 16, v84
    v_and_b32 v87, 0xffff0000, v86
    v_lshlrev_b32 v86, 16, v86
    v_and_b32 v89, 0xffff0000, v88
    v_lshlrev_b32 v88, 16, v88
    v_and_b32 v91, 0xffff0000, v90
    v_lshlrev_b32 v90, 16, v90
    v_mul_f32 v84, v84, v88
    v_mul_f32 v85, v85, v89
    v_mul_f32 v86, v86, v90
    v_mul_f32 v87, v87, v91
    v_cvt_pk_bf16_f32 v74, v84, v85
    v_cvt_pk_bf16_f32 v75, v86, v87
    s_nop 1
    v_permlane16_swap_b32 v72, v74
    v_permlane16_swap_b32 v73, v75
    buffer_store_dwordx4 v[72:75], v9, s[12:15], s30 offen offset:160
    v_accvgpr_read_b32 v36, a68
    v_accvgpr_read_b32 v40, a84
    v_accvgpr_read_b32 v37, a69
    v_accvgpr_read_b32 v41, a85
    v_accvgpr_read_b32 v38, a70
    v_accvgpr_read_b32 v42, a86
    v_accvgpr_read_b32 v39, a71
    v_accvgpr_read_b32 v43, a87
    v_max_f32 v36, 0, v36
    v_max_f32 v37, 0, v37
    v_max_f32 v38, 0, v38
    v_max_f32 v39, 0, v39
    v_cvt_pk_bf16_f32 v36, v36, v37
    v_cvt_pk_bf16_f32 v38, v38, v39
    v_cvt_pk_bf16_f32 v40, v40, v41
    v_cvt_pk_bf16_f32 v42, v42, v43
    v_and_b32 v37, 0xffff0000, v36
    v_lshlrev_b32 v36, 16, v36
    v_and_b32 v39, 0xffff0000, v38
    v_lshlrev_b32 v38, 16, v38
    v_and_b32 v41, 0xffff0000, v40
    v_lshlrev_b32 v40, 16, v40
    v_and_b32 v43, 0xffff0000, v42
    v_lshlrev_b32 v42, 16, v42
    v_mul_f32 v36, v36, v40
    v_mul_f32 v37, v37, v41
    v_mul_f32 v38, v38, v42
    v_mul_f32 v39, v39, v43
    v_cvt_pk_bf16_f32 v32, v36, v37
    v_cvt_pk_bf16_f32 v33, v38, v39
    v_accvgpr_read_b32 v44, a100
    v_accvgpr_read_b32 v48, a116
    v_accvgpr_read_b32 v45, a101
    v_accvgpr_read_b32 v49, a117
    v_accvgpr_read_b32 v46, a102
    v_accvgpr_read_b32 v50, a118
    v_accvgpr_read_b32 v47, a103
    v_accvgpr_read_b32 v51, a119
    v_max_f32 v44, 0, v44
    v_max_f32 v45, 0, v45
    v_max_f32 v46, 0, v46
    v_max_f32 v47, 0, v47
    v_cvt_pk_bf16_f32 v44, v44, v45
    v_cvt_pk_bf16_f32 v46, v46, v47
    v_cvt_pk_bf16_f32 v48, v48, v49
    v_cvt_pk_bf16_f32 v50, v50, v51
    v_and_b32 v45, 0xffff0000, v44
    v_lshlrev_b32 v44, 16, v44
    v_and_b32 v47, 0xffff0000, v46
    v_lshlrev_b32 v46, 16, v46
    v_and_b32 v49, 0xffff0000, v48
    v_lshlrev_b32 v48, 16, v48
    v_and_b32 v51, 0xffff0000, v50
    v_lshlrev_b32 v50, 16, v50
    v_mul_f32 v44, v44, v48
    v_mul_f32 v45, v45, v49
    v_mul_f32 v46, v46, v50
    v_mul_f32 v47, v47, v51
    v_cvt_pk_bf16_f32 v34, v44, v45
    v_cvt_pk_bf16_f32 v35, v46, v47
    s_nop 1
    v_permlane16_swap_b32 v32, v34
    v_permlane16_swap_b32 v33, v35
    buffer_store_dwordx4 v[32:35], v9, s[12:15], s30 offen offset:224
    s_mov_b32 s30, 294912
    v_accvgpr_read_b32 v56, a8
    v_accvgpr_read_b32 v60, a24
    v_accvgpr_read_b32 v57, a9
    v_accvgpr_read_b32 v61, a25
    v_accvgpr_read_b32 v58, a10
    v_accvgpr_read_b32 v62, a26
    v_accvgpr_read_b32 v59, a11
    v_accvgpr_read_b32 v63, a27
    v_max_f32 v56, 0, v56
    v_max_f32 v57, 0, v57
    v_max_f32 v58, 0, v58
    v_max_f32 v59, 0, v59
    v_cvt_pk_bf16_f32 v56, v56, v57
    v_cvt_pk_bf16_f32 v58, v58, v59
    v_cvt_pk_bf16_f32 v60, v60, v61
    v_cvt_pk_bf16_f32 v62, v62, v63
    v_and_b32 v57, 0xffff0000, v56
    v_lshlrev_b32 v56, 16, v56
    v_and_b32 v59, 0xffff0000, v58
    v_lshlrev_b32 v58, 16, v58
    v_and_b32 v61, 0xffff0000, v60
    v_lshlrev_b32 v60, 16, v60
    v_and_b32 v63, 0xffff0000, v62
    v_lshlrev_b32 v62, 16, v62
    v_mul_f32 v56, v56, v60
    v_mul_f32 v57, v57, v61
    v_mul_f32 v58, v58, v62
    v_mul_f32 v59, v59, v63
    v_cvt_pk_bf16_f32 v52, v56, v57
    v_cvt_pk_bf16_f32 v53, v58, v59
    v_accvgpr_read_b32 v64, a40
    v_accvgpr_read_b32 v68, a56
    v_accvgpr_read_b32 v65, a41
    v_accvgpr_read_b32 v69, a57
    v_accvgpr_read_b32 v66, a42
    v_accvgpr_read_b32 v70, a58
    v_accvgpr_read_b32 v67, a43
    v_accvgpr_read_b32 v71, a59
    v_max_f32 v64, 0, v64
    v_max_f32 v65, 0, v65
    v_max_f32 v66, 0, v66
    v_max_f32 v67, 0, v67
    v_cvt_pk_bf16_f32 v64, v64, v65
    v_cvt_pk_bf16_f32 v66, v66, v67
    v_cvt_pk_bf16_f32 v68, v68, v69
    v_cvt_pk_bf16_f32 v70, v70, v71
    v_and_b32 v65, 0xffff0000, v64
    v_lshlrev_b32 v64, 16, v64
    v_and_b32 v67, 0xffff0000, v66
    v_lshlrev_b32 v66, 16, v66
    v_and_b32 v69, 0xffff0000, v68
    v_lshlrev_b32 v68, 16, v68
    v_and_b32 v71, 0xffff0000, v70
    v_lshlrev_b32 v70, 16, v70
    v_mul_f32 v64, v64, v68
    v_mul_f32 v65, v65, v69
    v_mul_f32 v66, v66, v70
    v_mul_f32 v67, v67, v71
    v_cvt_pk_bf16_f32 v54, v64, v65
    v_cvt_pk_bf16_f32 v55, v66, v67
    s_nop 1
    v_permlane16_swap_b32 v52, v54
    v_permlane16_swap_b32 v53, v55
    buffer_store_dwordx4 v[52:55], v9, s[12:15], s30 offen offset:160
    v_accvgpr_read_b32 v76, a72
    v_accvgpr_read_b32 v80, a88
    v_accvgpr_read_b32 v77, a73
    v_accvgpr_read_b32 v81, a89
    v_accvgpr_read_b32 v78, a74
    v_accvgpr_read_b32 v82, a90
    v_accvgpr_read_b32 v79, a75
    v_accvgpr_read_b32 v83, a91
    v_max_f32 v76, 0, v76
    v_max_f32 v77, 0, v77
    v_max_f32 v78, 0, v78
    v_max_f32 v79, 0, v79
    v_cvt_pk_bf16_f32 v76, v76, v77
    v_cvt_pk_bf16_f32 v78, v78, v79
    v_cvt_pk_bf16_f32 v80, v80, v81
    v_cvt_pk_bf16_f32 v82, v82, v83
    v_and_b32 v77, 0xffff0000, v76
    v_lshlrev_b32 v76, 16, v76
    v_and_b32 v79, 0xffff0000, v78
    v_lshlrev_b32 v78, 16, v78
    v_and_b32 v81, 0xffff0000, v80
    v_lshlrev_b32 v80, 16, v80
    v_and_b32 v83, 0xffff0000, v82
    v_lshlrev_b32 v82, 16, v82
    v_mul_f32 v76, v76, v80
    v_mul_f32 v77, v77, v81
    v_mul_f32 v78, v78, v82
    v_mul_f32 v79, v79, v83
    v_cvt_pk_bf16_f32 v72, v76, v77
    v_cvt_pk_bf16_f32 v73, v78, v79
    v_accvgpr_read_b32 v84, a104
    v_accvgpr_read_b32 v88, a120
    v_accvgpr_read_b32 v85, a105
    v_accvgpr_read_b32 v89, a121
    v_accvgpr_read_b32 v86, a106
    v_accvgpr_read_b32 v90, a122
    v_accvgpr_read_b32 v87, a107
    v_accvgpr_read_b32 v91, a123
    v_max_f32 v84, 0, v84
    v_max_f32 v85, 0, v85
    v_max_f32 v86, 0, v86
    v_max_f32 v87, 0, v87
    v_cvt_pk_bf16_f32 v84, v84, v85
    v_cvt_pk_bf16_f32 v86, v86, v87
    v_cvt_pk_bf16_f32 v88, v88, v89
    v_cvt_pk_bf16_f32 v90, v90, v91
    v_and_b32 v85, 0xffff0000, v84
    v_lshlrev_b32 v84, 16, v84
    v_and_b32 v87, 0xffff0000, v86
    v_lshlrev_b32 v86, 16, v86
    v_and_b32 v89, 0xffff0000, v88
    v_lshlrev_b32 v88, 16, v88
    v_and_b32 v91, 0xffff0000, v90
    v_lshlrev_b32 v90, 16, v90
    v_mul_f32 v84, v84, v88
    v_mul_f32 v85, v85, v89
    v_mul_f32 v86, v86, v90
    v_mul_f32 v87, v87, v91
    v_cvt_pk_bf16_f32 v74, v84, v85
    v_cvt_pk_bf16_f32 v75, v86, v87
    s_nop 1
    v_permlane16_swap_b32 v72, v74
    v_permlane16_swap_b32 v73, v75
    buffer_store_dwordx4 v[72:75], v9, s[12:15], s30 offen offset:224
    s_mov_b32 s30, 442368
    v_accvgpr_read_b32 v36, a12
    v_accvgpr_read_b32 v40, a28
    v_accvgpr_read_b32 v37, a13
    v_accvgpr_read_b32 v41, a29
    v_accvgpr_read_b32 v38, a14
    v_accvgpr_read_b32 v42, a30
    v_accvgpr_read_b32 v39, a15
    v_accvgpr_read_b32 v43, a31
    v_max_f32 v36, 0, v36
    v_max_f32 v37, 0, v37
    v_max_f32 v38, 0, v38
    v_max_f32 v39, 0, v39
    v_cvt_pk_bf16_f32 v36, v36, v37
    v_cvt_pk_bf16_f32 v38, v38, v39
    v_cvt_pk_bf16_f32 v40, v40, v41
    v_cvt_pk_bf16_f32 v42, v42, v43
    v_and_b32 v37, 0xffff0000, v36
    v_lshlrev_b32 v36, 16, v36
    v_and_b32 v39, 0xffff0000, v38
    v_lshlrev_b32 v38, 16, v38
    v_and_b32 v41, 0xffff0000, v40
    v_lshlrev_b32 v40, 16, v40
    v_and_b32 v43, 0xffff0000, v42
    v_lshlrev_b32 v42, 16, v42
    v_mul_f32 v36, v36, v40
    v_mul_f32 v37, v37, v41
    v_mul_f32 v38, v38, v42
    v_mul_f32 v39, v39, v43
    v_cvt_pk_bf16_f32 v32, v36, v37
    v_cvt_pk_bf16_f32 v33, v38, v39
    v_accvgpr_read_b32 v44, a44
    v_accvgpr_read_b32 v48, a60
    v_accvgpr_read_b32 v45, a45
    v_accvgpr_read_b32 v49, a61
    v_accvgpr_read_b32 v46, a46
    v_accvgpr_read_b32 v50, a62
    v_accvgpr_read_b32 v47, a47
    v_accvgpr_read_b32 v51, a63
    v_max_f32 v44, 0, v44
    v_max_f32 v45, 0, v45
    v_max_f32 v46, 0, v46
    v_max_f32 v47, 0, v47
    v_cvt_pk_bf16_f32 v44, v44, v45
    v_cvt_pk_bf16_f32 v46, v46, v47
    v_cvt_pk_bf16_f32 v48, v48, v49
    v_cvt_pk_bf16_f32 v50, v50, v51
    v_and_b32 v45, 0xffff0000, v44
    v_lshlrev_b32 v44, 16, v44
    v_and_b32 v47, 0xffff0000, v46
    v_lshlrev_b32 v46, 16, v46
    v_and_b32 v49, 0xffff0000, v48
    v_lshlrev_b32 v48, 16, v48
    v_and_b32 v51, 0xffff0000, v50
    v_lshlrev_b32 v50, 16, v50
    v_mul_f32 v44, v44, v48
    v_mul_f32 v45, v45, v49
    v_mul_f32 v46, v46, v50
    v_mul_f32 v47, v47, v51
    v_cvt_pk_bf16_f32 v34, v44, v45
    v_cvt_pk_bf16_f32 v35, v46, v47
    s_nop 1
    v_permlane16_swap_b32 v32, v34
    v_permlane16_swap_b32 v33, v35
    buffer_store_dwordx4 v[32:35], v9, s[12:15], s30 offen offset:160
    v_accvgpr_read_b32 v56, a76
    v_accvgpr_read_b32 v60, a92
    v_accvgpr_read_b32 v57, a77
    v_accvgpr_read_b32 v61, a93
    v_accvgpr_read_b32 v58, a78
    v_accvgpr_read_b32 v62, a94
    v_accvgpr_read_b32 v59, a79
    v_accvgpr_read_b32 v63, a95
    v_max_f32 v56, 0, v56
    v_max_f32 v57, 0, v57
    v_max_f32 v58, 0, v58
    v_max_f32 v59, 0, v59
    v_cvt_pk_bf16_f32 v56, v56, v57
    v_cvt_pk_bf16_f32 v58, v58, v59
    v_cvt_pk_bf16_f32 v60, v60, v61
    v_cvt_pk_bf16_f32 v62, v62, v63
    v_and_b32 v57, 0xffff0000, v56
    v_lshlrev_b32 v56, 16, v56
    v_and_b32 v59, 0xffff0000, v58
    v_lshlrev_b32 v58, 16, v58
    v_and_b32 v61, 0xffff0000, v60
    v_lshlrev_b32 v60, 16, v60
    v_and_b32 v63, 0xffff0000, v62
    v_lshlrev_b32 v62, 16, v62
    v_mul_f32 v56, v56, v60
    v_mul_f32 v57, v57, v61
    v_mul_f32 v58, v58, v62
    v_mul_f32 v59, v59, v63
    v_cvt_pk_bf16_f32 v52, v56, v57
    v_cvt_pk_bf16_f32 v53, v58, v59
    v_accvgpr_read_b32 v64, a108
    v_accvgpr_read_b32 v68, a124
    v_accvgpr_read_b32 v65, a109
    v_accvgpr_read_b32 v69, a125
    v_accvgpr_read_b32 v66, a110
    v_accvgpr_read_b32 v70, a126
    v_accvgpr_read_b32 v67, a111
    v_accvgpr_read_b32 v71, a127
    v_max_f32 v64, 0, v64
    v_max_f32 v65, 0, v65
    v_max_f32 v66, 0, v66
    v_max_f32 v67, 0, v67
    v_cvt_pk_bf16_f32 v64, v64, v65
    v_cvt_pk_bf16_f32 v66, v66, v67
    v_cvt_pk_bf16_f32 v68, v68, v69
    v_cvt_pk_bf16_f32 v70, v70, v71
    v_and_b32 v65, 0xffff0000, v64
    v_lshlrev_b32 v64, 16, v64
    v_and_b32 v67, 0xffff0000, v66
    v_lshlrev_b32 v66, 16, v66
    v_and_b32 v69, 0xffff0000, v68
    v_lshlrev_b32 v68, 16, v68
    v_and_b32 v71, 0xffff0000, v70
    v_lshlrev_b32 v70, 16, v70
    v_mul_f32 v64, v64, v68
    v_mul_f32 v65, v65, v69
    v_mul_f32 v66, v66, v70
    v_mul_f32 v67, v67, v71
    v_cvt_pk_bf16_f32 v54, v64, v65
    v_cvt_pk_bf16_f32 v55, v66, v67
    s_nop 1
    v_permlane16_swap_b32 v52, v54
    v_permlane16_swap_b32 v53, v55
    buffer_store_dwordx4 v[52:55], v9, s[12:15], s30 offen offset:224
    s_endpgm
.ffn1_kernel_end:
    s_endpgm

.section .rodata,"a"
.p2align 6
.amdhsa_kernel ffn1_kernel
  .amdhsa_next_free_vgpr 256
  .amdhsa_next_free_sgpr 102
  .amdhsa_accum_offset 96
  .amdhsa_group_segment_fixed_size 0
  .amdhsa_kernarg_size 112
  .amdhsa_user_sgpr_count 2
  .amdhsa_user_sgpr_kernarg_segment_ptr 1
  .amdhsa_system_sgpr_workgroup_id_x 1
.end_amdhsa_kernel

.text
.globl down_kernel
.p2align 8
.type down_kernel,@function
down_kernel:
    s_cmp_ge_u32 s2, 256
    s_cbranch_scc1 .down_kernel_end_row
    s_load_dwordx2 s[4:5], s[0:1], 104
    s_load_dwordx2 s[34:35], s[0:1], 96
    s_load_dwordx2 s[36:37], s[0:1], 64
    v_lshrrev_b32 v1, 6, v0
    v_and_b32 v2, 63, v0
    s_nop 0
    v_readfirstlane_b32 s3, v1
    s_bfe_u32 s23, s2, 0x20001
    s_and_b32 s25, s2, 1
    s_lshl_b32 s25, s25, 3
    s_bfe_u32 s24, s2, 0x30003
    s_add_u32 s25, s25, s24
    s_lshl_b32 s25, s25, 7
    s_lshr_b32 s24, s2, 6
    s_and_b32 s21, s3, 1
    s_bfe_u32 s22, s3, 0x10001
    s_lshl_b32 s26, s3, 10
    s_cmp_lt_u32 s3, 2
    s_cselect_b32 s48, -1, 0
    s_mov_b32 s49, s48
    s_waitcnt lgkmcnt(0)
    s_add_u32 s8, s4, 25165824
    s_addc_u32 s9, s5, 0
    s_mov_b32 s10, 18874368
    s_mov_b32 s11, 0x00020000
    s_mov_b32 s80, s36
    s_mov_b32 s81, s37
    s_mov_b32 s82, 5308416
    s_mov_b32 s83, 0x00020000
    s_mov_b32 s84, s36
    s_mov_b32 s85, s37
    s_mov_b32 s86, 5308416
    s_mov_b32 s87, 0x00020000
    s_mov_b32 s88, s36
    s_mov_b32 s89, s37
    s_mov_b32 s90, 5308416
    s_mov_b32 s91, 0x00020000
    v_and_b32 v3, 15, v2
    v_lshrrev_b32 v4, 4, v2
    v_lshrrev_b32 v5, 2, v3
    v_and_b32 v6, 3, v2
    v_lshrrev_b32 v7, 2, v2
    v_sub_u32 v8, 0, v4
    v_and_b32 v8, 3, v8
    v_xor_b32 v8, v6, v8
    v_lshlrev_b32 v8, 4, v8
    s_mov_b32 s31, 9216
    s_mul_i32 s29, s23, 2304
    s_lshl_b32 s28, s3, 4
    s_add_u32 s28, s28, s25
    v_add_u32 v9, s28, v7
    v_mul_lo_u32 v9, v9, s31
    s_add_u32 s28, s29, 0
    v_add_u32 v9, s28, v9
    v_add_u32 v16, v9, v8
    s_lshl_b32 s28, s3, 4
    s_add_u32 s28, s28, s25
    v_add_u32 v9, s28, v7
    v_mul_lo_u32 v9, v9, s31
    s_add_u32 s28, s29, 64
    v_add_u32 v9, s28, v9
    v_add_u32 v17, v9, v8
    s_mov_b32 s31, 1152
    s_mul_i32 s29, s24, 288
    s_mul_i32 s28, s23, 1327104
    s_add_u32 s29, s29, s28
    s_add_u32 s30, s3, 0
    s_min_u32 s30, s30, 17
    s_cmp_ge_u32 s30, 9
    s_cselect_b32 s28, 9, 0
    s_sub_u32 s27, s30, s28
    s_lshl_b32 s27, s27, 6
    v_add_u32 v9, s27, v2
    s_movk_i32 s27, 3641
    v_mul_lo_u32 v10, v9, s27
    v_lshrrev_b32 v10, 16, v10
    v_mul_u32_u24 v11, 18, v10
    v_sub_u32 v11, v9, v11
    v_and_b32 v12, 0x13, v10
    v_and_b32 v13, 4, v10
    v_lshlrev_b32 v13, 1, v13
    v_or_b32 v12, v12, v13
    v_and_b32 v13, 8, v10
    v_lshrrev_b32 v13, 1, v13
    v_or_b32 v12, v12, v13
    v_mul_lo_u32 v12, v12, s31
    v_lshl_add_u32 v12, v11, 4, v12
    v_add_u32 v18, s29, v12
    s_cmp_ge_u32 s30, 9
    s_cselect_b32 s28, 36864, 0
    v_add_u32 v18, s28, v18
    s_lshl_b32 s44, s30, 10
    s_add_u32 s44, s44, 16384
    s_add_u32 s30, s3, 8
    s_min_u32 s30, s30, 17
    s_cmp_ge_u32 s30, 9
    s_cselect_b32 s28, 9, 0
    s_sub_u32 s27, s30, s28
    s_lshl_b32 s27, s27, 6
    v_add_u32 v9, s27, v2
    s_movk_i32 s27, 3641
    v_mul_lo_u32 v10, v9, s27
    v_lshrrev_b32 v10, 16, v10
    v_mul_u32_u24 v11, 18, v10
    v_sub_u32 v11, v9, v11
    v_and_b32 v12, 0x13, v10
    v_and_b32 v13, 4, v10
    v_lshlrev_b32 v13, 1, v13
    v_or_b32 v12, v12, v13
    v_and_b32 v13, 8, v10
    v_lshrrev_b32 v13, 1, v13
    v_or_b32 v12, v12, v13
    v_mul_lo_u32 v12, v12, s31
    v_lshl_add_u32 v12, v11, 4, v12
    v_add_u32 v19, s29, v12
    s_cmp_ge_u32 s30, 9
    s_cselect_b32 s28, 36864, 0
    v_add_u32 v19, s28, v19
    s_lshl_b32 s45, s30, 10
    s_add_u32 s45, s45, 16384
    s_add_u32 s30, s3, 16
    s_min_u32 s30, s30, 17
    s_cmp_ge_u32 s30, 9
    s_cselect_b32 s28, 9, 0
    s_sub_u32 s27, s30, s28
    s_lshl_b32 s27, s27, 6
    v_add_u32 v9, s27, v2
    s_movk_i32 s27, 3641
    v_mul_lo_u32 v10, v9, s27
    v_lshrrev_b32 v10, 16, v10
    v_mul_u32_u24 v11, 18, v10
    v_sub_u32 v11, v9, v11
    v_and_b32 v12, 0x13, v10
    v_and_b32 v13, 4, v10
    v_lshlrev_b32 v13, 1, v13
    v_or_b32 v12, v12, v13
    v_and_b32 v13, 8, v10
    v_lshrrev_b32 v13, 1, v13
    v_or_b32 v12, v12, v13
    v_mul_lo_u32 v12, v12, s31
    v_lshl_add_u32 v12, v11, 4, v12
    v_add_u32 v20, s29, v12
    s_cmp_ge_u32 s30, 9
    s_cselect_b32 s28, 36864, 0
    v_add_u32 v20, s28, v20
    s_lshl_b32 s46, s30, 10
    s_add_u32 s46, s46, 16384
    s_mov_b32 s27, 0
    s_mov_b32 s28, 0
    s_cmp_ge_u32 s3, 4
    s_cbranch_scc1 .down_kernel_end_p1
    s_nop 0
    s_add_u32 m0, s26, 0
    s_nop 0
    buffer_load_dwordx4 v16, s[8:11], s27 offen lds
    s_nop 0
    s_add_u32 m0, s26, 8192
    s_nop 0
    buffer_load_dwordx4 v17, s[8:11], s27 offen lds
    s_nop 0
    s_add_u32 m0, s44, 0
    s_nop 0
    buffer_load_dwordx4 v18, s[80:83], s28 offen lds
    s_nop 0
    s_add_u32 m0, s45, 0
    s_nop 0
    buffer_load_dwordx4 v19, s[84:87], s28 offen lds
    s_nop 0
    s_add_u32 m0, s46, 0
    s_nop 0
    s_mov_b64 exec, s[48:49]
    buffer_load_dwordx4 v20, s[88:91], s28 offen lds
    s_mov_b64 exec, -1
    s_nop 0
    s_add_u32 s27, s27, 128
    s_add_u32 s28, s28, 73728
    s_nop 0
    s_add_u32 m0, s26, 34816
    s_nop 0
    buffer_load_dwordx4 v16, s[8:11], s27 offen lds
    s_nop 0
    s_add_u32 m0, s26, 43008
    s_nop 0
    buffer_load_dwordx4 v17, s[8:11], s27 offen lds
    s_nop 0
    s_add_u32 m0, s44, 34816
    s_nop 0
    buffer_load_dwordx4 v18, s[80:83], s28 offen lds
    s_nop 0
    s_add_u32 m0, s45, 34816
    s_nop 0
    buffer_load_dwordx4 v19, s[84:87], s28 offen lds
    s_nop 0
    s_add_u32 m0, s46, 34816
    s_nop 0
    s_mov_b64 exec, s[48:49]
    buffer_load_dwordx4 v20, s[88:91], s28 offen lds
    s_mov_b64 exec, -1
    s_nop 0
    s_add_u32 s27, s27, 128
    s_add_u32 s28, s28, 73728
    s_nop 0
    s_add_u32 m0, s26, 69632
    s_nop 0
    buffer_load_dwordx4 v16, s[8:11], s27 offen lds
    s_nop 0
    s_add_u32 m0, s26, 77824
    s_nop 0
    buffer_load_dwordx4 v17, s[8:11], s27 offen lds
    s_nop 0
    s_add_u32 m0, s44, 69632
    s_nop 0
    buffer_load_dwordx4 v18, s[80:83], s28 offen lds
    s_nop 0
    s_add_u32 m0, s45, 69632
    s_nop 0
    buffer_load_dwordx4 v19, s[84:87], s28 offen lds
    s_nop 0
    s_add_u32 m0, s46, 69632
    s_nop 0
    s_mov_b64 exec, s[48:49]
    buffer_load_dwordx4 v20, s[88:91], s28 offen lds
    s_mov_b64 exec, -1
    s_nop 0
    s_add_u32 s27, s27, 128
    s_add_u32 s28, s28, 73728
    s_nop 0
    v_sub_u32 v8, 0, v5
    v_and_b32 v8, 3, v8
    v_xor_b32 v8, v4, v8
    v_lshlrev_b32 v8, 4, v8
    v_lshl_add_u32 v8, v3, 6, v8
    s_lshl_b32 s30, s21, 12
    s_lshl_b32 s31, s22, 13
    s_add_u32 s30, s30, s31
    v_add_u32 v8, s30, v8
    v_lshrrev_b32 v9, 1, v4
    v_lshlrev_b32 v9, 4, v9
    v_and_b32 v10, 1, v4
    v_lshl_add_u32 v9, v10, 2, v9
    v_add_u32 v9, v9, v5
    v_mul_u32_u24 v9, 288, v9
    v_lshl_add_u32 v9, v6, 3, v9
    s_mul_i32 s31, s22, 9216
    v_add_u32 v9, s31, v9
    v_add_u32 v22, 0, v8
    v_add_u32 v26, 16384, v9
    v_add_u32 v23, 34816, v8
    v_add_u32 v27, 51200, v9
    v_add_u32 v24, 69632, v8
    v_add_u32 v28, 86016, v9
    v_add_u32 v25, 104448, v8
    v_add_u32 v29, 120832, v9
    s_nop 0
    s_waitcnt vmcnt(10)
    s_barrier
    s_nop 0
    ds_read_b128 v[32:35], v22 offset:0
    ds_read_b128 v[36:39], v22 offset:1024
    ds_read_b64_tr_b16 v[64:65], v26 offset:0
    s_nop 0
    ds_read_b128 v[40:43], v22 offset:2048
    ds_read_b128 v[44:47], v22 offset:3072
    ds_read_b64_tr_b16 v[66:67], v26 offset:2304
    s_nop 0
    ds_read_b64_tr_b16 v[68:69], v26 offset:32
    s_nop 0
    ds_read_b64_tr_b16 v[70:71], v26 offset:2336
    s_nop 0
    ds_read_b64_tr_b16 v[72:73], v26 offset:64
    s_nop 0
    ds_read_b64_tr_b16 v[74:75], v26 offset:2368
    s_waitcnt lgkmcnt(4)
    v_mfma_f32_16x16x32_bf16 a[0:3], v[64:67], v[32:35], 0
    ds_read_b64_tr_b16 v[76:77], v26 offset:96
    v_mfma_f32_16x16x32_bf16 a[4:7], v[64:67], v[36:39], 0
    ds_read_b64_tr_b16 v[78:79], v26 offset:2400
    v_mfma_f32_16x16x32_bf16 a[8:11], v[64:67], v[40:43], 0
    v_mfma_f32_16x16x32_bf16 a[12:15], v[64:67], v[44:47], 0
    s_waitcnt lgkmcnt(4)
    v_mfma_f32_16x16x32_bf16 a[16:19], v[68:71], v[32:35], 0
    ds_read_b64_tr_b16 v[80:81], v26 offset:128
    v_mfma_f32_16x16x32_bf16 a[20:23], v[68:71], v[36:39], 0
    ds_read_b64_tr_b16 v[82:83], v26 offset:2432
    v_mfma_f32_16x16x32_bf16 a[24:27], v[68:71], v[40:43], 0
    v_mfma_f32_16x16x32_bf16 a[28:31], v[68:71], v[44:47], 0
    s_waitcnt vmcnt(5)
    s_barrier
    s_waitcnt lgkmcnt(4)
    v_mfma_f32_16x16x32_bf16 a[32:35], v[72:75], v[32:35], 0
    ds_read_b128 v[48:51], v23 offset:0
    ds_read_b128 v[52:55], v23 offset:1024
    ds_read_b64_tr_b16 v[84:85], v27 offset:0
    s_add_u32 m0, s26, 104448
    v_mfma_f32_16x16x32_bf16 a[36:39], v[72:75], v[36:39], 0
    ds_read_b128 v[56:59], v23 offset:2048
    ds_read_b128 v[60:63], v23 offset:3072
    ds_read_b64_tr_b16 v[86:87], v27 offset:2304
    buffer_load_dwordx4 v16, s[8:11], s27 offen lds
    v_mfma_f32_16x16x32_bf16 a[40:43], v[72:75], v[40:43], 0
    s_add_u32 m0, s26, 112640
    v_mfma_f32_16x16x32_bf16 a[44:47], v[72:75], v[44:47], 0
    buffer_load_dwordx4 v17, s[8:11], s27 offen lds
    s_waitcnt lgkmcnt(8)
    v_mfma_f32_16x16x32_bf16 a[48:51], v[76:79], v[32:35], 0
    ds_read_b64_tr_b16 v[88:89], v27 offset:32
    s_add_u32 m0, s44, 104448
    v_mfma_f32_16x16x32_bf16 a[52:55], v[76:79], v[36:39], 0
    ds_read_b64_tr_b16 v[90:91], v27 offset:2336
    buffer_load_dwordx4 v18, s[80:83], s28 offen lds
    v_mfma_f32_16x16x32_bf16 a[56:59], v[76:79], v[40:43], 0
    s_add_u32 m0, s45, 104448
    v_mfma_f32_16x16x32_bf16 a[60:63], v[76:79], v[44:47], 0
    buffer_load_dwordx4 v19, s[84:87], s28 offen lds
    s_waitcnt lgkmcnt(8)
    v_mfma_f32_16x16x32_bf16 a[64:67], v[80:83], v[32:35], 0
    ds_read_b64_tr_b16 v[92:93], v27 offset:64
    s_add_u32 m0, s46, 104448
    v_mfma_f32_16x16x32_bf16 a[68:71], v[80:83], v[36:39], 0
    ds_read_b64_tr_b16 v[94:95], v27 offset:2368
    s_mov_b64 exec, s[48:49]
    buffer_load_dwordx4 v20, s[88:91], s28 offen lds
    s_mov_b64 exec, -1
    v_mfma_f32_16x16x32_bf16 a[72:75], v[80:83], v[40:43], 0
    s_add_u32 s27, s27, 128
    s_add_u32 s28, s28, 73728
    v_mfma_f32_16x16x32_bf16 a[76:79], v[80:83], v[44:47], 0
    s_waitcnt lgkmcnt(4)
    v_mfma_f32_16x16x32_bf16 a[0:3], v[84:87], v[48:51], a[0:3]
    ds_read_b64_tr_b16 v[64:65], v27 offset:96
    v_mfma_f32_16x16x32_bf16 a[4:7], v[84:87], v[52:55], a[4:7]
    ds_read_b64_tr_b16 v[66:67], v27 offset:2400
    v_mfma_f32_16x16x32_bf16 a[8:11], v[84:87], v[56:59], a[8:11]
    v_mfma_f32_16x16x32_bf16 a[12:15], v[84:87], v[60:63], a[12:15]
    s_waitcnt lgkmcnt(4)
    v_mfma_f32_16x16x32_bf16 a[16:19], v[88:91], v[48:51], a[16:19]
    ds_read_b64_tr_b16 v[68:69], v27 offset:128
    v_mfma_f32_16x16x32_bf16 a[20:23], v[88:91], v[52:55], a[20:23]
    ds_read_b64_tr_b16 v[70:71], v27 offset:2432
    v_mfma_f32_16x16x32_bf16 a[24:27], v[88:91], v[56:59], a[24:27]
    v_mfma_f32_16x16x32_bf16 a[28:31], v[88:91], v[60:63], a[28:31]
    s_waitcnt vmcnt(5)
    s_barrier
    s_waitcnt lgkmcnt(4)
    v_mfma_f32_16x16x32_bf16 a[32:35], v[92:95], v[48:51], a[32:35]
    ds_read_b128 v[32:35], v24 offset:0
    ds_read_b128 v[36:39], v24 offset:1024
    ds_read_b64_tr_b16 v[72:73], v28 offset:0
    s_add_u32 m0, s26, 0
    v_mfma_f32_16x16x32_bf16 a[36:39], v[92:95], v[52:55], a[36:39]
    ds_read_b128 v[40:43], v24 offset:2048
    ds_read_b128 v[44:47], v24 offset:3072
    ds_read_b64_tr_b16 v[74:75], v28 offset:2304
    buffer_load_dwordx4 v16, s[8:11], s27 offen lds
    v_mfma_f32_16x16x32_bf16 a[40:43], v[92:95], v[56:59], a[40:43]
    s_add_u32 m0, s26, 8192
    v_mfma_f32_16x16x32_bf16 a[44:47], v[92:95], v[60:63], a[44:47]
    buffer_load_dwordx4 v17, s[8:11], s27 offen lds
    s_waitcnt lgkmcnt(8)
    v_mfma_f32_16x16x32_bf16 a[48:51], v[64:67], v[48:51], a[48:51]
    ds_read_b64_tr_b16 v[76:77], v28 offset:32
    s_add_u32 m0, s44, 0
    v_mfma_f32_16x16x32_bf16 a[52:55], v[64:67], v[52:55], a[52:55]
    ds_read_b64_tr_b16 v[78:79], v28 offset:2336
    buffer_load_dwordx4 v18, s[80:83], s28 offen lds
    v_mfma_f32_16x16x32_bf16 a[56:59], v[64:67], v[56:59], a[56:59]
    s_add_u32 m0, s45, 0
    v_mfma_f32_16x16x32_bf16 a[60:63], v[64:67], v[60:63], a[60:63]
    buffer_load_dwordx4 v19, s[84:87], s28 offen lds
    s_waitcnt lgkmcnt(8)
    v_mfma_f32_16x16x32_bf16 a[64:67], v[68:71], v[48:51], a[64:67]
    ds_read_b64_tr_b16 v[80:81], v28 offset:64
    s_add_u32 m0, s46, 0
    v_mfma_f32_16x16x32_bf16 a[68:71], v[68:71], v[52:55], a[68:71]
    ds_read_b64_tr_b16 v[82:83], v28 offset:2368
    s_mov_b64 exec, s[48:49]
    buffer_load_dwordx4 v20, s[88:91], s28 offen lds
    s_mov_b64 exec, -1
    v_mfma_f32_16x16x32_bf16 a[72:75], v[68:71], v[56:59], a[72:75]
    s_add_u32 s27, s27, 128
    s_add_u32 s28, s28, 73728
    v_mfma_f32_16x16x32_bf16 a[76:79], v[68:71], v[60:63], a[76:79]
    s_waitcnt lgkmcnt(4)
    v_mfma_f32_16x16x32_bf16 a[0:3], v[72:75], v[32:35], a[0:3]
    ds_read_b64_tr_b16 v[84:85], v28 offset:96
    v_mfma_f32_16x16x32_bf16 a[4:7], v[72:75], v[36:39], a[4:7]
    ds_read_b64_tr_b16 v[86:87], v28 offset:2400
    v_mfma_f32_16x16x32_bf16 a[8:11], v[72:75], v[40:43], a[8:11]
    v_mfma_f32_16x16x32_bf16 a[12:15], v[72:75], v[44:47], a[12:15]
    s_waitcnt lgkmcnt(4)
    v_mfma_f32_16x16x32_bf16 a[16:19], v[76:79], v[32:35], a[16:19]
    ds_read_b64_tr_b16 v[88:89], v28 offset:128
    v_mfma_f32_16x16x32_bf16 a[20:23], v[76:79], v[36:39], a[20:23]
    ds_read_b64_tr_b16 v[90:91], v28 offset:2432
    v_mfma_f32_16x16x32_bf16 a[24:27], v[76:79], v[40:43], a[24:27]
    v_mfma_f32_16x16x32_bf16 a[28:31], v[76:79], v[44:47], a[28:31]
    s_waitcnt vmcnt(5)
    s_barrier
    s_waitcnt lgkmcnt(4)
    v_mfma_f32_16x16x32_bf16 a[32:35], v[80:83], v[32:35], a[32:35]
    ds_read_b128 v[48:51], v25 offset:0
    ds_read_b128 v[52:55], v25 offset:1024
    ds_read_b64_tr_b16 v[92:93], v29 offset:0
    s_add_u32 m0, s26, 34816
    v_mfma_f32_16x16x32_bf16 a[36:39], v[80:83], v[36:39], a[36:39]
    ds_read_b128 v[56:59], v25 offset:2048
    ds_read_b128 v[60:63], v25 offset:3072
    ds_read_b64_tr_b16 v[94:95], v29 offset:2304
    buffer_load_dwordx4 v16, s[8:11], s27 offen lds
    v_mfma_f32_16x16x32_bf16 a[40:43], v[80:83], v[40:43], a[40:43]
    s_add_u32 m0, s26, 43008
    v_mfma_f32_16x16x32_bf16 a[44:47], v[80:83], v[44:47], a[44:47]
    buffer_load_dwordx4 v17, s[8:11], s27 offen lds
    s_waitcnt lgkmcnt(8)
    v_mfma_f32_16x16x32_bf16 a[48:51], v[84:87], v[32:35], a[48:51]
    ds_read_b64_tr_b16 v[64:65], v29 offset:32
    s_add_u32 m0, s44, 34816
    v_mfma_f32_16x16x32_bf16 a[52:55], v[84:87], v[36:39], a[52:55]
    ds_read_b64_tr_b16 v[66:67], v29 offset:2336
    buffer_load_dwordx4 v18, s[80:83], s28 offen lds
    v_mfma_f32_16x16x32_bf16 a[56:59], v[84:87], v[40:43], a[56:59]
    s_add_u32 m0, s45, 34816
    v_mfma_f32_16x16x32_bf16 a[60:63], v[84:87], v[44:47], a[60:63]
    buffer_load_dwordx4 v19, s[84:87], s28 offen lds
    s_waitcnt lgkmcnt(8)
    v_mfma_f32_16x16x32_bf16 a[64:67], v[88:91], v[32:35], a[64:67]
    ds_read_b64_tr_b16 v[68:69], v29 offset:64
    s_add_u32 m0, s46, 34816
    v_mfma_f32_16x16x32_bf16 a[68:71], v[88:91], v[36:39], a[68:71]
    ds_read_b64_tr_b16 v[70:71], v29 offset:2368
    s_mov_b64 exec, s[48:49]
    buffer_load_dwordx4 v20, s[88:91], s28 offen lds
    s_mov_b64 exec, -1
    v_mfma_f32_16x16x32_bf16 a[72:75], v[88:91], v[40:43], a[72:75]
    s_add_u32 s27, s27, 128
    s_add_u32 s28, s28, 73728
    v_mfma_f32_16x16x32_bf16 a[76:79], v[88:91], v[44:47], a[76:79]
    s_waitcnt lgkmcnt(4)
    v_mfma_f32_16x16x32_bf16 a[0:3], v[92:95], v[48:51], a[0:3]
    ds_read_b64_tr_b16 v[72:73], v29 offset:96
    v_mfma_f32_16x16x32_bf16 a[4:7], v[92:95], v[52:55], a[4:7]
    ds_read_b64_tr_b16 v[74:75], v29 offset:2400
    v_mfma_f32_16x16x32_bf16 a[8:11], v[92:95], v[56:59], a[8:11]
    v_mfma_f32_16x16x32_bf16 a[12:15], v[92:95], v[60:63], a[12:15]
    s_waitcnt lgkmcnt(4)
    v_mfma_f32_16x16x32_bf16 a[16:19], v[64:67], v[48:51], a[16:19]
    ds_read_b64_tr_b16 v[76:77], v29 offset:128
    v_mfma_f32_16x16x32_bf16 a[20:23], v[64:67], v[52:55], a[20:23]
    ds_read_b64_tr_b16 v[78:79], v29 offset:2432
    v_mfma_f32_16x16x32_bf16 a[24:27], v[64:67], v[56:59], a[24:27]
    v_mfma_f32_16x16x32_bf16 a[28:31], v[64:67], v[60:63], a[28:31]
    s_waitcnt vmcnt(5)
    s_barrier
    s_waitcnt lgkmcnt(4)
    v_mfma_f32_16x16x32_bf16 a[32:35], v[68:71], v[48:51], a[32:35]
    ds_read_b128 v[32:35], v22 offset:0
    ds_read_b128 v[36:39], v22 offset:1024
    ds_read_b64_tr_b16 v[80:81], v26 offset:0
    s_add_u32 m0, s26, 69632
    v_mfma_f32_16x16x32_bf16 a[36:39], v[68:71], v[52:55], a[36:39]
    ds_read_b128 v[40:43], v22 offset:2048
    ds_read_b128 v[44:47], v22 offset:3072
    ds_read_b64_tr_b16 v[82:83], v26 offset:2304
    buffer_load_dwordx4 v16, s[8:11], s27 offen lds
    v_mfma_f32_16x16x32_bf16 a[40:43], v[68:71], v[56:59], a[40:43]
    s_add_u32 m0, s26, 77824
    v_mfma_f32_16x16x32_bf16 a[44:47], v[68:71], v[60:63], a[44:47]
    buffer_load_dwordx4 v17, s[8:11], s27 offen lds
    s_waitcnt lgkmcnt(8)
    v_mfma_f32_16x16x32_bf16 a[48:51], v[72:75], v[48:51], a[48:51]
    ds_read_b64_tr_b16 v[84:85], v26 offset:32
    s_add_u32 m0, s44, 69632
    v_mfma_f32_16x16x32_bf16 a[52:55], v[72:75], v[52:55], a[52:55]
    ds_read_b64_tr_b16 v[86:87], v26 offset:2336
    buffer_load_dwordx4 v18, s[80:83], s28 offen lds
    v_mfma_f32_16x16x32_bf16 a[56:59], v[72:75], v[56:59], a[56:59]
    s_add_u32 m0, s45, 69632
    v_mfma_f32_16x16x32_bf16 a[60:63], v[72:75], v[60:63], a[60:63]
    buffer_load_dwordx4 v19, s[84:87], s28 offen lds
    s_waitcnt lgkmcnt(8)
    v_mfma_f32_16x16x32_bf16 a[64:67], v[76:79], v[48:51], a[64:67]
    ds_read_b64_tr_b16 v[88:89], v26 offset:64
    s_add_u32 m0, s46, 69632
    v_mfma_f32_16x16x32_bf16 a[68:71], v[76:79], v[52:55], a[68:71]
    ds_read_b64_tr_b16 v[90:91], v26 offset:2368
    s_mov_b64 exec, s[48:49]
    buffer_load_dwordx4 v20, s[88:91], s28 offen lds
    s_mov_b64 exec, -1
    v_mfma_f32_16x16x32_bf16 a[72:75], v[76:79], v[56:59], a[72:75]
    s_add_u32 s27, s27, 128
    s_add_u32 s28, s28, 73728
    v_mfma_f32_16x16x32_bf16 a[76:79], v[76:79], v[60:63], a[76:79]
    s_waitcnt lgkmcnt(4)
    v_mfma_f32_16x16x32_bf16 a[0:3], v[80:83], v[32:35], a[0:3]
    ds_read_b64_tr_b16 v[92:93], v26 offset:96
    v_mfma_f32_16x16x32_bf16 a[4:7], v[80:83], v[36:39], a[4:7]
    ds_read_b64_tr_b16 v[94:95], v26 offset:2400
    v_mfma_f32_16x16x32_bf16 a[8:11], v[80:83], v[40:43], a[8:11]
    v_mfma_f32_16x16x32_bf16 a[12:15], v[80:83], v[44:47], a[12:15]
    s_waitcnt lgkmcnt(4)
    v_mfma_f32_16x16x32_bf16 a[16:19], v[84:87], v[32:35], a[16:19]
    ds_read_b64_tr_b16 v[64:65], v26 offset:128
    v_mfma_f32_16x16x32_bf16 a[20:23], v[84:87], v[36:39], a[20:23]
    ds_read_b64_tr_b16 v[66:67], v26 offset:2432
    v_mfma_f32_16x16x32_bf16 a[24:27], v[84:87], v[40:43], a[24:27]
    v_mfma_f32_16x16x32_bf16 a[28:31], v[84:87], v[44:47], a[28:31]
    s_waitcnt vmcnt(5)
    s_barrier
    s_waitcnt lgkmcnt(4)
    v_mfma_f32_16x16x32_bf16 a[32:35], v[88:91], v[32:35], a[32:35]
    ds_read_b128 v[48:51], v23 offset:0
    ds_read_b128 v[52:55], v23 offset:1024
    ds_read_b64_tr_b16 v[68:69], v27 offset:0
    s_add_u32 m0, s26, 104448
    v_mfma_f32_16x16x32_bf16 a[36:39], v[88:91], v[36:39], a[36:39]
    ds_read_b128 v[56:59], v23 offset:2048
    ds_read_b128 v[60:63], v23 offset:3072
    ds_read_b64_tr_b16 v[70:71], v27 offset:2304
    buffer_load_dwordx4 v16, s[8:11], s27 offen lds
    v_mfma_f32_16x16x32_bf16 a[40:43], v[88:91], v[40:43], a[40:43]
    s_add_u32 m0, s26, 112640
    v_mfma_f32_16x16x32_bf16 a[44:47], v[88:91], v[44:47], a[44:47]
    buffer_load_dwordx4 v17, s[8:11], s27 offen lds
    s_waitcnt lgkmcnt(8)
    v_mfma_f32_16x16x32_bf16 a[48:51], v[92:95], v[32:35], a[48:51]
    ds_read_b64_tr_b16 v[72:73], v27 offset:32
    s_add_u32 m0, s44, 104448
    v_mfma_f32_16x16x32_bf16 a[52:55], v[92:95], v[36:39], a[52:55]
    ds_read_b64_tr_b16 v[74:75], v27 offset:2336
    buffer_load_dwordx4 v18, s[80:83], s28 offen lds
    v_mfma_f32_16x16x32_bf16 a[56:59], v[92:95], v[40:43], a[56:59]
    s_add_u32 m0, s45, 104448
    v_mfma_f32_16x16x32_bf16 a[60:63], v[92:95], v[44:47], a[60:63]
    buffer_load_dwordx4 v19, s[84:87], s28 offen lds
    s_waitcnt lgkmcnt(8)
    v_mfma_f32_16x16x32_bf16 a[64:67], v[64:67], v[32:35], a[64:67]
    ds_read_b64_tr_b16 v[76:77], v27 offset:64
    s_add_u32 m0, s46, 104448
    v_mfma_f32_16x16x32_bf16 a[68:71], v[64:67], v[36:39], a[68:71]
    ds_read_b64_tr_b16 v[78:79], v27 offset:2368
    s_mov_b64 exec, s[48:49]
    buffer_load_dwordx4 v20, s[88:91], s28 offen lds
    s_mov_b64 exec, -1
    v_mfma_f32_16x16x32_bf16 a[72:75], v[64:67], v[40:43], a[72:75]
    s_add_u32 s27, s27, 128
    s_add_u32 s28, s28, 73728
    v_mfma_f32_16x16x32_bf16 a[76:79], v[64:67], v[44:47], a[76:79]
    s_waitcnt lgkmcnt(4)
    v_mfma_f32_16x16x32_bf16 a[0:3], v[68:71], v[48:51], a[0:3]
    ds_read_b64_tr_b16 v[80:81], v27 offset:96
    v_mfma_f32_16x16x32_bf16 a[4:7], v[68:71], v[52:55], a[4:7]
    ds_read_b64_tr_b16 v[82:83], v27 offset:2400
    v_mfma_f32_16x16x32_bf16 a[8:11], v[68:71], v[56:59], a[8:11]
    v_mfma_f32_16x16x32_bf16 a[12:15], v[68:71], v[60:63], a[12:15]
    s_waitcnt lgkmcnt(4)
    v_mfma_f32_16x16x32_bf16 a[16:19], v[72:75], v[48:51], a[16:19]
    ds_read_b64_tr_b16 v[84:85], v27 offset:128
    v_mfma_f32_16x16x32_bf16 a[20:23], v[72:75], v[52:55], a[20:23]
    ds_read_b64_tr_b16 v[86:87], v27 offset:2432
    v_mfma_f32_16x16x32_bf16 a[24:27], v[72:75], v[56:59], a[24:27]
    v_mfma_f32_16x16x32_bf16 a[28:31], v[72:75], v[60:63], a[28:31]
    s_waitcnt vmcnt(5)
    s_barrier
    s_waitcnt lgkmcnt(4)
    v_mfma_f32_16x16x32_bf16 a[32:35], v[76:79], v[48:51], a[32:35]
    ds_read_b128 v[32:35], v24 offset:0
    ds_read_b128 v[36:39], v24 offset:1024
    ds_read_b64_tr_b16 v[88:89], v28 offset:0
    s_add_u32 m0, s26, 0
    v_mfma_f32_16x16x32_bf16 a[36:39], v[76:79], v[52:55], a[36:39]
    ds_read_b128 v[40:43], v24 offset:2048
    ds_read_b128 v[44:47], v24 offset:3072
    ds_read_b64_tr_b16 v[90:91], v28 offset:2304
    buffer_load_dwordx4 v16, s[8:11], s27 offen lds
    v_mfma_f32_16x16x32_bf16 a[40:43], v[76:79], v[56:59], a[40:43]
    s_add_u32 m0, s26, 8192
    v_mfma_f32_16x16x32_bf16 a[44:47], v[76:79], v[60:63], a[44:47]
    buffer_load_dwordx4 v17, s[8:11], s27 offen lds
    s_waitcnt lgkmcnt(8)
    v_mfma_f32_16x16x32_bf16 a[48:51], v[80:83], v[48:51], a[48:51]
    ds_read_b64_tr_b16 v[92:93], v28 offset:32
    s_add_u32 m0, s44, 0
    v_mfma_f32_16x16x32_bf16 a[52:55], v[80:83], v[52:55], a[52:55]
    ds_read_b64_tr_b16 v[94:95], v28 offset:2336
    buffer_load_dwordx4 v18, s[80:83], s28 offen lds
    v_mfma_f32_16x16x32_bf16 a[56:59], v[80:83], v[56:59], a[56:59]
    s_add_u32 m0, s45, 0
    v_mfma_f32_16x16x32_bf16 a[60:63], v[80:83], v[60:63], a[60:63]
    buffer_load_dwordx4 v19, s[84:87], s28 offen lds
    s_waitcnt lgkmcnt(8)
    v_mfma_f32_16x16x32_bf16 a[64:67], v[84:87], v[48:51], a[64:67]
    ds_read_b64_tr_b16 v[64:65], v28 offset:64
    s_add_u32 m0, s46, 0
    v_mfma_f32_16x16x32_bf16 a[68:71], v[84:87], v[52:55], a[68:71]
    ds_read_b64_tr_b16 v[66:67], v28 offset:2368
    s_mov_b64 exec, s[48:49]
    buffer_load_dwordx4 v20, s[88:91], s28 offen lds
    s_mov_b64 exec, -1
    v_mfma_f32_16x16x32_bf16 a[72:75], v[84:87], v[56:59], a[72:75]
    s_add_u32 s27, s27, 128
    s_add_u32 s28, s28, 73728
    v_mfma_f32_16x16x32_bf16 a[76:79], v[84:87], v[60:63], a[76:79]
    s_waitcnt lgkmcnt(4)
    v_mfma_f32_16x16x32_bf16 a[0:3], v[88:91], v[32:35], a[0:3]
    ds_read_b64_tr_b16 v[68:69], v28 offset:96
    v_mfma_f32_16x16x32_bf16 a[4:7], v[88:91], v[36:39], a[4:7]
    ds_read_b64_tr_b16 v[70:71], v28 offset:2400
    v_mfma_f32_16x16x32_bf16 a[8:11], v[88:91], v[40:43], a[8:11]
    v_mfma_f32_16x16x32_bf16 a[12:15], v[88:91], v[44:47], a[12:15]
    s_waitcnt lgkmcnt(4)
    v_mfma_f32_16x16x32_bf16 a[16:19], v[92:95], v[32:35], a[16:19]
    ds_read_b64_tr_b16 v[72:73], v28 offset:128
    v_mfma_f32_16x16x32_bf16 a[20:23], v[92:95], v[36:39], a[20:23]
    ds_read_b64_tr_b16 v[74:75], v28 offset:2432
    v_mfma_f32_16x16x32_bf16 a[24:27], v[92:95], v[40:43], a[24:27]
    v_mfma_f32_16x16x32_bf16 a[28:31], v[92:95], v[44:47], a[28:31]
    s_waitcnt vmcnt(5)
    s_barrier
    s_waitcnt lgkmcnt(4)
    v_mfma_f32_16x16x32_bf16 a[32:35], v[64:67], v[32:35], a[32:35]
    ds_read_b128 v[48:51], v25 offset:0
    ds_read_b128 v[52:55], v25 offset:1024
    ds_read_b64_tr_b16 v[76:77], v29 offset:0
    s_add_u32 m0, s26, 34816
    v_mfma_f32_16x16x32_bf16 a[36:39], v[64:67], v[36:39], a[36:39]
    ds_read_b128 v[56:59], v25 offset:2048
    ds_read_b128 v[60:63], v25 offset:3072
    ds_read_b64_tr_b16 v[78:79], v29 offset:2304
    buffer_load_dwordx4 v16, s[8:11], s27 offen lds
    v_mfma_f32_16x16x32_bf16 a[40:43], v[64:67], v[40:43], a[40:43]
    s_add_u32 m0, s26, 43008
    v_mfma_f32_16x16x32_bf16 a[44:47], v[64:67], v[44:47], a[44:47]
    buffer_load_dwordx4 v17, s[8:11], s27 offen lds
    s_waitcnt lgkmcnt(8)
    v_mfma_f32_16x16x32_bf16 a[48:51], v[68:71], v[32:35], a[48:51]
    ds_read_b64_tr_b16 v[80:81], v29 offset:32
    s_add_u32 m0, s44, 34816
    v_mfma_f32_16x16x32_bf16 a[52:55], v[68:71], v[36:39], a[52:55]
    ds_read_b64_tr_b16 v[82:83], v29 offset:2336
    buffer_load_dwordx4 v18, s[80:83], s28 offen lds
    v_mfma_f32_16x16x32_bf16 a[56:59], v[68:71], v[40:43], a[56:59]
    s_add_u32 m0, s45, 34816
    v_mfma_f32_16x16x32_bf16 a[60:63], v[68:71], v[44:47], a[60:63]
    buffer_load_dwordx4 v19, s[84:87], s28 offen lds
    s_waitcnt lgkmcnt(8)
    v_mfma_f32_16x16x32_bf16 a[64:67], v[72:75], v[32:35], a[64:67]
    ds_read_b64_tr_b16 v[84:85], v29 offset:64
    s_add_u32 m0, s46, 34816
    v_mfma_f32_16x16x32_bf16 a[68:71], v[72:75], v[36:39], a[68:71]
    ds_read_b64_tr_b16 v[86:87], v29 offset:2368
    s_mov_b64 exec, s[48:49]
    buffer_load_dwordx4 v20, s[88:91], s28 offen lds
    s_mov_b64 exec, -1
    v_mfma_f32_16x16x32_bf16 a[72:75], v[72:75], v[40:43], a[72:75]
    s_add_u32 s27, s27, 128
    s_add_u32 s28, s28, 73728
    v_mfma_f32_16x16x32_bf16 a[76:79], v[72:75], v[44:47], a[76:79]
    s_waitcnt lgkmcnt(4)
    v_mfma_f32_16x16x32_bf16 a[0:3], v[76:79], v[48:51], a[0:3]
    ds_read_b64_tr_b16 v[88:89], v29 offset:96
    v_mfma_f32_16x16x32_bf16 a[4:7], v[76:79], v[52:55], a[4:7]
    ds_read_b64_tr_b16 v[90:91], v29 offset:2400
    v_mfma_f32_16x16x32_bf16 a[8:11], v[76:79], v[56:59], a[8:11]
    v_mfma_f32_16x16x32_bf16 a[12:15], v[76:79], v[60:63], a[12:15]
    s_waitcnt lgkmcnt(4)
    v_mfma_f32_16x16x32_bf16 a[16:19], v[80:83], v[48:51], a[16:19]
    ds_read_b64_tr_b16 v[92:93], v29 offset:128
    v_mfma_f32_16x16x32_bf16 a[20:23], v[80:83], v[52:55], a[20:23]
    ds_read_b64_tr_b16 v[94:95], v29 offset:2432
    v_mfma_f32_16x16x32_bf16 a[24:27], v[80:83], v[56:59], a[24:27]
    v_mfma_f32_16x16x32_bf16 a[28:31], v[80:83], v[60:63], a[28:31]
    s_waitcnt vmcnt(5)
    s_barrier
    s_waitcnt lgkmcnt(4)
    v_mfma_f32_16x16x32_bf16 a[32:35], v[84:87], v[48:51], a[32:35]
    ds_read_b128 v[32:35], v22 offset:0
    ds_read_b128 v[36:39], v22 offset:1024
    ds_read_b64_tr_b16 v[64:65], v26 offset:0
    s_add_u32 m0, s26, 69632
    v_mfma_f32_16x16x32_bf16 a[36:39], v[84:87], v[52:55], a[36:39]
    ds_read_b128 v[40:43], v22 offset:2048
    ds_read_b128 v[44:47], v22 offset:3072
    ds_read_b64_tr_b16 v[66:67], v26 offset:2304
    buffer_load_dwordx4 v16, s[8:11], s27 offen lds
    v_mfma_f32_16x16x32_bf16 a[40:43], v[84:87], v[56:59], a[40:43]
    s_add_u32 m0, s26, 77824
    v_mfma_f32_16x16x32_bf16 a[44:47], v[84:87], v[60:63], a[44:47]
    buffer_load_dwordx4 v17, s[8:11], s27 offen lds
    s_waitcnt lgkmcnt(8)
    v_mfma_f32_16x16x32_bf16 a[48:51], v[88:91], v[48:51], a[48:51]
    ds_read_b64_tr_b16 v[68:69], v26 offset:32
    s_add_u32 m0, s44, 69632
    v_mfma_f32_16x16x32_bf16 a[52:55], v[88:91], v[52:55], a[52:55]
    ds_read_b64_tr_b16 v[70:71], v26 offset:2336
    buffer_load_dwordx4 v18, s[80:83], s28 offen lds
    v_mfma_f32_16x16x32_bf16 a[56:59], v[88:91], v[56:59], a[56:59]
    s_add_u32 m0, s45, 69632
    v_mfma_f32_16x16x32_bf16 a[60:63], v[88:91], v[60:63], a[60:63]
    buffer_load_dwordx4 v19, s[84:87], s28 offen lds
    s_waitcnt lgkmcnt(8)
    v_mfma_f32_16x16x32_bf16 a[64:67], v[92:95], v[48:51], a[64:67]
    ds_read_b64_tr_b16 v[72:73], v26 offset:64
    s_add_u32 m0, s46, 69632
    v_mfma_f32_16x16x32_bf16 a[68:71], v[92:95], v[52:55], a[68:71]
    ds_read_b64_tr_b16 v[74:75], v26 offset:2368
    s_mov_b64 exec, s[48:49]
    buffer_load_dwordx4 v20, s[88:91], s28 offen lds
    s_mov_b64 exec, -1
    v_mfma_f32_16x16x32_bf16 a[72:75], v[92:95], v[56:59], a[72:75]
    s_add_u32 s27, s27, 128
    s_add_u32 s28, s28, 73728
    v_mfma_f32_16x16x32_bf16 a[76:79], v[92:95], v[60:63], a[76:79]
    s_waitcnt lgkmcnt(4)
    v_mfma_f32_16x16x32_bf16 a[0:3], v[64:67], v[32:35], a[0:3]
    ds_read_b64_tr_b16 v[76:77], v26 offset:96
    v_mfma_f32_16x16x32_bf16 a[4:7], v[64:67], v[36:39], a[4:7]
    ds_read_b64_tr_b16 v[78:79], v26 offset:2400
    v_mfma_f32_16x16x32_bf16 a[8:11], v[64:67], v[40:43], a[8:11]
    v_mfma_f32_16x16x32_bf16 a[12:15], v[64:67], v[44:47], a[12:15]
    s_waitcnt lgkmcnt(4)
    v_mfma_f32_16x16x32_bf16 a[16:19], v[68:71], v[32:35], a[16:19]
    ds_read_b64_tr_b16 v[80:81], v26 offset:128
    v_mfma_f32_16x16x32_bf16 a[20:23], v[68:71], v[36:39], a[20:23]
    ds_read_b64_tr_b16 v[82:83], v26 offset:2432
    v_mfma_f32_16x16x32_bf16 a[24:27], v[68:71], v[40:43], a[24:27]
    v_mfma_f32_16x16x32_bf16 a[28:31], v[68:71], v[44:47], a[28:31]
    s_waitcnt vmcnt(5)
    s_barrier
    s_waitcnt lgkmcnt(4)
    v_mfma_f32_16x16x32_bf16 a[32:35], v[72:75], v[32:35], a[32:35]
    ds_read_b128 v[48:51], v23 offset:0
    ds_read_b128 v[52:55], v23 offset:1024
    ds_read_b64_tr_b16 v[84:85], v27 offset:0
    s_add_u32 m0, s26, 104448
    v_mfma_f32_16x16x32_bf16 a[36:39], v[72:75], v[36:39], a[36:39]
    ds_read_b128 v[56:59], v23 offset:2048
    ds_read_b128 v[60:63], v23 offset:3072
    ds_read_b64_tr_b16 v[86:87], v27 offset:2304
    buffer_load_dwordx4 v16, s[8:11], s27 offen lds
    v_mfma_f32_16x16x32_bf16 a[40:43], v[72:75], v[40:43], a[40:43]
    s_add_u32 m0, s26, 112640
    v_mfma_f32_16x16x32_bf16 a[44:47], v[72:75], v[44:47], a[44:47]
    buffer_load_dwordx4 v17, s[8:11], s27 offen lds
    s_waitcnt lgkmcnt(8)
    v_mfma_f32_16x16x32_bf16 a[48:51], v[76:79], v[32:35], a[48:51]
    ds_read_b64_tr_b16 v[88:89], v27 offset:32
    s_add_u32 m0, s44, 104448
    v_mfma_f32_16x16x32_bf16 a[52:55], v[76:79], v[36:39], a[52:55]
    ds_read_b64_tr_b16 v[90:91], v27 offset:2336
    buffer_load_dwordx4 v18, s[80:83], s28 offen lds
    v_mfma_f32_16x16x32_bf16 a[56:59], v[76:79], v[40:43], a[56:59]
    s_add_u32 m0, s45, 104448
    v_mfma_f32_16x16x32_bf16 a[60:63], v[76:79], v[44:47], a[60:63]
    buffer_load_dwordx4 v19, s[84:87], s28 offen lds
    s_waitcnt lgkmcnt(8)
    v_mfma_f32_16x16x32_bf16 a[64:67], v[80:83], v[32:35], a[64:67]
    ds_read_b64_tr_b16 v[92:93], v27 offset:64
    s_add_u32 m0, s46, 104448
    v_mfma_f32_16x16x32_bf16 a[68:71], v[80:83], v[36:39], a[68:71]
    ds_read_b64_tr_b16 v[94:95], v27 offset:2368
    s_mov_b64 exec, s[48:49]
    buffer_load_dwordx4 v20, s[88:91], s28 offen lds
    s_mov_b64 exec, -1
    v_mfma_f32_16x16x32_bf16 a[72:75], v[80:83], v[40:43], a[72:75]
    s_add_u32 s27, s27, 128
    s_add_u32 s28, s28, 73728
    v_mfma_f32_16x16x32_bf16 a[76:79], v[80:83], v[44:47], a[76:79]
    s_waitcnt lgkmcnt(4)
    v_mfma_f32_16x16x32_bf16 a[0:3], v[84:87], v[48:51], a[0:3]
    ds_read_b64_tr_b16 v[64:65], v27 offset:96
    v_mfma_f32_16x16x32_bf16 a[4:7], v[84:87], v[52:55], a[4:7]
    ds_read_b64_tr_b16 v[66:67], v27 offset:2400
    v_mfma_f32_16x16x32_bf16 a[8:11], v[84:87], v[56:59], a[8:11]
    v_mfma_f32_16x16x32_bf16 a[12:15], v[84:87], v[60:63], a[12:15]
    s_waitcnt lgkmcnt(4)
    v_mfma_f32_16x16x32_bf16 a[16:19], v[88:91], v[48:51], a[16:19]
    ds_read_b64_tr_b16 v[68:69], v27 offset:128
    v_mfma_f32_16x16x32_bf16 a[20:23], v[88:91], v[52:55], a[20:23]
    ds_read_b64_tr_b16 v[70:71], v27 offset:2432
    v_mfma_f32_16x16x32_bf16 a[24:27], v[88:91], v[56:59], a[24:27]
    v_mfma_f32_16x16x32_bf16 a[28:31], v[88:91], v[60:63], a[28:31]
    s_waitcnt vmcnt(5)
    s_barrier
    s_waitcnt lgkmcnt(4)
    v_mfma_f32_16x16x32_bf16 a[32:35], v[92:95], v[48:51], a[32:35]
    ds_read_b128 v[32:35], v24 offset:0
    ds_read_b128 v[36:39], v24 offset:1024
    ds_read_b64_tr_b16 v[72:73], v28 offset:0
    s_add_u32 m0, s26, 0
    v_mfma_f32_16x16x32_bf16 a[36:39], v[92:95], v[52:55], a[36:39]
    ds_read_b128 v[40:43], v24 offset:2048
    ds_read_b128 v[44:47], v24 offset:3072
    ds_read_b64_tr_b16 v[74:75], v28 offset:2304
    buffer_load_dwordx4 v16, s[8:11], s27 offen lds
    v_mfma_f32_16x16x32_bf16 a[40:43], v[92:95], v[56:59], a[40:43]
    s_add_u32 m0, s26, 8192
    v_mfma_f32_16x16x32_bf16 a[44:47], v[92:95], v[60:63], a[44:47]
    buffer_load_dwordx4 v17, s[8:11], s27 offen lds
    s_waitcnt lgkmcnt(8)
    v_mfma_f32_16x16x32_bf16 a[48:51], v[64:67], v[48:51], a[48:51]
    ds_read_b64_tr_b16 v[76:77], v28 offset:32
    s_add_u32 m0, s44, 0
    v_mfma_f32_16x16x32_bf16 a[52:55], v[64:67], v[52:55], a[52:55]
    ds_read_b64_tr_b16 v[78:79], v28 offset:2336
    buffer_load_dwordx4 v18, s[80:83], s28 offen lds
    v_mfma_f32_16x16x32_bf16 a[56:59], v[64:67], v[56:59], a[56:59]
    s_add_u32 m0, s45, 0
    v_mfma_f32_16x16x32_bf16 a[60:63], v[64:67], v[60:63], a[60:63]
    buffer_load_dwordx4 v19, s[84:87], s28 offen lds
    s_waitcnt lgkmcnt(8)
    v_mfma_f32_16x16x32_bf16 a[64:67], v[68:71], v[48:51], a[64:67]
    ds_read_b64_tr_b16 v[80:81], v28 offset:64
    s_add_u32 m0, s46, 0
    v_mfma_f32_16x16x32_bf16 a[68:71], v[68:71], v[52:55], a[68:71]
    ds_read_b64_tr_b16 v[82:83], v28 offset:2368
    s_mov_b64 exec, s[48:49]
    buffer_load_dwordx4 v20, s[88:91], s28 offen lds
    s_mov_b64 exec, -1
    v_mfma_f32_16x16x32_bf16 a[72:75], v[68:71], v[56:59], a[72:75]
    s_add_u32 s27, s27, 128
    s_add_u32 s28, s28, 73728
    v_mfma_f32_16x16x32_bf16 a[76:79], v[68:71], v[60:63], a[76:79]
    s_waitcnt lgkmcnt(4)
    v_mfma_f32_16x16x32_bf16 a[0:3], v[72:75], v[32:35], a[0:3]
    ds_read_b64_tr_b16 v[84:85], v28 offset:96
    v_mfma_f32_16x16x32_bf16 a[4:7], v[72:75], v[36:39], a[4:7]
    ds_read_b64_tr_b16 v[86:87], v28 offset:2400
    v_mfma_f32_16x16x32_bf16 a[8:11], v[72:75], v[40:43], a[8:11]
    v_mfma_f32_16x16x32_bf16 a[12:15], v[72:75], v[44:47], a[12:15]
    s_waitcnt lgkmcnt(4)
    v_mfma_f32_16x16x32_bf16 a[16:19], v[76:79], v[32:35], a[16:19]
    ds_read_b64_tr_b16 v[88:89], v28 offset:128
    v_mfma_f32_16x16x32_bf16 a[20:23], v[76:79], v[36:39], a[20:23]
    ds_read_b64_tr_b16 v[90:91], v28 offset:2432
    v_mfma_f32_16x16x32_bf16 a[24:27], v[76:79], v[40:43], a[24:27]
    v_mfma_f32_16x16x32_bf16 a[28:31], v[76:79], v[44:47], a[28:31]
    s_waitcnt vmcnt(5)
    s_barrier
    s_waitcnt lgkmcnt(4)
    v_mfma_f32_16x16x32_bf16 a[32:35], v[80:83], v[32:35], a[32:35]
    ds_read_b128 v[48:51], v25 offset:0
    ds_read_b128 v[52:55], v25 offset:1024
    ds_read_b64_tr_b16 v[92:93], v29 offset:0
    s_add_u32 m0, s26, 34816
    v_mfma_f32_16x16x32_bf16 a[36:39], v[80:83], v[36:39], a[36:39]
    ds_read_b128 v[56:59], v25 offset:2048
    ds_read_b128 v[60:63], v25 offset:3072
    ds_read_b64_tr_b16 v[94:95], v29 offset:2304
    buffer_load_dwordx4 v16, s[8:11], s27 offen lds
    v_mfma_f32_16x16x32_bf16 a[40:43], v[80:83], v[40:43], a[40:43]
    s_add_u32 m0, s26, 43008
    v_mfma_f32_16x16x32_bf16 a[44:47], v[80:83], v[44:47], a[44:47]
    buffer_load_dwordx4 v17, s[8:11], s27 offen lds
    s_waitcnt lgkmcnt(8)
    v_mfma_f32_16x16x32_bf16 a[48:51], v[84:87], v[32:35], a[48:51]
    ds_read_b64_tr_b16 v[64:65], v29 offset:32
    s_add_u32 m0, s44, 34816
    v_mfma_f32_16x16x32_bf16 a[52:55], v[84:87], v[36:39], a[52:55]
    ds_read_b64_tr_b16 v[66:67], v29 offset:2336
    buffer_load_dwordx4 v18, s[80:83], s28 offen lds
    v_mfma_f32_16x16x32_bf16 a[56:59], v[84:87], v[40:43], a[56:59]
    s_add_u32 m0, s45, 34816
    v_mfma_f32_16x16x32_bf16 a[60:63], v[84:87], v[44:47], a[60:63]
    buffer_load_dwordx4 v19, s[84:87], s28 offen lds
    s_waitcnt lgkmcnt(8)
    v_mfma_f32_16x16x32_bf16 a[64:67], v[88:91], v[32:35], a[64:67]
    ds_read_b64_tr_b16 v[68:69], v29 offset:64
    s_add_u32 m0, s46, 34816
    v_mfma_f32_16x16x32_bf16 a[68:71], v[88:91], v[36:39], a[68:71]
    ds_read_b64_tr_b16 v[70:71], v29 offset:2368
    s_mov_b64 exec, s[48:49]
    buffer_load_dwordx4 v20, s[88:91], s28 offen lds
    s_mov_b64 exec, -1
    v_mfma_f32_16x16x32_bf16 a[72:75], v[88:91], v[40:43], a[72:75]
    s_add_u32 s27, s27, 128
    s_add_u32 s28, s28, 73728
    v_mfma_f32_16x16x32_bf16 a[76:79], v[88:91], v[44:47], a[76:79]
    s_waitcnt lgkmcnt(4)
    v_mfma_f32_16x16x32_bf16 a[0:3], v[92:95], v[48:51], a[0:3]
    ds_read_b64_tr_b16 v[72:73], v29 offset:96
    v_mfma_f32_16x16x32_bf16 a[4:7], v[92:95], v[52:55], a[4:7]
    ds_read_b64_tr_b16 v[74:75], v29 offset:2400
    v_mfma_f32_16x16x32_bf16 a[8:11], v[92:95], v[56:59], a[8:11]
    v_mfma_f32_16x16x32_bf16 a[12:15], v[92:95], v[60:63], a[12:15]
    s_waitcnt lgkmcnt(4)
    v_mfma_f32_16x16x32_bf16 a[16:19], v[64:67], v[48:51], a[16:19]
    ds_read_b64_tr_b16 v[76:77], v29 offset:128
    v_mfma_f32_16x16x32_bf16 a[20:23], v[64:67], v[52:55], a[20:23]
    ds_read_b64_tr_b16 v[78:79], v29 offset:2432
    v_mfma_f32_16x16x32_bf16 a[24:27], v[64:67], v[56:59], a[24:27]
    v_mfma_f32_16x16x32_bf16 a[28:31], v[64:67], v[60:63], a[28:31]
    s_waitcnt vmcnt(5)
    s_barrier
    s_waitcnt lgkmcnt(4)
    v_mfma_f32_16x16x32_bf16 a[32:35], v[68:71], v[48:51], a[32:35]
    ds_read_b128 v[32:35], v22 offset:0
    ds_read_b128 v[36:39], v22 offset:1024
    ds_read_b64_tr_b16 v[80:81], v26 offset:0
    s_add_u32 m0, s26, 69632
    v_mfma_f32_16x16x32_bf16 a[36:39], v[68:71], v[52:55], a[36:39]
    ds_read_b128 v[40:43], v22 offset:2048
    ds_read_b128 v[44:47], v22 offset:3072
    ds_read_b64_tr_b16 v[82:83], v26 offset:2304
    buffer_load_dwordx4 v16, s[8:11], s27 offen lds
    v_mfma_f32_16x16x32_bf16 a[40:43], v[68:71], v[56:59], a[40:43]
    s_add_u32 m0, s26, 77824
    v_mfma_f32_16x16x32_bf16 a[44:47], v[68:71], v[60:63], a[44:47]
    buffer_load_dwordx4 v17, s[8:11], s27 offen lds
    s_waitcnt lgkmcnt(8)
    v_mfma_f32_16x16x32_bf16 a[48:51], v[72:75], v[48:51], a[48:51]
    ds_read_b64_tr_b16 v[84:85], v26 offset:32
    s_add_u32 m0, s44, 69632
    v_mfma_f32_16x16x32_bf16 a[52:55], v[72:75], v[52:55], a[52:55]
    ds_read_b64_tr_b16 v[86:87], v26 offset:2336
    buffer_load_dwordx4 v18, s[80:83], s28 offen lds
    v_mfma_f32_16x16x32_bf16 a[56:59], v[72:75], v[56:59], a[56:59]
    s_add_u32 m0, s45, 69632
    v_mfma_f32_16x16x32_bf16 a[60:63], v[72:75], v[60:63], a[60:63]
    buffer_load_dwordx4 v19, s[84:87], s28 offen lds
    s_waitcnt lgkmcnt(8)
    v_mfma_f32_16x16x32_bf16 a[64:67], v[76:79], v[48:51], a[64:67]
    ds_read_b64_tr_b16 v[88:89], v26 offset:64
    s_add_u32 m0, s46, 69632
    v_mfma_f32_16x16x32_bf16 a[68:71], v[76:79], v[52:55], a[68:71]
    ds_read_b64_tr_b16 v[90:91], v26 offset:2368
    s_mov_b64 exec, s[48:49]
    buffer_load_dwordx4 v20, s[88:91], s28 offen lds
    s_mov_b64 exec, -1
    v_mfma_f32_16x16x32_bf16 a[72:75], v[76:79], v[56:59], a[72:75]
    s_add_u32 s27, s27, 128
    s_add_u32 s28, s28, 73728
    v_mfma_f32_16x16x32_bf16 a[76:79], v[76:79], v[60:63], a[76:79]
    s_waitcnt lgkmcnt(4)
    v_mfma_f32_16x16x32_bf16 a[0:3], v[80:83], v[32:35], a[0:3]
    ds_read_b64_tr_b16 v[92:93], v26 offset:96
    v_mfma_f32_16x16x32_bf16 a[4:7], v[80:83], v[36:39], a[4:7]
    ds_read_b64_tr_b16 v[94:95], v26 offset:2400
    v_mfma_f32_16x16x32_bf16 a[8:11], v[80:83], v[40:43], a[8:11]
    v_mfma_f32_16x16x32_bf16 a[12:15], v[80:83], v[44:47], a[12:15]
    s_waitcnt lgkmcnt(4)
    v_mfma_f32_16x16x32_bf16 a[16:19], v[84:87], v[32:35], a[16:19]
    ds_read_b64_tr_b16 v[64:65], v26 offset:128
    v_mfma_f32_16x16x32_bf16 a[20:23], v[84:87], v[36:39], a[20:23]
    ds_read_b64_tr_b16 v[66:67], v26 offset:2432
    v_mfma_f32_16x16x32_bf16 a[24:27], v[84:87], v[40:43], a[24:27]
    v_mfma_f32_16x16x32_bf16 a[28:31], v[84:87], v[44:47], a[28:31]
    s_waitcnt vmcnt(5)
    s_barrier
    s_waitcnt lgkmcnt(4)
    v_mfma_f32_16x16x32_bf16 a[32:35], v[88:91], v[32:35], a[32:35]
    ds_read_b128 v[48:51], v23 offset:0
    ds_read_b128 v[52:55], v23 offset:1024
    ds_read_b64_tr_b16 v[68:69], v27 offset:0
    s_add_u32 m0, s26, 104448
    v_mfma_f32_16x16x32_bf16 a[36:39], v[88:91], v[36:39], a[36:39]
    ds_read_b128 v[56:59], v23 offset:2048
    ds_read_b128 v[60:63], v23 offset:3072
    ds_read_b64_tr_b16 v[70:71], v27 offset:2304
    buffer_load_dwordx4 v16, s[8:11], s27 offen lds
    v_mfma_f32_16x16x32_bf16 a[40:43], v[88:91], v[40:43], a[40:43]
    s_add_u32 m0, s26, 112640
    v_mfma_f32_16x16x32_bf16 a[44:47], v[88:91], v[44:47], a[44:47]
    buffer_load_dwordx4 v17, s[8:11], s27 offen lds
    s_waitcnt lgkmcnt(8)
    v_mfma_f32_16x16x32_bf16 a[48:51], v[92:95], v[32:35], a[48:51]
    ds_read_b64_tr_b16 v[72:73], v27 offset:32
    s_add_u32 m0, s44, 104448
    v_mfma_f32_16x16x32_bf16 a[52:55], v[92:95], v[36:39], a[52:55]
    ds_read_b64_tr_b16 v[74:75], v27 offset:2336
    buffer_load_dwordx4 v18, s[80:83], s28 offen lds
    v_mfma_f32_16x16x32_bf16 a[56:59], v[92:95], v[40:43], a[56:59]
    s_add_u32 m0, s45, 104448
    v_mfma_f32_16x16x32_bf16 a[60:63], v[92:95], v[44:47], a[60:63]
    buffer_load_dwordx4 v19, s[84:87], s28 offen lds
    s_waitcnt lgkmcnt(8)
    v_mfma_f32_16x16x32_bf16 a[64:67], v[64:67], v[32:35], a[64:67]
    ds_read_b64_tr_b16 v[76:77], v27 offset:64
    s_add_u32 m0, s46, 104448
    v_mfma_f32_16x16x32_bf16 a[68:71], v[64:67], v[36:39], a[68:71]
    ds_read_b64_tr_b16 v[78:79], v27 offset:2368
    s_mov_b64 exec, s[48:49]
    buffer_load_dwordx4 v20, s[88:91], s28 offen lds
    s_mov_b64 exec, -1
    v_mfma_f32_16x16x32_bf16 a[72:75], v[64:67], v[40:43], a[72:75]
    s_add_u32 s27, s27, 128
    s_add_u32 s28, s28, 73728
    v_mfma_f32_16x16x32_bf16 a[76:79], v[64:67], v[44:47], a[76:79]
    s_waitcnt lgkmcnt(4)
    v_mfma_f32_16x16x32_bf16 a[0:3], v[68:71], v[48:51], a[0:3]
    ds_read_b64_tr_b16 v[80:81], v27 offset:96
    v_mfma_f32_16x16x32_bf16 a[4:7], v[68:71], v[52:55], a[4:7]
    ds_read_b64_tr_b16 v[82:83], v27 offset:2400
    v_mfma_f32_16x16x32_bf16 a[8:11], v[68:71], v[56:59], a[8:11]
    v_mfma_f32_16x16x32_bf16 a[12:15], v[68:71], v[60:63], a[12:15]
    s_waitcnt lgkmcnt(4)
    v_mfma_f32_16x16x32_bf16 a[16:19], v[72:75], v[48:51], a[16:19]
    ds_read_b64_tr_b16 v[84:85], v27 offset:128
    v_mfma_f32_16x16x32_bf16 a[20:23], v[72:75], v[52:55], a[20:23]
    ds_read_b64_tr_b16 v[86:87], v27 offset:2432
    v_mfma_f32_16x16x32_bf16 a[24:27], v[72:75], v[56:59], a[24:27]
    v_mfma_f32_16x16x32_bf16 a[28:31], v[72:75], v[60:63], a[28:31]
    s_waitcnt vmcnt(5)
    s_barrier
    s_waitcnt lgkmcnt(4)
    v_mfma_f32_16x16x32_bf16 a[32:35], v[76:79], v[48:51], a[32:35]
    ds_read_b128 v[32:35], v24 offset:0
    ds_read_b128 v[36:39], v24 offset:1024
    ds_read_b64_tr_b16 v[88:89], v28 offset:0
    s_add_u32 m0, s26, 0
    v_mfma_f32_16x16x32_bf16 a[36:39], v[76:79], v[52:55], a[36:39]
    ds_read_b128 v[40:43], v24 offset:2048
    ds_read_b128 v[44:47], v24 offset:3072
    ds_read_b64_tr_b16 v[90:91], v28 offset:2304
    buffer_load_dwordx4 v16, s[8:11], s27 offen lds
    v_mfma_f32_16x16x32_bf16 a[40:43], v[76:79], v[56:59], a[40:43]
    s_add_u32 m0, s26, 8192
    v_mfma_f32_16x16x32_bf16 a[44:47], v[76:79], v[60:63], a[44:47]
    buffer_load_dwordx4 v17, s[8:11], s27 offen lds
    s_waitcnt lgkmcnt(8)
    v_mfma_f32_16x16x32_bf16 a[48:51], v[80:83], v[48:51], a[48:51]
    ds_read_b64_tr_b16 v[92:93], v28 offset:32
    s_add_u32 m0, s44, 0
    v_mfma_f32_16x16x32_bf16 a[52:55], v[80:83], v[52:55], a[52:55]
    ds_read_b64_tr_b16 v[94:95], v28 offset:2336
    buffer_load_dwordx4 v18, s[80:83], s28 offen lds
    v_mfma_f32_16x16x32_bf16 a[56:59], v[80:83], v[56:59], a[56:59]
    s_add_u32 m0, s45, 0
    v_mfma_f32_16x16x32_bf16 a[60:63], v[80:83], v[60:63], a[60:63]
    buffer_load_dwordx4 v19, s[84:87], s28 offen lds
    s_waitcnt lgkmcnt(8)
    v_mfma_f32_16x16x32_bf16 a[64:67], v[84:87], v[48:51], a[64:67]
    ds_read_b64_tr_b16 v[64:65], v28 offset:64
    s_add_u32 m0, s46, 0
    v_mfma_f32_16x16x32_bf16 a[68:71], v[84:87], v[52:55], a[68:71]
    ds_read_b64_tr_b16 v[66:67], v28 offset:2368
    s_mov_b64 exec, s[48:49]
    buffer_load_dwordx4 v20, s[88:91], s28 offen lds
    s_mov_b64 exec, -1
    v_mfma_f32_16x16x32_bf16 a[72:75], v[84:87], v[56:59], a[72:75]
    s_add_u32 s27, s27, 128
    s_add_u32 s28, s28, 73728
    v_mfma_f32_16x16x32_bf16 a[76:79], v[84:87], v[60:63], a[76:79]
    s_waitcnt lgkmcnt(4)
    v_mfma_f32_16x16x32_bf16 a[0:3], v[88:91], v[32:35], a[0:3]
    ds_read_b64_tr_b16 v[68:69], v28 offset:96
    v_mfma_f32_16x16x32_bf16 a[4:7], v[88:91], v[36:39], a[4:7]
    ds_read_b64_tr_b16 v[70:71], v28 offset:2400
    v_mfma_f32_16x16x32_bf16 a[8:11], v[88:91], v[40:43], a[8:11]
    v_mfma_f32_16x16x32_bf16 a[12:15], v[88:91], v[44:47], a[12:15]
    s_waitcnt lgkmcnt(4)
    v_mfma_f32_16x16x32_bf16 a[16:19], v[92:95], v[32:35], a[16:19]
    ds_read_b64_tr_b16 v[72:73], v28 offset:128
    v_mfma_f32_16x16x32_bf16 a[20:23], v[92:95], v[36:39], a[20:23]
    ds_read_b64_tr_b16 v[74:75], v28 offset:2432
    v_mfma_f32_16x16x32_bf16 a[24:27], v[92:95], v[40:43], a[24:27]
    v_mfma_f32_16x16x32_bf16 a[28:31], v[92:95], v[44:47], a[28:31]
    s_waitcnt vmcnt(5)
    s_barrier
    s_waitcnt lgkmcnt(4)
    v_mfma_f32_16x16x32_bf16 a[32:35], v[64:67], v[32:35], a[32:35]
    ds_read_b128 v[48:51], v25 offset:0
    ds_read_b128 v[52:55], v25 offset:1024
    ds_read_b64_tr_b16 v[76:77], v29 offset:0
    s_add_u32 m0, s26, 34816
    v_mfma_f32_16x16x32_bf16 a[36:39], v[64:67], v[36:39], a[36:39]
    ds_read_b128 v[56:59], v25 offset:2048
    ds_read_b128 v[60:63], v25 offset:3072
    ds_read_b64_tr_b16 v[78:79], v29 offset:2304
    buffer_load_dwordx4 v16, s[8:11], s27 offen lds
    v_mfma_f32_16x16x32_bf16 a[40:43], v[64:67], v[40:43], a[40:43]
    s_add_u32 m0, s26, 43008
    v_mfma_f32_16x16x32_bf16 a[44:47], v[64:67], v[44:47], a[44:47]
    buffer_load_dwordx4 v17, s[8:11], s27 offen lds
    s_waitcnt lgkmcnt(8)
    v_mfma_f32_16x16x32_bf16 a[48:51], v[68:71], v[32:35], a[48:51]
    ds_read_b64_tr_b16 v[80:81], v29 offset:32
    s_add_u32 m0, s44, 34816
    v_mfma_f32_16x16x32_bf16 a[52:55], v[68:71], v[36:39], a[52:55]
    ds_read_b64_tr_b16 v[82:83], v29 offset:2336
    buffer_load_dwordx4 v18, s[80:83], s28 offen lds
    v_mfma_f32_16x16x32_bf16 a[56:59], v[68:71], v[40:43], a[56:59]
    s_add_u32 m0, s45, 34816
    v_mfma_f32_16x16x32_bf16 a[60:63], v[68:71], v[44:47], a[60:63]
    buffer_load_dwordx4 v19, s[84:87], s28 offen lds
    s_waitcnt lgkmcnt(8)
    v_mfma_f32_16x16x32_bf16 a[64:67], v[72:75], v[32:35], a[64:67]
    ds_read_b64_tr_b16 v[84:85], v29 offset:64
    s_add_u32 m0, s46, 34816
    v_mfma_f32_16x16x32_bf16 a[68:71], v[72:75], v[36:39], a[68:71]
    ds_read_b64_tr_b16 v[86:87], v29 offset:2368
    s_mov_b64 exec, s[48:49]
    buffer_load_dwordx4 v20, s[88:91], s28 offen lds
    s_mov_b64 exec, -1
    v_mfma_f32_16x16x32_bf16 a[72:75], v[72:75], v[40:43], a[72:75]
    s_add_u32 s27, s27, 128
    s_add_u32 s28, s28, 73728
    v_mfma_f32_16x16x32_bf16 a[76:79], v[72:75], v[44:47], a[76:79]
    s_waitcnt lgkmcnt(4)
    v_mfma_f32_16x16x32_bf16 a[0:3], v[76:79], v[48:51], a[0:3]
    ds_read_b64_tr_b16 v[88:89], v29 offset:96
    v_mfma_f32_16x16x32_bf16 a[4:7], v[76:79], v[52:55], a[4:7]
    ds_read_b64_tr_b16 v[90:91], v29 offset:2400
    v_mfma_f32_16x16x32_bf16 a[8:11], v[76:79], v[56:59], a[8:11]
    v_mfma_f32_16x16x32_bf16 a[12:15], v[76:79], v[60:63], a[12:15]
    s_waitcnt lgkmcnt(4)
    v_mfma_f32_16x16x32_bf16 a[16:19], v[80:83], v[48:51], a[16:19]
    ds_read_b64_tr_b16 v[92:93], v29 offset:128
    v_mfma_f32_16x16x32_bf16 a[20:23], v[80:83], v[52:55], a[20:23]
    ds_read_b64_tr_b16 v[94:95], v29 offset:2432
    v_mfma_f32_16x16x32_bf16 a[24:27], v[80:83], v[56:59], a[24:27]
    v_mfma_f32_16x16x32_bf16 a[28:31], v[80:83], v[60:63], a[28:31]
    s_waitcnt vmcnt(5)
    s_barrier
    s_waitcnt lgkmcnt(4)
    v_mfma_f32_16x16x32_bf16 a[32:35], v[84:87], v[48:51], a[32:35]
    ds_read_b128 v[32:35], v22 offset:0
    ds_read_b128 v[36:39], v22 offset:1024
    ds_read_b64_tr_b16 v[64:65], v26 offset:0
    v_mfma_f32_16x16x32_bf16 a[36:39], v[84:87], v[52:55], a[36:39]
    ds_read_b128 v[40:43], v22 offset:2048
    ds_read_b128 v[44:47], v22 offset:3072
    ds_read_b64_tr_b16 v[66:67], v26 offset:2304
    v_mfma_f32_16x16x32_bf16 a[40:43], v[84:87], v[56:59], a[40:43]
    v_mfma_f32_16x16x32_bf16 a[44:47], v[84:87], v[60:63], a[44:47]
    s_waitcnt lgkmcnt(8)
    v_mfma_f32_16x16x32_bf16 a[48:51], v[88:91], v[48:51], a[48:51]
    ds_read_b64_tr_b16 v[68:69], v26 offset:32
    v_mfma_f32_16x16x32_bf16 a[52:55], v[88:91], v[52:55], a[52:55]
    ds_read_b64_tr_b16 v[70:71], v26 offset:2336
    v_mfma_f32_16x16x32_bf16 a[56:59], v[88:91], v[56:59], a[56:59]
    v_mfma_f32_16x16x32_bf16 a[60:63], v[88:91], v[60:63], a[60:63]
    s_waitcnt lgkmcnt(8)
    v_mfma_f32_16x16x32_bf16 a[64:67], v[92:95], v[48:51], a[64:67]
    ds_read_b64_tr_b16 v[72:73], v26 offset:64
    v_mfma_f32_16x16x32_bf16 a[68:71], v[92:95], v[52:55], a[68:71]
    ds_read_b64_tr_b16 v[74:75], v26 offset:2368
    v_mfma_f32_16x16x32_bf16 a[72:75], v[92:95], v[56:59], a[72:75]
    v_mfma_f32_16x16x32_bf16 a[76:79], v[92:95], v[60:63], a[76:79]
    s_waitcnt lgkmcnt(4)
    v_mfma_f32_16x16x32_bf16 a[0:3], v[64:67], v[32:35], a[0:3]
    ds_read_b64_tr_b16 v[76:77], v26 offset:96
    v_mfma_f32_16x16x32_bf16 a[4:7], v[64:67], v[36:39], a[4:7]
    ds_read_b64_tr_b16 v[78:79], v26 offset:2400
    v_mfma_f32_16x16x32_bf16 a[8:11], v[64:67], v[40:43], a[8:11]
    v_mfma_f32_16x16x32_bf16 a[12:15], v[64:67], v[44:47], a[12:15]
    s_waitcnt lgkmcnt(4)
    v_mfma_f32_16x16x32_bf16 a[16:19], v[68:71], v[32:35], a[16:19]
    ds_read_b64_tr_b16 v[80:81], v26 offset:128
    v_mfma_f32_16x16x32_bf16 a[20:23], v[68:71], v[36:39], a[20:23]
    ds_read_b64_tr_b16 v[82:83], v26 offset:2432
    v_mfma_f32_16x16x32_bf16 a[24:27], v[68:71], v[40:43], a[24:27]
    v_mfma_f32_16x16x32_bf16 a[28:31], v[68:71], v[44:47], a[28:31]
    s_waitcnt vmcnt(0)
    s_barrier
    s_waitcnt lgkmcnt(4)
    v_mfma_f32_16x16x32_bf16 a[32:35], v[72:75], v[32:35], a[32:35]
    ds_read_b128 v[48:51], v23 offset:0
    ds_read_b128 v[52:55], v23 offset:1024
    ds_read_b64_tr_b16 v[84:85], v27 offset:0
    v_mfma_f32_16x16x32_bf16 a[36:39], v[72:75], v[36:39], a[36:39]
    ds_read_b128 v[56:59], v23 offset:2048
    ds_read_b128 v[60:63], v23 offset:3072
    ds_read_b64_tr_b16 v[86:87], v27 offset:2304
    v_mfma_f32_16x16x32_bf16 a[40:43], v[72:75], v[40:43], a[40:43]
    v_mfma_f32_16x16x32_bf16 a[44:47], v[72:75], v[44:47], a[44:47]
    s_waitcnt lgkmcnt(8)
    v_mfma_f32_16x16x32_bf16 a[48:51], v[76:79], v[32:35], a[48:51]
    ds_read_b64_tr_b16 v[88:89], v27 offset:32
    v_mfma_f32_16x16x32_bf16 a[52:55], v[76:79], v[36:39], a[52:55]
    ds_read_b64_tr_b16 v[90:91], v27 offset:2336
    v_mfma_f32_16x16x32_bf16 a[56:59], v[76:79], v[40:43], a[56:59]
    v_mfma_f32_16x16x32_bf16 a[60:63], v[76:79], v[44:47], a[60:63]
    s_waitcnt lgkmcnt(8)
    v_mfma_f32_16x16x32_bf16 a[64:67], v[80:83], v[32:35], a[64:67]
    ds_read_b64_tr_b16 v[92:93], v27 offset:64
    v_mfma_f32_16x16x32_bf16 a[68:71], v[80:83], v[36:39], a[68:71]
    ds_read_b64_tr_b16 v[94:95], v27 offset:2368
    v_mfma_f32_16x16x32_bf16 a[72:75], v[80:83], v[40:43], a[72:75]
    v_mfma_f32_16x16x32_bf16 a[76:79], v[80:83], v[44:47], a[76:79]
    s_waitcnt lgkmcnt(4)
    v_mfma_f32_16x16x32_bf16 a[0:3], v[84:87], v[48:51], a[0:3]
    ds_read_b64_tr_b16 v[64:65], v27 offset:96
    v_mfma_f32_16x16x32_bf16 a[4:7], v[84:87], v[52:55], a[4:7]
    ds_read_b64_tr_b16 v[66:67], v27 offset:2400
    v_mfma_f32_16x16x32_bf16 a[8:11], v[84:87], v[56:59], a[8:11]
    v_mfma_f32_16x16x32_bf16 a[12:15], v[84:87], v[60:63], a[12:15]
    s_waitcnt lgkmcnt(4)
    v_mfma_f32_16x16x32_bf16 a[16:19], v[88:91], v[48:51], a[16:19]
    ds_read_b64_tr_b16 v[68:69], v27 offset:128
    v_mfma_f32_16x16x32_bf16 a[20:23], v[88:91], v[52:55], a[20:23]
    ds_read_b64_tr_b16 v[70:71], v27 offset:2432
    v_mfma_f32_16x16x32_bf16 a[24:27], v[88:91], v[56:59], a[24:27]
    v_mfma_f32_16x16x32_bf16 a[28:31], v[88:91], v[60:63], a[28:31]
    s_waitcnt lgkmcnt(4)
    v_mfma_f32_16x16x32_bf16 a[32:35], v[92:95], v[48:51], a[32:35]
    v_mfma_f32_16x16x32_bf16 a[36:39], v[92:95], v[52:55], a[36:39]
    v_mfma_f32_16x16x32_bf16 a[40:43], v[92:95], v[56:59], a[40:43]
    v_mfma_f32_16x16x32_bf16 a[44:47], v[92:95], v[60:63], a[44:47]
    s_waitcnt lgkmcnt(2)
    v_mfma_f32_16x16x32_bf16 a[48:51], v[64:67], v[48:51], a[48:51]
    v_mfma_f32_16x16x32_bf16 a[52:55], v[64:67], v[52:55], a[52:55]
    v_mfma_f32_16x16x32_bf16 a[56:59], v[64:67], v[56:59], a[56:59]
    v_mfma_f32_16x16x32_bf16 a[60:63], v[64:67], v[60:63], a[60:63]
    s_waitcnt lgkmcnt(0)
    v_mfma_f32_16x16x32_bf16 a[64:67], v[68:71], v[48:51], a[64:67]
    v_mfma_f32_16x16x32_bf16 a[68:71], v[68:71], v[52:55], a[68:71]
    v_mfma_f32_16x16x32_bf16 a[72:75], v[68:71], v[56:59], a[72:75]
    v_mfma_f32_16x16x32_bf16 a[76:79], v[68:71], v[60:63], a[76:79]
    s_nop 15
    s_waitcnt vmcnt(0) lgkmcnt(0)
    s_add_u32 s40, s4, 49152
    s_addc_u32 s41, s5, 0
    s_mov_b32 s42, 16384
    s_mov_b32 s43, 0x00020000
    s_lshr_b32 s32, s25, 7
    s_lshl_b32 s32, s32, 8
    s_barrier
    v_lshlrev_b32 v8, 4, v2
    s_xor_b32 s30, s3, 2
    s_mul_i32 s30, s30, 10240
    s_mul_i32 s31, s3, 10240
    v_add_u32 v7, s30, v8
    v_add_u32 v8, s31, v8
    s_cmp_eq_u32 s22, 0
    s_cbranch_scc1 .down_kernel_end_p0_w0
    ds_write_b128 v7, a[0:3] offset:0
    ds_write_b128 v7, a[16:19] offset:1024
    ds_write_b128 v7, a[32:35] offset:2048
    ds_write_b128 v7, a[48:51] offset:3072
    ds_write_b128 v7, a[64:67] offset:4096
    ds_write_b128 v7, a[4:7] offset:5120
    ds_write_b128 v7, a[20:23] offset:6144
    ds_write_b128 v7, a[36:39] offset:7168
    ds_write_b128 v7, a[52:55] offset:8192
    ds_write_b128 v7, a[68:71] offset:9216
    s_branch .down_kernel_end_p0_w1
.down_kernel_end_p0_w0:
    ds_write_b128 v7, a[8:11] offset:0
    ds_write_b128 v7, a[24:27] offset:1024
    ds_write_b128 v7, a[40:43] offset:2048
    ds_write_b128 v7, a[56:59] offset:3072
    ds_write_b128 v7, a[72:75] offset:4096
    ds_write_b128 v7, a[12:15] offset:5120
    ds_write_b128 v7, a[28:31] offset:6144
    ds_write_b128 v7, a[44:47] offset:7168
    ds_write_b128 v7, a[60:63] offset:8192
    ds_write_b128 v7, a[76:79] offset:9216
.down_kernel_end_p0_w1:
    s_add_u32 s12, s4, 62914560
    s_addc_u32 s13, s5, 0
    s_mov_b32 s14, 9437184
    s_mov_b32 s15, 0x00020000
    s_lshl_b32 s30, s21, 6
    s_add_u32 s30, s30, s25
    s_lshl_b32 s31, s22, 5
    s_add_u32 s30, s30, s31
    s_lshl_b32 s31, s23, 11
    s_add_u32 s30, s30, s31
    v_add_u32 v12, s30, v3
    s_movk_i32 s31, 1152
    v_mul_lo_u32 v12, v12, s31
    s_mul_i32 s29, s24, 288
    v_add_u32 v12, s29, v12
    v_and_b32 v9, 1, v4
    v_lshrrev_b32 v10, 1, v4
    v_lshlrev_b32 v9, 5, v9
    v_lshl_add_u32 v9, v10, 4, v9
    v_add_u32 v9, v12, v9
    v_lshl_add_u32 v10, v4, 3, v12
    s_waitcnt lgkmcnt(0)
    s_barrier
    ds_read_b128 v[32:35], v8 offset:0
    ds_read_b128 v[36:39], v8 offset:1024
    ds_read_b128 v[40:43], v8 offset:2048
    ds_read_b128 v[44:47], v8 offset:3072
    ds_read_b128 v[48:51], v8 offset:4096
    ds_read_b128 v[52:55], v8 offset:5120
    ds_read_b128 v[56:59], v8 offset:6144
    ds_read_b128 v[60:63], v8 offset:7168
    ds_read_b128 v[64:67], v8 offset:8192
    ds_read_b128 v[68:71], v8 offset:9216
    s_cmp_eq_u32 s22, 0
    s_cbranch_scc1 .down_kernel_end_p0_a0
    v_accvgpr_read_b32 v80, a8
    v_accvgpr_read_b32 v81, a9
    v_accvgpr_read_b32 v82, a10
    v_accvgpr_read_b32 v83, a11
    v_accvgpr_read_b32 v84, a24
    v_accvgpr_read_b32 v85, a25
    v_accvgpr_read_b32 v86, a26
    v_accvgpr_read_b32 v87, a27
    v_accvgpr_read_b32 v88, a40
    v_accvgpr_read_b32 v89, a41
    v_accvgpr_read_b32 v90, a42
    v_accvgpr_read_b32 v91, a43
    v_accvgpr_read_b32 v92, a56
    v_accvgpr_read_b32 v93, a57
    v_accvgpr_read_b32 v94, a58
    v_accvgpr_read_b32 v95, a59
    v_accvgpr_read_b32 v96, a72
    v_accvgpr_read_b32 v97, a73
    v_accvgpr_read_b32 v98, a74
    v_accvgpr_read_b32 v99, a75
    v_accvgpr_read_b32 v100, a12
    v_accvgpr_read_b32 v101, a13
    v_accvgpr_read_b32 v102, a14
    v_accvgpr_read_b32 v103, a15
    v_accvgpr_read_b32 v104, a28
    v_accvgpr_read_b32 v105, a29
    v_accvgpr_read_b32 v106, a30
    v_accvgpr_read_b32 v107, a31
    v_accvgpr_read_b32 v108, a44
    v_accvgpr_read_b32 v109, a45
    v_accvgpr_read_b32 v110, a46
    v_accvgpr_read_b32 v111, a47
    v_accvgpr_read_b32 v112, a60
    v_accvgpr_read_b32 v113, a61
    v_accvgpr_read_b32 v114, a62
    v_accvgpr_read_b32 v115, a63
    v_accvgpr_read_b32 v116, a76
    v_accvgpr_read_b32 v117, a77
    v_accvgpr_read_b32 v118, a78
    v_accvgpr_read_b32 v119, a79
    s_branch .down_kernel_end_p0_a1
.down_kernel_end_p0_a0:
    v_accvgpr_read_b32 v80, a0
    v_accvgpr_read_b32 v81, a1
    v_accvgpr_read_b32 v82, a2
    v_accvgpr_read_b32 v83, a3
    v_accvgpr_read_b32 v84, a16
    v_accvgpr_read_b32 v85, a17
    v_accvgpr_read_b32 v86, a18
    v_accvgpr_read_b32 v87, a19
    v_accvgpr_read_b32 v88, a32
    v_accvgpr_read_b32 v89, a33
    v_accvgpr_read_b32 v90, a34
    v_accvgpr_read_b32 v91, a35
    v_accvgpr_read_b32 v92, a48
    v_accvgpr_read_b32 v93, a49
    v_accvgpr_read_b32 v94, a50
    v_accvgpr_read_b32 v95, a51
    v_accvgpr_read_b32 v96, a64
    v_accvgpr_read_b32 v97, a65
    v_accvgpr_read_b32 v98, a66
    v_accvgpr_read_b32 v99, a67
    v_accvgpr_read_b32 v100, a4
    v_accvgpr_read_b32 v101, a5
    v_accvgpr_read_b32 v102, a6
    v_accvgpr_read_b32 v103, a7
    v_accvgpr_read_b32 v104, a20
    v_accvgpr_read_b32 v105, a21
    v_accvgpr_read_b32 v106, a22
    v_accvgpr_read_b32 v107, a23
    v_accvgpr_read_b32 v108, a36
    v_accvgpr_read_b32 v109, a37
    v_accvgpr_read_b32 v110, a38
    v_accvgpr_read_b32 v111, a39
    v_accvgpr_read_b32 v112, a52
    v_accvgpr_read_b32 v113, a53
    v_accvgpr_read_b32 v114, a54
    v_accvgpr_read_b32 v115, a55
    v_accvgpr_read_b32 v116, a68
    v_accvgpr_read_b32 v117, a69
    v_accvgpr_read_b32 v118, a70
    v_accvgpr_read_b32 v119, a71
.down_kernel_end_p0_a1:
    s_mov_b32 s30, 0
    s_waitcnt lgkmcnt(9)
    v_add_f32 v32, v32, v80
    v_add_f32 v33, v33, v81
    v_add_f32 v34, v34, v82
    v_add_f32 v35, v35, v83
    v_cvt_pk_bf16_f32 v124, v32, v33
    v_cvt_pk_bf16_f32 v125, v34, v35
    s_waitcnt lgkmcnt(8)
    v_add_f32 v36, v36, v84
    v_add_f32 v37, v37, v85
    v_add_f32 v38, v38, v86
    v_add_f32 v39, v39, v87
    v_cvt_pk_bf16_f32 v126, v36, v37
    v_cvt_pk_bf16_f32 v127, v38, v39
    s_nop 1
    v_permlane16_swap_b32 v124, v126
    v_permlane16_swap_b32 v125, v127
    buffer_store_dwordx4 v[124:127], v9, s[12:15], s30 offen offset:0 sc1
    s_waitcnt lgkmcnt(7)
    v_add_f32 v40, v40, v88
    v_add_f32 v41, v41, v89
    v_add_f32 v42, v42, v90
    v_add_f32 v43, v43, v91
    v_cvt_pk_bf16_f32 v128, v40, v41
    v_cvt_pk_bf16_f32 v129, v42, v43
    s_waitcnt lgkmcnt(6)
    v_add_f32 v44, v44, v92
    v_add_f32 v45, v45, v93
    v_add_f32 v46, v46, v94
    v_add_f32 v47, v47, v95
    v_cvt_pk_bf16_f32 v130, v44, v45
    v_cvt_pk_bf16_f32 v131, v46, v47
    s_nop 1
    v_permlane16_swap_b32 v128, v130
    v_permlane16_swap_b32 v129, v131
    buffer_store_dwordx4 v[128:131], v9, s[12:15], s30 offen offset:64 sc1
    s_waitcnt lgkmcnt(5)
    v_add_f32 v48, v48, v96
    v_add_f32 v49, v49, v97
    v_add_f32 v50, v50, v98
    v_add_f32 v51, v51, v99
    v_cvt_pk_bf16_f32 v132, v48, v49
    v_cvt_pk_bf16_f32 v133, v50, v51
    buffer_store_dwordx2 v[132:133], v10, s[12:15], s30 offen offset:128 sc1
    s_mov_b32 s30, 18432
    s_waitcnt lgkmcnt(4)
    v_add_f32 v52, v52, v100
    v_add_f32 v53, v53, v101
    v_add_f32 v54, v54, v102
    v_add_f32 v55, v55, v103
    v_cvt_pk_bf16_f32 v136, v52, v53
    v_cvt_pk_bf16_f32 v137, v54, v55
    s_waitcnt lgkmcnt(3)
    v_add_f32 v56, v56, v104
    v_add_f32 v57, v57, v105
    v_add_f32 v58, v58, v106
    v_add_f32 v59, v59, v107
    v_cvt_pk_bf16_f32 v138, v56, v57
    v_cvt_pk_bf16_f32 v139, v58, v59
    s_nop 1
    v_permlane16_swap_b32 v136, v138
    v_permlane16_swap_b32 v137, v139
    buffer_store_dwordx4 v[136:139], v9, s[12:15], s30 offen offset:0 sc1
    s_waitcnt lgkmcnt(2)
    v_add_f32 v60, v60, v108
    v_add_f32 v61, v61, v109
    v_add_f32 v62, v62, v110
    v_add_f32 v63, v63, v111
    v_cvt_pk_bf16_f32 v140, v60, v61
    v_cvt_pk_bf16_f32 v141, v62, v63
    s_waitcnt lgkmcnt(1)
    v_add_f32 v64, v64, v112
    v_add_f32 v65, v65, v113
    v_add_f32 v66, v66, v114
    v_add_f32 v67, v67, v115
    v_cvt_pk_bf16_f32 v142, v64, v65
    v_cvt_pk_bf16_f32 v143, v66, v67
    s_nop 1
    v_permlane16_swap_b32 v140, v142
    v_permlane16_swap_b32 v141, v143
    buffer_store_dwordx4 v[140:143], v9, s[12:15], s30 offen offset:64 sc1
    s_waitcnt lgkmcnt(0)
    v_add_f32 v68, v68, v116
    v_add_f32 v69, v69, v117
    v_add_f32 v70, v70, v118
    v_add_f32 v71, v71, v119
    v_cvt_pk_bf16_f32 v144, v68, v69
    v_cvt_pk_bf16_f32 v145, v70, v71
    buffer_store_dwordx2 v[144:145], v10, s[12:15], s30 offen offset:128 sc1
    v_mov_b32 v1, 1
    v_mov_b32 v2, 0
    s_waitcnt vmcnt(0)
    s_barrier
    s_cmp_lg_u32 s3, 0
    s_cbranch_scc1 .down_kernel_end_p0_x
    s_mov_b64 exec, 1
    buffer_atomic_add v1, v2, s[40:43], s32 offen sc1
.down_kernel_end_p0_x:
    s_endpgm
.down_kernel_end_p1:
    s_nop 0
    s_add_u32 m0, s26, 0
    s_nop 0
    buffer_load_dwordx4 v16, s[8:11], s27 offen lds
    s_nop 0
    s_add_u32 m0, s26, 8192
    s_nop 0
    buffer_load_dwordx4 v17, s[8:11], s27 offen lds
    s_nop 0
    s_add_u32 m0, s44, 0
    s_nop 0
    buffer_load_dwordx4 v18, s[80:83], s28 offen lds
    s_nop 0
    s_add_u32 m0, s45, 0
    s_nop 0
    buffer_load_dwordx4 v19, s[84:87], s28 offen lds
    s_nop 0
    s_add_u32 s27, s27, 128
    s_add_u32 s28, s28, 73728
    s_nop 0
    s_add_u32 m0, s26, 34816
    s_nop 0
    buffer_load_dwordx4 v16, s[8:11], s27 offen lds
    s_nop 0
    s_add_u32 m0, s26, 43008
    s_nop 0
    buffer_load_dwordx4 v17, s[8:11], s27 offen lds
    s_nop 0
    s_add_u32 m0, s44, 34816
    s_nop 0
    buffer_load_dwordx4 v18, s[80:83], s28 offen lds
    s_nop 0
    s_add_u32 m0, s45, 34816
    s_nop 0
    buffer_load_dwordx4 v19, s[84:87], s28 offen lds
    s_nop 0
    s_add_u32 s27, s27, 128
    s_add_u32 s28, s28, 73728
    s_nop 0
    s_add_u32 m0, s26, 69632
    s_nop 0
    buffer_load_dwordx4 v16, s[8:11], s27 offen lds
    s_nop 0
    s_add_u32 m0, s26, 77824
    s_nop 0
    buffer_load_dwordx4 v17, s[8:11], s27 offen lds
    s_nop 0
    s_add_u32 m0, s44, 69632
    s_nop 0
    buffer_load_dwordx4 v18, s[80:83], s28 offen lds
    s_nop 0
    s_add_u32 m0, s45, 69632
    s_nop 0
    buffer_load_dwordx4 v19, s[84:87], s28 offen lds
    s_nop 0
    s_add_u32 s27, s27, 128
    s_add_u32 s28, s28, 73728
    s_nop 0
    v_sub_u32 v8, 0, v5
    v_and_b32 v8, 3, v8
    v_xor_b32 v8, v4, v8
    v_lshlrev_b32 v8, 4, v8
    v_lshl_add_u32 v8, v3, 6, v8
    s_lshl_b32 s30, s21, 12
    s_lshl_b32 s31, s22, 13
    s_add_u32 s30, s30, s31
    v_add_u32 v8, s30, v8
    v_lshrrev_b32 v9, 1, v4
    v_lshlrev_b32 v9, 4, v9
    v_and_b32 v10, 1, v4
    v_lshl_add_u32 v9, v10, 2, v9
    v_add_u32 v9, v9, v5
    v_mul_u32_u24 v9, 288, v9
    v_lshl_add_u32 v9, v6, 3, v9
    s_mul_i32 s31, s22, 9216
    v_add_u32 v9, s31, v9
    v_add_u32 v22, 0, v8
    v_add_u32 v26, 16384, v9
    v_add_u32 v23, 34816, v8
    v_add_u32 v27, 51200, v9
    v_add_u32 v24, 69632, v8
    v_add_u32 v28, 86016, v9
    v_add_u32 v25, 104448, v8
    v_add_u32 v29, 120832, v9
    s_nop 0
    s_waitcnt vmcnt(8)
    s_barrier
    s_nop 0
    ds_read_b128 v[32:35], v22 offset:0
    ds_read_b128 v[36:39], v22 offset:1024
    ds_read_b64_tr_b16 v[64:65], v26 offset:160
    s_nop 0
    ds_read_b128 v[40:43], v22 offset:2048
    ds_read_b128 v[44:47], v22 offset:3072
    ds_read_b64_tr_b16 v[66:67], v26 offset:2464
    s_nop 0
    ds_read_b64_tr_b16 v[68:69], v26 offset:192
    s_nop 0
    ds_read_b64_tr_b16 v[70:71], v26 offset:2496
    s_nop 0
    ds_read_b64_tr_b16 v[72:73], v26 offset:224
    s_nop 0
    ds_read_b64_tr_b16 v[74:75], v26 offset:2528
    s_waitcnt lgkmcnt(4)
    v_mfma_f32_16x16x32_bf16 a[0:3], v[64:67], v[32:35], 0
    ds_read_b64_tr_b16 v[76:77], v26 offset:256
    v_mfma_f32_16x16x32_bf16 a[4:7], v[64:67], v[36:39], 0
    ds_read_b64_tr_b16 v[78:79], v26 offset:2560
    v_mfma_f32_16x16x32_bf16 a[8:11], v[64:67], v[40:43], 0
    v_mfma_f32_16x16x32_bf16 a[12:15], v[64:67], v[44:47], 0
    s_waitcnt vmcnt(4)
    s_barrier
    s_waitcnt lgkmcnt(4)
    v_mfma_f32_16x16x32_bf16 a[16:19], v[68:71], v[32:35], 0
    ds_read_b128 v[48:51], v23 offset:0
    ds_read_b128 v[52:55], v23 offset:1024
    ds_read_b64_tr_b16 v[80:81], v27 offset:160
    s_add_u32 m0, s26, 104448
    v_mfma_f32_16x16x32_bf16 a[20:23], v[68:71], v[36:39], 0
    ds_read_b128 v[56:59], v23 offset:2048
    ds_read_b128 v[60:63], v23 offset:3072
    ds_read_b64_tr_b16 v[82:83], v27 offset:2464
    buffer_load_dwordx4 v16, s[8:11], s27 offen lds
    v_mfma_f32_16x16x32_bf16 a[24:27], v[68:71], v[40:43], 0
    s_add_u32 m0, s26, 112640
    v_mfma_f32_16x16x32_bf16 a[28:31], v[68:71], v[44:47], 0
    buffer_load_dwordx4 v17, s[8:11], s27 offen lds
    s_waitcnt lgkmcnt(8)
    v_mfma_f32_16x16x32_bf16 a[32:35], v[72:75], v[32:35], 0
    ds_read_b64_tr_b16 v[84:85], v27 offset:192
    s_add_u32 m0, s44, 104448
    v_mfma_f32_16x16x32_bf16 a[36:39], v[72:75], v[36:39], 0
    ds_read_b64_tr_b16 v[86:87], v27 offset:2496
    buffer_load_dwordx4 v18, s[80:83], s28 offen lds
    v_mfma_f32_16x16x32_bf16 a[40:43], v[72:75], v[40:43], 0
    s_add_u32 m0, s45, 104448
    v_mfma_f32_16x16x32_bf16 a[44:47], v[72:75], v[44:47], 0
    buffer_load_dwordx4 v19, s[84:87], s28 offen lds
    s_waitcnt lgkmcnt(8)
    v_mfma_f32_16x16x32_bf16 a[48:51], v[76:79], v[32:35], 0
    ds_read_b64_tr_b16 v[88:89], v27 offset:224
    s_add_u32 s27, s27, 128
    s_add_u32 s28, s28, 73728
    v_mfma_f32_16x16x32_bf16 a[52:55], v[76:79], v[36:39], 0
    ds_read_b64_tr_b16 v[90:91], v27 offset:2528
    v_mfma_f32_16x16x32_bf16 a[56:59], v[76:79], v[40:43], 0
    v_mfma_f32_16x16x32_bf16 a[60:63], v[76:79], v[44:47], 0
    s_waitcnt lgkmcnt(4)
    v_mfma_f32_16x16x32_bf16 a[0:3], v[80:83], v[48:51], a[0:3]
    ds_read_b64_tr_b16 v[92:93], v27 offset:256
    v_mfma_f32_16x16x32_bf16 a[4:7], v[80:83], v[52:55], a[4:7]
    ds_read_b64_tr_b16 v[94:95], v27 offset:2560
    v_mfma_f32_16x16x32_bf16 a[8:11], v[80:83], v[56:59], a[8:11]
    v_mfma_f32_16x16x32_bf16 a[12:15], v[80:83], v[60:63], a[12:15]
    s_waitcnt vmcnt(4)
    s_barrier
    s_waitcnt lgkmcnt(4)
    v_mfma_f32_16x16x32_bf16 a[16:19], v[84:87], v[48:51], a[16:19]
    ds_read_b128 v[32:35], v24 offset:0
    ds_read_b128 v[36:39], v24 offset:1024
    ds_read_b64_tr_b16 v[64:65], v28 offset:160
    s_add_u32 m0, s26, 0
    v_mfma_f32_16x16x32_bf16 a[20:23], v[84:87], v[52:55], a[20:23]
    ds_read_b128 v[40:43], v24 offset:2048
    ds_read_b128 v[44:47], v24 offset:3072
    ds_read_b64_tr_b16 v[66:67], v28 offset:2464
    buffer_load_dwordx4 v16, s[8:11], s27 offen lds
    v_mfma_f32_16x16x32_bf16 a[24:27], v[84:87], v[56:59], a[24:27]
    s_add_u32 m0, s26, 8192
    v_mfma_f32_16x16x32_bf16 a[28:31], v[84:87], v[60:63], a[28:31]
    buffer_load_dwordx4 v17, s[8:11], s27 offen lds
    s_waitcnt lgkmcnt(8)
    v_mfma_f32_16x16x32_bf16 a[32:35], v[88:91], v[48:51], a[32:35]
    ds_read_b64_tr_b16 v[68:69], v28 offset:192
    s_add_u32 m0, s44, 0
    v_mfma_f32_16x16x32_bf16 a[36:39], v[88:91], v[52:55], a[36:39]
    ds_read_b64_tr_b16 v[70:71], v28 offset:2496
    buffer_load_dwordx4 v18, s[80:83], s28 offen lds
    v_mfma_f32_16x16x32_bf16 a[40:43], v[88:91], v[56:59], a[40:43]
    s_add_u32 m0, s45, 0
    v_mfma_f32_16x16x32_bf16 a[44:47], v[88:91], v[60:63], a[44:47]
    buffer_load_dwordx4 v19, s[84:87], s28 offen lds
    s_waitcnt lgkmcnt(8)
    v_mfma_f32_16x16x32_bf16 a[48:51], v[92:95], v[48:51], a[48:51]
    ds_read_b64_tr_b16 v[72:73], v28 offset:224
    s_add_u32 s27, s27, 128
    s_add_u32 s28, s28, 73728
    v_mfma_f32_16x16x32_bf16 a[52:55], v[92:95], v[52:55], a[52:55]
    ds_read_b64_tr_b16 v[74:75], v28 offset:2528
    v_mfma_f32_16x16x32_bf16 a[56:59], v[92:95], v[56:59], a[56:59]
    v_mfma_f32_16x16x32_bf16 a[60:63], v[92:95], v[60:63], a[60:63]
    s_waitcnt lgkmcnt(4)
    v_mfma_f32_16x16x32_bf16 a[0:3], v[64:67], v[32:35], a[0:3]
    ds_read_b64_tr_b16 v[76:77], v28 offset:256
    v_mfma_f32_16x16x32_bf16 a[4:7], v[64:67], v[36:39], a[4:7]
    ds_read_b64_tr_b16 v[78:79], v28 offset:2560
    v_mfma_f32_16x16x32_bf16 a[8:11], v[64:67], v[40:43], a[8:11]
    v_mfma_f32_16x16x32_bf16 a[12:15], v[64:67], v[44:47], a[12:15]
    s_waitcnt vmcnt(4)
    s_barrier
    s_waitcnt lgkmcnt(4)
    v_mfma_f32_16x16x32_bf16 a[16:19], v[68:71], v[32:35], a[16:19]
    ds_read_b128 v[48:51], v25 offset:0
    ds_read_b128 v[52:55], v25 offset:1024
    ds_read_b64_tr_b16 v[80:81], v29 offset:160
    s_add_u32 m0, s26, 34816
    v_mfma_f32_16x16x32_bf16 a[20:23], v[68:71], v[36:39], a[20:23]
    ds_read_b128 v[56:59], v25 offset:2048
    ds_read_b128 v[60:63], v25 offset:3072
    ds_read_b64_tr_b16 v[82:83], v29 offset:2464
    buffer_load_dwordx4 v16, s[8:11], s27 offen lds
    v_mfma_f32_16x16x32_bf16 a[24:27], v[68:71], v[40:43], a[24:27]
    s_add_u32 m0, s26, 43008
    v_mfma_f32_16x16x32_bf16 a[28:31], v[68:71], v[44:47], a[28:31]
    buffer_load_dwordx4 v17, s[8:11], s27 offen lds
    s_waitcnt lgkmcnt(8)
    v_mfma_f32_16x16x32_bf16 a[32:35], v[72:75], v[32:35], a[32:35]
    ds_read_b64_tr_b16 v[84:85], v29 offset:192
    s_add_u32 m0, s44, 34816
    v_mfma_f32_16x16x32_bf16 a[36:39], v[72:75], v[36:39], a[36:39]
    ds_read_b64_tr_b16 v[86:87], v29 offset:2496
    buffer_load_dwordx4 v18, s[80:83], s28 offen lds
    v_mfma_f32_16x16x32_bf16 a[40:43], v[72:75], v[40:43], a[40:43]
    s_add_u32 m0, s45, 34816
    v_mfma_f32_16x16x32_bf16 a[44:47], v[72:75], v[44:47], a[44:47]
    buffer_load_dwordx4 v19, s[84:87], s28 offen lds
    s_waitcnt lgkmcnt(8)
    v_mfma_f32_16x16x32_bf16 a[48:51], v[76:79], v[32:35], a[48:51]
    ds_read_b64_tr_b16 v[88:89], v29 offset:224
    s_add_u32 s27, s27, 128
    s_add_u32 s28, s28, 73728
    v_mfma_f32_16x16x32_bf16 a[52:55], v[76:79], v[36:39], a[52:55]
    ds_read_b64_tr_b16 v[90:91], v29 offset:2528
    v_mfma_f32_16x16x32_bf16 a[56:59], v[76:79], v[40:43], a[56:59]
    v_mfma_f32_16x16x32_bf16 a[60:63], v[76:79], v[44:47], a[60:63]
    s_waitcnt lgkmcnt(4)
    v_mfma_f32_16x16x32_bf16 a[0:3], v[80:83], v[48:51], a[0:3]
    ds_read_b64_tr_b16 v[92:93], v29 offset:256
    v_mfma_f32_16x16x32_bf16 a[4:7], v[80:83], v[52:55], a[4:7]
    ds_read_b64_tr_b16 v[94:95], v29 offset:2560
    v_mfma_f32_16x16x32_bf16 a[8:11], v[80:83], v[56:59], a[8:11]
    v_mfma_f32_16x16x32_bf16 a[12:15], v[80:83], v[60:63], a[12:15]
    s_waitcnt vmcnt(4)
    s_barrier
    s_waitcnt lgkmcnt(4)
    v_mfma_f32_16x16x32_bf16 a[16:19], v[84:87], v[48:51], a[16:19]
    ds_read_b128 v[32:35], v22 offset:0
    ds_read_b128 v[36:39], v22 offset:1024
    ds_read_b64_tr_b16 v[64:65], v26 offset:160
    s_add_u32 m0, s26, 69632
    v_mfma_f32_16x16x32_bf16 a[20:23], v[84:87], v[52:55], a[20:23]
    ds_read_b128 v[40:43], v22 offset:2048
    ds_read_b128 v[44:47], v22 offset:3072
    ds_read_b64_tr_b16 v[66:67], v26 offset:2464
    buffer_load_dwordx4 v16, s[8:11], s27 offen lds
    v_mfma_f32_16x16x32_bf16 a[24:27], v[84:87], v[56:59], a[24:27]
    s_add_u32 m0, s26, 77824
    v_mfma_f32_16x16x32_bf16 a[28:31], v[84:87], v[60:63], a[28:31]
    buffer_load_dwordx4 v17, s[8:11], s27 offen lds
    s_waitcnt lgkmcnt(8)
    v_mfma_f32_16x16x32_bf16 a[32:35], v[88:91], v[48:51], a[32:35]
    ds_read_b64_tr_b16 v[68:69], v26 offset:192
    s_add_u32 m0, s44, 69632
    v_mfma_f32_16x16x32_bf16 a[36:39], v[88:91], v[52:55], a[36:39]
    ds_read_b64_tr_b16 v[70:71], v26 offset:2496
    buffer_load_dwordx4 v18, s[80:83], s28 offen lds
    v_mfma_f32_16x16x32_bf16 a[40:43], v[88:91], v[56:59], a[40:43]
    s_add_u32 m0, s45, 69632
    v_mfma_f32_16x16x32_bf16 a[44:47], v[88:91], v[60:63], a[44:47]
    buffer_load_dwordx4 v19, s[84:87], s28 offen lds
    s_waitcnt lgkmcnt(8)
    v_mfma_f32_16x16x32_bf16 a[48:51], v[92:95], v[48:51], a[48:51]
    ds_read_b64_tr_b16 v[72:73], v26 offset:224
    s_add_u32 s27, s27, 128
    s_add_u32 s28, s28, 73728
    v_mfma_f32_16x16x32_bf16 a[52:55], v[92:95], v[52:55], a[52:55]
    ds_read_b64_tr_b16 v[74:75], v26 offset:2528
    v_mfma_f32_16x16x32_bf16 a[56:59], v[92:95], v[56:59], a[56:59]
    v_mfma_f32_16x16x32_bf16 a[60:63], v[92:95], v[60:63], a[60:63]
    s_waitcnt lgkmcnt(4)
    v_mfma_f32_16x16x32_bf16 a[0:3], v[64:67], v[32:35], a[0:3]
    ds_read_b64_tr_b16 v[76:77], v26 offset:256
    v_mfma_f32_16x16x32_bf16 a[4:7], v[64:67], v[36:39], a[4:7]
    ds_read_b64_tr_b16 v[78:79], v26 offset:2560
    v_mfma_f32_16x16x32_bf16 a[8:11], v[64:67], v[40:43], a[8:11]
    v_mfma_f32_16x16x32_bf16 a[12:15], v[64:67], v[44:47], a[12:15]
    s_waitcnt vmcnt(4)
    s_barrier
    s_waitcnt lgkmcnt(4)
    v_mfma_f32_16x16x32_bf16 a[16:19], v[68:71], v[32:35], a[16:19]
    ds_read_b128 v[48:51], v23 offset:0
    ds_read_b128 v[52:55], v23 offset:1024
    ds_read_b64_tr_b16 v[80:81], v27 offset:160
    s_add_u32 m0, s26, 104448
    v_mfma_f32_16x16x32_bf16 a[20:23], v[68:71], v[36:39], a[20:23]
    ds_read_b128 v[56:59], v23 offset:2048
    ds_read_b128 v[60:63], v23 offset:3072
    ds_read_b64_tr_b16 v[82:83], v27 offset:2464
    buffer_load_dwordx4 v16, s[8:11], s27 offen lds
    v_mfma_f32_16x16x32_bf16 a[24:27], v[68:71], v[40:43], a[24:27]
    s_add_u32 m0, s26, 112640
    v_mfma_f32_16x16x32_bf16 a[28:31], v[68:71], v[44:47], a[28:31]
    buffer_load_dwordx4 v17, s[8:11], s27 offen lds
    s_waitcnt lgkmcnt(8)
    v_mfma_f32_16x16x32_bf16 a[32:35], v[72:75], v[32:35], a[32:35]
    ds_read_b64_tr_b16 v[84:85], v27 offset:192
    s_add_u32 m0, s44, 104448
    v_mfma_f32_16x16x32_bf16 a[36:39], v[72:75], v[36:39], a[36:39]
    ds_read_b64_tr_b16 v[86:87], v27 offset:2496
    buffer_load_dwordx4 v18, s[80:83], s28 offen lds
    v_mfma_f32_16x16x32_bf16 a[40:43], v[72:75], v[40:43], a[40:43]
    s_add_u32 m0, s45, 104448
    v_mfma_f32_16x16x32_bf16 a[44:47], v[72:75], v[44:47], a[44:47]
    buffer_load_dwordx4 v19, s[84:87], s28 offen lds
    s_waitcnt lgkmcnt(8)
    v_mfma_f32_16x16x32_bf16 a[48:51], v[76:79], v[32:35], a[48:51]
    ds_read_b64_tr_b16 v[88:89], v27 offset:224
    s_add_u32 s27, s27, 128
    s_add_u32 s28, s28, 73728
    v_mfma_f32_16x16x32_bf16 a[52:55], v[76:79], v[36:39], a[52:55]
    ds_read_b64_tr_b16 v[90:91], v27 offset:2528
    v_mfma_f32_16x16x32_bf16 a[56:59], v[76:79], v[40:43], a[56:59]
    v_mfma_f32_16x16x32_bf16 a[60:63], v[76:79], v[44:47], a[60:63]
    s_waitcnt lgkmcnt(4)
    v_mfma_f32_16x16x32_bf16 a[0:3], v[80:83], v[48:51], a[0:3]
    ds_read_b64_tr_b16 v[92:93], v27 offset:256
    v_mfma_f32_16x16x32_bf16 a[4:7], v[80:83], v[52:55], a[4:7]
    ds_read_b64_tr_b16 v[94:95], v27 offset:2560
    v_mfma_f32_16x16x32_bf16 a[8:11], v[80:83], v[56:59], a[8:11]
    v_mfma_f32_16x16x32_bf16 a[12:15], v[80:83], v[60:63], a[12:15]
    s_waitcnt vmcnt(4)
    s_barrier
    s_waitcnt lgkmcnt(4)
    v_mfma_f32_16x16x32_bf16 a[16:19], v[84:87], v[48:51], a[16:19]
    ds_read_b128 v[32:35], v24 offset:0
    ds_read_b128 v[36:39], v24 offset:1024
    ds_read_b64_tr_b16 v[64:65], v28 offset:160
    s_add_u32 m0, s26, 0
    v_mfma_f32_16x16x32_bf16 a[20:23], v[84:87], v[52:55], a[20:23]
    ds_read_b128 v[40:43], v24 offset:2048
    ds_read_b128 v[44:47], v24 offset:3072
    ds_read_b64_tr_b16 v[66:67], v28 offset:2464
    buffer_load_dwordx4 v16, s[8:11], s27 offen lds
    v_mfma_f32_16x16x32_bf16 a[24:27], v[84:87], v[56:59], a[24:27]
    s_add_u32 m0, s26, 8192
    v_mfma_f32_16x16x32_bf16 a[28:31], v[84:87], v[60:63], a[28:31]
    buffer_load_dwordx4 v17, s[8:11], s27 offen lds
    s_waitcnt lgkmcnt(8)
    v_mfma_f32_16x16x32_bf16 a[32:35], v[88:91], v[48:51], a[32:35]
    ds_read_b64_tr_b16 v[68:69], v28 offset:192
    s_add_u32 m0, s44, 0
    v_mfma_f32_16x16x32_bf16 a[36:39], v[88:91], v[52:55], a[36:39]
    ds_read_b64_tr_b16 v[70:71], v28 offset:2496
    buffer_load_dwordx4 v18, s[80:83], s28 offen lds
    v_mfma_f32_16x16x32_bf16 a[40:43], v[88:91], v[56:59], a[40:43]
    s_add_u32 m0, s45, 0
    v_mfma_f32_16x16x32_bf16 a[44:47], v[88:91], v[60:63], a[44:47]
    buffer_load_dwordx4 v19, s[84:87], s28 offen lds
    s_waitcnt lgkmcnt(8)
    v_mfma_f32_16x16x32_bf16 a[48:51], v[92:95], v[48:51], a[48:51]
    ds_read_b64_tr_b16 v[72:73], v28 offset:224
    s_add_u32 s27, s27, 128
    s_add_u32 s28, s28, 73728
    v_mfma_f32_16x16x32_bf16 a[52:55], v[92:95], v[52:55], a[52:55]
    ds_read_b64_tr_b16 v[74:75], v28 offset:2528
    v_mfma_f32_16x16x32_bf16 a[56:59], v[92:95], v[56:59], a[56:59]
    v_mfma_f32_16x16x32_bf16 a[60:63], v[92:95], v[60:63], a[60:63]
    s_waitcnt lgkmcnt(4)
    v_mfma_f32_16x16x32_bf16 a[0:3], v[64:67], v[32:35], a[0:3]
    ds_read_b64_tr_b16 v[76:77], v28 offset:256
    v_mfma_f32_16x16x32_bf16 a[4:7], v[64:67], v[36:39], a[4:7]
    ds_read_b64_tr_b16 v[78:79], v28 offset:2560
    v_mfma_f32_16x16x32_bf16 a[8:11], v[64:67], v[40:43], a[8:11]
    v_mfma_f32_16x16x32_bf16 a[12:15], v[64:67], v[44:47], a[12:15]
    s_waitcnt vmcnt(4)
    s_barrier
    s_waitcnt lgkmcnt(4)
    v_mfma_f32_16x16x32_bf16 a[16:19], v[68:71], v[32:35], a[16:19]
    ds_read_b128 v[48:51], v25 offset:0
    ds_read_b128 v[52:55], v25 offset:1024
    ds_read_b64_tr_b16 v[80:81], v29 offset:160
    s_add_u32 m0, s26, 34816
    v_mfma_f32_16x16x32_bf16 a[20:23], v[68:71], v[36:39], a[20:23]
    ds_read_b128 v[56:59], v25 offset:2048
    ds_read_b128 v[60:63], v25 offset:3072
    ds_read_b64_tr_b16 v[82:83], v29 offset:2464
    buffer_load_dwordx4 v16, s[8:11], s27 offen lds
    v_mfma_f32_16x16x32_bf16 a[24:27], v[68:71], v[40:43], a[24:27]
    s_add_u32 m0, s26, 43008
    v_mfma_f32_16x16x32_bf16 a[28:31], v[68:71], v[44:47], a[28:31]
    buffer_load_dwordx4 v17, s[8:11], s27 offen lds
    s_waitcnt lgkmcnt(8)
    v_mfma_f32_16x16x32_bf16 a[32:35], v[72:75], v[32:35], a[32:35]
    ds_read_b64_tr_b16 v[84:85], v29 offset:192
    s_add_u32 m0, s44, 34816
    v_mfma_f32_16x16x32_bf16 a[36:39], v[72:75], v[36:39], a[36:39]
    ds_read_b64_tr_b16 v[86:87], v29 offset:2496
    buffer_load_dwordx4 v18, s[80:83], s28 offen lds
    v_mfma_f32_16x16x32_bf16 a[40:43], v[72:75], v[40:43], a[40:43]
    s_add_u32 m0, s45, 34816
    v_mfma_f32_16x16x32_bf16 a[44:47], v[72:75], v[44:47], a[44:47]
    buffer_load_dwordx4 v19, s[84:87], s28 offen lds
    s_waitcnt lgkmcnt(8)
    v_mfma_f32_16x16x32_bf16 a[48:51], v[76:79], v[32:35], a[48:51]
    ds_read_b64_tr_b16 v[88:89], v29 offset:224
    s_add_u32 s27, s27, 128
    s_add_u32 s28, s28, 73728
    v_mfma_f32_16x16x32_bf16 a[52:55], v[76:79], v[36:39], a[52:55]
    ds_read_b64_tr_b16 v[90:91], v29 offset:2528
    v_mfma_f32_16x16x32_bf16 a[56:59], v[76:79], v[40:43], a[56:59]
    v_mfma_f32_16x16x32_bf16 a[60:63], v[76:79], v[44:47], a[60:63]
    s_waitcnt lgkmcnt(4)
    v_mfma_f32_16x16x32_bf16 a[0:3], v[80:83], v[48:51], a[0:3]
    ds_read_b64_tr_b16 v[92:93], v29 offset:256
    v_mfma_f32_16x16x32_bf16 a[4:7], v[80:83], v[52:55], a[4:7]
    ds_read_b64_tr_b16 v[94:95], v29 offset:2560
    v_mfma_f32_16x16x32_bf16 a[8:11], v[80:83], v[56:59], a[8:11]
    v_mfma_f32_16x16x32_bf16 a[12:15], v[80:83], v[60:63], a[12:15]
    s_waitcnt vmcnt(4)
    s_barrier
    s_waitcnt lgkmcnt(4)
    v_mfma_f32_16x16x32_bf16 a[16:19], v[84:87], v[48:51], a[16:19]
    ds_read_b128 v[32:35], v22 offset:0
    ds_read_b128 v[36:39], v22 offset:1024
    ds_read_b64_tr_b16 v[64:65], v26 offset:160
    s_add_u32 m0, s26, 69632
    v_mfma_f32_16x16x32_bf16 a[20:23], v[84:87], v[52:55], a[20:23]
    ds_read_b128 v[40:43], v22 offset:2048
    ds_read_b128 v[44:47], v22 offset:3072
    ds_read_b64_tr_b16 v[66:67], v26 offset:2464
    buffer_load_dwordx4 v16, s[8:11], s27 offen lds
    v_mfma_f32_16x16x32_bf16 a[24:27], v[84:87], v[56:59], a[24:27]
    s_add_u32 m0, s26, 77824
    v_mfma_f32_16x16x32_bf16 a[28:31], v[84:87], v[60:63], a[28:31]
    buffer_load_dwordx4 v17, s[8:11], s27 offen lds
    s_waitcnt lgkmcnt(8)
    v_mfma_f32_16x16x32_bf16 a[32:35], v[88:91], v[48:51], a[32:35]
    ds_read_b64_tr_b16 v[68:69], v26 offset:192
    s_add_u32 m0, s44, 69632
    v_mfma_f32_16x16x32_bf16 a[36:39], v[88:91], v[52:55], a[36:39]
    ds_read_b64_tr_b16 v[70:71], v26 offset:2496
    buffer_load_dwordx4 v18, s[80:83], s28 offen lds
    v_mfma_f32_16x16x32_bf16 a[40:43], v[88:91], v[56:59], a[40:43]
    s_add_u32 m0, s45, 69632
    v_mfma_f32_16x16x32_bf16 a[44:47], v[88:91], v[60:63], a[44:47]
    buffer_load_dwordx4 v19, s[84:87], s28 offen lds
    s_waitcnt lgkmcnt(8)
    v_mfma_f32_16x16x32_bf16 a[48:51], v[92:95], v[48:51], a[48:51]
    ds_read_b64_tr_b16 v[72:73], v26 offset:224
    s_add_u32 s27, s27, 128
    s_add_u32 s28, s28, 73728
    v_mfma_f32_16x16x32_bf16 a[52:55], v[92:95], v[52:55], a[52:55]
    ds_read_b64_tr_b16 v[74:75], v26 offset:2528
    v_mfma_f32_16x16x32_bf16 a[56:59], v[92:95], v[56:59], a[56:59]
    v_mfma_f32_16x16x32_bf16 a[60:63], v[92:95], v[60:63], a[60:63]
    s_waitcnt lgkmcnt(4)
    v_mfma_f32_16x16x32_bf16 a[0:3], v[64:67], v[32:35], a[0:3]
    ds_read_b64_tr_b16 v[76:77], v26 offset:256
    v_mfma_f32_16x16x32_bf16 a[4:7], v[64:67], v[36:39], a[4:7]
    ds_read_b64_tr_b16 v[78:79], v26 offset:2560
    v_mfma_f32_16x16x32_bf16 a[8:11], v[64:67], v[40:43], a[8:11]
    v_mfma_f32_16x16x32_bf16 a[12:15], v[64:67], v[44:47], a[12:15]
    s_waitcnt vmcnt(4)
    s_barrier
    s_waitcnt lgkmcnt(4)
    v_mfma_f32_16x16x32_bf16 a[16:19], v[68:71], v[32:35], a[16:19]
    ds_read_b128 v[48:51], v23 offset:0
    ds_read_b128 v[52:55], v23 offset:1024
    ds_read_b64_tr_b16 v[80:81], v27 offset:160
    s_add_u32 m0, s26, 104448
    v_mfma_f32_16x16x32_bf16 a[20:23], v[68:71], v[36:39], a[20:23]
    ds_read_b128 v[56:59], v23 offset:2048
    ds_read_b128 v[60:63], v23 offset:3072
    ds_read_b64_tr_b16 v[82:83], v27 offset:2464
    buffer_load_dwordx4 v16, s[8:11], s27 offen lds
    v_mfma_f32_16x16x32_bf16 a[24:27], v[68:71], v[40:43], a[24:27]
    s_add_u32 m0, s26, 112640
    v_mfma_f32_16x16x32_bf16 a[28:31], v[68:71], v[44:47], a[28:31]
    buffer_load_dwordx4 v17, s[8:11], s27 offen lds
    s_waitcnt lgkmcnt(8)
    v_mfma_f32_16x16x32_bf16 a[32:35], v[72:75], v[32:35], a[32:35]
    ds_read_b64_tr_b16 v[84:85], v27 offset:192
    s_add_u32 m0, s44, 104448
    v_mfma_f32_16x16x32_bf16 a[36:39], v[72:75], v[36:39], a[36:39]
    ds_read_b64_tr_b16 v[86:87], v27 offset:2496
    buffer_load_dwordx4 v18, s[80:83], s28 offen lds
    v_mfma_f32_16x16x32_bf16 a[40:43], v[72:75], v[40:43], a[40:43]
    s_add_u32 m0, s45, 104448
    v_mfma_f32_16x16x32_bf16 a[44:47], v[72:75], v[44:47], a[44:47]
    buffer_load_dwordx4 v19, s[84:87], s28 offen lds
    s_waitcnt lgkmcnt(8)
    v_mfma_f32_16x16x32_bf16 a[48:51], v[76:79], v[32:35], a[48:51]
    ds_read_b64_tr_b16 v[88:89], v27 offset:224
    s_add_u32 s27, s27, 128
    s_add_u32 s28, s28, 73728
    v_mfma_f32_16x16x32_bf16 a[52:55], v[76:79], v[36:39], a[52:55]
    ds_read_b64_tr_b16 v[90:91], v27 offset:2528
    v_mfma_f32_16x16x32_bf16 a[56:59], v[76:79], v[40:43], a[56:59]
    v_mfma_f32_16x16x32_bf16 a[60:63], v[76:79], v[44:47], a[60:63]
    s_waitcnt lgkmcnt(4)
    v_mfma_f32_16x16x32_bf16 a[0:3], v[80:83], v[48:51], a[0:3]
    ds_read_b64_tr_b16 v[92:93], v27 offset:256
    v_mfma_f32_16x16x32_bf16 a[4:7], v[80:83], v[52:55], a[4:7]
    ds_read_b64_tr_b16 v[94:95], v27 offset:2560
    v_mfma_f32_16x16x32_bf16 a[8:11], v[80:83], v[56:59], a[8:11]
    v_mfma_f32_16x16x32_bf16 a[12:15], v[80:83], v[60:63], a[12:15]
    s_waitcnt vmcnt(4)
    s_barrier
    s_waitcnt lgkmcnt(4)
    v_mfma_f32_16x16x32_bf16 a[16:19], v[84:87], v[48:51], a[16:19]
    ds_read_b128 v[32:35], v24 offset:0
    ds_read_b128 v[36:39], v24 offset:1024
    ds_read_b64_tr_b16 v[64:65], v28 offset:160
    s_add_u32 m0, s26, 0
    v_mfma_f32_16x16x32_bf16 a[20:23], v[84:87], v[52:55], a[20:23]
    ds_read_b128 v[40:43], v24 offset:2048
    ds_read_b128 v[44:47], v24 offset:3072
    ds_read_b64_tr_b16 v[66:67], v28 offset:2464
    buffer_load_dwordx4 v16, s[8:11], s27 offen lds
    v_mfma_f32_16x16x32_bf16 a[24:27], v[84:87], v[56:59], a[24:27]
    s_add_u32 m0, s26, 8192
    v_mfma_f32_16x16x32_bf16 a[28:31], v[84:87], v[60:63], a[28:31]
    buffer_load_dwordx4 v17, s[8:11], s27 offen lds
    s_waitcnt lgkmcnt(8)
    v_mfma_f32_16x16x32_bf16 a[32:35], v[88:91], v[48:51], a[32:35]
    ds_read_b64_tr_b16 v[68:69], v28 offset:192
    s_add_u32 m0, s44, 0
    v_mfma_f32_16x16x32_bf16 a[36:39], v[88:91], v[52:55], a[36:39]
    ds_read_b64_tr_b16 v[70:71], v28 offset:2496
    buffer_load_dwordx4 v18, s[80:83], s28 offen lds
    v_mfma_f32_16x16x32_bf16 a[40:43], v[88:91], v[56:59], a[40:43]
    s_add_u32 m0, s45, 0
    v_mfma_f32_16x16x32_bf16 a[44:47], v[88:91], v[60:63], a[44:47]
    buffer_load_dwordx4 v19, s[84:87], s28 offen lds
    s_waitcnt lgkmcnt(8)
    v_mfma_f32_16x16x32_bf16 a[48:51], v[92:95], v[48:51], a[48:51]
    ds_read_b64_tr_b16 v[72:73], v28 offset:224
    s_add_u32 s27, s27, 128
    s_add_u32 s28, s28, 73728
    v_mfma_f32_16x16x32_bf16 a[52:55], v[92:95], v[52:55], a[52:55]
    ds_read_b64_tr_b16 v[74:75], v28 offset:2528
    v_mfma_f32_16x16x32_bf16 a[56:59], v[92:95], v[56:59], a[56:59]
    v_mfma_f32_16x16x32_bf16 a[60:63], v[92:95], v[60:63], a[60:63]
    s_waitcnt lgkmcnt(4)
    v_mfma_f32_16x16x32_bf16 a[0:3], v[64:67], v[32:35], a[0:3]
    ds_read_b64_tr_b16 v[76:77], v28 offset:256
    v_mfma_f32_16x16x32_bf16 a[4:7], v[64:67], v[36:39], a[4:7]
    ds_read_b64_tr_b16 v[78:79], v28 offset:2560
    v_mfma_f32_16x16x32_bf16 a[8:11], v[64:67], v[40:43], a[8:11]
    v_mfma_f32_16x16x32_bf16 a[12:15], v[64:67], v[44:47], a[12:15]
    s_waitcnt vmcnt(4)
    s_barrier
    s_waitcnt lgkmcnt(4)
    v_mfma_f32_16x16x32_bf16 a[16:19], v[68:71], v[32:35], a[16:19]
    ds_read_b128 v[48:51], v25 offset:0
    ds_read_b128 v[52:55], v25 offset:1024
    ds_read_b64_tr_b16 v[80:81], v29 offset:160
    s_add_u32 m0, s26, 34816
    v_mfma_f32_16x16x32_bf16 a[20:23], v[68:71], v[36:39], a[20:23]
    ds_read_b128 v[56:59], v25 offset:2048
    ds_read_b128 v[60:63], v25 offset:3072
    ds_read_b64_tr_b16 v[82:83], v29 offset:2464
    buffer_load_dwordx4 v16, s[8:11], s27 offen lds
    v_mfma_f32_16x16x32_bf16 a[24:27], v[68:71], v[40:43], a[24:27]
    s_add_u32 m0, s26, 43008
    v_mfma_f32_16x16x32_bf16 a[28:31], v[68:71], v[44:47], a[28:31]
    buffer_load_dwordx4 v17, s[8:11], s27 offen lds
    s_waitcnt lgkmcnt(8)
    v_mfma_f32_16x16x32_bf16 a[32:35], v[72:75], v[32:35], a[32:35]
    ds_read_b64_tr_b16 v[84:85], v29 offset:192
    s_add_u32 m0, s44, 34816
    v_mfma_f32_16x16x32_bf16 a[36:39], v[72:75], v[36:39], a[36:39]
    ds_read_b64_tr_b16 v[86:87], v29 offset:2496
    buffer_load_dwordx4 v18, s[80:83], s28 offen lds
    v_mfma_f32_16x16x32_bf16 a[40:43], v[72:75], v[40:43], a[40:43]
    s_add_u32 m0, s45, 34816
    v_mfma_f32_16x16x32_bf16 a[44:47], v[72:75], v[44:47], a[44:47]
    buffer_load_dwordx4 v19, s[84:87], s28 offen lds
    s_waitcnt lgkmcnt(8)
    v_mfma_f32_16x16x32_bf16 a[48:51], v[76:79], v[32:35], a[48:51]
    ds_read_b64_tr_b16 v[88:89], v29 offset:224
    s_add_u32 s27, s27, 128
    s_add_u32 s28, s28, 73728
    v_mfma_f32_16x16x32_bf16 a[52:55], v[76:79], v[36:39], a[52:55]
    ds_read_b64_tr_b16 v[90:91], v29 offset:2528
    v_mfma_f32_16x16x32_bf16 a[56:59], v[76:79], v[40:43], a[56:59]
    v_mfma_f32_16x16x32_bf16 a[60:63], v[76:79], v[44:47], a[60:63]
    s_waitcnt lgkmcnt(4)
    v_mfma_f32_16x16x32_bf16 a[0:3], v[80:83], v[48:51], a[0:3]
    ds_read_b64_tr_b16 v[92:93], v29 offset:256
    v_mfma_f32_16x16x32_bf16 a[4:7], v[80:83], v[52:55], a[4:7]
    ds_read_b64_tr_b16 v[94:95], v29 offset:2560
    v_mfma_f32_16x16x32_bf16 a[8:11], v[80:83], v[56:59], a[8:11]
    v_mfma_f32_16x16x32_bf16 a[12:15], v[80:83], v[60:63], a[12:15]
    s_waitcnt vmcnt(4)
    s_barrier
    s_waitcnt lgkmcnt(4)
    v_mfma_f32_16x16x32_bf16 a[16:19], v[84:87], v[48:51], a[16:19]
    ds_read_b128 v[32:35], v22 offset:0
    ds_read_b128 v[36:39], v22 offset:1024
    ds_read_b64_tr_b16 v[64:65], v26 offset:160
    s_add_u32 m0, s26, 69632
    v_mfma_f32_16x16x32_bf16 a[20:23], v[84:87], v[52:55], a[20:23]
    ds_read_b128 v[40:43], v22 offset:2048
    ds_read_b128 v[44:47], v22 offset:3072
    ds_read_b64_tr_b16 v[66:67], v26 offset:2464
    buffer_load_dwordx4 v16, s[8:11], s27 offen lds
    v_mfma_f32_16x16x32_bf16 a[24:27], v[84:87], v[56:59], a[24:27]
    s_add_u32 m0, s26, 77824
    v_mfma_f32_16x16x32_bf16 a[28:31], v[84:87], v[60:63], a[28:31]
    buffer_load_dwordx4 v17, s[8:11], s27 offen lds
    s_waitcnt lgkmcnt(8)
    v_mfma_f32_16x16x32_bf16 a[32:35], v[88:91], v[48:51], a[32:35]
    ds_read_b64_tr_b16 v[68:69], v26 offset:192
    s_add_u32 m0, s44, 69632
    v_mfma_f32_16x16x32_bf16 a[36:39], v[88:91], v[52:55], a[36:39]
    ds_read_b64_tr_b16 v[70:71], v26 offset:2496
    buffer_load_dwordx4 v18, s[80:83], s28 offen lds
    v_mfma_f32_16x16x32_bf16 a[40:43], v[88:91], v[56:59], a[40:43]
    s_add_u32 m0, s45, 69632
    v_mfma_f32_16x16x32_bf16 a[44:47], v[88:91], v[60:63], a[44:47]
    buffer_load_dwordx4 v19, s[84:87], s28 offen lds
    s_waitcnt lgkmcnt(8)
    v_mfma_f32_16x16x32_bf16 a[48:51], v[92:95], v[48:51], a[48:51]
    ds_read_b64_tr_b16 v[72:73], v26 offset:224
    s_add_u32 s27, s27, 128
    s_add_u32 s28, s28, 73728
    v_mfma_f32_16x16x32_bf16 a[52:55], v[92:95], v[52:55], a[52:55]
    ds_read_b64_tr_b16 v[74:75], v26 offset:2528
    v_mfma_f32_16x16x32_bf16 a[56:59], v[92:95], v[56:59], a[56:59]
    v_mfma_f32_16x16x32_bf16 a[60:63], v[92:95], v[60:63], a[60:63]
    s_waitcnt lgkmcnt(4)
    v_mfma_f32_16x16x32_bf16 a[0:3], v[64:67], v[32:35], a[0:3]
    ds_read_b64_tr_b16 v[76:77], v26 offset:256
    v_mfma_f32_16x16x32_bf16 a[4:7], v[64:67], v[36:39], a[4:7]
    ds_read_b64_tr_b16 v[78:79], v26 offset:2560
    v_mfma_f32_16x16x32_bf16 a[8:11], v[64:67], v[40:43], a[8:11]
    v_mfma_f32_16x16x32_bf16 a[12:15], v[64:67], v[44:47], a[12:15]
    s_waitcnt vmcnt(4)
    s_barrier
    s_waitcnt lgkmcnt(4)
    v_mfma_f32_16x16x32_bf16 a[16:19], v[68:71], v[32:35], a[16:19]
    ds_read_b128 v[48:51], v23 offset:0
    ds_read_b128 v[52:55], v23 offset:1024
    ds_read_b64_tr_b16 v[80:81], v27 offset:160
    s_add_u32 m0, s26, 104448
    v_mfma_f32_16x16x32_bf16 a[20:23], v[68:71], v[36:39], a[20:23]
    ds_read_b128 v[56:59], v23 offset:2048
    ds_read_b128 v[60:63], v23 offset:3072
    ds_read_b64_tr_b16 v[82:83], v27 offset:2464
    buffer_load_dwordx4 v16, s[8:11], s27 offen lds
    v_mfma_f32_16x16x32_bf16 a[24:27], v[68:71], v[40:43], a[24:27]
    s_add_u32 m0, s26, 112640
    v_mfma_f32_16x16x32_bf16 a[28:31], v[68:71], v[44:47], a[28:31]
    buffer_load_dwordx4 v17, s[8:11], s27 offen lds
    s_waitcnt lgkmcnt(8)
    v_mfma_f32_16x16x32_bf16 a[32:35], v[72:75], v[32:35], a[32:35]
    ds_read_b64_tr_b16 v[84:85], v27 offset:192
    s_add_u32 m0, s44, 104448
    v_mfma_f32_16x16x32_bf16 a[36:39], v[72:75], v[36:39], a[36:39]
    ds_read_b64_tr_b16 v[86:87], v27 offset:2496
    buffer_load_dwordx4 v18, s[80:83], s28 offen lds
    v_mfma_f32_16x16x32_bf16 a[40:43], v[72:75], v[40:43], a[40:43]
    s_add_u32 m0, s45, 104448
    v_mfma_f32_16x16x32_bf16 a[44:47], v[72:75], v[44:47], a[44:47]
    buffer_load_dwordx4 v19, s[84:87], s28 offen lds
    s_waitcnt lgkmcnt(8)
    v_mfma_f32_16x16x32_bf16 a[48:51], v[76:79], v[32:35], a[48:51]
    ds_read_b64_tr_b16 v[88:89], v27 offset:224
    s_add_u32 s27, s27, 128
    s_add_u32 s28, s28, 73728
    v_mfma_f32_16x16x32_bf16 a[52:55], v[76:79], v[36:39], a[52:55]
    ds_read_b64_tr_b16 v[90:91], v27 offset:2528
    v_mfma_f32_16x16x32_bf16 a[56:59], v[76:79], v[40:43], a[56:59]
    v_mfma_f32_16x16x32_bf16 a[60:63], v[76:79], v[44:47], a[60:63]
    s_waitcnt lgkmcnt(4)
    v_mfma_f32_16x16x32_bf16 a[0:3], v[80:83], v[48:51], a[0:3]
    ds_read_b64_tr_b16 v[92:93], v27 offset:256
    v_mfma_f32_16x16x32_bf16 a[4:7], v[80:83], v[52:55], a[4:7]
    ds_read_b64_tr_b16 v[94:95], v27 offset:2560
    v_mfma_f32_16x16x32_bf16 a[8:11], v[80:83], v[56:59], a[8:11]
    v_mfma_f32_16x16x32_bf16 a[12:15], v[80:83], v[60:63], a[12:15]
    s_waitcnt vmcnt(4)
    s_barrier
    s_waitcnt lgkmcnt(4)
    v_mfma_f32_16x16x32_bf16 a[16:19], v[84:87], v[48:51], a[16:19]
    ds_read_b128 v[32:35], v24 offset:0
    ds_read_b128 v[36:39], v24 offset:1024
    ds_read_b64_tr_b16 v[64:65], v28 offset:160
    s_add_u32 m0, s26, 0
    v_mfma_f32_16x16x32_bf16 a[20:23], v[84:87], v[52:55], a[20:23]
    ds_read_b128 v[40:43], v24 offset:2048
    ds_read_b128 v[44:47], v24 offset:3072
    ds_read_b64_tr_b16 v[66:67], v28 offset:2464
    buffer_load_dwordx4 v16, s[8:11], s27 offen lds
    v_mfma_f32_16x16x32_bf16 a[24:27], v[84:87], v[56:59], a[24:27]
    s_add_u32 m0, s26, 8192
    v_mfma_f32_16x16x32_bf16 a[28:31], v[84:87], v[60:63], a[28:31]
    buffer_load_dwordx4 v17, s[8:11], s27 offen lds
    s_waitcnt lgkmcnt(8)
    v_mfma_f32_16x16x32_bf16 a[32:35], v[88:91], v[48:51], a[32:35]
    ds_read_b64_tr_b16 v[68:69], v28 offset:192
    s_add_u32 m0, s44, 0
    v_mfma_f32_16x16x32_bf16 a[36:39], v[88:91], v[52:55], a[36:39]
    ds_read_b64_tr_b16 v[70:71], v28 offset:2496
    buffer_load_dwordx4 v18, s[80:83], s28 offen lds
    v_mfma_f32_16x16x32_bf16 a[40:43], v[88:91], v[56:59], a[40:43]
    s_add_u32 m0, s45, 0
    v_mfma_f32_16x16x32_bf16 a[44:47], v[88:91], v[60:63], a[44:47]
    buffer_load_dwordx4 v19, s[84:87], s28 offen lds
    s_waitcnt lgkmcnt(8)
    v_mfma_f32_16x16x32_bf16 a[48:51], v[92:95], v[48:51], a[48:51]
    ds_read_b64_tr_b16 v[72:73], v28 offset:224
    s_add_u32 s27, s27, 128
    s_add_u32 s28, s28, 73728
    v_mfma_f32_16x16x32_bf16 a[52:55], v[92:95], v[52:55], a[52:55]
    ds_read_b64_tr_b16 v[74:75], v28 offset:2528
    v_mfma_f32_16x16x32_bf16 a[56:59], v[92:95], v[56:59], a[56:59]
    v_mfma_f32_16x16x32_bf16 a[60:63], v[92:95], v[60:63], a[60:63]
    s_waitcnt lgkmcnt(4)
    v_mfma_f32_16x16x32_bf16 a[0:3], v[64:67], v[32:35], a[0:3]
    ds_read_b64_tr_b16 v[76:77], v28 offset:256
    v_mfma_f32_16x16x32_bf16 a[4:7], v[64:67], v[36:39], a[4:7]
    ds_read_b64_tr_b16 v[78:79], v28 offset:2560
    v_mfma_f32_16x16x32_bf16 a[8:11], v[64:67], v[40:43], a[8:11]
    v_mfma_f32_16x16x32_bf16 a[12:15], v[64:67], v[44:47], a[12:15]
    s_waitcnt vmcnt(4)
    s_barrier
    s_waitcnt lgkmcnt(4)
    v_mfma_f32_16x16x32_bf16 a[16:19], v[68:71], v[32:35], a[16:19]
    ds_read_b128 v[48:51], v25 offset:0
    ds_read_b128 v[52:55], v25 offset:1024
    ds_read_b64_tr_b16 v[80:81], v29 offset:160
    s_add_u32 m0, s26, 34816
    v_mfma_f32_16x16x32_bf16 a[20:23], v[68:71], v[36:39], a[20:23]
    ds_read_b128 v[56:59], v25 offset:2048
    ds_read_b128 v[60:63], v25 offset:3072
    ds_read_b64_tr_b16 v[82:83], v29 offset:2464
    buffer_load_dwordx4 v16, s[8:11], s27 offen lds
    v_mfma_f32_16x16x32_bf16 a[24:27], v[68:71], v[40:43], a[24:27]
    s_add_u32 m0, s26, 43008
    v_mfma_f32_16x16x32_bf16 a[28:31], v[68:71], v[44:47], a[28:31]
    buffer_load_dwordx4 v17, s[8:11], s27 offen lds
    s_waitcnt lgkmcnt(8)
    v_mfma_f32_16x16x32_bf16 a[32:35], v[72:75], v[32:35], a[32:35]
    ds_read_b64_tr_b16 v[84:85], v29 offset:192
    s_add_u32 m0, s44, 34816
    v_mfma_f32_16x16x32_bf16 a[36:39], v[72:75], v[36:39], a[36:39]
    ds_read_b64_tr_b16 v[86:87], v29 offset:2496
    buffer_load_dwordx4 v18, s[80:83], s28 offen lds
    v_mfma_f32_16x16x32_bf16 a[40:43], v[72:75], v[40:43], a[40:43]
    s_add_u32 m0, s45, 34816
    v_mfma_f32_16x16x32_bf16 a[44:47], v[72:75], v[44:47], a[44:47]
    buffer_load_dwordx4 v19, s[84:87], s28 offen lds
    s_waitcnt lgkmcnt(8)
    v_mfma_f32_16x16x32_bf16 a[48:51], v[76:79], v[32:35], a[48:51]
    ds_read_b64_tr_b16 v[88:89], v29 offset:224
    s_add_u32 s27, s27, 128
    s_add_u32 s28, s28, 73728
    v_mfma_f32_16x16x32_bf16 a[52:55], v[76:79], v[36:39], a[52:55]
    ds_read_b64_tr_b16 v[90:91], v29 offset:2528
    v_mfma_f32_16x16x32_bf16 a[56:59], v[76:79], v[40:43], a[56:59]
    v_mfma_f32_16x16x32_bf16 a[60:63], v[76:79], v[44:47], a[60:63]
    s_waitcnt lgkmcnt(4)
    v_mfma_f32_16x16x32_bf16 a[0:3], v[80:83], v[48:51], a[0:3]
    ds_read_b64_tr_b16 v[92:93], v29 offset:256
    v_mfma_f32_16x16x32_bf16 a[4:7], v[80:83], v[52:55], a[4:7]
    ds_read_b64_tr_b16 v[94:95], v29 offset:2560
    v_mfma_f32_16x16x32_bf16 a[8:11], v[80:83], v[56:59], a[8:11]
    v_mfma_f32_16x16x32_bf16 a[12:15], v[80:83], v[60:63], a[12:15]
    s_waitcnt vmcnt(4)
    s_barrier
    s_waitcnt lgkmcnt(4)
    v_mfma_f32_16x16x32_bf16 a[16:19], v[84:87], v[48:51], a[16:19]
    ds_read_b128 v[32:35], v22 offset:0
    ds_read_b128 v[36:39], v22 offset:1024
    ds_read_b64_tr_b16 v[64:65], v26 offset:160
    v_mfma_f32_16x16x32_bf16 a[20:23], v[84:87], v[52:55], a[20:23]
    ds_read_b128 v[40:43], v22 offset:2048
    ds_read_b128 v[44:47], v22 offset:3072
    ds_read_b64_tr_b16 v[66:67], v26 offset:2464
    v_mfma_f32_16x16x32_bf16 a[24:27], v[84:87], v[56:59], a[24:27]
    v_mfma_f32_16x16x32_bf16 a[28:31], v[84:87], v[60:63], a[28:31]
    s_waitcnt lgkmcnt(8)
    v_mfma_f32_16x16x32_bf16 a[32:35], v[88:91], v[48:51], a[32:35]
    ds_read_b64_tr_b16 v[68:69], v26 offset:192
    v_mfma_f32_16x16x32_bf16 a[36:39], v[88:91], v[52:55], a[36:39]
    ds_read_b64_tr_b16 v[70:71], v26 offset:2496
    v_mfma_f32_16x16x32_bf16 a[40:43], v[88:91], v[56:59], a[40:43]
    v_mfma_f32_16x16x32_bf16 a[44:47], v[88:91], v[60:63], a[44:47]
    s_waitcnt lgkmcnt(8)
    v_mfma_f32_16x16x32_bf16 a[48:51], v[92:95], v[48:51], a[48:51]
    ds_read_b64_tr_b16 v[72:73], v26 offset:224
    v_mfma_f32_16x16x32_bf16 a[52:55], v[92:95], v[52:55], a[52:55]
    ds_read_b64_tr_b16 v[74:75], v26 offset:2528
    v_mfma_f32_16x16x32_bf16 a[56:59], v[92:95], v[56:59], a[56:59]
    v_mfma_f32_16x16x32_bf16 a[60:63], v[92:95], v[60:63], a[60:63]
    s_waitcnt lgkmcnt(4)
    v_mfma_f32_16x16x32_bf16 a[0:3], v[64:67], v[32:35], a[0:3]
    ds_read_b64_tr_b16 v[76:77], v26 offset:256
    v_mfma_f32_16x16x32_bf16 a[4:7], v[64:67], v[36:39], a[4:7]
    ds_read_b64_tr_b16 v[78:79], v26 offset:2560
    v_mfma_f32_16x16x32_bf16 a[8:11], v[64:67], v[40:43], a[8:11]
    v_mfma_f32_16x16x32_bf16 a[12:15], v[64:67], v[44:47], a[12:15]
    s_waitcnt vmcnt(0)
    s_barrier
    s_waitcnt lgkmcnt(4)
    v_mfma_f32_16x16x32_bf16 a[16:19], v[68:71], v[32:35], a[16:19]
    ds_read_b128 v[48:51], v23 offset:0
    ds_read_b128 v[52:55], v23 offset:1024
    ds_read_b64_tr_b16 v[80:81], v27 offset:160
    v_mfma_f32_16x16x32_bf16 a[20:23], v[68:71], v[36:39], a[20:23]
    ds_read_b128 v[56:59], v23 offset:2048
    ds_read_b128 v[60:63], v23 offset:3072
    ds_read_b64_tr_b16 v[82:83], v27 offset:2464
    v_mfma_f32_16x16x32_bf16 a[24:27], v[68:71], v[40:43], a[24:27]
    v_mfma_f32_16x16x32_bf16 a[28:31], v[68:71], v[44:47], a[28:31]
    s_waitcnt lgkmcnt(8)
    v_mfma_f32_16x16x32_bf16 a[32:35], v[72:75], v[32:35], a[32:35]
    ds_read_b64_tr_b16 v[84:85], v27 offset:192
    v_mfma_f32_16x16x32_bf16 a[36:39], v[72:75], v[36:39], a[36:39]
    ds_read_b64_tr_b16 v[86:87], v27 offset:2496
    v_mfma_f32_16x16x32_bf16 a[40:43], v[72:75], v[40:43], a[40:43]
    v_mfma_f32_16x16x32_bf16 a[44:47], v[72:75], v[44:47], a[44:47]
    s_waitcnt lgkmcnt(8)
    v_mfma_f32_16x16x32_bf16 a[48:51], v[76:79], v[32:35], a[48:51]
    ds_read_b64_tr_b16 v[88:89], v27 offset:224
    v_mfma_f32_16x16x32_bf16 a[52:55], v[76:79], v[36:39], a[52:55]
    ds_read_b64_tr_b16 v[90:91], v27 offset:2528
    v_mfma_f32_16x16x32_bf16 a[56:59], v[76:79], v[40:43], a[56:59]
    v_mfma_f32_16x16x32_bf16 a[60:63], v[76:79], v[44:47], a[60:63]
    s_waitcnt lgkmcnt(4)
    v_mfma_f32_16x16x32_bf16 a[0:3], v[80:83], v[48:51], a[0:3]
    ds_read_b64_tr_b16 v[92:93], v27 offset:256
    v_mfma_f32_16x16x32_bf16 a[4:7], v[80:83], v[52:55], a[4:7]
    ds_read_b64_tr_b16 v[94:95], v27 offset:2560
    v_mfma_f32_16x16x32_bf16 a[8:11], v[80:83], v[56:59], a[8:11]
    v_mfma_f32_16x16x32_bf16 a[12:15], v[80:83], v[60:63], a[12:15]
    s_waitcnt lgkmcnt(4)
    v_mfma_f32_16x16x32_bf16 a[16:19], v[84:87], v[48:51], a[16:19]
    v_mfma_f32_16x16x32_bf16 a[20:23], v[84:87], v[52:55], a[20:23]
    v_mfma_f32_16x16x32_bf16 a[24:27], v[84:87], v[56:59], a[24:27]
    v_mfma_f32_16x16x32_bf16 a[28:31], v[84:87], v[60:63], a[28:31]
    s_waitcnt lgkmcnt(2)
    v_mfma_f32_16x16x32_bf16 a[32:35], v[88:91], v[48:51], a[32:35]
    v_mfma_f32_16x16x32_bf16 a[36:39], v[88:91], v[52:55], a[36:39]
    v_mfma_f32_16x16x32_bf16 a[40:43], v[88:91], v[56:59], a[40:43]
    v_mfma_f32_16x16x32_bf16 a[44:47], v[88:91], v[60:63], a[44:47]
    s_waitcnt lgkmcnt(0)
    v_mfma_f32_16x16x32_bf16 a[48:51], v[92:95], v[48:51], a[48:51]
    v_mfma_f32_16x16x32_bf16 a[52:55], v[92:95], v[52:55], a[52:55]
    v_mfma_f32_16x16x32_bf16 a[56:59], v[92:95], v[56:59], a[56:59]
    v_mfma_f32_16x16x32_bf16 a[60:63], v[92:95], v[60:63], a[60:63]
    s_nop 15
    s_waitcnt vmcnt(0) lgkmcnt(0)
    s_add_u32 s40, s4, 49152
    s_addc_u32 s41, s5, 0
    s_mov_b32 s42, 16384
    s_mov_b32 s43, 0x00020000
    s_lshr_b32 s32, s25, 7
    s_lshl_b32 s32, s32, 8
    s_barrier
    v_lshlrev_b32 v8, 4, v2
    s_xor_b32 s30, s3, 2
    s_mul_i32 s30, s30, 10240
    s_mul_i32 s31, s3, 10240
    v_add_u32 v7, s30, v8
    v_add_u32 v8, s31, v8
    s_cmp_eq_u32 s22, 0
    s_cbranch_scc1 .down_kernel_end_p1_w0
    ds_write_b128 v7, a[0:3] offset:0
    ds_write_b128 v7, a[16:19] offset:1024
    ds_write_b128 v7, a[32:35] offset:2048
    ds_write_b128 v7, a[48:51] offset:3072
    ds_write_b128 v7, a[4:7] offset:4096
    ds_write_b128 v7, a[20:23] offset:5120
    ds_write_b128 v7, a[36:39] offset:6144
    ds_write_b128 v7, a[52:55] offset:7168
    s_branch .down_kernel_end_p1_w1
.down_kernel_end_p1_w0:
    ds_write_b128 v7, a[8:11] offset:0
    ds_write_b128 v7, a[24:27] offset:1024
    ds_write_b128 v7, a[40:43] offset:2048
    ds_write_b128 v7, a[56:59] offset:3072
    ds_write_b128 v7, a[12:15] offset:4096
    ds_write_b128 v7, a[28:31] offset:5120
    ds_write_b128 v7, a[44:47] offset:6144
    ds_write_b128 v7, a[60:63] offset:7168
.down_kernel_end_p1_w1:
    s_add_u32 s12, s4, 62914560
    s_addc_u32 s13, s5, 0
    s_mov_b32 s14, 9437184
    s_mov_b32 s15, 0x00020000
    s_lshl_b32 s30, s21, 6
    s_add_u32 s30, s30, s25
    s_lshl_b32 s31, s22, 5
    s_add_u32 s30, s30, s31
    s_lshl_b32 s31, s23, 11
    s_add_u32 s30, s30, s31
    v_add_u32 v12, s30, v3
    s_movk_i32 s31, 1152
    v_mul_lo_u32 v12, v12, s31
    s_mul_i32 s29, s24, 288
    v_add_u32 v12, s29, v12
    v_and_b32 v9, 1, v4
    v_lshrrev_b32 v10, 1, v4
    v_lshlrev_b32 v9, 5, v9
    v_lshl_add_u32 v9, v10, 4, v9
    v_add_u32 v9, v12, v9
    v_lshl_add_u32 v10, v4, 3, v12
    s_waitcnt lgkmcnt(0)
    s_barrier
    ds_read_b128 v[32:35], v8 offset:0
    ds_read_b128 v[36:39], v8 offset:1024
    ds_read_b128 v[40:43], v8 offset:2048
    ds_read_b128 v[44:47], v8 offset:3072
    ds_read_b128 v[48:51], v8 offset:4096
    ds_read_b128 v[52:55], v8 offset:5120
    ds_read_b128 v[56:59], v8 offset:6144
    ds_read_b128 v[60:63], v8 offset:7168
    s_cmp_eq_u32 s22, 0
    s_cbranch_scc1 .down_kernel_end_p1_a0
    v_accvgpr_read_b32 v80, a8
    v_accvgpr_read_b32 v81, a9
    v_accvgpr_read_b32 v82, a10
    v_accvgpr_read_b32 v83, a11
    v_accvgpr_read_b32 v84, a24
    v_accvgpr_read_b32 v85, a25
    v_accvgpr_read_b32 v86, a26
    v_accvgpr_read_b32 v87, a27
    v_accvgpr_read_b32 v88, a40
    v_accvgpr_read_b32 v89, a41
    v_accvgpr_read_b32 v90, a42
    v_accvgpr_read_b32 v91, a43
    v_accvgpr_read_b32 v92, a56
    v_accvgpr_read_b32 v93, a57
    v_accvgpr_read_b32 v94, a58
    v_accvgpr_read_b32 v95, a59
    v_accvgpr_read_b32 v96, a12
    v_accvgpr_read_b32 v97, a13
    v_accvgpr_read_b32 v98, a14
    v_accvgpr_read_b32 v99, a15
    v_accvgpr_read_b32 v100, a28
    v_accvgpr_read_b32 v101, a29
    v_accvgpr_read_b32 v102, a30
    v_accvgpr_read_b32 v103, a31
    v_accvgpr_read_b32 v104, a44
    v_accvgpr_read_b32 v105, a45
    v_accvgpr_read_b32 v106, a46
    v_accvgpr_read_b32 v107, a47
    v_accvgpr_read_b32 v108, a60
    v_accvgpr_read_b32 v109, a61
    v_accvgpr_read_b32 v110, a62
    v_accvgpr_read_b32 v111, a63
    s_branch .down_kernel_end_p1_a1
.down_kernel_end_p1_a0:
    v_accvgpr_read_b32 v80, a0
    v_accvgpr_read_b32 v81, a1
    v_accvgpr_read_b32 v82, a2
    v_accvgpr_read_b32 v83, a3
    v_accvgpr_read_b32 v84, a16
    v_accvgpr_read_b32 v85, a17
    v_accvgpr_read_b32 v86, a18
    v_accvgpr_read_b32 v87, a19
    v_accvgpr_read_b32 v88, a32
    v_accvgpr_read_b32 v89, a33
    v_accvgpr_read_b32 v90, a34
    v_accvgpr_read_b32 v91, a35
    v_accvgpr_read_b32 v92, a48
    v_accvgpr_read_b32 v93, a49
    v_accvgpr_read_b32 v94, a50
    v_accvgpr_read_b32 v95, a51
    v_accvgpr_read_b32 v96, a4
    v_accvgpr_read_b32 v97, a5
    v_accvgpr_read_b32 v98, a6
    v_accvgpr_read_b32 v99, a7
    v_accvgpr_read_b32 v100, a20
    v_accvgpr_read_b32 v101, a21
    v_accvgpr_read_b32 v102, a22
    v_accvgpr_read_b32 v103, a23
    v_accvgpr_read_b32 v104, a36
    v_accvgpr_read_b32 v105, a37
    v_accvgpr_read_b32 v106, a38
    v_accvgpr_read_b32 v107, a39
    v_accvgpr_read_b32 v108, a52
    v_accvgpr_read_b32 v109, a53
    v_accvgpr_read_b32 v110, a54
    v_accvgpr_read_b32 v111, a55
.down_kernel_end_p1_a1:
    s_mov_b32 s30, 0
    s_waitcnt lgkmcnt(7)
    v_add_f32 v32, v32, v80
    v_add_f32 v33, v33, v81
    v_add_f32 v34, v34, v82
    v_add_f32 v35, v35, v83
    v_cvt_pk_bf16_f32 v124, v32, v33
    v_cvt_pk_bf16_f32 v125, v34, v35
    s_waitcnt lgkmcnt(6)
    v_add_f32 v36, v36, v84
    v_add_f32 v37, v37, v85
    v_add_f32 v38, v38, v86
    v_add_f32 v39, v39, v87
    v_cvt_pk_bf16_f32 v126, v36, v37
    v_cvt_pk_bf16_f32 v127, v38, v39
    s_nop 1
    v_permlane16_swap_b32 v124, v126
    v_permlane16_swap_b32 v125, v127
    buffer_store_dwordx4 v[124:127], v9, s[12:15], s30 offen offset:160 sc1
    s_waitcnt lgkmcnt(5)
    v_add_f32 v40, v40, v88
    v_add_f32 v41, v41, v89
    v_add_f32 v42, v42, v90
    v_add_f32 v43, v43, v91
    v_cvt_pk_bf16_f32 v128, v40, v41
    v_cvt_pk_bf16_f32 v129, v42, v43
    s_waitcnt lgkmcnt(4)
    v_add_f32 v44, v44, v92
    v_add_f32 v45, v45, v93
    v_add_f32 v46, v46, v94
    v_add_f32 v47, v47, v95
    v_cvt_pk_bf16_f32 v130, v44, v45
    v_cvt_pk_bf16_f32 v131, v46, v47
    s_nop 1
    v_permlane16_swap_b32 v128, v130
    v_permlane16_swap_b32 v129, v131
    buffer_store_dwordx4 v[128:131], v9, s[12:15], s30 offen offset:224 sc1
    s_mov_b32 s30, 18432
    s_waitcnt lgkmcnt(3)
    v_add_f32 v48, v48, v96
    v_add_f32 v49, v49, v97
    v_add_f32 v50, v50, v98
    v_add_f32 v51, v51, v99
    v_cvt_pk_bf16_f32 v136, v48, v49
    v_cvt_pk_bf16_f32 v137, v50, v51
    s_waitcnt lgkmcnt(2)
    v_add_f32 v52, v52, v100
    v_add_f32 v53, v53, v101
    v_add_f32 v54, v54, v102
    v_add_f32 v55, v55, v103
    v_cvt_pk_bf16_f32 v138, v52, v53
    v_cvt_pk_bf16_f32 v139, v54, v55
    s_nop 1
    v_permlane16_swap_b32 v136, v138
    v_permlane16_swap_b32 v137, v139
    buffer_store_dwordx4 v[136:139], v9, s[12:15], s30 offen offset:160 sc1
    s_waitcnt lgkmcnt(1)
    v_add_f32 v56, v56, v104
    v_add_f32 v57, v57, v105
    v_add_f32 v58, v58, v106
    v_add_f32 v59, v59, v107
    v_cvt_pk_bf16_f32 v140, v56, v57
    v_cvt_pk_bf16_f32 v141, v58, v59
    s_waitcnt lgkmcnt(0)
    v_add_f32 v60, v60, v108
    v_add_f32 v61, v61, v109
    v_add_f32 v62, v62, v110
    v_add_f32 v63, v63, v111
    v_cvt_pk_bf16_f32 v142, v60, v61
    v_cvt_pk_bf16_f32 v143, v62, v63
    s_nop 1
    v_permlane16_swap_b32 v140, v142
    v_permlane16_swap_b32 v141, v143
    buffer_store_dwordx4 v[140:143], v9, s[12:15], s30 offen offset:224 sc1
    v_mov_b32 v1, 1
    v_mov_b32 v2, 0
    s_waitcnt vmcnt(0)
    s_barrier
    s_cmp_lg_u32 s3, 0
    s_cbranch_scc1 .down_kernel_end_p1_x
    s_mov_b64 exec, 1
    buffer_atomic_add v1, v2, s[40:43], s32 offen sc1
.down_kernel_end_p1_x:
    s_endpgm
.down_kernel_end_row:
    s_cmp_ge_u32 s2, 512
    s_cbranch_scc1 .down_kernel_end
    s_sub_u32 s36, s2, 256
    v_lshrrev_b32 v7, 6, v0
    s_nop 0
    v_readfirstlane_b32 s33, v7
    s_nop 3
    s_cmp_ge_u32 s33, 4
    s_cbranch_scc1 .down_kernel_end
    s_load_dwordx2 s[4:5], s[0:1], 0
    s_load_dwordx2 s[6:7], s[0:1], 104
    s_load_dwordx2 s[28:29], s[0:1], 88
    s_load_dwordx2 s[34:35], s[0:1], 96
    v_lshrrev_b32 v1, 5, v0
    s_lshl_b32 s3, s36, 3
    v_add_u32 v1, s3, v1
    v_and_b32 v2, 31, v0
    s_movk_i32 s30, 1152
    v_mul_lo_u32 v3, v1, s30
    v_lshl_add_u32 v3, v2, 2, v3
    v_lshlrev_b32 v4, 3, v2
    s_waitcnt lgkmcnt(0)
    s_add_u32 s12, s6, 0
    s_addc_u32 s13, s7, 0
    s_mov_b32 s14, 13824
    s_mov_b32 s15, 0x00020000
    s_add_u32 s40, s6, 49152
    s_addc_u32 s41, s7, 0
    s_mov_b32 s42, 16384
    s_mov_b32 s43, 0x00020000
    s_add_u32 s8, s6, 2424832
    s_addc_u32 s9, s7, 0
    s_mov_b32 s10, 2359296
    s_mov_b32 s11, 0x00020000
    s_mov_b32 s16, s28
    s_mov_b32 s17, s29
    s_mov_b32 s18, 2359296
    s_mov_b32 s19, 0x00020000
    s_add_u32 s24, s6, 62914560
    s_addc_u32 s25, s7, 0
    s_mov_b32 s26, 9437184
    s_mov_b32 s27, 0x00020000
    buffer_load_dword v8, v3, s[8:11], 0 offen offset:0
    buffer_load_dword v9, v3, s[8:11], 0 offen offset:128
    buffer_load_dword v10, v3, s[8:11], 0 offen offset:256
    buffer_load_dword v11, v3, s[8:11], 0 offen offset:384
    buffer_load_dword v12, v3, s[8:11], 0 offen offset:512
    buffer_load_dword v13, v3, s[8:11], 0 offen offset:640
    buffer_load_dword v14, v3, s[8:11], 0 offen offset:768
    buffer_load_dword v15, v3, s[8:11], 0 offen offset:896
    buffer_load_dword v16, v3, s[8:11], 0 offen offset:1024
    s_movk_i32 s31, 11520
    buffer_load_dwordx2 v[80:81], v4, s[12:15], s31 offen offset:0
    buffer_load_dwordx2 v[82:83], v4, s[12:15], s31 offen offset:256
    buffer_load_dwordx2 v[84:85], v4, s[12:15], s31 offen offset:512
    buffer_load_dwordx2 v[86:87], v4, s[12:15], s31 offen offset:768
    buffer_load_dwordx2 v[88:89], v4, s[12:15], s31 offen offset:1024
    buffer_load_dwordx2 v[90:91], v4, s[12:15], s31 offen offset:1280
    buffer_load_dwordx2 v[92:93], v4, s[12:15], s31 offen offset:1536
    buffer_load_dwordx2 v[94:95], v4, s[12:15], s31 offen offset:1792
    buffer_load_dwordx2 v[96:97], v4, s[12:15], s31 offen offset:2048
    s_lshr_b32 s32, s36, 4
    s_lshl_b32 s32, s32, 8
    v_lshrrev_b32 v7, 6, v0
    s_nop 0
    v_readfirstlane_b32 s33, v7
    s_nop 3
    s_cmp_lg_u32 s33, 0
    s_cbranch_scc1 .poll_fin_done
    v_mov_b32 v7, 0
.poll_fin:
    buffer_load_dword v6, v7, s[40:43], s32 offen sc1
    s_waitcnt vmcnt(0)
    v_readfirstlane_b32 s33, v6
    s_nop 3
    s_cmp_ge_u32 s33, 16
    s_cbranch_scc1 .poll_fin_done
    s_sleep 2
    s_branch .poll_fin
.poll_fin_done:
    s_barrier
    s_mov_b32 s31, 0
    buffer_load_dword v136, v3, s[24:27], s31 offen offset:0 sc1
    buffer_load_dword v137, v3, s[24:27], s31 offen offset:128 sc1
    buffer_load_dword v138, v3, s[24:27], s31 offen offset:256 sc1
    buffer_load_dword v139, v3, s[24:27], s31 offen offset:384 sc1
    buffer_load_dword v140, v3, s[24:27], s31 offen offset:512 sc1
    buffer_load_dword v141, v3, s[24:27], s31 offen offset:640 sc1
    buffer_load_dword v142, v3, s[24:27], s31 offen offset:768 sc1
    buffer_load_dword v143, v3, s[24:27], s31 offen offset:896 sc1
    buffer_load_dword v144, v3, s[24:27], s31 offen offset:1024 sc1
    s_mov_b32 s31, 2359296
    buffer_load_dword v145, v3, s[24:27], s31 offen offset:0 sc1
    buffer_load_dword v146, v3, s[24:27], s31 offen offset:128 sc1
    buffer_load_dword v147, v3, s[24:27], s31 offen offset:256 sc1
    buffer_load_dword v148, v3, s[24:27], s31 offen offset:384 sc1
    buffer_load_dword v149, v3, s[24:27], s31 offen offset:512 sc1
    buffer_load_dword v150, v3, s[24:27], s31 offen offset:640 sc1
    buffer_load_dword v151, v3, s[24:27], s31 offen offset:768 sc1
    buffer_load_dword v152, v3, s[24:27], s31 offen offset:896 sc1
    buffer_load_dword v153, v3, s[24:27], s31 offen offset:1024 sc1
    s_mov_b32 s31, 4718592
    buffer_load_dword v154, v3, s[24:27], s31 offen offset:0 sc1
    buffer_load_dword v155, v3, s[24:27], s31 offen offset:128 sc1
    buffer_load_dword v156, v3, s[24:27], s31 offen offset:256 sc1
    buffer_load_dword v157, v3, s[24:27], s31 offen offset:384 sc1
    buffer_load_dword v158, v3, s[24:27], s31 offen offset:512 sc1
    buffer_load_dword v159, v3, s[24:27], s31 offen offset:640 sc1
    buffer_load_dword v160, v3, s[24:27], s31 offen offset:768 sc1
    buffer_load_dword v161, v3, s[24:27], s31 offen offset:896 sc1
    buffer_load_dword v162, v3, s[24:27], s31 offen offset:1024 sc1
    s_mov_b32 s31, 7077888
    buffer_load_dword v163, v3, s[24:27], s31 offen offset:0 sc1
    buffer_load_dword v164, v3, s[24:27], s31 offen offset:128 sc1
    buffer_load_dword v165, v3, s[24:27], s31 offen offset:256 sc1
    buffer_load_dword v166, v3, s[24:27], s31 offen offset:384 sc1
    buffer_load_dword v167, v3, s[24:27], s31 offen offset:512 sc1
    buffer_load_dword v168, v3, s[24:27], s31 offen offset:640 sc1
    buffer_load_dword v169, v3, s[24:27], s31 offen offset:768 sc1
    buffer_load_dword v170, v3, s[24:27], s31 offen offset:896 sc1
    buffer_load_dword v171, v3, s[24:27], s31 offen offset:1024 sc1
    s_waitcnt vmcnt(0)
    v_lshlrev_b32 v20, 16, v8
    v_and_b32 v21, 0xffff0000, v8
    v_lshlrev_b32 v22, 16, v9
    v_and_b32 v23, 0xffff0000, v9
    v_lshlrev_b32 v24, 16, v10
    v_and_b32 v25, 0xffff0000, v10
    v_lshlrev_b32 v26, 16, v11
    v_and_b32 v27, 0xffff0000, v11
    v_lshlrev_b32 v28, 16, v12
    v_and_b32 v29, 0xffff0000, v12
    v_lshlrev_b32 v30, 16, v13
    v_and_b32 v31, 0xffff0000, v13
    v_lshlrev_b32 v32, 16, v14
    v_and_b32 v33, 0xffff0000, v14
    v_lshlrev_b32 v34, 16, v15
    v_and_b32 v35, 0xffff0000, v15
    v_lshlrev_b32 v36, 16, v16
    v_and_b32 v37, 0xffff0000, v16
    v_lshlrev_b32 v100, 16, v136
    v_and_b32 v101, 0xffff0000, v136
    v_lshlrev_b32 v6, 16, v145
    v_and_b32 v7, 0xffff0000, v145
    v_add_f32 v100, v100, v6
    v_add_f32 v101, v101, v7
    v_lshlrev_b32 v6, 16, v154
    v_and_b32 v7, 0xffff0000, v154
    v_add_f32 v100, v100, v6
    v_add_f32 v101, v101, v7
    v_lshlrev_b32 v6, 16, v163
    v_and_b32 v7, 0xffff0000, v163
    v_add_f32 v100, v100, v6
    v_add_f32 v101, v101, v7
    v_lshlrev_b32 v102, 16, v137
    v_and_b32 v103, 0xffff0000, v137
    v_lshlrev_b32 v6, 16, v146
    v_and_b32 v7, 0xffff0000, v146
    v_add_f32 v102, v102, v6
    v_add_f32 v103, v103, v7
    v_lshlrev_b32 v6, 16, v155
    v_and_b32 v7, 0xffff0000, v155
    v_add_f32 v102, v102, v6
    v_add_f32 v103, v103, v7
    v_lshlrev_b32 v6, 16, v164
    v_and_b32 v7, 0xffff0000, v164
    v_add_f32 v102, v102, v6
    v_add_f32 v103, v103, v7
    v_lshlrev_b32 v104, 16, v138
    v_and_b32 v105, 0xffff0000, v138
    v_lshlrev_b32 v6, 16, v147
    v_and_b32 v7, 0xffff0000, v147
    v_add_f32 v104, v104, v6
    v_add_f32 v105, v105, v7
    v_lshlrev_b32 v6, 16, v156
    v_and_b32 v7, 0xffff0000, v156
    v_add_f32 v104, v104, v6
    v_add_f32 v105, v105, v7
    v_lshlrev_b32 v6, 16, v165
    v_and_b32 v7, 0xffff0000, v165
    v_add_f32 v104, v104, v6
    v_add_f32 v105, v105, v7
    v_lshlrev_b32 v106, 16, v139
    v_and_b32 v107, 0xffff0000, v139
    v_lshlrev_b32 v6, 16, v148
    v_and_b32 v7, 0xffff0000, v148
    v_add_f32 v106, v106, v6
    v_add_f32 v107, v107, v7
    v_lshlrev_b32 v6, 16, v157
    v_and_b32 v7, 0xffff0000, v157
    v_add_f32 v106, v106, v6
    v_add_f32 v107, v107, v7
    v_lshlrev_b32 v6, 16, v166
    v_and_b32 v7, 0xffff0000, v166
    v_add_f32 v106, v106, v6
    v_add_f32 v107, v107, v7
    v_lshlrev_b32 v108, 16, v140
    v_and_b32 v109, 0xffff0000, v140
    v_lshlrev_b32 v6, 16, v149
    v_and_b32 v7, 0xffff0000, v149
    v_add_f32 v108, v108, v6
    v_add_f32 v109, v109, v7
    v_lshlrev_b32 v6, 16, v158
    v_and_b32 v7, 0xffff0000, v158
    v_add_f32 v108, v108, v6
    v_add_f32 v109, v109, v7
    v_lshlrev_b32 v6, 16, v167
    v_and_b32 v7, 0xffff0000, v167
    v_add_f32 v108, v108, v6
    v_add_f32 v109, v109, v7
    v_lshlrev_b32 v110, 16, v141
    v_and_b32 v111, 0xffff0000, v141
    v_lshlrev_b32 v6, 16, v150
    v_and_b32 v7, 0xffff0000, v150
    v_add_f32 v110, v110, v6
    v_add_f32 v111, v111, v7
    v_lshlrev_b32 v6, 16, v159
    v_and_b32 v7, 0xffff0000, v159
    v_add_f32 v110, v110, v6
    v_add_f32 v111, v111, v7
    v_lshlrev_b32 v6, 16, v168
    v_and_b32 v7, 0xffff0000, v168
    v_add_f32 v110, v110, v6
    v_add_f32 v111, v111, v7
    v_lshlrev_b32 v112, 16, v142
    v_and_b32 v113, 0xffff0000, v142
    v_lshlrev_b32 v6, 16, v151
    v_and_b32 v7, 0xffff0000, v151
    v_add_f32 v112, v112, v6
    v_add_f32 v113, v113, v7
    v_lshlrev_b32 v6, 16, v160
    v_and_b32 v7, 0xffff0000, v160
    v_add_f32 v112, v112, v6
    v_add_f32 v113, v113, v7
    v_lshlrev_b32 v6, 16, v169
    v_and_b32 v7, 0xffff0000, v169
    v_add_f32 v112, v112, v6
    v_add_f32 v113, v113, v7
    v_lshlrev_b32 v114, 16, v143
    v_and_b32 v115, 0xffff0000, v143
    v_lshlrev_b32 v6, 16, v152
    v_and_b32 v7, 0xffff0000, v152
    v_add_f32 v114, v114, v6
    v_add_f32 v115, v115, v7
    v_lshlrev_b32 v6, 16, v161
    v_and_b32 v7, 0xffff0000, v161
    v_add_f32 v114, v114, v6
    v_add_f32 v115, v115, v7
    v_lshlrev_b32 v6, 16, v170
    v_and_b32 v7, 0xffff0000, v170
    v_add_f32 v114, v114, v6
    v_add_f32 v115, v115, v7
    v_lshlrev_b32 v116, 16, v144
    v_and_b32 v117, 0xffff0000, v144
    v_lshlrev_b32 v6, 16, v153
    v_and_b32 v7, 0xffff0000, v153
    v_add_f32 v116, v116, v6
    v_add_f32 v117, v117, v7
    v_lshlrev_b32 v6, 16, v162
    v_and_b32 v7, 0xffff0000, v162
    v_add_f32 v116, v116, v6
    v_add_f32 v117, v117, v7
    v_lshlrev_b32 v6, 16, v171
    v_and_b32 v7, 0xffff0000, v171
    v_add_f32 v116, v116, v6
    v_add_f32 v117, v117, v7
    v_cvt_pk_bf16_f32 v6, v100, v101
    v_lshlrev_b32 v100, 16, v6
    v_and_b32 v101, 0xffff0000, v6
    v_mul_f32 v100, v80, v100
    v_mul_f32 v101, v81, v101
    v_cvt_pk_bf16_f32 v6, v100, v101
    v_lshlrev_b32 v100, 16, v6
    v_and_b32 v101, 0xffff0000, v6
    v_add_f32 v20, v20, v100
    v_add_f32 v21, v21, v101
    v_cvt_pk_bf16_f32 v8, v20, v21
    v_lshlrev_b32 v20, 16, v8
    v_and_b32 v21, 0xffff0000, v8
    v_cvt_pk_bf16_f32 v6, v102, v103
    v_lshlrev_b32 v102, 16, v6
    v_and_b32 v103, 0xffff0000, v6
    v_mul_f32 v102, v82, v102
    v_mul_f32 v103, v83, v103
    v_cvt_pk_bf16_f32 v6, v102, v103
    v_lshlrev_b32 v102, 16, v6
    v_and_b32 v103, 0xffff0000, v6
    v_add_f32 v22, v22, v102
    v_add_f32 v23, v23, v103
    v_cvt_pk_bf16_f32 v9, v22, v23
    v_lshlrev_b32 v22, 16, v9
    v_and_b32 v23, 0xffff0000, v9
    v_cvt_pk_bf16_f32 v6, v104, v105
    v_lshlrev_b32 v104, 16, v6
    v_and_b32 v105, 0xffff0000, v6
    v_mul_f32 v104, v84, v104
    v_mul_f32 v105, v85, v105
    v_cvt_pk_bf16_f32 v6, v104, v105
    v_lshlrev_b32 v104, 16, v6
    v_and_b32 v105, 0xffff0000, v6
    v_add_f32 v24, v24, v104
    v_add_f32 v25, v25, v105
    v_cvt_pk_bf16_f32 v10, v24, v25
    v_lshlrev_b32 v24, 16, v10
    v_and_b32 v25, 0xffff0000, v10
    v_cvt_pk_bf16_f32 v6, v106, v107
    v_lshlrev_b32 v106, 16, v6
    v_and_b32 v107, 0xffff0000, v6
    v_mul_f32 v106, v86, v106
    v_mul_f32 v107, v87, v107
    v_cvt_pk_bf16_f32 v6, v106, v107
    v_lshlrev_b32 v106, 16, v6
    v_and_b32 v107, 0xffff0000, v6
    v_add_f32 v26, v26, v106
    v_add_f32 v27, v27, v107
    v_cvt_pk_bf16_f32 v11, v26, v27
    v_lshlrev_b32 v26, 16, v11
    v_and_b32 v27, 0xffff0000, v11
    v_cvt_pk_bf16_f32 v6, v108, v109
    v_lshlrev_b32 v108, 16, v6
    v_and_b32 v109, 0xffff0000, v6
    v_mul_f32 v108, v88, v108
    v_mul_f32 v109, v89, v109
    v_cvt_pk_bf16_f32 v6, v108, v109
    v_lshlrev_b32 v108, 16, v6
    v_and_b32 v109, 0xffff0000, v6
    v_add_f32 v28, v28, v108
    v_add_f32 v29, v29, v109
    v_cvt_pk_bf16_f32 v12, v28, v29
    v_lshlrev_b32 v28, 16, v12
    v_and_b32 v29, 0xffff0000, v12
    v_cvt_pk_bf16_f32 v6, v110, v111
    v_lshlrev_b32 v110, 16, v6
    v_and_b32 v111, 0xffff0000, v6
    v_mul_f32 v110, v90, v110
    v_mul_f32 v111, v91, v111
    v_cvt_pk_bf16_f32 v6, v110, v111
    v_lshlrev_b32 v110, 16, v6
    v_and_b32 v111, 0xffff0000, v6
    v_add_f32 v30, v30, v110
    v_add_f32 v31, v31, v111
    v_cvt_pk_bf16_f32 v13, v30, v31
    v_lshlrev_b32 v30, 16, v13
    v_and_b32 v31, 0xffff0000, v13
    v_cvt_pk_bf16_f32 v6, v112, v113
    v_lshlrev_b32 v112, 16, v6
    v_and_b32 v113, 0xffff0000, v6
    v_mul_f32 v112, v92, v112
    v_mul_f32 v113, v93, v113
    v_cvt_pk_bf16_f32 v6, v112, v113
    v_lshlrev_b32 v112, 16, v6
    v_and_b32 v113, 0xffff0000, v6
    v_add_f32 v32, v32, v112
    v_add_f32 v33, v33, v113
    v_cvt_pk_bf16_f32 v14, v32, v33
    v_lshlrev_b32 v32, 16, v14
    v_and_b32 v33, 0xffff0000, v14
    v_cvt_pk_bf16_f32 v6, v114, v115
    v_lshlrev_b32 v114, 16, v6
    v_and_b32 v115, 0xffff0000, v6
    v_mul_f32 v114, v94, v114
    v_mul_f32 v115, v95, v115
    v_cvt_pk_bf16_f32 v6, v114, v115
    v_lshlrev_b32 v114, 16, v6
    v_and_b32 v115, 0xffff0000, v6
    v_add_f32 v34, v34, v114
    v_add_f32 v35, v35, v115
    v_cvt_pk_bf16_f32 v15, v34, v35
    v_lshlrev_b32 v34, 16, v15
    v_and_b32 v35, 0xffff0000, v15
    v_cvt_pk_bf16_f32 v6, v116, v117
    v_lshlrev_b32 v116, 16, v6
    v_and_b32 v117, 0xffff0000, v6
    v_mul_f32 v116, v96, v116
    v_mul_f32 v117, v97, v117
    v_cvt_pk_bf16_f32 v6, v116, v117
    v_lshlrev_b32 v116, 16, v6
    v_and_b32 v117, 0xffff0000, v6
    v_add_f32 v36, v36, v116
    v_add_f32 v37, v37, v117
    v_cvt_pk_bf16_f32 v16, v36, v37
    v_lshlrev_b32 v36, 16, v16
    v_and_b32 v37, 0xffff0000, v16
    buffer_store_dword v8, v3, s[16:19], 0 offen offset:0
    buffer_store_dword v9, v3, s[16:19], 0 offen offset:128
    buffer_store_dword v10, v3, s[16:19], 0 offen offset:256
    buffer_store_dword v11, v3, s[16:19], 0 offen offset:384
    buffer_store_dword v12, v3, s[16:19], 0 offen offset:512
    buffer_store_dword v13, v3, s[16:19], 0 offen offset:640
    buffer_store_dword v14, v3, s[16:19], 0 offen offset:768
    buffer_store_dword v15, v3, s[16:19], 0 offen offset:896
    buffer_store_dword v16, v3, s[16:19], 0 offen offset:1024
.down_kernel_end:
    s_endpgm

.section .rodata,"a"
.p2align 6
.amdhsa_kernel down_kernel
  .amdhsa_next_free_vgpr 256
  .amdhsa_next_free_sgpr 102
  .amdhsa_accum_offset 176
  .amdhsa_group_segment_fixed_size 0
  .amdhsa_kernarg_size 112
  .amdhsa_user_sgpr_count 2
  .amdhsa_user_sgpr_kernarg_segment_ptr 1
  .amdhsa_system_sgpr_workgroup_id_x 1
.end_amdhsa_kernel
```
